```python
import torch

def _softmax(x, axis=-1):
    return torch.softmax(x, dim=axis)
def _gelu(x):
    return torch.nn.functional.gelu(x, approximate="tanh")
def _silu(x):
    return torch.nn.functional.silu(x)
def _sigmoid(x):
    return torch.sigmoid(x)
def _layernorm(x, axis=-1, eps=1e-5):
    m = x.mean(dim=axis, keepdim=True)
    v = x.var(dim=axis, keepdim=True, unbiased=False)
    return (x - m) / torch.sqrt(v + eps)
def _scatter_add(tgt, idx, src, axis=0):
    return tgt.clone().index_add_(axis, idx, src)
def _segment_sum(src, seg, n):
    out = torch.zeros((n,) + src.shape[1:], dtype=src.dtype)
    return out.index_add_(0, seg, src)
def _pad(x, pw):
    flat = tuple(v for pair in reversed(pw) for v in pair)
    return torch.nn.functional.pad(x, flat)

kernel_name = 'gated_mix__compressed_kv_cla__mha_block__prompt'

def setup_inputs():

    _w = (lambda a: (lambda t: t.to(torch.bfloat16) if t.is_floating_point() else t)(torch.as_tensor(a)))
    def _A_setup():
        B, H, Sq, Sk, D, M = 1, 32, 2048, 2048, 128, 512
        Dc = 4 * D
        return {
            "x": _w((lambda *s: torch.randn(*s, dtype=torch.bfloat16) * 0.05)(B, Sq, M)),
            "c_kv": _w((lambda *s: torch.randn(*s, dtype=torch.bfloat16) * 1.6)(B, Sk, Dc)),
            "w_q": _w((lambda *s: torch.randn(*s, dtype=torch.bfloat16) * 3.2)(M, H, D) * (M ** -0.5)),
            "w_uk": _w((lambda *s: torch.randn(*s, dtype=torch.bfloat16) * 3.2)(Dc, H, D) * (Dc ** -0.5)),
            "w_uv": _w((lambda *s: torch.randn(*s, dtype=torch.bfloat16) * 1.6)(Dc, H, D) * (Dc ** -0.5)),
            "w_o": _w((lambda *s: torch.randn(*s, dtype=torch.bfloat16) * 1.6)(H, D, M) * ((H * D) ** -0.5)),
        }
    _A_in = _A_setup()

    def _B_setup():
        B, S, D, H = 1, 2048, 512, 32
        return {
            "x": _w((lambda *s: torch.randn(*s, dtype=torch.bfloat16) * 0.05)(B, S, D)),
            "wqkv": _w((lambda *s: torch.randn(*s, dtype=torch.bfloat16) * 1.6)(D, 3 * D)),
            "wo": _w((lambda *s: torch.randn(*s, dtype=torch.bfloat16) * 0.05)(D, D)),
        }
    _B_in = _B_setup()

    return {
        "A_x": _A_in["x"],
        "A_c_kv": _A_in["c_kv"],
        "A_w_q": _A_in["w_q"],
        "A_w_uk": _A_in["w_uk"],
        "A_w_uv": _A_in["w_uv"],
        "A_w_o": _A_in["w_o"],
        "B_x": _B_in["x"],
        "B_wqkv": _B_in["wqkv"],
        "B_wo": _B_in["wo"],
        "gate_w": _w((lambda *s: torch.randn(*s, dtype=torch.bfloat16) * 0.05)(512) * 16.0),
    }

def reference(A_x, A_c_kv, A_w_q, A_w_uk, A_w_uv, A_w_o, B_x, B_wqkv, B_wo, gate_w):
    def _A_ref(x, c_kv, w_q, w_uk, w_uv, w_o):
        B, Sq, M = x.shape[0], x.shape[1], x.shape[2]
        Sk = c_kv.shape[1]
        H, D = w_q.shape[1], w_q.shape[2]
        q = torch.einsum("bqm,mhd->bhqd", x, w_q)
        k = torch.einsum("bkc,chd->bhkd", c_kv, w_uk)
        v = torch.einsum("bkc,chd->bhkd", c_kv, w_uv)
        scores = torch.einsum("bhqd,bhkd->bhqk", q, k) * (D ** -0.5)
        off = Sk - Sq
        qi = torch.arange(Sq)[:, None]
        kj = torch.arange(Sk)[None, :]
        cmask = kj <= (qi + off)
        scores = torch.where(cmask[None, None], scores, -1e9)
        p = _softmax(scores, axis=-1)
        ctx = torch.einsum("bhqk,bhkd->bhqd", p, v)
        return torch.einsum("bhqd,hdm->bqm", ctx, w_o)

    def _B_ref(x, wqkv, wo):
        B, S, D = x.shape
        H = 32
        Dh = D // H
        qkv = (lambda x, *d: x.permute(*d))((x @ wqkv).reshape(B, S, 3, H, Dh), 2, 0, 3, 1, 4)
        q, k, v = qkv[0], qkv[1], qkv[2]
        scores = torch.einsum("bhqd,bhkd->bhqk", q, k) * (Dh ** -0.5)
        p = _softmax(scores, axis=-1)
        o = torch.einsum("bhqk,bhkd->bhqd", p, v)
        return (lambda x, *d: x.permute(*d))(o, 0, 2, 1, 3).reshape(B, S, D) @ wo

    x = A_x
    g = _sigmoid((x * gate_w).sum(-1, keepdims=True))
    a = _A_ref(x, A_c_kv, A_w_q, A_w_uk, A_w_uv, A_w_o)
    b = _B_ref(x, B_wqkv, B_wo)
    return g * a + (1 - g) * b
```

```asm
; @launch grid=(256,1,1) block=(512,1,1) lds=163840
.amdgcn_target "amdgcn-amd-amdhsa--gfx950"
.text
.globl gated_mix__compressed_kv_cla__mha_block__prompt_kernel
.p2align 8
.type gated_mix__compressed_kv_cla__mha_block__prompt_kernel,@function
gated_mix__compressed_kv_cla__mha_block__prompt_kernel:
    s_cmp_ge_u32 s2, 256
    s_cbranch_scc1 L12_end
    s_getpc_b64 s[100:101]
L12_pc:
    s_load_dwordx16 s[64:79], s[0:1], 0
    s_load_dwordx8 s[80:87], s[0:1], 64
    s_load_dwordx2 s[88:89], s[0:1], 96
    v_lshrrev_b32 v24, 6, v0
    v_and_b32 v1, 63, v0
    v_readfirstlane_b32 s42, v24
    v_lshlrev_b32 v2, 4, v1
    s_and_b32 s40, s2, 7
    s_lshl_b32 s40, s40, 2
    s_lshr_b32 s50, s2, 6
    s_add_u32 s40, s40, s50
    s_lshr_b32 s41, s2, 3
    s_and_b32 s41, s41, 7
    s_sub_u32 s44, 15, s41
    s_and_b32 s43, s42, 3
    v_add_u32 v11, 4096, v2
    s_and_b32 s39, s2, 7
    s_cmp_lt_u32 s42, 4
    s_cbranch_scc1 L12_roleA
    v_lshrrev_b32 v25, 4, v1
    v_and_b32 v26, 15, v1
    v_lshlrev_b32 v4, 2, v25
    v_xor_b32 v4, v4, v26
    v_lshlrev_b32 v4, 4, v4
    v_lshl_add_u32 v4, v25, 13, v4
    v_add_u32 v5, 31744, v4
    v_xor_b32 v6, 32, v4
    v_add_u32 v7, 95232, v6
    v_add_u32 v6, 63488, v6
    s_lshl_b32 s50, s43, 17
    s_lshl_b32 s51, s40, 8
    s_add_u32 s45, s50, s51
    s_lshl_b32 s47, s43, 12
    v_lshrrev_b32 v24, 3, v1
    v_and_b32 v26, 7, v1
    v_xor_b32 v0, v25, v26
    v_lshlrev_b32 v0, 4, v0
    v_lshl_add_u32 v0, v24, 10, v0
    v_xor_b32 v30, 64, v0
    s_cmp_lt_u32 s43, 2
    s_cselect_b32 s50, s44, s41
    s_lshl_b32 s50, s50, 17
    s_and_b32 s51, s43, 1
    s_lshl_b32 s51, s51, 16
    s_add_u32 s36, s50, s51
    s_lshl_b32 s63, s43, 13
    s_setprio 1
    s_waitcnt lgkmcnt(0)
    s_mov_b32 s4, s70
    s_and_b32 s5, s71, 0xffff
    s_mov_b32 s6, 0x400000
    s_mov_b32 s7, 0x20000
    s_mov_b32 s8, s72
    s_and_b32 s9, s73, 0xffff
    s_mov_b32 s10, 0x400000
    s_mov_b32 s11, 0x20000
    s_mov_b32 s28, s66
    s_and_b32 s29, s67, 0xffff
    s_mov_b32 s30, 0x200000
    s_mov_b32 s31, 0x20000
    s_add_u32 m0, s47, 98304
    s_add_u32 s50, s39, 0
    s_and_b32 s50, s50, 7
    s_mul_i32 s50, s50, 524288
    s_add_u32 s50, s50, s45
    buffer_load_dwordx4 v4, s[4:7], s50 offen offset:0 lds
    buffer_load_dwordx4 v5, s[4:7], s50 offen offset:1024 lds
    buffer_load_dwordx4 v6, s[4:7], s50 offen offset:2048 lds
    buffer_load_dwordx4 v7, s[4:7], s50 offen offset:3072 lds
    s_add_u32 m0, s47, 114688
    s_nop 0
    buffer_load_dwordx4 v4, s[8:11], s50 offen offset:0 lds
    buffer_load_dwordx4 v5, s[8:11], s50 offen offset:1024 lds
    buffer_load_dwordx4 v6, s[8:11], s50 offen offset:2048 lds
    buffer_load_dwordx4 v7, s[8:11], s50 offen offset:3072 lds
    s_add_u32 m0, s63, 0
    s_add_u32 s50, s39, 0
    s_and_b32 s50, s50, 7
    s_mul_i32 s50, s50, 128
    s_add_u32 s50, s50, s36
    buffer_load_dwordx4 v0, s[28:31], s50 offen offset:0 lds
    s_add_u32 s50, s50, 0x1c00
    buffer_load_dwordx4 v30, s[28:31], s50 offen offset:1024 lds
    s_add_u32 s50, s50, 0x1c00
    buffer_load_dwordx4 v0, s[28:31], s50 offen offset:2048 lds
    s_add_u32 s50, s50, 0x1c00
    buffer_load_dwordx4 v30, s[28:31], s50 offen offset:3072 lds
    s_add_u32 m0, s63, 4096
    s_add_u32 s50, s50, 0x2c00
    buffer_load_dwordx4 v0, s[28:31], s50 offen offset:0 lds
    s_add_u32 s50, s50, 0x1c00
    buffer_load_dwordx4 v30, s[28:31], s50 offen offset:1024 lds
    s_add_u32 s50, s50, 0x1c00
    buffer_load_dwordx4 v0, s[28:31], s50 offen offset:2048 lds
    s_add_u32 s50, s50, 0x1c00
    buffer_load_dwordx4 v30, s[28:31], s50 offen offset:3072 lds
    s_mov_b32 s12, s68
    s_and_b32 s13, s69, 0xffff
    s_mov_b32 s14, 0x400000
    s_mov_b32 s15, 0x20000
    s_mov_b32 s16, s78
    s_and_b32 s17, s79, 0xffff
    s_mov_b32 s18, 0x180000
    s_mov_b32 s19, 0x20000
    s_mov_b32 s20, s88
    s_and_b32 s21, s89, 0xffff
    s_mov_b32 s22, 0x7000000
    s_mov_b32 s23, 0x20000
    s_mov_b32 s32, s64
    s_and_b32 s33, s65, 0xffff
    s_mov_b32 s34, 0x200000
    s_mov_b32 s35, 0x20000
    v_lshrrev_b32 v24, 3, v1
    v_bfe_u32 v25, v1, 4, 1
    v_lshlrev_b32 v25, 1, v25
    v_and_b32 v26, 7, v1
    v_xor_b32 v25, v25, v26
    v_mul_u32_u24 v24, 3072, v24
    v_and_b32 v26, 1, v25
    v_lshl_add_u32 v24, v26, 4, v24
    v_lshrrev_b32 v26, 1, v25
    v_lshl_add_u32 v8, v26, 10, v24
    v_xor_b32 v26, 2, v26
    v_lshl_add_u32 v9, v26, 10, v24
    v_add_u32 v9, 23552, v9
    s_lshl_b32 s50, s43, 11
    s_add_u32 s50, s50, 114688
    v_add_u32 v23, s50, v2
    s_mul_i32 s46, s43, 49152
    s_lshl_b32 s50, s40, 5
    s_add_u32 s46, s46, s50
    s_add_u32 s51, s41, s39
    s_and_b32 s51, s51, 7
    s_lshl_b32 s50, s51, 19
    s_and_b32 s37, s40, 3
    s_lshl_b32 s37, s37, 2
    s_add_u32 s37, s37, s43
    s_lshl_b32 s37, s37, 15
    s_add_u32 s37, s37, s50
    s_and_b32 s50, s40, 28
    s_lshl_b32 s50, s50, 8
    s_add_u32 s37, s37, s50
    s_sub_u32 s50, s41, s51
    s_mul_i32 s50, s50, 0
    s_add_u32 s3, s37, s50
    s_xor_b32 s50, s36, 0x18000
    s_cmp_lt_u32 s43, 2
    s_cselect_b32 s38, s36, s50
    s_mov_b32 s50, 11264
    s_cselect_b32 s90, s50, 0xffff2c00
    s_mov_b32 s52, 0
    v_and_b32 v24, 15, v1
    v_lshrrev_b32 v25, 4, v1
    v_lshrrev_b32 v26, 1, v24
    v_xor_b32 v25, v25, v26
    v_lshlrev_b32 v24, 7, v24
    v_add_u32 v24, s52, v24
    v_lshl_add_u32 v12, v25, 4, v24
    v_xor_b32 v13, 64, v12
    v_add_u32 v14, 0x10000, v12
    v_add_u32 v15, 0x10000, v13
    v_bfe_u32 v24, v1, 2, 2
    v_lshrrev_b32 v25, 4, v1
    v_lshl_add_u32 v26, v25, 3, v24
    v_lshlrev_b32 v26, 7, v26
    v_and_b32 v25, 1, v25
    v_lshrrev_b32 v24, 1, v24
    v_lshlrev_b32 v24, 5, v24
    v_lshl_add_u32 v24, v25, 6, v24
    v_add_u32 v26, v26, v24
    v_and_b32 v24, 3, v1
    v_lshl_add_u32 v26, v24, 3, v26
    v_add_u32 v26, 114688, v26
    v_xor_b32 v16, 0, v26
    v_xor_b32 v17, 32, v26
    v_xor_b32 v18, 64, v26
    s_lshl_b32 s53, s43, 6
    v_bfe_u32 v24, v1, 2, 2
    v_lshrrev_b32 v25, 4, v1
    v_lshl_add_u32 v26, v25, 3, v24
    v_lshlrev_b32 v26, 8, v26
    v_and_b32 v25, 1, v25
    v_lshlrev_b32 v24, 6, v24
    v_lshl_add_u32 v24, v25, 5, v24
    v_add_u32 v26, v26, v24
    v_and_b32 v24, 3, v1
    v_lshl_add_u32 v26, v24, 3, v26
    v_add_u32 v26, 98304, v26
    v_xor_b32 v26, s53, v26
    v_xor_b32 v20, 0, v26
    v_xor_b32 v21, 32, v26
    s_lshl_b32 s48, s44, 16
    s_mul_i32 s53, s40, 1050880
    s_add_u32 s48, s48, s53
    s_lshl_b32 s53, s43, 10
    s_add_u32 s48, s48, s53
    s_add_u32 s49, s48, 8192
    s_add_u32 s49, s49, s53
    s_add_u32 m0, s63, 32768
    s_add_u32 s50, s39, 1
    s_and_b32 s50, s50, 7
    s_mul_i32 s50, s50, 128
    s_add_u32 s50, s50, s36
    buffer_load_dwordx4 v0, s[28:31], s50 offen offset:0 lds
    s_add_u32 s50, s50, 0x1c00
    buffer_load_dwordx4 v30, s[28:31], s50 offen offset:1024 lds
    s_add_u32 s50, s50, 0x1c00
    buffer_load_dwordx4 v0, s[28:31], s50 offen offset:2048 lds
    s_add_u32 s50, s50, 0x1c00
    buffer_load_dwordx4 v30, s[28:31], s50 offen offset:3072 lds
    s_add_u32 m0, s63, 36864
    s_add_u32 s50, s50, 0x2c00
    buffer_load_dwordx4 v0, s[28:31], s50 offen offset:0 lds
    s_add_u32 s50, s50, 0x1c00
    buffer_load_dwordx4 v30, s[28:31], s50 offen offset:1024 lds
    s_add_u32 s50, s50, 0x1c00
    buffer_load_dwordx4 v0, s[28:31], s50 offen offset:2048 lds
    s_add_u32 s50, s50, 0x1c00
    buffer_load_dwordx4 v30, s[28:31], s50 offen offset:3072 lds
    s_waitcnt vmcnt(8)
    s_barrier
    ds_read_b64_tr_b16 v[32:33], v20 offset:0
    ds_read_b64_tr_b16 v[34:35], v20 offset:1024
    ds_read_b128 v[64:67], v12 offset:0
    ds_read_b64_tr_b16 v[36:37], v20 offset:8192
    ds_read_b64_tr_b16 v[38:39], v20 offset:9216
    ds_read_b128 v[68:71], v13 offset:0
    ds_read_b64_tr_b16 v[40:41], v21 offset:0
    ds_read_b64_tr_b16 v[42:43], v21 offset:1024
    ds_read_b64_tr_b16 v[44:45], v21 offset:8192
    ds_read_b64_tr_b16 v[46:47], v21 offset:9216
    ds_read_b64_tr_b16 v[48:49], v20 offset:16384
    ds_read_b64_tr_b16 v[50:51], v20 offset:17408
    ds_read_b64_tr_b16 v[52:53], v20 offset:24576
    ds_read_b64_tr_b16 v[54:55], v20 offset:25600
    ds_read_b64_tr_b16 v[56:57], v21 offset:16384
    s_waitcnt lgkmcnt(14)
    ds_read_b64_tr_b16 v[58:59], v21 offset:17408
    s_waitcnt lgkmcnt(14)
    ds_read_b64_tr_b16 v[60:61], v21 offset:24576
    s_waitcnt lgkmcnt(14)
    ds_read_b64_tr_b16 v[62:63], v21 offset:25600
    s_mov_b32 s95, 0x3e0293ee
    v_mfma_f32_16x16x32_bf16 v[128:131], v[32:35], v[64:67], 0
    s_waitcnt lgkmcnt(14)
    ds_read_b128 v[72:75], v12 offset:2048
    s_add_u32 m0, s47, 131072
    s_add_u32 s50, s39, 1
    s_and_b32 s50, s50, 7
    s_mul_i32 s50, s50, 524288
    s_add_u32 s50, s50, s45
    buffer_load_dwordx4 v4, s[4:7], s50 offen offset:0 lds
    s_waitcnt lgkmcnt(13)
    v_mfma_f32_16x16x32_bf16 v[128:131], v[36:39], v[68:71], v[128:131]
    ds_read_b128 v[76:79], v13 offset:2048
    s_waitcnt lgkmcnt(12)
    v_mfma_f32_16x16x32_bf16 v[132:135], v[40:43], v[64:67], 0
    buffer_load_dwordx4 v5, s[4:7], s50 offen offset:1024 lds
    s_waitcnt lgkmcnt(10)
    v_mfma_f32_16x16x32_bf16 v[132:135], v[44:47], v[68:71], v[132:135]
    s_waitcnt lgkmcnt(8)
    v_mfma_f32_16x16x32_bf16 v[144:147], v[64:67], v[48:51], 0
    buffer_load_dwordx4 v6, s[4:7], s50 offen offset:2048 lds
    s_waitcnt lgkmcnt(6)
    v_mfma_f32_16x16x32_bf16 v[144:147], v[68:71], v[52:55], v[144:147]
    s_waitcnt lgkmcnt(4)
    v_mfma_f32_16x16x32_bf16 v[152:155], v[64:67], v[56:59], 0
    s_waitcnt lgkmcnt(2)
    v_mfma_f32_16x16x32_bf16 v[152:155], v[68:71], v[60:63], v[152:155]
    buffer_load_dwordx4 v7, s[4:7], s50 offen offset:3072 lds
    s_waitcnt lgkmcnt(1)
    v_mfma_f32_16x16x32_bf16 v[136:139], v[32:35], v[72:75], 0
    ds_read_b128 v[64:67], v12 offset:4096
    s_waitcnt lgkmcnt(1)
    v_mfma_f32_16x16x32_bf16 v[136:139], v[36:39], v[76:79], v[136:139]
    ds_read_b128 v[68:71], v13 offset:4096
    s_add_u32 m0, s47, 147456
    s_nop 0
    buffer_load_dwordx4 v4, s[8:11], s50 offen offset:0 lds
    v_mfma_f32_16x16x32_bf16 v[140:143], v[40:43], v[72:75], 0
    v_mfma_f32_16x16x32_bf16 v[140:143], v[44:47], v[76:79], v[140:143]
    v_mfma_f32_16x16x32_bf16 v[148:151], v[72:75], v[48:51], 0
    buffer_load_dwordx4 v5, s[8:11], s50 offen offset:1024 lds
    v_mfma_f32_16x16x32_bf16 v[148:151], v[76:79], v[52:55], v[148:151]
    v_mfma_f32_16x16x32_bf16 v[156:159], v[72:75], v[56:59], 0
    buffer_load_dwordx4 v6, s[8:11], s50 offen offset:2048 lds
    v_mfma_f32_16x16x32_bf16 v[156:159], v[76:79], v[60:63], v[156:159]
    s_waitcnt lgkmcnt(1)
    v_mfma_f32_16x16x32_bf16 v[160:163], v[32:35], v[64:67], 0
    ds_read_b128 v[72:75], v12 offset:6144
    s_waitcnt lgkmcnt(1)
    v_mfma_f32_16x16x32_bf16 v[160:163], v[36:39], v[68:71], v[160:163]
    ds_read_b128 v[76:79], v13 offset:6144
    buffer_load_dwordx4 v7, s[8:11], s50 offen offset:3072 lds
    v_mfma_f32_16x16x32_bf16 v[164:167], v[40:43], v[64:67], 0
    v_mfma_f32_16x16x32_bf16 v[164:167], v[44:47], v[68:71], v[164:167]
    s_add_u32 m0, s63, 65536
    s_add_u32 s50, s39, 2
    s_and_b32 s50, s50, 7
    s_mul_i32 s50, s50, 128
    s_add_u32 s50, s50, s36
    buffer_load_dwordx4 v0, s[28:31], s50 offen offset:0 lds
    v_mfma_f32_16x16x32_bf16 v[176:179], v[64:67], v[48:51], 0
    v_mfma_f32_16x16x32_bf16 v[176:179], v[68:71], v[52:55], v[176:179]
    v_mfma_f32_16x16x32_bf16 v[184:187], v[64:67], v[56:59], 0
    s_add_u32 s50, s50, 0x1c00
    buffer_load_dwordx4 v30, s[28:31], s50 offen offset:1024 lds
    v_mfma_f32_16x16x32_bf16 v[184:187], v[68:71], v[60:63], v[184:187]
    s_waitcnt lgkmcnt(1)
    v_mfma_f32_16x16x32_bf16 v[168:171], v[32:35], v[72:75], 0
    ds_read_b128 v[64:67], v12 offset:8192
    s_add_u32 s50, s50, 0x1c00
    buffer_load_dwordx4 v0, s[28:31], s50 offen offset:2048 lds
    s_waitcnt lgkmcnt(1)
    v_mfma_f32_16x16x32_bf16 v[168:171], v[36:39], v[76:79], v[168:171]
    ds_read_b128 v[68:71], v13 offset:8192
    v_mfma_f32_16x16x32_bf16 v[172:175], v[40:43], v[72:75], 0
    v_mfma_f32_16x16x32_bf16 v[172:175], v[44:47], v[76:79], v[172:175]
    s_add_u32 s50, s50, 0x1c00
    buffer_load_dwordx4 v30, s[28:31], s50 offen offset:3072 lds
    v_mfma_f32_16x16x32_bf16 v[180:183], v[72:75], v[48:51], 0
    v_mfma_f32_16x16x32_bf16 v[180:183], v[76:79], v[52:55], v[180:183]
    s_add_u32 m0, s63, 69632
    s_add_u32 s50, s50, 0x2c00
    buffer_load_dwordx4 v0, s[28:31], s50 offen offset:0 lds
    v_mfma_f32_16x16x32_bf16 v[188:191], v[72:75], v[56:59], 0
    v_mfma_f32_16x16x32_bf16 v[188:191], v[76:79], v[60:63], v[188:191]
    s_waitcnt lgkmcnt(1)
    v_mfma_f32_16x16x32_bf16 v[192:195], v[32:35], v[64:67], 0
    ds_read_b128 v[72:75], v12 offset:10240
    s_add_u32 s50, s50, 0x1c00
    buffer_load_dwordx4 v30, s[28:31], s50 offen offset:1024 lds
    s_waitcnt lgkmcnt(1)
    v_mfma_f32_16x16x32_bf16 v[192:195], v[36:39], v[68:71], v[192:195]
    ds_read_b128 v[76:79], v13 offset:10240
    v_mfma_f32_16x16x32_bf16 v[196:199], v[40:43], v[64:67], 0
    s_add_u32 s50, s50, 0x1c00
    buffer_load_dwordx4 v0, s[28:31], s50 offen offset:2048 lds
    v_mfma_f32_16x16x32_bf16 v[196:199], v[44:47], v[68:71], v[196:199]
    v_mfma_f32_16x16x32_bf16 v[208:211], v[64:67], v[48:51], 0
    v_mfma_f32_16x16x32_bf16 v[208:211], v[68:71], v[52:55], v[208:211]
    s_add_u32 s50, s50, 0x1c00
    buffer_load_dwordx4 v30, s[28:31], s50 offen offset:3072 lds
    v_mfma_f32_16x16x32_bf16 v[216:219], v[64:67], v[56:59], 0
    v_mfma_f32_16x16x32_bf16 v[216:219], v[68:71], v[60:63], v[216:219]
    s_mov_b32 s52, 8
    s_bitcmp0_b32 s52, s41
    s_cbranch_scc1 LA_t0
    v_bfe_u32 v24, v1, 3, 2
    v_and_b32 v25, 7, v1
    v_lshlrev_b32 v25, 7, v25
    v_lshl_add_u32 v24, v24, 13, v25
    buffer_load_dword v31, v24, s[4:7], s3 offen
    buffer_load_dword v31, v24, s[8:11], s3 offen
LA_t0:
    s_waitcnt lgkmcnt(1)
    v_mfma_f32_16x16x32_bf16 v[200:203], v[32:35], v[72:75], 0
    ds_read_b128 v[64:67], v12 offset:12288
    s_waitcnt lgkmcnt(1)
    v_mfma_f32_16x16x32_bf16 v[200:203], v[36:39], v[76:79], v[200:203]
    ds_read_b128 v[68:71], v13 offset:12288
    v_mfma_f32_16x16x32_bf16 v[204:207], v[40:43], v[72:75], 0
    v_mfma_f32_16x16x32_bf16 v[204:207], v[44:47], v[76:79], v[204:207]
    v_mfma_f32_16x16x32_bf16 v[212:215], v[72:75], v[48:51], 0
    v_mfma_f32_16x16x32_bf16 v[212:215], v[76:79], v[52:55], v[212:215]
    v_mfma_f32_16x16x32_bf16 v[220:223], v[72:75], v[56:59], 0
    v_mfma_f32_16x16x32_bf16 v[220:223], v[76:79], v[60:63], v[220:223]
    s_waitcnt lgkmcnt(1)
    v_mfma_f32_16x16x32_bf16 v[224:227], v[32:35], v[64:67], 0
    ds_read_b128 v[72:75], v12 offset:14336
    s_waitcnt lgkmcnt(1)
    v_mfma_f32_16x16x32_bf16 v[224:227], v[36:39], v[68:71], v[224:227]
    ds_read_b128 v[76:79], v13 offset:14336
    v_mfma_f32_16x16x32_bf16 v[228:231], v[40:43], v[64:67], 0
    v_mfma_f32_16x16x32_bf16 v[228:231], v[44:47], v[68:71], v[228:231]
    v_mfma_f32_16x16x32_bf16 v[240:243], v[64:67], v[48:51], 0
    v_mfma_f32_16x16x32_bf16 v[240:243], v[68:71], v[52:55], v[240:243]
    v_mfma_f32_16x16x32_bf16 v[248:251], v[64:67], v[56:59], 0
    v_mfma_f32_16x16x32_bf16 v[248:251], v[68:71], v[60:63], v[248:251]
    s_waitcnt vmcnt(8) lgkmcnt(0)
    s_barrier
    ds_read_b128 v[64:67], v12 offset:32768
    v_mfma_f32_16x16x32_bf16 v[232:235], v[32:35], v[72:75], 0
    ds_read_b128 v[68:71], v13 offset:32768
    s_add_u32 m0, s47, 98304
    s_add_u32 s50, s39, 2
    s_and_b32 s50, s50, 7
    s_mul_i32 s50, s50, 524288
    s_add_u32 s50, s50, s45
    buffer_load_dwordx4 v4, s[4:7], s50 offen offset:0 lds
    v_mfma_f32_16x16x32_bf16 v[232:235], v[36:39], v[76:79], v[232:235]
    ds_read_b64_tr_b16 v[32:33], v20 offset:32768
    ds_read_b64_tr_b16 v[34:35], v20 offset:33792
    v_mfma_f32_16x16x32_bf16 v[236:239], v[40:43], v[72:75], 0
    ds_read_b64_tr_b16 v[36:37], v20 offset:40960
    ds_read_b64_tr_b16 v[38:39], v20 offset:41984
    buffer_load_dwordx4 v5, s[4:7], s50 offen offset:1024 lds
    v_mfma_f32_16x16x32_bf16 v[236:239], v[44:47], v[76:79], v[236:239]
    ds_read_b64_tr_b16 v[40:41], v21 offset:32768
    ds_read_b64_tr_b16 v[42:43], v21 offset:33792
    v_mfma_f32_16x16x32_bf16 v[244:247], v[72:75], v[48:51], 0
    ds_read_b64_tr_b16 v[44:45], v21 offset:40960
    ds_read_b64_tr_b16 v[46:47], v21 offset:41984
    buffer_load_dwordx4 v6, s[4:7], s50 offen offset:2048 lds
    v_mfma_f32_16x16x32_bf16 v[244:247], v[76:79], v[52:55], v[244:247]
    ds_read_b64_tr_b16 v[48:49], v20 offset:49152
    ds_read_b64_tr_b16 v[50:51], v20 offset:50176
    v_mfma_f32_16x16x32_bf16 v[252:255], v[72:75], v[56:59], 0
    ds_read_b64_tr_b16 v[52:53], v20 offset:57344
    ds_read_b64_tr_b16 v[54:55], v20 offset:58368
    v_mfma_f32_16x16x32_bf16 v[252:255], v[76:79], v[60:63], v[252:255]
    ds_read_b64_tr_b16 v[56:57], v21 offset:49152
    s_waitcnt lgkmcnt(14)
    ds_read_b64_tr_b16 v[58:59], v21 offset:50176
    s_waitcnt lgkmcnt(14)
    ds_read_b64_tr_b16 v[60:61], v21 offset:57344
    s_waitcnt lgkmcnt(14)
    ds_read_b64_tr_b16 v[62:63], v21 offset:58368
    buffer_load_dwordx4 v7, s[4:7], s50 offen offset:3072 lds
    s_waitcnt lgkmcnt(14)
    v_mfma_f32_16x16x32_bf16 v[128:131], v[32:35], v[64:67], v[128:131]
    ds_read_b128 v[72:75], v12 offset:34816
    s_waitcnt lgkmcnt(13)
    v_mfma_f32_16x16x32_bf16 v[128:131], v[36:39], v[68:71], v[128:131]
    ds_read_b128 v[76:79], v13 offset:34816
    s_add_u32 m0, s47, 114688
    s_nop 0
    buffer_load_dwordx4 v4, s[8:11], s50 offen offset:0 lds
    s_waitcnt lgkmcnt(12)
    v_mfma_f32_16x16x32_bf16 v[132:135], v[40:43], v[64:67], v[132:135]
    s_waitcnt lgkmcnt(10)
    v_mfma_f32_16x16x32_bf16 v[132:135], v[44:47], v[68:71], v[132:135]
    s_waitcnt lgkmcnt(8)
    v_mfma_f32_16x16x32_bf16 v[144:147], v[64:67], v[48:51], v[144:147]
    buffer_load_dwordx4 v5, s[8:11], s50 offen offset:1024 lds
    s_waitcnt lgkmcnt(6)
    v_mfma_f32_16x16x32_bf16 v[144:147], v[68:71], v[52:55], v[144:147]
    s_waitcnt lgkmcnt(4)
    v_mfma_f32_16x16x32_bf16 v[152:155], v[64:67], v[56:59], v[152:155]
    buffer_load_dwordx4 v6, s[8:11], s50 offen offset:2048 lds
    s_waitcnt lgkmcnt(2)
    v_mfma_f32_16x16x32_bf16 v[152:155], v[68:71], v[60:63], v[152:155]
    s_waitcnt lgkmcnt(1)
    v_mfma_f32_16x16x32_bf16 v[136:139], v[32:35], v[72:75], v[136:139]
    ds_read_b128 v[64:67], v12 offset:36864
    s_waitcnt lgkmcnt(1)
    v_mfma_f32_16x16x32_bf16 v[136:139], v[36:39], v[76:79], v[136:139]
    ds_read_b128 v[68:71], v13 offset:36864
    buffer_load_dwordx4 v7, s[8:11], s50 offen offset:3072 lds
    v_mfma_f32_16x16x32_bf16 v[140:143], v[40:43], v[72:75], v[140:143]
    v_mfma_f32_16x16x32_bf16 v[140:143], v[44:47], v[76:79], v[140:143]
    s_add_u32 m0, s63, 0
    s_add_u32 s50, s39, 3
    s_and_b32 s50, s50, 7
    s_mul_i32 s50, s50, 128
    s_add_u32 s50, s50, s36
    buffer_load_dwordx4 v0, s[28:31], s50 offen offset:0 lds
    v_mfma_f32_16x16x32_bf16 v[148:151], v[72:75], v[48:51], v[148:151]
    v_mfma_f32_16x16x32_bf16 v[148:151], v[76:79], v[52:55], v[148:151]
    v_mfma_f32_16x16x32_bf16 v[156:159], v[72:75], v[56:59], v[156:159]
    s_add_u32 s50, s50, 0x1c00
    buffer_load_dwordx4 v30, s[28:31], s50 offen offset:1024 lds
    v_mfma_f32_16x16x32_bf16 v[156:159], v[76:79], v[60:63], v[156:159]
    s_waitcnt lgkmcnt(1)
    v_mfma_f32_16x16x32_bf16 v[160:163], v[32:35], v[64:67], v[160:163]
    ds_read_b128 v[72:75], v12 offset:38912
    s_add_u32 s50, s50, 0x1c00
    buffer_load_dwordx4 v0, s[28:31], s50 offen offset:2048 lds
    s_waitcnt lgkmcnt(1)
    v_mfma_f32_16x16x32_bf16 v[160:163], v[36:39], v[68:71], v[160:163]
    ds_read_b128 v[76:79], v13 offset:38912
    v_mfma_f32_16x16x32_bf16 v[164:167], v[40:43], v[64:67], v[164:167]
    v_mfma_f32_16x16x32_bf16 v[164:167], v[44:47], v[68:71], v[164:167]
    s_add_u32 s50, s50, 0x1c00
    buffer_load_dwordx4 v30, s[28:31], s50 offen offset:3072 lds
    v_mfma_f32_16x16x32_bf16 v[176:179], v[64:67], v[48:51], v[176:179]
    v_mfma_f32_16x16x32_bf16 v[176:179], v[68:71], v[52:55], v[176:179]
    s_add_u32 m0, s63, 4096
    s_add_u32 s50, s50, 0x2c00
    buffer_load_dwordx4 v0, s[28:31], s50 offen offset:0 lds
    v_mfma_f32_16x16x32_bf16 v[184:187], v[64:67], v[56:59], v[184:187]
    v_mfma_f32_16x16x32_bf16 v[184:187], v[68:71], v[60:63], v[184:187]
    s_waitcnt lgkmcnt(1)
    v_mfma_f32_16x16x32_bf16 v[168:171], v[32:35], v[72:75], v[168:171]
    ds_read_b128 v[64:67], v12 offset:40960
    s_add_u32 s50, s50, 0x1c00
    buffer_load_dwordx4 v30, s[28:31], s50 offen offset:1024 lds
    s_waitcnt lgkmcnt(1)
    v_mfma_f32_16x16x32_bf16 v[168:171], v[36:39], v[76:79], v[168:171]
    ds_read_b128 v[68:71], v13 offset:40960
    v_mfma_f32_16x16x32_bf16 v[172:175], v[40:43], v[72:75], v[172:175]
    s_add_u32 s50, s50, 0x1c00
    buffer_load_dwordx4 v0, s[28:31], s50 offen offset:2048 lds
    v_mfma_f32_16x16x32_bf16 v[172:175], v[44:47], v[76:79], v[172:175]
    v_mfma_f32_16x16x32_bf16 v[180:183], v[72:75], v[48:51], v[180:183]
    v_mfma_f32_16x16x32_bf16 v[180:183], v[76:79], v[52:55], v[180:183]
    s_add_u32 s50, s50, 0x1c00
    buffer_load_dwordx4 v30, s[28:31], s50 offen offset:3072 lds
    v_mfma_f32_16x16x32_bf16 v[188:191], v[72:75], v[56:59], v[188:191]
    v_mfma_f32_16x16x32_bf16 v[188:191], v[76:79], v[60:63], v[188:191]
    s_add_u32 s50, s39, 1
    s_and_b32 s50, s50, 7
    s_mul_i32 s50, s50, 196608
    s_add_u32 s50, s50, s46
    buffer_load_dwordx4 v[80:83], v8, s[16:19], s50 offen offset:0
    s_waitcnt lgkmcnt(1)
    v_mfma_f32_16x16x32_bf16 v[192:195], v[32:35], v[64:67], v[192:195]
    ds_read_b128 v[72:75], v12 offset:43008
    s_waitcnt lgkmcnt(1)
    v_mfma_f32_16x16x32_bf16 v[192:195], v[36:39], v[68:71], v[192:195]
    ds_read_b128 v[76:79], v13 offset:43008
    v_mfma_f32_16x16x32_bf16 v[196:199], v[40:43], v[64:67], v[196:199]
    buffer_load_dwordx4 v[84:87], v9, s[16:19], s50 offen offset:1024
    v_mfma_f32_16x16x32_bf16 v[196:199], v[44:47], v[68:71], v[196:199]
    v_mfma_f32_16x16x32_bf16 v[208:211], v[64:67], v[48:51], v[208:211]
    s_mov_b32 s52, 16
    s_bitcmp0_b32 s52, s41
    s_cbranch_scc1 LA_t1
    v_bfe_u32 v24, v1, 3, 2
    v_and_b32 v25, 7, v1
    v_lshlrev_b32 v25, 7, v25
    v_lshl_add_u32 v24, v24, 13, v25
    buffer_load_dword v31, v24, s[4:7], s3 offen
    buffer_load_dword v31, v24, s[8:11], s3 offen
LA_t1:
    v_mfma_f32_16x16x32_bf16 v[208:211], v[68:71], v[52:55], v[208:211]
    v_mfma_f32_16x16x32_bf16 v[216:219], v[64:67], v[56:59], v[216:219]
    v_mfma_f32_16x16x32_bf16 v[216:219], v[68:71], v[60:63], v[216:219]
    s_waitcnt lgkmcnt(1)
    v_mfma_f32_16x16x32_bf16 v[200:203], v[32:35], v[72:75], v[200:203]
    ds_read_b128 v[64:67], v12 offset:45056
    s_waitcnt lgkmcnt(1)
    v_mfma_f32_16x16x32_bf16 v[200:203], v[36:39], v[76:79], v[200:203]
    ds_read_b128 v[68:71], v13 offset:45056
    v_mfma_f32_16x16x32_bf16 v[204:207], v[40:43], v[72:75], v[204:207]
    v_mfma_f32_16x16x32_bf16 v[204:207], v[44:47], v[76:79], v[204:207]
    v_mfma_f32_16x16x32_bf16 v[212:215], v[72:75], v[48:51], v[212:215]
    v_mfma_f32_16x16x32_bf16 v[212:215], v[76:79], v[52:55], v[212:215]
    v_mfma_f32_16x16x32_bf16 v[220:223], v[72:75], v[56:59], v[220:223]
    v_mfma_f32_16x16x32_bf16 v[220:223], v[76:79], v[60:63], v[220:223]
    s_waitcnt lgkmcnt(1)
    v_mfma_f32_16x16x32_bf16 v[224:227], v[32:35], v[64:67], v[224:227]
    ds_read_b128 v[72:75], v12 offset:47104
    s_waitcnt lgkmcnt(1)
    v_mfma_f32_16x16x32_bf16 v[224:227], v[36:39], v[68:71], v[224:227]
    ds_read_b128 v[76:79], v13 offset:47104
    v_mfma_f32_16x16x32_bf16 v[228:231], v[40:43], v[64:67], v[228:231]
    v_mfma_f32_16x16x32_bf16 v[228:231], v[44:47], v[68:71], v[228:231]
    v_mfma_f32_16x16x32_bf16 v[240:243], v[64:67], v[48:51], v[240:243]
    v_mfma_f32_16x16x32_bf16 v[240:243], v[68:71], v[52:55], v[240:243]
    v_mfma_f32_16x16x32_bf16 v[248:251], v[64:67], v[56:59], v[248:251]
    v_mfma_f32_16x16x32_bf16 v[248:251], v[68:71], v[60:63], v[248:251]
    s_waitcnt vmcnt(10) lgkmcnt(0)
    s_barrier
    ds_read_b128 v[64:67], v14 offset:0
    v_mfma_f32_16x16x32_bf16 v[232:235], v[32:35], v[72:75], v[232:235]
    ds_read_b128 v[68:71], v15 offset:0
    s_add_u32 m0, s47, 131072
    s_add_u32 s50, s39, 3
    s_and_b32 s50, s50, 7
    s_mul_i32 s50, s50, 524288
    s_add_u32 s50, s50, s45
    buffer_load_dwordx4 v4, s[4:7], s50 offen offset:0 lds
    v_mfma_f32_16x16x32_bf16 v[232:235], v[36:39], v[76:79], v[232:235]
    ds_read_b64_tr_b16 v[32:33], v20 offset:0
    ds_read_b64_tr_b16 v[34:35], v20 offset:1024
    v_mfma_f32_16x16x32_bf16 v[236:239], v[40:43], v[72:75], v[236:239]
    ds_read_b64_tr_b16 v[36:37], v20 offset:8192
    ds_read_b64_tr_b16 v[38:39], v20 offset:9216
    buffer_load_dwordx4 v5, s[4:7], s50 offen offset:1024 lds
    v_mfma_f32_16x16x32_bf16 v[236:239], v[44:47], v[76:79], v[236:239]
    ds_read_b64_tr_b16 v[40:41], v21 offset:0
    ds_read_b64_tr_b16 v[42:43], v21 offset:1024
    v_mfma_f32_16x16x32_bf16 v[244:247], v[72:75], v[48:51], v[244:247]
    ds_read_b64_tr_b16 v[44:45], v21 offset:8192
    ds_read_b64_tr_b16 v[46:47], v21 offset:9216
    buffer_load_dwordx4 v6, s[4:7], s50 offen offset:2048 lds
    v_mfma_f32_16x16x32_bf16 v[244:247], v[76:79], v[52:55], v[244:247]
    ds_read_b64_tr_b16 v[48:49], v20 offset:16384
    ds_read_b64_tr_b16 v[50:51], v20 offset:17408
    v_mfma_f32_16x16x32_bf16 v[252:255], v[72:75], v[56:59], v[252:255]
    ds_read_b64_tr_b16 v[52:53], v20 offset:24576
    ds_read_b64_tr_b16 v[54:55], v20 offset:25600
    v_mfma_f32_16x16x32_bf16 v[252:255], v[76:79], v[60:63], v[252:255]
    ds_read_b64_tr_b16 v[56:57], v21 offset:16384
    s_waitcnt lgkmcnt(14)
    ds_read_b64_tr_b16 v[58:59], v21 offset:17408
    s_waitcnt lgkmcnt(14)
    ds_read_b64_tr_b16 v[60:61], v21 offset:24576
    s_waitcnt lgkmcnt(14)
    ds_read_b64_tr_b16 v[62:63], v21 offset:25600
    buffer_load_dwordx4 v7, s[4:7], s50 offen offset:3072 lds
    s_waitcnt lgkmcnt(14)
    v_mfma_f32_16x16x32_bf16 v[128:131], v[32:35], v[64:67], v[128:131]
    ds_read_b128 v[72:75], v14 offset:2048
    s_waitcnt lgkmcnt(13)
    v_mfma_f32_16x16x32_bf16 v[128:131], v[36:39], v[68:71], v[128:131]
    ds_read_b128 v[76:79], v15 offset:2048
    s_add_u32 m0, s47, 147456
    s_nop 0
    buffer_load_dwordx4 v4, s[8:11], s50 offen offset:0 lds
    s_waitcnt lgkmcnt(12)
    v_mfma_f32_16x16x32_bf16 v[132:135], v[40:43], v[64:67], v[132:135]
    s_waitcnt lgkmcnt(10)
    v_mfma_f32_16x16x32_bf16 v[132:135], v[44:47], v[68:71], v[132:135]
    s_waitcnt lgkmcnt(8)
    v_mfma_f32_16x16x32_bf16 v[144:147], v[64:67], v[48:51], v[144:147]
    buffer_load_dwordx4 v5, s[8:11], s50 offen offset:1024 lds
    s_waitcnt lgkmcnt(6)
    v_mfma_f32_16x16x32_bf16 v[144:147], v[68:71], v[52:55], v[144:147]
    s_waitcnt lgkmcnt(4)
    v_mfma_f32_16x16x32_bf16 v[152:155], v[64:67], v[56:59], v[152:155]
    buffer_load_dwordx4 v6, s[8:11], s50 offen offset:2048 lds
    s_waitcnt lgkmcnt(2)
    v_mfma_f32_16x16x32_bf16 v[152:155], v[68:71], v[60:63], v[152:155]
    s_waitcnt lgkmcnt(1)
    v_mfma_f32_16x16x32_bf16 v[136:139], v[32:35], v[72:75], v[136:139]
    ds_read_b128 v[64:67], v14 offset:4096
    s_waitcnt lgkmcnt(1)
    v_mfma_f32_16x16x32_bf16 v[136:139], v[36:39], v[76:79], v[136:139]
    ds_read_b128 v[68:71], v15 offset:4096
    buffer_load_dwordx4 v7, s[8:11], s50 offen offset:3072 lds
    v_mfma_f32_16x16x32_bf16 v[140:143], v[40:43], v[72:75], v[140:143]
    v_mfma_f32_16x16x32_bf16 v[140:143], v[44:47], v[76:79], v[140:143]
    s_add_u32 m0, s63, 32768
    s_add_u32 s50, s39, 4
    s_and_b32 s50, s50, 7
    s_mul_i32 s50, s50, 128
    s_add_u32 s50, s50, s36
    buffer_load_dwordx4 v0, s[28:31], s50 offen offset:0 lds
    v_mfma_f32_16x16x32_bf16 v[148:151], v[72:75], v[48:51], v[148:151]
    v_mfma_f32_16x16x32_bf16 v[148:151], v[76:79], v[52:55], v[148:151]
    v_mfma_f32_16x16x32_bf16 v[156:159], v[72:75], v[56:59], v[156:159]
    s_add_u32 s50, s50, 0x1c00
    buffer_load_dwordx4 v30, s[28:31], s50 offen offset:1024 lds
    v_mfma_f32_16x16x32_bf16 v[156:159], v[76:79], v[60:63], v[156:159]
    s_waitcnt lgkmcnt(1)
    v_mfma_f32_16x16x32_bf16 v[160:163], v[32:35], v[64:67], v[160:163]
    ds_read_b128 v[72:75], v14 offset:6144
    s_add_u32 s50, s50, 0x1c00
    buffer_load_dwordx4 v0, s[28:31], s50 offen offset:2048 lds
    s_waitcnt lgkmcnt(1)
    v_mfma_f32_16x16x32_bf16 v[160:163], v[36:39], v[68:71], v[160:163]
    ds_read_b128 v[76:79], v15 offset:6144
    v_mfma_f32_16x16x32_bf16 v[164:167], v[40:43], v[64:67], v[164:167]
    v_mfma_f32_16x16x32_bf16 v[164:167], v[44:47], v[68:71], v[164:167]
    s_add_u32 s50, s50, 0x1c00
    buffer_load_dwordx4 v30, s[28:31], s50 offen offset:3072 lds
    v_mfma_f32_16x16x32_bf16 v[176:179], v[64:67], v[48:51], v[176:179]
    v_mfma_f32_16x16x32_bf16 v[176:179], v[68:71], v[52:55], v[176:179]
    s_add_u32 m0, s63, 36864
    s_add_u32 s50, s50, 0x2c00
    buffer_load_dwordx4 v0, s[28:31], s50 offen offset:0 lds
    v_mfma_f32_16x16x32_bf16 v[184:187], v[64:67], v[56:59], v[184:187]
    v_mfma_f32_16x16x32_bf16 v[184:187], v[68:71], v[60:63], v[184:187]
    s_waitcnt lgkmcnt(1)
    v_mfma_f32_16x16x32_bf16 v[168:171], v[32:35], v[72:75], v[168:171]
    ds_read_b128 v[64:67], v14 offset:8192
    s_add_u32 s50, s50, 0x1c00
    buffer_load_dwordx4 v30, s[28:31], s50 offen offset:1024 lds
    s_waitcnt lgkmcnt(1)
    v_mfma_f32_16x16x32_bf16 v[168:171], v[36:39], v[76:79], v[168:171]
    ds_read_b128 v[68:71], v15 offset:8192
    v_mfma_f32_16x16x32_bf16 v[172:175], v[40:43], v[72:75], v[172:175]
    s_add_u32 s50, s50, 0x1c00
    buffer_load_dwordx4 v0, s[28:31], s50 offen offset:2048 lds
    v_mfma_f32_16x16x32_bf16 v[172:175], v[44:47], v[76:79], v[172:175]
    v_mfma_f32_16x16x32_bf16 v[180:183], v[72:75], v[48:51], v[180:183]
    v_mfma_f32_16x16x32_bf16 v[180:183], v[76:79], v[52:55], v[180:183]
    s_add_u32 s50, s50, 0x1c00
    buffer_load_dwordx4 v30, s[28:31], s50 offen offset:3072 lds
    v_mfma_f32_16x16x32_bf16 v[188:191], v[72:75], v[56:59], v[188:191]
    v_mfma_f32_16x16x32_bf16 v[188:191], v[76:79], v[60:63], v[188:191]
    s_add_u32 s50, s39, 2
    s_and_b32 s50, s50, 7
    s_mul_i32 s50, s50, 196608
    s_add_u32 s50, s50, s46
    buffer_load_dwordx4 v[88:91], v8, s[16:19], s50 offen offset:0
    s_waitcnt lgkmcnt(1)
    v_mfma_f32_16x16x32_bf16 v[192:195], v[32:35], v[64:67], v[192:195]
    ds_read_b128 v[72:75], v14 offset:10240
    s_waitcnt lgkmcnt(1)
    v_mfma_f32_16x16x32_bf16 v[192:195], v[36:39], v[68:71], v[192:195]
    ds_read_b128 v[76:79], v15 offset:10240
    v_mfma_f32_16x16x32_bf16 v[196:199], v[40:43], v[64:67], v[196:199]
    buffer_load_dwordx4 v[92:95], v9, s[16:19], s50 offen offset:1024
    v_mfma_f32_16x16x32_bf16 v[196:199], v[44:47], v[68:71], v[196:199]
    v_mfma_f32_16x16x32_bf16 v[208:211], v[64:67], v[48:51], v[208:211]
    s_mov_b32 s52, 32
    s_bitcmp0_b32 s52, s41
    s_cbranch_scc1 LA_t2
    v_bfe_u32 v24, v1, 3, 2
    v_and_b32 v25, 7, v1
    v_lshlrev_b32 v25, 7, v25
    v_lshl_add_u32 v24, v24, 13, v25
    buffer_load_dword v31, v24, s[4:7], s3 offen
    buffer_load_dword v31, v24, s[8:11], s3 offen
LA_t2:
    v_mfma_f32_16x16x32_bf16 v[208:211], v[68:71], v[52:55], v[208:211]
    v_mfma_f32_16x16x32_bf16 v[216:219], v[64:67], v[56:59], v[216:219]
    v_mfma_f32_16x16x32_bf16 v[216:219], v[68:71], v[60:63], v[216:219]
    s_waitcnt lgkmcnt(1)
    v_mfma_f32_16x16x32_bf16 v[200:203], v[32:35], v[72:75], v[200:203]
    ds_read_b128 v[64:67], v14 offset:12288
    s_waitcnt lgkmcnt(1)
    v_mfma_f32_16x16x32_bf16 v[200:203], v[36:39], v[76:79], v[200:203]
    ds_read_b128 v[68:71], v15 offset:12288
    v_mfma_f32_16x16x32_bf16 v[204:207], v[40:43], v[72:75], v[204:207]
    v_mfma_f32_16x16x32_bf16 v[204:207], v[44:47], v[76:79], v[204:207]
    v_mfma_f32_16x16x32_bf16 v[212:215], v[72:75], v[48:51], v[212:215]
    v_mfma_f32_16x16x32_bf16 v[212:215], v[76:79], v[52:55], v[212:215]
    v_mfma_f32_16x16x32_bf16 v[220:223], v[72:75], v[56:59], v[220:223]
    v_mfma_f32_16x16x32_bf16 v[220:223], v[76:79], v[60:63], v[220:223]
    s_waitcnt lgkmcnt(1)
    v_mfma_f32_16x16x32_bf16 v[224:227], v[32:35], v[64:67], v[224:227]
    ds_read_b128 v[72:75], v14 offset:14336
    s_waitcnt lgkmcnt(1)
    v_mfma_f32_16x16x32_bf16 v[224:227], v[36:39], v[68:71], v[224:227]
    ds_read_b128 v[76:79], v15 offset:14336
    v_mfma_f32_16x16x32_bf16 v[228:231], v[40:43], v[64:67], v[228:231]
    v_mfma_f32_16x16x32_bf16 v[228:231], v[44:47], v[68:71], v[228:231]
    v_mfma_f32_16x16x32_bf16 v[240:243], v[64:67], v[48:51], v[240:243]
    v_mfma_f32_16x16x32_bf16 v[240:243], v[68:71], v[52:55], v[240:243]
    v_mfma_f32_16x16x32_bf16 v[248:251], v[64:67], v[56:59], v[248:251]
    v_mfma_f32_16x16x32_bf16 v[248:251], v[68:71], v[60:63], v[248:251]
    s_waitcnt vmcnt(10) lgkmcnt(0)
    s_barrier
    ds_read_b128 v[64:67], v12 offset:0
    v_mfma_f32_16x16x32_bf16 v[232:235], v[32:35], v[72:75], v[232:235]
    ds_read_b128 v[68:71], v13 offset:0
    s_add_u32 m0, s47, 98304
    s_add_u32 s50, s39, 4
    s_and_b32 s50, s50, 7
    s_mul_i32 s50, s50, 524288
    s_add_u32 s50, s50, s45
    buffer_load_dwordx4 v4, s[4:7], s50 offen offset:0 lds
    v_mfma_f32_16x16x32_bf16 v[232:235], v[36:39], v[76:79], v[232:235]
    ds_read_b64_tr_b16 v[32:33], v20 offset:32768
    ds_read_b64_tr_b16 v[34:35], v20 offset:33792
    v_mfma_f32_16x16x32_bf16 v[236:239], v[40:43], v[72:75], v[236:239]
    ds_read_b64_tr_b16 v[36:37], v20 offset:40960
    ds_read_b64_tr_b16 v[38:39], v20 offset:41984
    buffer_load_dwordx4 v5, s[4:7], s50 offen offset:1024 lds
    v_mfma_f32_16x16x32_bf16 v[236:239], v[44:47], v[76:79], v[236:239]
    ds_read_b64_tr_b16 v[40:41], v21 offset:32768
    ds_read_b64_tr_b16 v[42:43], v21 offset:33792
    v_mfma_f32_16x16x32_bf16 v[244:247], v[72:75], v[48:51], v[244:247]
    ds_read_b64_tr_b16 v[44:45], v21 offset:40960
    ds_read_b64_tr_b16 v[46:47], v21 offset:41984
    v_mfma_f32_16x16x32_bf16 v[244:247], v[76:79], v[52:55], v[244:247]
    ds_read_b64_tr_b16 v[48:49], v20 offset:49152
    ds_read_b64_tr_b16 v[50:51], v20 offset:50176
    buffer_load_dwordx4 v6, s[4:7], s50 offen offset:2048 lds
    v_mfma_f32_16x16x32_bf16 v[252:255], v[72:75], v[56:59], v[252:255]
    ds_read_b64_tr_b16 v[52:53], v20 offset:57344
    ds_read_b64_tr_b16 v[54:55], v20 offset:58368
    v_mfma_f32_16x16x32_bf16 v[252:255], v[76:79], v[60:63], v[252:255]
    ds_read_b64_tr_b16 v[56:57], v21 offset:49152
    s_waitcnt lgkmcnt(14)
    ds_read_b64_tr_b16 v[58:59], v21 offset:50176
    s_waitcnt lgkmcnt(14)
    ds_read_b64_tr_b16 v[60:61], v21 offset:57344
    s_waitcnt lgkmcnt(14)
    ds_read_b64_tr_b16 v[62:63], v21 offset:58368
    buffer_load_dwordx4 v7, s[4:7], s50 offen offset:3072 lds
    s_waitcnt lgkmcnt(14)
    v_mfma_f32_16x16x32_bf16 v[128:131], v[32:35], v[64:67], v[128:131]
    ds_read_b128 v[72:75], v12 offset:2048
    s_waitcnt lgkmcnt(13)
    v_mfma_f32_16x16x32_bf16 v[128:131], v[36:39], v[68:71], v[128:131]
    ds_read_b128 v[76:79], v13 offset:2048
    s_waitcnt lgkmcnt(12)
    v_mfma_f32_16x16x32_bf16 v[132:135], v[40:43], v[64:67], v[132:135]
    s_add_u32 m0, s47, 114688
    s_nop 0
    buffer_load_dwordx4 v4, s[8:11], s50 offen offset:0 lds
    s_waitcnt lgkmcnt(10)
    v_mfma_f32_16x16x32_bf16 v[132:135], v[44:47], v[68:71], v[132:135]
    s_waitcnt lgkmcnt(8)
    v_mfma_f32_16x16x32_bf16 v[144:147], v[64:67], v[48:51], v[144:147]
    buffer_load_dwordx4 v5, s[8:11], s50 offen offset:1024 lds
    s_waitcnt lgkmcnt(6)
    v_mfma_f32_16x16x32_bf16 v[144:147], v[68:71], v[52:55], v[144:147]
    s_waitcnt lgkmcnt(4)
    v_mfma_f32_16x16x32_bf16 v[152:155], v[64:67], v[56:59], v[152:155]
    s_waitcnt lgkmcnt(2)
    v_mfma_f32_16x16x32_bf16 v[152:155], v[68:71], v[60:63], v[152:155]
    buffer_load_dwordx4 v6, s[8:11], s50 offen offset:2048 lds
    s_waitcnt lgkmcnt(1)
    v_mfma_f32_16x16x32_bf16 v[136:139], v[32:35], v[72:75], v[136:139]
    ds_read_b128 v[64:67], v12 offset:4096
    s_waitcnt lgkmcnt(1)
    v_mfma_f32_16x16x32_bf16 v[136:139], v[36:39], v[76:79], v[136:139]
    ds_read_b128 v[68:71], v13 offset:4096
    buffer_load_dwordx4 v7, s[8:11], s50 offen offset:3072 lds
    v_mfma_f32_16x16x32_bf16 v[140:143], v[40:43], v[72:75], v[140:143]
    v_mfma_f32_16x16x32_bf16 v[140:143], v[44:47], v[76:79], v[140:143]
    v_mfma_f32_16x16x32_bf16 v[148:151], v[72:75], v[48:51], v[148:151]
    s_add_u32 m0, s63, 65536
    s_add_u32 s50, s39, 5
    s_and_b32 s50, s50, 7
    s_mul_i32 s50, s50, 128
    s_add_u32 s50, s50, s36
    buffer_load_dwordx4 v0, s[28:31], s50 offen offset:0 lds
    v_mfma_f32_16x16x32_bf16 v[148:151], v[76:79], v[52:55], v[148:151]
    v_mfma_f32_16x16x32_bf16 v[156:159], v[72:75], v[56:59], v[156:159]
    s_add_u32 s50, s50, 0x1c00
    buffer_load_dwordx4 v30, s[28:31], s50 offen offset:1024 lds
    v_mfma_f32_16x16x32_bf16 v[156:159], v[76:79], v[60:63], v[156:159]
    s_waitcnt lgkmcnt(1)
    v_mfma_f32_16x16x32_bf16 v[160:163], v[32:35], v[64:67], v[160:163]
    ds_read_b128 v[72:75], v12 offset:6144
    s_waitcnt lgkmcnt(1)
    v_mfma_f32_16x16x32_bf16 v[160:163], v[36:39], v[68:71], v[160:163]
    ds_read_b128 v[76:79], v13 offset:6144
    s_add_u32 s50, s50, 0x1c00
    buffer_load_dwordx4 v0, s[28:31], s50 offen offset:2048 lds
    v_mfma_f32_16x16x32_bf16 v[164:167], v[40:43], v[64:67], v[164:167]
    v_mfma_f32_16x16x32_bf16 v[164:167], v[44:47], v[68:71], v[164:167]
    s_add_u32 s50, s50, 0x1c00
    buffer_load_dwordx4 v30, s[28:31], s50 offen offset:3072 lds
    v_mfma_f32_16x16x32_bf16 v[176:179], v[64:67], v[48:51], v[176:179]
    v_mfma_f32_16x16x32_bf16 v[176:179], v[68:71], v[52:55], v[176:179]
    v_mfma_f32_16x16x32_bf16 v[184:187], v[64:67], v[56:59], v[184:187]
    s_add_u32 m0, s63, 69632
    s_add_u32 s50, s50, 0x2c00
    buffer_load_dwordx4 v0, s[28:31], s50 offen offset:0 lds
    v_mfma_f32_16x16x32_bf16 v[184:187], v[68:71], v[60:63], v[184:187]
    s_waitcnt lgkmcnt(1)
    v_mfma_f32_16x16x32_bf16 v[168:171], v[32:35], v[72:75], v[168:171]
    ds_read_b128 v[64:67], v12 offset:8192
    s_add_u32 s50, s50, 0x1c00
    buffer_load_dwordx4 v30, s[28:31], s50 offen offset:1024 lds
    s_waitcnt lgkmcnt(1)
    v_mfma_f32_16x16x32_bf16 v[168:171], v[36:39], v[76:79], v[168:171]
    ds_read_b128 v[68:71], v13 offset:8192
    v_mfma_f32_16x16x32_bf16 v[172:175], v[40:43], v[72:75], v[172:175]
    v_mfma_f32_16x16x32_bf16 v[172:175], v[44:47], v[76:79], v[172:175]
    s_add_u32 s50, s50, 0x1c00
    buffer_load_dwordx4 v0, s[28:31], s50 offen offset:2048 lds
    v_mfma_f32_16x16x32_bf16 v[180:183], v[72:75], v[48:51], v[180:183]
    v_mfma_f32_16x16x32_bf16 v[180:183], v[76:79], v[52:55], v[180:183]
    s_add_u32 s50, s50, 0x1c00
    buffer_load_dwordx4 v30, s[28:31], s50 offen offset:3072 lds
    v_mfma_f32_16x16x32_bf16 v[188:191], v[72:75], v[56:59], v[188:191]
    v_mfma_f32_16x16x32_bf16 v[188:191], v[76:79], v[60:63], v[188:191]
    s_waitcnt lgkmcnt(1)
    v_mfma_f32_16x16x32_bf16 v[192:195], v[32:35], v[64:67], v[192:195]
    ds_read_b128 v[72:75], v12 offset:10240
    s_add_u32 s50, s39, 3
    s_and_b32 s50, s50, 7
    s_mul_i32 s50, s50, 196608
    s_add_u32 s50, s50, s46
    buffer_load_dwordx4 v[96:99], v8, s[16:19], s50 offen offset:0
    s_waitcnt lgkmcnt(1)
    v_mfma_f32_16x16x32_bf16 v[192:195], v[36:39], v[68:71], v[192:195]
    ds_read_b128 v[76:79], v13 offset:10240
    v_mfma_f32_16x16x32_bf16 v[196:199], v[40:43], v[64:67], v[196:199]
    buffer_load_dwordx4 v[100:103], v9, s[16:19], s50 offen offset:1024
    v_mfma_f32_16x16x32_bf16 v[196:199], v[44:47], v[68:71], v[196:199]
    v_mfma_f32_16x16x32_bf16 v[208:211], v[64:67], v[48:51], v[208:211]
    v_mfma_f32_16x16x32_bf16 v[208:211], v[68:71], v[52:55], v[208:211]
    s_mov_b32 s52, 64
    s_bitcmp0_b32 s52, s41
    s_cbranch_scc1 LA_t3
    v_bfe_u32 v24, v1, 3, 2
    v_and_b32 v25, 7, v1
    v_lshlrev_b32 v25, 7, v25
    v_lshl_add_u32 v24, v24, 13, v25
    buffer_load_dword v31, v24, s[4:7], s3 offen
    buffer_load_dword v31, v24, s[8:11], s3 offen
LA_t3:
    v_mfma_f32_16x16x32_bf16 v[216:219], v[64:67], v[56:59], v[216:219]
    v_mfma_f32_16x16x32_bf16 v[216:219], v[68:71], v[60:63], v[216:219]
    s_mov_b32 s52, 3
    s_bitcmp0_b32 s52, s41
    s_cbranch_scc1 LB_tq3
    v_bfe_u32 v24, v1, 3, 2
    v_and_b32 v25, 7, v1
    v_lshlrev_b32 v25, 7, v25
    v_lshl_add_u32 v24, v24, 13, v25
    buffer_load_dword v31, v24, s[12:15], s37 offen
LB_tq3:
    s_waitcnt lgkmcnt(1)
    v_mfma_f32_16x16x32_bf16 v[200:203], v[32:35], v[72:75], v[200:203]
    ds_read_b128 v[64:67], v12 offset:12288
    s_waitcnt lgkmcnt(1)
    v_mfma_f32_16x16x32_bf16 v[200:203], v[36:39], v[76:79], v[200:203]
    ds_read_b128 v[68:71], v13 offset:12288
    v_mfma_f32_16x16x32_bf16 v[204:207], v[40:43], v[72:75], v[204:207]
    v_mfma_f32_16x16x32_bf16 v[204:207], v[44:47], v[76:79], v[204:207]
    v_mfma_f32_16x16x32_bf16 v[212:215], v[72:75], v[48:51], v[212:215]
    v_mfma_f32_16x16x32_bf16 v[212:215], v[76:79], v[52:55], v[212:215]
    v_mfma_f32_16x16x32_bf16 v[220:223], v[72:75], v[56:59], v[220:223]
    v_mfma_f32_16x16x32_bf16 v[220:223], v[76:79], v[60:63], v[220:223]
    s_waitcnt lgkmcnt(1)
    v_mfma_f32_16x16x32_bf16 v[224:227], v[32:35], v[64:67], v[224:227]
    ds_read_b128 v[72:75], v12 offset:14336
    s_waitcnt lgkmcnt(1)
    v_mfma_f32_16x16x32_bf16 v[224:227], v[36:39], v[68:71], v[224:227]
    ds_read_b128 v[76:79], v13 offset:14336
    v_mfma_f32_16x16x32_bf16 v[228:231], v[40:43], v[64:67], v[228:231]
    v_mfma_f32_16x16x32_bf16 v[228:231], v[44:47], v[68:71], v[228:231]
    v_mfma_f32_16x16x32_bf16 v[240:243], v[64:67], v[48:51], v[240:243]
    v_mfma_f32_16x16x32_bf16 v[240:243], v[68:71], v[52:55], v[240:243]
    v_mfma_f32_16x16x32_bf16 v[248:251], v[64:67], v[56:59], v[248:251]
    v_mfma_f32_16x16x32_bf16 v[248:251], v[68:71], v[60:63], v[248:251]
    s_waitcnt vmcnt(10) lgkmcnt(0)
    s_barrier
    ds_read_b128 v[64:67], v12 offset:32768
    v_mfma_f32_16x16x32_bf16 v[232:235], v[32:35], v[72:75], v[232:235]
    ds_read_b128 v[68:71], v13 offset:32768
    s_add_u32 m0, s47, 131072
    s_add_u32 s50, s39, 5
    s_and_b32 s50, s50, 7
    s_mul_i32 s50, s50, 524288
    s_add_u32 s50, s50, s45
    buffer_load_dwordx4 v4, s[4:7], s50 offen offset:0 lds
    v_mfma_f32_16x16x32_bf16 v[232:235], v[36:39], v[76:79], v[232:235]
    ds_read_b64_tr_b16 v[32:33], v20 offset:0
    ds_read_b64_tr_b16 v[34:35], v20 offset:1024
    v_mfma_f32_16x16x32_bf16 v[236:239], v[40:43], v[72:75], v[236:239]
    ds_read_b64_tr_b16 v[36:37], v20 offset:8192
    ds_read_b64_tr_b16 v[38:39], v20 offset:9216
    buffer_load_dwordx4 v5, s[4:7], s50 offen offset:1024 lds
    v_mfma_f32_16x16x32_bf16 v[236:239], v[44:47], v[76:79], v[236:239]
    ds_read_b64_tr_b16 v[40:41], v21 offset:0
    ds_read_b64_tr_b16 v[42:43], v21 offset:1024
    v_mfma_f32_16x16x32_bf16 v[244:247], v[72:75], v[48:51], v[244:247]
    ds_read_b64_tr_b16 v[44:45], v21 offset:8192
    ds_read_b64_tr_b16 v[46:47], v21 offset:9216
    v_mfma_f32_16x16x32_bf16 v[244:247], v[76:79], v[52:55], v[244:247]
    ds_read_b64_tr_b16 v[48:49], v20 offset:16384
    ds_read_b64_tr_b16 v[50:51], v20 offset:17408
    buffer_load_dwordx4 v6, s[4:7], s50 offen offset:2048 lds
    v_mfma_f32_16x16x32_bf16 v[252:255], v[72:75], v[56:59], v[252:255]
    ds_read_b64_tr_b16 v[52:53], v20 offset:24576
    ds_read_b64_tr_b16 v[54:55], v20 offset:25600
    v_mfma_f32_16x16x32_bf16 v[252:255], v[76:79], v[60:63], v[252:255]
    ds_read_b64_tr_b16 v[56:57], v21 offset:16384
    s_waitcnt lgkmcnt(14)
    ds_read_b64_tr_b16 v[58:59], v21 offset:17408
    s_waitcnt lgkmcnt(14)
    ds_read_b64_tr_b16 v[60:61], v21 offset:24576
    s_waitcnt lgkmcnt(14)
    ds_read_b64_tr_b16 v[62:63], v21 offset:25600
    buffer_load_dwordx4 v7, s[4:7], s50 offen offset:3072 lds
    s_waitcnt lgkmcnt(14)
    v_mfma_f32_16x16x32_bf16 v[128:131], v[32:35], v[64:67], v[128:131]
    ds_read_b128 v[72:75], v12 offset:34816
    s_waitcnt lgkmcnt(13)
    v_mfma_f32_16x16x32_bf16 v[128:131], v[36:39], v[68:71], v[128:131]
    ds_read_b128 v[76:79], v13 offset:34816
    s_waitcnt lgkmcnt(12)
    v_mfma_f32_16x16x32_bf16 v[132:135], v[40:43], v[64:67], v[132:135]
    s_add_u32 m0, s47, 147456
    s_nop 0
    buffer_load_dwordx4 v4, s[8:11], s50 offen offset:0 lds
    s_waitcnt lgkmcnt(10)
    v_mfma_f32_16x16x32_bf16 v[132:135], v[44:47], v[68:71], v[132:135]
    s_waitcnt lgkmcnt(8)
    v_mfma_f32_16x16x32_bf16 v[144:147], v[64:67], v[48:51], v[144:147]
    buffer_load_dwordx4 v5, s[8:11], s50 offen offset:1024 lds
    s_waitcnt lgkmcnt(6)
    v_mfma_f32_16x16x32_bf16 v[144:147], v[68:71], v[52:55], v[144:147]
    s_waitcnt lgkmcnt(4)
    v_mfma_f32_16x16x32_bf16 v[152:155], v[64:67], v[56:59], v[152:155]
    s_waitcnt lgkmcnt(2)
    v_mfma_f32_16x16x32_bf16 v[152:155], v[68:71], v[60:63], v[152:155]
    buffer_load_dwordx4 v6, s[8:11], s50 offen offset:2048 lds
    s_waitcnt lgkmcnt(1)
    v_mfma_f32_16x16x32_bf16 v[136:139], v[32:35], v[72:75], v[136:139]
    ds_read_b128 v[64:67], v12 offset:36864
    s_waitcnt lgkmcnt(1)
    v_mfma_f32_16x16x32_bf16 v[136:139], v[36:39], v[76:79], v[136:139]
    ds_read_b128 v[68:71], v13 offset:36864
    buffer_load_dwordx4 v7, s[8:11], s50 offen offset:3072 lds
    v_mfma_f32_16x16x32_bf16 v[140:143], v[40:43], v[72:75], v[140:143]
    v_mfma_f32_16x16x32_bf16 v[140:143], v[44:47], v[76:79], v[140:143]
    v_mfma_f32_16x16x32_bf16 v[148:151], v[72:75], v[48:51], v[148:151]
    s_add_u32 m0, s63, 0
    s_add_u32 s50, s39, 6
    s_and_b32 s50, s50, 7
    s_mul_i32 s50, s50, 128
    s_add_u32 s50, s50, s36
    buffer_load_dwordx4 v0, s[28:31], s50 offen offset:0 lds
    v_mfma_f32_16x16x32_bf16 v[148:151], v[76:79], v[52:55], v[148:151]
    v_mfma_f32_16x16x32_bf16 v[156:159], v[72:75], v[56:59], v[156:159]
    s_add_u32 s50, s50, 0x1c00
    buffer_load_dwordx4 v30, s[28:31], s50 offen offset:1024 lds
    v_mfma_f32_16x16x32_bf16 v[156:159], v[76:79], v[60:63], v[156:159]
    s_waitcnt lgkmcnt(1)
    v_mfma_f32_16x16x32_bf16 v[160:163], v[32:35], v[64:67], v[160:163]
    ds_read_b128 v[72:75], v12 offset:38912
    s_waitcnt lgkmcnt(1)
    v_mfma_f32_16x16x32_bf16 v[160:163], v[36:39], v[68:71], v[160:163]
    ds_read_b128 v[76:79], v13 offset:38912
    s_add_u32 s50, s50, 0x1c00
    buffer_load_dwordx4 v0, s[28:31], s50 offen offset:2048 lds
    v_mfma_f32_16x16x32_bf16 v[164:167], v[40:43], v[64:67], v[164:167]
    v_mfma_f32_16x16x32_bf16 v[164:167], v[44:47], v[68:71], v[164:167]
    s_add_u32 s50, s50, 0x1c00
    buffer_load_dwordx4 v30, s[28:31], s50 offen offset:3072 lds
    v_mfma_f32_16x16x32_bf16 v[176:179], v[64:67], v[48:51], v[176:179]
    v_mfma_f32_16x16x32_bf16 v[176:179], v[68:71], v[52:55], v[176:179]
    v_mfma_f32_16x16x32_bf16 v[184:187], v[64:67], v[56:59], v[184:187]
    s_add_u32 m0, s63, 4096
    s_add_u32 s50, s50, 0x2c00
    buffer_load_dwordx4 v0, s[28:31], s50 offen offset:0 lds
    v_mfma_f32_16x16x32_bf16 v[184:187], v[68:71], v[60:63], v[184:187]
    s_waitcnt lgkmcnt(1)
    v_mfma_f32_16x16x32_bf16 v[168:171], v[32:35], v[72:75], v[168:171]
    ds_read_b128 v[64:67], v12 offset:40960
    s_add_u32 s50, s50, 0x1c00
    buffer_load_dwordx4 v30, s[28:31], s50 offen offset:1024 lds
    s_waitcnt lgkmcnt(1)
    v_mfma_f32_16x16x32_bf16 v[168:171], v[36:39], v[76:79], v[168:171]
    ds_read_b128 v[68:71], v13 offset:40960
    v_mfma_f32_16x16x32_bf16 v[172:175], v[40:43], v[72:75], v[172:175]
    v_mfma_f32_16x16x32_bf16 v[172:175], v[44:47], v[76:79], v[172:175]
    s_add_u32 s50, s50, 0x1c00
    buffer_load_dwordx4 v0, s[28:31], s50 offen offset:2048 lds
    v_mfma_f32_16x16x32_bf16 v[180:183], v[72:75], v[48:51], v[180:183]
    v_mfma_f32_16x16x32_bf16 v[180:183], v[76:79], v[52:55], v[180:183]
    s_add_u32 s50, s50, 0x1c00
    buffer_load_dwordx4 v30, s[28:31], s50 offen offset:3072 lds
    v_mfma_f32_16x16x32_bf16 v[188:191], v[72:75], v[56:59], v[188:191]
    v_mfma_f32_16x16x32_bf16 v[188:191], v[76:79], v[60:63], v[188:191]
    s_waitcnt lgkmcnt(1)
    v_mfma_f32_16x16x32_bf16 v[192:195], v[32:35], v[64:67], v[192:195]
    ds_read_b128 v[72:75], v12 offset:43008
    s_add_u32 s50, s39, 4
    s_and_b32 s50, s50, 7
    s_mul_i32 s50, s50, 196608
    s_add_u32 s50, s50, s46
    buffer_load_dwordx4 v[104:107], v8, s[16:19], s50 offen offset:0
    s_waitcnt lgkmcnt(1)
    v_mfma_f32_16x16x32_bf16 v[192:195], v[36:39], v[68:71], v[192:195]
    ds_read_b128 v[76:79], v13 offset:43008
    v_mfma_f32_16x16x32_bf16 v[196:199], v[40:43], v[64:67], v[196:199]
    buffer_load_dwordx4 v[108:111], v9, s[16:19], s50 offen offset:1024
    v_mfma_f32_16x16x32_bf16 v[196:199], v[44:47], v[68:71], v[196:199]
    v_mfma_f32_16x16x32_bf16 v[208:211], v[64:67], v[48:51], v[208:211]
    v_mfma_f32_16x16x32_bf16 v[208:211], v[68:71], v[52:55], v[208:211]
    s_mov_b32 s52, 128
    s_bitcmp0_b32 s52, s41
    s_cbranch_scc1 LA_t4
    v_bfe_u32 v24, v1, 3, 2
    v_and_b32 v25, 7, v1
    v_lshlrev_b32 v25, 7, v25
    v_lshl_add_u32 v24, v24, 13, v25
    buffer_load_dword v31, v24, s[4:7], s3 offen
    buffer_load_dword v31, v24, s[8:11], s3 offen
LA_t4:
    v_mfma_f32_16x16x32_bf16 v[216:219], v[64:67], v[56:59], v[216:219]
    v_mfma_f32_16x16x32_bf16 v[216:219], v[68:71], v[60:63], v[216:219]
    s_mov_b32 s52, 12
    s_bitcmp0_b32 s52, s41
    s_cbranch_scc1 LB_tq4
    v_bfe_u32 v24, v1, 3, 2
    v_and_b32 v25, 7, v1
    v_lshlrev_b32 v25, 7, v25
    v_lshl_add_u32 v24, v24, 13, v25
    buffer_load_dword v31, v24, s[12:15], s37 offen
LB_tq4:
    s_waitcnt lgkmcnt(1)
    v_mfma_f32_16x16x32_bf16 v[200:203], v[32:35], v[72:75], v[200:203]
    ds_read_b128 v[64:67], v12 offset:45056
    s_waitcnt lgkmcnt(1)
    v_mfma_f32_16x16x32_bf16 v[200:203], v[36:39], v[76:79], v[200:203]
    ds_read_b128 v[68:71], v13 offset:45056
    v_mfma_f32_16x16x32_bf16 v[204:207], v[40:43], v[72:75], v[204:207]
    v_mfma_f32_16x16x32_bf16 v[204:207], v[44:47], v[76:79], v[204:207]
    v_mfma_f32_16x16x32_bf16 v[212:215], v[72:75], v[48:51], v[212:215]
    v_mfma_f32_16x16x32_bf16 v[212:215], v[76:79], v[52:55], v[212:215]
    v_mfma_f32_16x16x32_bf16 v[220:223], v[72:75], v[56:59], v[220:223]
    v_mfma_f32_16x16x32_bf16 v[220:223], v[76:79], v[60:63], v[220:223]
    s_waitcnt lgkmcnt(1)
    v_mfma_f32_16x16x32_bf16 v[224:227], v[32:35], v[64:67], v[224:227]
    ds_read_b128 v[72:75], v12 offset:47104
    s_waitcnt lgkmcnt(1)
    v_mfma_f32_16x16x32_bf16 v[224:227], v[36:39], v[68:71], v[224:227]
    ds_read_b128 v[76:79], v13 offset:47104
    v_mfma_f32_16x16x32_bf16 v[228:231], v[40:43], v[64:67], v[228:231]
    v_mfma_f32_16x16x32_bf16 v[228:231], v[44:47], v[68:71], v[228:231]
    v_mfma_f32_16x16x32_bf16 v[240:243], v[64:67], v[48:51], v[240:243]
    v_mfma_f32_16x16x32_bf16 v[240:243], v[68:71], v[52:55], v[240:243]
    v_mfma_f32_16x16x32_bf16 v[248:251], v[64:67], v[56:59], v[248:251]
    v_mfma_f32_16x16x32_bf16 v[248:251], v[68:71], v[60:63], v[248:251]
    s_waitcnt vmcnt(10) lgkmcnt(0)
    s_barrier
    ds_read_b128 v[64:67], v14 offset:0
    v_mfma_f32_16x16x32_bf16 v[232:235], v[32:35], v[72:75], v[232:235]
    ds_read_b128 v[68:71], v15 offset:0
    s_add_u32 m0, s47, 98304
    s_add_u32 s50, s39, 6
    s_and_b32 s50, s50, 7
    s_mul_i32 s50, s50, 524288
    s_add_u32 s50, s50, s45
    buffer_load_dwordx4 v4, s[4:7], s50 offen offset:0 lds
    v_mfma_f32_16x16x32_bf16 v[232:235], v[36:39], v[76:79], v[232:235]
    ds_read_b64_tr_b16 v[32:33], v20 offset:32768
    ds_read_b64_tr_b16 v[34:35], v20 offset:33792
    v_mfma_f32_16x16x32_bf16 v[236:239], v[40:43], v[72:75], v[236:239]
    ds_read_b64_tr_b16 v[36:37], v20 offset:40960
    ds_read_b64_tr_b16 v[38:39], v20 offset:41984
    buffer_load_dwordx4 v5, s[4:7], s50 offen offset:1024 lds
    v_mfma_f32_16x16x32_bf16 v[236:239], v[44:47], v[76:79], v[236:239]
    ds_read_b64_tr_b16 v[40:41], v21 offset:32768
    ds_read_b64_tr_b16 v[42:43], v21 offset:33792
    v_mfma_f32_16x16x32_bf16 v[244:247], v[72:75], v[48:51], v[244:247]
    ds_read_b64_tr_b16 v[44:45], v21 offset:40960
    ds_read_b64_tr_b16 v[46:47], v21 offset:41984
    buffer_load_dwordx4 v6, s[4:7], s50 offen offset:2048 lds
    v_mfma_f32_16x16x32_bf16 v[244:247], v[76:79], v[52:55], v[244:247]
    ds_read_b64_tr_b16 v[48:49], v20 offset:49152
    ds_read_b64_tr_b16 v[50:51], v20 offset:50176
    v_mfma_f32_16x16x32_bf16 v[252:255], v[72:75], v[56:59], v[252:255]
    ds_read_b64_tr_b16 v[52:53], v20 offset:57344
    ds_read_b64_tr_b16 v[54:55], v20 offset:58368
    v_mfma_f32_16x16x32_bf16 v[252:255], v[76:79], v[60:63], v[252:255]
    ds_read_b64_tr_b16 v[56:57], v21 offset:49152
    s_waitcnt lgkmcnt(14)
    ds_read_b64_tr_b16 v[58:59], v21 offset:50176
    s_waitcnt lgkmcnt(14)
    ds_read_b64_tr_b16 v[60:61], v21 offset:57344
    s_waitcnt lgkmcnt(14)
    ds_read_b64_tr_b16 v[62:63], v21 offset:58368
    buffer_load_dwordx4 v7, s[4:7], s50 offen offset:3072 lds
    s_waitcnt lgkmcnt(14)
    v_mfma_f32_16x16x32_bf16 v[128:131], v[32:35], v[64:67], v[128:131]
    ds_read_b128 v[72:75], v14 offset:2048
    s_waitcnt lgkmcnt(13)
    v_mfma_f32_16x16x32_bf16 v[128:131], v[36:39], v[68:71], v[128:131]
    ds_read_b128 v[76:79], v15 offset:2048
    s_add_u32 m0, s47, 114688
    s_nop 0
    buffer_load_dwordx4 v4, s[8:11], s50 offen offset:0 lds
    s_waitcnt lgkmcnt(12)
    v_mfma_f32_16x16x32_bf16 v[132:135], v[40:43], v[64:67], v[132:135]
    s_waitcnt lgkmcnt(10)
    v_mfma_f32_16x16x32_bf16 v[132:135], v[44:47], v[68:71], v[132:135]
    s_waitcnt lgkmcnt(8)
    v_mfma_f32_16x16x32_bf16 v[144:147], v[64:67], v[48:51], v[144:147]
    buffer_load_dwordx4 v5, s[8:11], s50 offen offset:1024 lds
    s_waitcnt lgkmcnt(6)
    v_mfma_f32_16x16x32_bf16 v[144:147], v[68:71], v[52:55], v[144:147]
    s_waitcnt lgkmcnt(4)
    v_mfma_f32_16x16x32_bf16 v[152:155], v[64:67], v[56:59], v[152:155]
    buffer_load_dwordx4 v6, s[8:11], s50 offen offset:2048 lds
    s_waitcnt lgkmcnt(2)
    v_mfma_f32_16x16x32_bf16 v[152:155], v[68:71], v[60:63], v[152:155]
    s_waitcnt lgkmcnt(1)
    v_mfma_f32_16x16x32_bf16 v[136:139], v[32:35], v[72:75], v[136:139]
    ds_read_b128 v[64:67], v14 offset:4096
    s_waitcnt lgkmcnt(1)
    v_mfma_f32_16x16x32_bf16 v[136:139], v[36:39], v[76:79], v[136:139]
    ds_read_b128 v[68:71], v15 offset:4096
    buffer_load_dwordx4 v7, s[8:11], s50 offen offset:3072 lds
    v_mfma_f32_16x16x32_bf16 v[140:143], v[40:43], v[72:75], v[140:143]
    v_mfma_f32_16x16x32_bf16 v[140:143], v[44:47], v[76:79], v[140:143]
    s_add_u32 m0, s63, 32768
    s_add_u32 s50, s39, 7
    s_and_b32 s50, s50, 7
    s_mul_i32 s50, s50, 128
    s_add_u32 s50, s50, s36
    buffer_load_dwordx4 v0, s[28:31], s50 offen offset:0 lds
    v_mfma_f32_16x16x32_bf16 v[148:151], v[72:75], v[48:51], v[148:151]
    v_mfma_f32_16x16x32_bf16 v[148:151], v[76:79], v[52:55], v[148:151]
    v_mfma_f32_16x16x32_bf16 v[156:159], v[72:75], v[56:59], v[156:159]
    s_add_u32 s50, s50, 0x1c00
    buffer_load_dwordx4 v30, s[28:31], s50 offen offset:1024 lds
    v_mfma_f32_16x16x32_bf16 v[156:159], v[76:79], v[60:63], v[156:159]
    s_waitcnt lgkmcnt(1)
    v_mfma_f32_16x16x32_bf16 v[160:163], v[32:35], v[64:67], v[160:163]
    ds_read_b128 v[72:75], v14 offset:6144
    s_add_u32 s50, s50, 0x1c00
    buffer_load_dwordx4 v0, s[28:31], s50 offen offset:2048 lds
    s_waitcnt lgkmcnt(1)
    v_mfma_f32_16x16x32_bf16 v[160:163], v[36:39], v[68:71], v[160:163]
    ds_read_b128 v[76:79], v15 offset:6144
    v_mfma_f32_16x16x32_bf16 v[164:167], v[40:43], v[64:67], v[164:167]
    v_mfma_f32_16x16x32_bf16 v[164:167], v[44:47], v[68:71], v[164:167]
    s_add_u32 s50, s50, 0x1c00
    buffer_load_dwordx4 v30, s[28:31], s50 offen offset:3072 lds
    v_mfma_f32_16x16x32_bf16 v[176:179], v[64:67], v[48:51], v[176:179]
    v_mfma_f32_16x16x32_bf16 v[176:179], v[68:71], v[52:55], v[176:179]
    s_add_u32 m0, s63, 36864
    s_add_u32 s50, s50, 0x2c00
    buffer_load_dwordx4 v0, s[28:31], s50 offen offset:0 lds
    v_mfma_f32_16x16x32_bf16 v[184:187], v[64:67], v[56:59], v[184:187]
    v_mfma_f32_16x16x32_bf16 v[184:187], v[68:71], v[60:63], v[184:187]
    s_waitcnt lgkmcnt(1)
    v_mfma_f32_16x16x32_bf16 v[168:171], v[32:35], v[72:75], v[168:171]
    ds_read_b128 v[64:67], v14 offset:8192
    s_add_u32 s50, s50, 0x1c00
    buffer_load_dwordx4 v30, s[28:31], s50 offen offset:1024 lds
    s_waitcnt lgkmcnt(1)
    v_mfma_f32_16x16x32_bf16 v[168:171], v[36:39], v[76:79], v[168:171]
    ds_read_b128 v[68:71], v15 offset:8192
    v_mfma_f32_16x16x32_bf16 v[172:175], v[40:43], v[72:75], v[172:175]
    s_add_u32 s50, s50, 0x1c00
    buffer_load_dwordx4 v0, s[28:31], s50 offen offset:2048 lds
    v_mfma_f32_16x16x32_bf16 v[172:175], v[44:47], v[76:79], v[172:175]
    v_mfma_f32_16x16x32_bf16 v[180:183], v[72:75], v[48:51], v[180:183]
    v_mfma_f32_16x16x32_bf16 v[180:183], v[76:79], v[52:55], v[180:183]
    s_add_u32 s50, s50, 0x1c00
    buffer_load_dwordx4 v30, s[28:31], s50 offen offset:3072 lds
    v_mfma_f32_16x16x32_bf16 v[188:191], v[72:75], v[56:59], v[188:191]
    v_mfma_f32_16x16x32_bf16 v[188:191], v[76:79], v[60:63], v[188:191]
    s_add_u32 s50, s39, 5
    s_and_b32 s50, s50, 7
    s_mul_i32 s50, s50, 196608
    s_add_u32 s50, s50, s46
    buffer_load_dwordx4 v[112:115], v8, s[16:19], s50 offen offset:0
    s_waitcnt lgkmcnt(1)
    v_mfma_f32_16x16x32_bf16 v[192:195], v[32:35], v[64:67], v[192:195]
    ds_read_b128 v[72:75], v14 offset:10240
    s_waitcnt lgkmcnt(1)
    v_mfma_f32_16x16x32_bf16 v[192:195], v[36:39], v[68:71], v[192:195]
    ds_read_b128 v[76:79], v15 offset:10240
    v_mfma_f32_16x16x32_bf16 v[196:199], v[40:43], v[64:67], v[196:199]
    buffer_load_dwordx4 v[116:119], v9, s[16:19], s50 offen offset:1024
    v_mfma_f32_16x16x32_bf16 v[196:199], v[44:47], v[68:71], v[196:199]
    v_mfma_f32_16x16x32_bf16 v[208:211], v[64:67], v[48:51], v[208:211]
    s_mov_b32 s52, 48
    s_bitcmp0_b32 s52, s41
    s_cbranch_scc1 LB_tq5
    v_bfe_u32 v24, v1, 3, 2
    v_and_b32 v25, 7, v1
    v_lshlrev_b32 v25, 7, v25
    v_lshl_add_u32 v24, v24, 13, v25
    buffer_load_dword v31, v24, s[12:15], s37 offen
LB_tq5:
    v_mfma_f32_16x16x32_bf16 v[208:211], v[68:71], v[52:55], v[208:211]
    v_mfma_f32_16x16x32_bf16 v[216:219], v[64:67], v[56:59], v[216:219]
    v_mfma_f32_16x16x32_bf16 v[216:219], v[68:71], v[60:63], v[216:219]
    s_waitcnt lgkmcnt(1)
    v_mfma_f32_16x16x32_bf16 v[200:203], v[32:35], v[72:75], v[200:203]
    ds_read_b128 v[64:67], v14 offset:12288
    s_waitcnt lgkmcnt(1)
    v_mfma_f32_16x16x32_bf16 v[200:203], v[36:39], v[76:79], v[200:203]
    ds_read_b128 v[68:71], v15 offset:12288
    v_mfma_f32_16x16x32_bf16 v[204:207], v[40:43], v[72:75], v[204:207]
    v_mfma_f32_16x16x32_bf16 v[204:207], v[44:47], v[76:79], v[204:207]
    v_mfma_f32_16x16x32_bf16 v[212:215], v[72:75], v[48:51], v[212:215]
    v_mfma_f32_16x16x32_bf16 v[212:215], v[76:79], v[52:55], v[212:215]
    v_mfma_f32_16x16x32_bf16 v[220:223], v[72:75], v[56:59], v[220:223]
    v_mfma_f32_16x16x32_bf16 v[220:223], v[76:79], v[60:63], v[220:223]
    s_waitcnt lgkmcnt(1)
    v_mfma_f32_16x16x32_bf16 v[224:227], v[32:35], v[64:67], v[224:227]
    ds_read_b128 v[72:75], v14 offset:14336
    s_waitcnt lgkmcnt(1)
    v_mfma_f32_16x16x32_bf16 v[224:227], v[36:39], v[68:71], v[224:227]
    ds_read_b128 v[76:79], v15 offset:14336
    v_mfma_f32_16x16x32_bf16 v[228:231], v[40:43], v[64:67], v[228:231]
    v_mfma_f32_16x16x32_bf16 v[228:231], v[44:47], v[68:71], v[228:231]
    v_mfma_f32_16x16x32_bf16 v[240:243], v[64:67], v[48:51], v[240:243]
    v_mfma_f32_16x16x32_bf16 v[240:243], v[68:71], v[52:55], v[240:243]
    v_mfma_f32_16x16x32_bf16 v[248:251], v[64:67], v[56:59], v[248:251]
    v_mfma_f32_16x16x32_bf16 v[248:251], v[68:71], v[60:63], v[248:251]
    s_waitcnt vmcnt(10) lgkmcnt(0)
    s_barrier
    ds_read_b128 v[64:67], v12 offset:0
    v_mfma_f32_16x16x32_bf16 v[232:235], v[32:35], v[72:75], v[232:235]
    ds_read_b128 v[68:71], v13 offset:0
    s_add_u32 m0, s47, 131072
    s_add_u32 s50, s39, 7
    s_and_b32 s50, s50, 7
    s_mul_i32 s50, s50, 524288
    s_add_u32 s50, s50, s45
    buffer_load_dwordx4 v4, s[4:7], s50 offen offset:0 lds
    v_mfma_f32_16x16x32_bf16 v[232:235], v[36:39], v[76:79], v[232:235]
    ds_read_b64_tr_b16 v[32:33], v20 offset:0
    ds_read_b64_tr_b16 v[34:35], v20 offset:1024
    v_mfma_f32_16x16x32_bf16 v[236:239], v[40:43], v[72:75], v[236:239]
    ds_read_b64_tr_b16 v[36:37], v20 offset:8192
    ds_read_b64_tr_b16 v[38:39], v20 offset:9216
    buffer_load_dwordx4 v5, s[4:7], s50 offen offset:1024 lds
    v_mfma_f32_16x16x32_bf16 v[236:239], v[44:47], v[76:79], v[236:239]
    ds_read_b64_tr_b16 v[40:41], v21 offset:0
    ds_read_b64_tr_b16 v[42:43], v21 offset:1024
    v_mfma_f32_16x16x32_bf16 v[244:247], v[72:75], v[48:51], v[244:247]
    ds_read_b64_tr_b16 v[44:45], v21 offset:8192
    ds_read_b64_tr_b16 v[46:47], v21 offset:9216
    buffer_load_dwordx4 v6, s[4:7], s50 offen offset:2048 lds
    v_mfma_f32_16x16x32_bf16 v[244:247], v[76:79], v[52:55], v[244:247]
    ds_read_b64_tr_b16 v[48:49], v20 offset:16384
    ds_read_b64_tr_b16 v[50:51], v20 offset:17408
    v_mfma_f32_16x16x32_bf16 v[252:255], v[72:75], v[56:59], v[252:255]
    ds_read_b64_tr_b16 v[52:53], v20 offset:24576
    ds_read_b64_tr_b16 v[54:55], v20 offset:25600
    v_mfma_f32_16x16x32_bf16 v[252:255], v[76:79], v[60:63], v[252:255]
    ds_read_b64_tr_b16 v[56:57], v21 offset:16384
    s_waitcnt lgkmcnt(14)
    ds_read_b64_tr_b16 v[58:59], v21 offset:17408
    s_waitcnt lgkmcnt(14)
    ds_read_b64_tr_b16 v[60:61], v21 offset:24576
    s_waitcnt lgkmcnt(14)
    ds_read_b64_tr_b16 v[62:63], v21 offset:25600
    buffer_load_dwordx4 v7, s[4:7], s50 offen offset:3072 lds
    s_waitcnt lgkmcnt(14)
    v_mfma_f32_16x16x32_bf16 v[128:131], v[32:35], v[64:67], v[128:131]
    ds_read_b128 v[72:75], v12 offset:2048
    s_waitcnt lgkmcnt(13)
    v_mfma_f32_16x16x32_bf16 v[128:131], v[36:39], v[68:71], v[128:131]
    ds_read_b128 v[76:79], v13 offset:2048
    s_add_u32 m0, s47, 147456
    s_nop 0
    buffer_load_dwordx4 v4, s[8:11], s50 offen offset:0 lds
    s_waitcnt lgkmcnt(12)
    v_mfma_f32_16x16x32_bf16 v[132:135], v[40:43], v[64:67], v[132:135]
    s_waitcnt lgkmcnt(10)
    v_mfma_f32_16x16x32_bf16 v[132:135], v[44:47], v[68:71], v[132:135]
    s_waitcnt lgkmcnt(8)
    v_mfma_f32_16x16x32_bf16 v[144:147], v[64:67], v[48:51], v[144:147]
    buffer_load_dwordx4 v5, s[8:11], s50 offen offset:1024 lds
    s_waitcnt lgkmcnt(6)
    v_mfma_f32_16x16x32_bf16 v[144:147], v[68:71], v[52:55], v[144:147]
    s_waitcnt lgkmcnt(4)
    v_mfma_f32_16x16x32_bf16 v[152:155], v[64:67], v[56:59], v[152:155]
    buffer_load_dwordx4 v6, s[8:11], s50 offen offset:2048 lds
    s_waitcnt lgkmcnt(2)
    v_mfma_f32_16x16x32_bf16 v[152:155], v[68:71], v[60:63], v[152:155]
    s_waitcnt lgkmcnt(1)
    v_mfma_f32_16x16x32_bf16 v[136:139], v[32:35], v[72:75], v[136:139]
    ds_read_b128 v[64:67], v12 offset:4096
    s_waitcnt lgkmcnt(1)
    v_mfma_f32_16x16x32_bf16 v[136:139], v[36:39], v[76:79], v[136:139]
    ds_read_b128 v[68:71], v13 offset:4096
    buffer_load_dwordx4 v7, s[8:11], s50 offen offset:3072 lds
    v_mfma_f32_16x16x32_bf16 v[140:143], v[40:43], v[72:75], v[140:143]
    v_mfma_f32_16x16x32_bf16 v[140:143], v[44:47], v[76:79], v[140:143]
    s_add_u32 m0, s63, 65536
    s_add_u32 s50, s39, 0
    s_and_b32 s50, s50, 7
    s_mul_i32 s50, s50, 128
    s_add_u32 s50, s50, s38
    buffer_load_dwordx4 v0, s[32:35], s50 offen offset:0 lds
    v_mfma_f32_16x16x32_bf16 v[148:151], v[72:75], v[48:51], v[148:151]
    v_mfma_f32_16x16x32_bf16 v[148:151], v[76:79], v[52:55], v[148:151]
    v_mfma_f32_16x16x32_bf16 v[156:159], v[72:75], v[56:59], v[156:159]
    s_add_u32 s50, s50, 0x1c00
    buffer_load_dwordx4 v30, s[32:35], s50 offen offset:1024 lds
    v_mfma_f32_16x16x32_bf16 v[156:159], v[76:79], v[60:63], v[156:159]
    s_waitcnt lgkmcnt(1)
    v_mfma_f32_16x16x32_bf16 v[160:163], v[32:35], v[64:67], v[160:163]
    ds_read_b128 v[72:75], v12 offset:6144
    s_add_u32 s50, s50, 0x1c00
    buffer_load_dwordx4 v0, s[32:35], s50 offen offset:2048 lds
    s_waitcnt lgkmcnt(1)
    v_mfma_f32_16x16x32_bf16 v[160:163], v[36:39], v[68:71], v[160:163]
    ds_read_b128 v[76:79], v13 offset:6144
    v_mfma_f32_16x16x32_bf16 v[164:167], v[40:43], v[64:67], v[164:167]
    v_mfma_f32_16x16x32_bf16 v[164:167], v[44:47], v[68:71], v[164:167]
    s_add_u32 s50, s50, 0x1c00
    buffer_load_dwordx4 v30, s[32:35], s50 offen offset:3072 lds
    v_mfma_f32_16x16x32_bf16 v[176:179], v[64:67], v[48:51], v[176:179]
    v_mfma_f32_16x16x32_bf16 v[176:179], v[68:71], v[52:55], v[176:179]
    s_add_u32 m0, s63, 69632
    s_add_u32 s50, s50, s90
    buffer_load_dwordx4 v0, s[32:35], s50 offen offset:0 lds
    v_mfma_f32_16x16x32_bf16 v[184:187], v[64:67], v[56:59], v[184:187]
    v_mfma_f32_16x16x32_bf16 v[184:187], v[68:71], v[60:63], v[184:187]
    s_waitcnt lgkmcnt(1)
    v_mfma_f32_16x16x32_bf16 v[168:171], v[32:35], v[72:75], v[168:171]
    ds_read_b128 v[64:67], v12 offset:8192
    s_add_u32 s50, s50, 0x1c00
    buffer_load_dwordx4 v30, s[32:35], s50 offen offset:1024 lds
    s_waitcnt lgkmcnt(1)
    v_mfma_f32_16x16x32_bf16 v[168:171], v[36:39], v[76:79], v[168:171]
    ds_read_b128 v[68:71], v13 offset:8192
    v_mfma_f32_16x16x32_bf16 v[172:175], v[40:43], v[72:75], v[172:175]
    s_add_u32 s50, s50, 0x1c00
    buffer_load_dwordx4 v0, s[32:35], s50 offen offset:2048 lds
    v_mfma_f32_16x16x32_bf16 v[172:175], v[44:47], v[76:79], v[172:175]
    v_mfma_f32_16x16x32_bf16 v[180:183], v[72:75], v[48:51], v[180:183]
    v_mfma_f32_16x16x32_bf16 v[180:183], v[76:79], v[52:55], v[180:183]
    s_add_u32 s50, s50, 0x1c00
    buffer_load_dwordx4 v30, s[32:35], s50 offen offset:3072 lds
    v_mfma_f32_16x16x32_bf16 v[188:191], v[72:75], v[56:59], v[188:191]
    v_mfma_f32_16x16x32_bf16 v[188:191], v[76:79], v[60:63], v[188:191]
    s_add_u32 s50, s39, 6
    s_and_b32 s50, s50, 7
    s_mul_i32 s50, s50, 196608
    s_add_u32 s50, s50, s46
    buffer_load_dwordx4 v[120:123], v8, s[16:19], s50 offen offset:0
    s_waitcnt lgkmcnt(1)
    v_mfma_f32_16x16x32_bf16 v[192:195], v[32:35], v[64:67], v[192:195]
    ds_read_b128 v[72:75], v12 offset:10240
    s_waitcnt lgkmcnt(1)
    v_mfma_f32_16x16x32_bf16 v[192:195], v[36:39], v[68:71], v[192:195]
    ds_read_b128 v[76:79], v13 offset:10240
    v_mfma_f32_16x16x32_bf16 v[196:199], v[40:43], v[64:67], v[196:199]
    buffer_load_dwordx4 v[124:127], v9, s[16:19], s50 offen offset:1024
    v_mfma_f32_16x16x32_bf16 v[196:199], v[44:47], v[68:71], v[196:199]
    v_mfma_f32_16x16x32_bf16 v[208:211], v[64:67], v[48:51], v[208:211]
    s_mov_b32 s52, 192
    s_bitcmp0_b32 s52, s41
    s_cbranch_scc1 LB_tq6
    v_bfe_u32 v24, v1, 3, 2
    v_and_b32 v25, 7, v1
    v_lshlrev_b32 v25, 7, v25
    v_lshl_add_u32 v24, v24, 13, v25
    buffer_load_dword v31, v24, s[12:15], s37 offen
LB_tq6:
    v_mfma_f32_16x16x32_bf16 v[208:211], v[68:71], v[52:55], v[208:211]
    v_mfma_f32_16x16x32_bf16 v[216:219], v[64:67], v[56:59], v[216:219]
    v_mfma_f32_16x16x32_bf16 v[216:219], v[68:71], v[60:63], v[216:219]
    s_waitcnt lgkmcnt(1)
    v_mfma_f32_16x16x32_bf16 v[200:203], v[32:35], v[72:75], v[200:203]
    ds_read_b128 v[64:67], v12 offset:12288
    s_waitcnt lgkmcnt(1)
    v_mfma_f32_16x16x32_bf16 v[200:203], v[36:39], v[76:79], v[200:203]
    ds_read_b128 v[68:71], v13 offset:12288
    v_mfma_f32_16x16x32_bf16 v[204:207], v[40:43], v[72:75], v[204:207]
    v_mfma_f32_16x16x32_bf16 v[204:207], v[44:47], v[76:79], v[204:207]
    v_mfma_f32_16x16x32_bf16 v[212:215], v[72:75], v[48:51], v[212:215]
    v_mfma_f32_16x16x32_bf16 v[212:215], v[76:79], v[52:55], v[212:215]
    v_mfma_f32_16x16x32_bf16 v[220:223], v[72:75], v[56:59], v[220:223]
    v_mfma_f32_16x16x32_bf16 v[220:223], v[76:79], v[60:63], v[220:223]
    s_waitcnt lgkmcnt(1)
    v_mfma_f32_16x16x32_bf16 v[224:227], v[32:35], v[64:67], v[224:227]
    ds_read_b128 v[72:75], v12 offset:14336
    s_waitcnt lgkmcnt(1)
    v_mfma_f32_16x16x32_bf16 v[224:227], v[36:39], v[68:71], v[224:227]
    ds_read_b128 v[76:79], v13 offset:14336
    v_mfma_f32_16x16x32_bf16 v[228:231], v[40:43], v[64:67], v[228:231]
    v_mfma_f32_16x16x32_bf16 v[228:231], v[44:47], v[68:71], v[228:231]
    v_mfma_f32_16x16x32_bf16 v[240:243], v[64:67], v[48:51], v[240:243]
    v_mfma_f32_16x16x32_bf16 v[240:243], v[68:71], v[52:55], v[240:243]
    v_mfma_f32_16x16x32_bf16 v[248:251], v[64:67], v[56:59], v[248:251]
    v_mfma_f32_16x16x32_bf16 v[248:251], v[68:71], v[60:63], v[248:251]
    s_waitcnt vmcnt(10) lgkmcnt(0)
    s_barrier
    ds_read_b128 v[64:67], v12 offset:32768
    v_mfma_f32_16x16x32_bf16 v[232:235], v[32:35], v[72:75], v[232:235]
    ds_read_b128 v[68:71], v13 offset:32768
    s_add_u32 m0, s47, 98304
    s_add_u32 s50, s39, 0
    s_and_b32 s50, s50, 7
    s_mul_i32 s50, s50, 524288
    s_add_u32 s50, s50, s45
    buffer_load_dwordx4 v4, s[12:15], s50 offen offset:0 lds
    v_mfma_f32_16x16x32_bf16 v[232:235], v[36:39], v[76:79], v[232:235]
    ds_read_b64_tr_b16 v[32:33], v20 offset:32768
    ds_read_b64_tr_b16 v[34:35], v20 offset:33792
    v_mfma_f32_16x16x32_bf16 v[236:239], v[40:43], v[72:75], v[236:239]
    ds_read_b64_tr_b16 v[36:37], v20 offset:40960
    ds_read_b64_tr_b16 v[38:39], v20 offset:41984
    buffer_load_dwordx4 v5, s[12:15], s50 offen offset:1024 lds
    v_mfma_f32_16x16x32_bf16 v[236:239], v[44:47], v[76:79], v[236:239]
    ds_read_b64_tr_b16 v[40:41], v21 offset:32768
    ds_read_b64_tr_b16 v[42:43], v21 offset:33792
    v_mfma_f32_16x16x32_bf16 v[244:247], v[72:75], v[48:51], v[244:247]
    ds_read_b64_tr_b16 v[44:45], v21 offset:40960
    ds_read_b64_tr_b16 v[46:47], v21 offset:41984
    v_mfma_f32_16x16x32_bf16 v[244:247], v[76:79], v[52:55], v[244:247]
    ds_read_b64_tr_b16 v[48:49], v20 offset:49152
    ds_read_b64_tr_b16 v[50:51], v20 offset:50176
    buffer_load_dwordx4 v6, s[12:15], s50 offen offset:2048 lds
    v_mfma_f32_16x16x32_bf16 v[252:255], v[72:75], v[56:59], v[252:255]
    ds_read_b64_tr_b16 v[52:53], v20 offset:57344
    ds_read_b64_tr_b16 v[54:55], v20 offset:58368
    v_mfma_f32_16x16x32_bf16 v[252:255], v[76:79], v[60:63], v[252:255]
    ds_read_b64_tr_b16 v[56:57], v21 offset:49152
    s_waitcnt lgkmcnt(14)
    ds_read_b64_tr_b16 v[58:59], v21 offset:50176
    s_waitcnt lgkmcnt(14)
    ds_read_b64_tr_b16 v[60:61], v21 offset:57344
    s_waitcnt lgkmcnt(14)
    ds_read_b64_tr_b16 v[62:63], v21 offset:58368
    buffer_load_dwordx4 v7, s[12:15], s50 offen offset:3072 lds
    s_waitcnt lgkmcnt(14)
    v_mfma_f32_16x16x32_bf16 v[128:131], v[32:35], v[64:67], v[128:131]
    ds_read_b128 v[72:75], v12 offset:34816
    s_waitcnt lgkmcnt(13)
    v_mfma_f32_16x16x32_bf16 v[128:131], v[36:39], v[68:71], v[128:131]
    ds_read_b128 v[76:79], v13 offset:34816
    s_waitcnt lgkmcnt(12)
    v_mfma_f32_16x16x32_bf16 v[132:135], v[40:43], v[64:67], v[132:135]
    s_lshl_b32 s50, s43, 11
    s_add_u32 m0, s50, 114688
    s_add_u32 s50, s39, 0
    s_and_b32 s50, s50, 7
    s_mul_i32 s50, s50, 196608
    s_add_u32 s50, s50, s46
    buffer_load_dwordx4 v8, s[16:19], s50 offen offset:0 lds
    s_waitcnt lgkmcnt(10)
    v_mfma_f32_16x16x32_bf16 v[132:135], v[44:47], v[68:71], v[132:135]
    s_waitcnt lgkmcnt(8)
    v_mfma_f32_16x16x32_bf16 v[144:147], v[64:67], v[48:51], v[144:147]
    buffer_load_dwordx4 v9, s[16:19], s50 offen offset:1024 lds
    s_waitcnt lgkmcnt(6)
    v_mfma_f32_16x16x32_bf16 v[144:147], v[68:71], v[52:55], v[144:147]
    s_waitcnt lgkmcnt(4)
    v_mfma_f32_16x16x32_bf16 v[152:155], v[64:67], v[56:59], v[152:155]
    s_waitcnt lgkmcnt(2)
    v_mfma_f32_16x16x32_bf16 v[152:155], v[68:71], v[60:63], v[152:155]
    s_add_u32 m0, s63, 0
    s_add_u32 s50, s39, 1
    s_and_b32 s50, s50, 7
    s_mul_i32 s50, s50, 128
    s_add_u32 s50, s50, s38
    buffer_load_dwordx4 v0, s[32:35], s50 offen offset:0 lds
    s_waitcnt lgkmcnt(1)
    v_mfma_f32_16x16x32_bf16 v[136:139], v[32:35], v[72:75], v[136:139]
    ds_read_b128 v[64:67], v12 offset:36864
    s_waitcnt lgkmcnt(1)
    v_mfma_f32_16x16x32_bf16 v[136:139], v[36:39], v[76:79], v[136:139]
    ds_read_b128 v[68:71], v13 offset:36864
    s_add_u32 s50, s50, 0x1c00
    buffer_load_dwordx4 v30, s[32:35], s50 offen offset:1024 lds
    v_mfma_f32_16x16x32_bf16 v[140:143], v[40:43], v[72:75], v[140:143]
    v_mfma_f32_16x16x32_bf16 v[140:143], v[44:47], v[76:79], v[140:143]
    v_mfma_f32_16x16x32_bf16 v[148:151], v[72:75], v[48:51], v[148:151]
    s_add_u32 s50, s50, 0x1c00
    buffer_load_dwordx4 v0, s[32:35], s50 offen offset:2048 lds
    v_mfma_f32_16x16x32_bf16 v[148:151], v[76:79], v[52:55], v[148:151]
    v_mfma_f32_16x16x32_bf16 v[156:159], v[72:75], v[56:59], v[156:159]
    s_add_u32 s50, s50, 0x1c00
    buffer_load_dwordx4 v30, s[32:35], s50 offen offset:3072 lds
    v_mfma_f32_16x16x32_bf16 v[156:159], v[76:79], v[60:63], v[156:159]
    s_waitcnt lgkmcnt(1)
    v_mfma_f32_16x16x32_bf16 v[160:163], v[32:35], v[64:67], v[160:163]
    ds_read_b128 v[72:75], v12 offset:38912
    s_waitcnt lgkmcnt(1)
    v_mfma_f32_16x16x32_bf16 v[160:163], v[36:39], v[68:71], v[160:163]
    ds_read_b128 v[76:79], v13 offset:38912
    s_add_u32 m0, s63, 4096
    s_add_u32 s50, s50, s90
    buffer_load_dwordx4 v0, s[32:35], s50 offen offset:0 lds
    v_mfma_f32_16x16x32_bf16 v[164:167], v[40:43], v[64:67], v[164:167]
    v_mfma_f32_16x16x32_bf16 v[164:167], v[44:47], v[68:71], v[164:167]
    s_add_u32 s50, s50, 0x1c00
    buffer_load_dwordx4 v30, s[32:35], s50 offen offset:1024 lds
    v_mfma_f32_16x16x32_bf16 v[176:179], v[64:67], v[48:51], v[176:179]
    v_mul_f32 v128, s95, v128
    v_mfma_f32_16x16x32_bf16 v[176:179], v[68:71], v[52:55], v[176:179]
    v_mul_f32 v129, s95, v129
    v_mfma_f32_16x16x32_bf16 v[184:187], v[64:67], v[56:59], v[184:187]
    s_add_u32 s50, s50, 0x1c00
    buffer_load_dwordx4 v0, s[32:35], s50 offen offset:2048 lds
    v_mul_f32 v130, s95, v130
    v_mfma_f32_16x16x32_bf16 v[184:187], v[68:71], v[60:63], v[184:187]
    v_mul_f32 v131, s95, v131
    s_waitcnt lgkmcnt(1)
    v_mfma_f32_16x16x32_bf16 v[168:171], v[32:35], v[72:75], v[168:171]
    ds_read_b128 v[64:67], v12 offset:40960
    s_add_u32 s50, s50, 0x1c00
    buffer_load_dwordx4 v30, s[32:35], s50 offen offset:3072 lds
    v_mul_f32 v132, s95, v132
    s_waitcnt lgkmcnt(1)
    v_mfma_f32_16x16x32_bf16 v[168:171], v[36:39], v[76:79], v[168:171]
    ds_read_b128 v[68:71], v13 offset:40960
    v_mul_f32 v133, s95, v133
    v_mfma_f32_16x16x32_bf16 v[172:175], v[40:43], v[72:75], v[172:175]
    v_mul_f32 v134, s95, v134
    v_mfma_f32_16x16x32_bf16 v[172:175], v[44:47], v[76:79], v[172:175]
    v_mul_f32 v135, s95, v135
    v_mfma_f32_16x16x32_bf16 v[180:183], v[72:75], v[48:51], v[180:183]
    v_mul_f32 v136, s95, v136
    v_mfma_f32_16x16x32_bf16 v[180:183], v[76:79], v[52:55], v[180:183]
    v_mul_f32 v137, s95, v137
    v_mfma_f32_16x16x32_bf16 v[188:191], v[72:75], v[56:59], v[188:191]
    v_mul_f32 v138, s95, v138
    v_mfma_f32_16x16x32_bf16 v[188:191], v[76:79], v[60:63], v[188:191]
    v_mul_f32 v139, s95, v139
LB_g23:
    s_waitcnt lgkmcnt(1)
    v_mfma_f32_16x16x32_bf16 v[192:195], v[32:35], v[64:67], v[192:195]
    ds_read_b128 v[72:75], v12 offset:43008
    v_mul_f32 v140, s95, v140
    s_waitcnt lgkmcnt(1)
    v_mfma_f32_16x16x32_bf16 v[192:195], v[36:39], v[68:71], v[192:195]
    ds_read_b128 v[76:79], v13 offset:43008
    v_mul_f32 v141, s95, v141
    v_mfma_f32_16x16x32_bf16 v[196:199], v[40:43], v[64:67], v[196:199]
    v_mul_f32 v142, s95, v142
    v_mfma_f32_16x16x32_bf16 v[196:199], v[44:47], v[68:71], v[196:199]
    v_mul_f32 v143, s95, v143
    v_mfma_f32_16x16x32_bf16 v[208:211], v[64:67], v[48:51], v[208:211]
    v_mul_f32 v160, s95, v160
    v_mfma_f32_16x16x32_bf16 v[208:211], v[68:71], v[52:55], v[208:211]
    v_mul_f32 v161, s95, v161
    v_mfma_f32_16x16x32_bf16 v[216:219], v[64:67], v[56:59], v[216:219]
    v_mul_f32 v162, s95, v162
    v_mfma_f32_16x16x32_bf16 v[216:219], v[68:71], v[60:63], v[216:219]
    v_mul_f32 v163, s95, v163
    s_waitcnt lgkmcnt(1)
    v_mfma_f32_16x16x32_bf16 v[200:203], v[32:35], v[72:75], v[200:203]
    ds_read_b128 v[64:67], v12 offset:45056
    v_mul_f32 v164, s95, v164
    s_waitcnt lgkmcnt(1)
    v_mfma_f32_16x16x32_bf16 v[200:203], v[36:39], v[76:79], v[200:203]
    ds_read_b128 v[68:71], v13 offset:45056
    v_mul_f32 v165, s95, v165
    v_mfma_f32_16x16x32_bf16 v[204:207], v[40:43], v[72:75], v[204:207]
    v_mul_f32 v166, s95, v166
    v_mfma_f32_16x16x32_bf16 v[204:207], v[44:47], v[76:79], v[204:207]
    v_mul_f32 v167, s95, v167
    v_mfma_f32_16x16x32_bf16 v[212:215], v[72:75], v[48:51], v[212:215]
    v_mul_f32 v168, s95, v168
    v_mfma_f32_16x16x32_bf16 v[212:215], v[76:79], v[52:55], v[212:215]
    v_mul_f32 v169, s95, v169
    v_mfma_f32_16x16x32_bf16 v[220:223], v[72:75], v[56:59], v[220:223]
    v_mul_f32 v170, s95, v170
    v_mfma_f32_16x16x32_bf16 v[220:223], v[76:79], v[60:63], v[220:223]
    v_mul_f32 v171, s95, v171
    s_waitcnt lgkmcnt(1)
    v_mfma_f32_16x16x32_bf16 v[224:227], v[32:35], v[64:67], v[224:227]
    ds_read_b128 v[72:75], v12 offset:47104
    v_mul_f32 v172, s95, v172
    s_waitcnt lgkmcnt(1)
    v_mfma_f32_16x16x32_bf16 v[224:227], v[36:39], v[68:71], v[224:227]
    ds_read_b128 v[76:79], v13 offset:47104
    v_mul_f32 v173, s95, v173
    v_mfma_f32_16x16x32_bf16 v[228:231], v[40:43], v[64:67], v[228:231]
    v_mul_f32 v174, s95, v174
    v_mfma_f32_16x16x32_bf16 v[228:231], v[44:47], v[68:71], v[228:231]
    v_mul_f32 v175, s95, v175
    v_mfma_f32_16x16x32_bf16 v[240:243], v[64:67], v[48:51], v[240:243]
    s_lshl_b32 s52, s43, 12
    s_sub_u32 s52, s52, 0
    s_lshl_b32 s53, s43, 6
    v_add_u32 v12, s52, v12
    v_add_u32 v13, s52, v13
    v_add_u32 v14, s52, v14
    v_add_u32 v15, s52, v15
    v_mul_f32 v192, s95, v192
    v_mul_f32 v193, s95, v193
    v_mul_f32 v194, s95, v194
    v_mfma_f32_16x16x32_bf16 v[240:243], v[68:71], v[52:55], v[240:243]
    v_mul_f32 v195, s95, v195
    v_mul_f32 v196, s95, v196
    v_mul_f32 v197, s95, v197
    v_mfma_f32_16x16x32_bf16 v[248:251], v[64:67], v[56:59], v[248:251]
    v_mul_f32 v198, s95, v198
    v_mul_f32 v199, s95, v199
    v_mul_f32 v200, s95, v200
    v_mfma_f32_16x16x32_bf16 v[248:251], v[68:71], v[60:63], v[248:251]
    v_mul_f32 v201, s95, v201
    v_mul_f32 v202, s95, v202
    v_mul_f32 v203, s95, v203
    s_waitcnt vmcnt(8) lgkmcnt(0)
    s_barrier
    ds_read_b64_tr_b16 v[64:65], v16 offset:0
    ds_read_b64_tr_b16 v[66:67], v16 offset:512
    v_mfma_f32_16x16x32_bf16 v[232:235], v[32:35], v[72:75], v[232:235]
    ds_read_b64_tr_b16 v[68:69], v16 offset:4096
    ds_read_b64_tr_b16 v[70:71], v16 offset:4608
    s_add_u32 m0, s47, 131072
    s_add_u32 s50, s39, 1
    s_and_b32 s50, s50, 7
    s_mul_i32 s50, s50, 524288
    s_add_u32 s50, s50, s45
    buffer_load_dwordx4 v4, s[12:15], s50 offen offset:0 lds
    v_mul_f32 v204, s95, v204
    v_mul_f32 v205, s95, v205
    v_mul_f32 v206, s95, v206
    v_mfma_f32_16x16x32_bf16 v[232:235], v[36:39], v[76:79], v[232:235]
    ds_read_b128 v[32:35], v14 offset:0
    buffer_load_dwordx4 v5, s[12:15], s50 offen offset:1024 lds
    v_mul_f32 v207, s95, v207
    v_cvt_pk_bf16_f32 v192, v192, v193
    v_cvt_pk_bf16_f32 v193, v194, v195
    v_mfma_f32_16x16x32_bf16 v[236:239], v[40:43], v[72:75], v[236:239]
    ds_read_b128 v[36:39], v15 offset:0
    v_cvt_pk_bf16_f32 v194, v196, v197
    v_cvt_pk_bf16_f32 v195, v198, v199
    v_cvt_pk_bf16_f32 v196, v200, v201
    v_mfma_f32_16x16x32_bf16 v[236:239], v[44:47], v[76:79], v[236:239]
    ds_read_b128 v[40:43], v14 offset:2048
    buffer_load_dwordx4 v6, s[12:15], s50 offen offset:2048 lds
    v_cvt_pk_bf16_f32 v197, v202, v203
    v_cvt_pk_bf16_f32 v198, v204, v205
    v_cvt_pk_bf16_f32 v199, v206, v207
    v_mfma_f32_16x16x32_bf16 v[244:247], v[72:75], v[48:51], v[244:247]
    ds_read_b128 v[44:47], v15 offset:2048
    buffer_load_dwordx4 v7, s[12:15], s50 offen offset:3072 lds
    v_cvt_pk_bf16_f32 v200, v128, v129
    v_cvt_pk_bf16_f32 v201, v130, v131
    v_cvt_pk_bf16_f32 v202, v132, v133
    v_mfma_f32_16x16x32_bf16 v[244:247], v[76:79], v[52:55], v[244:247]
    ds_read_b128 v[48:51], v14 offset:16384
    v_cvt_pk_bf16_f32 v203, v134, v135
    v_cvt_pk_bf16_f32 v204, v136, v137
    v_cvt_pk_bf16_f32 v205, v138, v139
    v_mfma_f32_16x16x32_bf16 v[252:255], v[72:75], v[56:59], v[252:255]
    ds_read_b128 v[52:55], v15 offset:16384
    ds_write_b128 v23, v[80:83] offset:32768
    v_cvt_pk_bf16_f32 v206, v140, v141
    v_cvt_pk_bf16_f32 v207, v142, v143
    v_mfma_f32_16x16x32_bf16 v[252:255], v[76:79], v[60:63], v[252:255]
    ds_read_b128 v[56:59], v14 offset:18432
    ds_read_b128 v[60:63], v15 offset:18432
    s_waitcnt lgkmcnt(8)
    v_mfma_f32_16x16x32_bf16 v[128:131], v[64:67], v[32:35], 0
    ds_read_b64_tr_b16 v[72:73], v17 offset:0
    ds_write_b128 v23, v[84:87] offset:33792
    v_cvt_pk_bf16_f32 v208, v208, v209
    v_cvt_pk_bf16_f32 v209, v210, v211
    s_waitcnt lgkmcnt(9)
    v_mfma_f32_16x16x32_bf16 v[128:131], v[68:71], v[36:39], v[128:131]
    ds_read_b64_tr_b16 v[74:75], v17 offset:512
    s_add_u32 m0, s63, 32768
    s_add_u32 s50, s39, 2
    s_and_b32 s50, s50, 7
    s_mul_i32 s50, s50, 128
    s_add_u32 s50, s50, s38
    buffer_load_dwordx4 v0, s[32:35], s50 offen offset:0 lds
    v_cvt_pk_bf16_f32 v210, v212, v213
    v_cvt_pk_bf16_f32 v211, v214, v215
    s_waitcnt lgkmcnt(9)
    v_mfma_f32_16x16x32_bf16 v[132:135], v[64:67], v[40:43], 0
    ds_read_b64_tr_b16 v[76:77], v17 offset:4096
    v_cvt_pk_bf16_f32 v212, v216, v217
    v_cvt_pk_bf16_f32 v213, v218, v219
    s_waitcnt lgkmcnt(9)
    v_mfma_f32_16x16x32_bf16 v[132:135], v[68:71], v[44:47], v[132:135]
    ds_read_b64_tr_b16 v[78:79], v17 offset:4608
    s_add_u32 s50, s50, 0x1c00
    buffer_load_dwordx4 v30, s[32:35], s50 offen offset:1024 lds
    v_cvt_pk_bf16_f32 v214, v220, v221
    v_cvt_pk_bf16_f32 v215, v222, v223
    s_waitcnt lgkmcnt(9)
    v_mfma_f32_16x16x32_bf16 v[136:139], v[64:67], v[48:51], 0
    v_cvt_pk_bf16_f32 v216, v144, v145
    v_cvt_pk_bf16_f32 v217, v146, v147
    s_waitcnt lgkmcnt(8)
    v_mfma_f32_16x16x32_bf16 v[136:139], v[68:71], v[52:55], v[136:139]
    s_add_u32 s50, s50, 0x1c00
    buffer_load_dwordx4 v0, s[32:35], s50 offen offset:2048 lds
    v_cvt_pk_bf16_f32 v218, v148, v149
    v_cvt_pk_bf16_f32 v219, v150, v151
    s_waitcnt lgkmcnt(6)
    v_mfma_f32_16x16x32_bf16 v[140:143], v[64:67], v[56:59], 0
    s_add_u32 s50, s50, 0x1c00
    buffer_load_dwordx4 v30, s[32:35], s50 offen offset:3072 lds
    v_cvt_pk_bf16_f32 v220, v152, v153
    v_cvt_pk_bf16_f32 v221, v154, v155
    s_waitcnt lgkmcnt(5)
    v_mfma_f32_16x16x32_bf16 v[140:143], v[68:71], v[60:63], v[140:143]
    v_cvt_pk_bf16_f32 v222, v156, v157
    v_cvt_pk_bf16_f32 v223, v158, v159
    s_waitcnt lgkmcnt(2)
    v_mfma_f32_16x16x32_bf16 v[144:147], v[72:75], v[32:35], 0
    ds_read_b64_tr_b16 v[64:65], v18 offset:0
    s_add_u32 m0, s63, 36864
    s_add_u32 s50, s50, s90
    buffer_load_dwordx4 v0, s[32:35], s50 offen offset:0 lds
    v_mul_f32 v224, s95, v224
    v_mul_f32 v225, s95, v225
    v_mul_f32 v226, s95, v226
    v_mul_f32 v227, s95, v227
    s_waitcnt lgkmcnt(1)
    v_mfma_f32_16x16x32_bf16 v[144:147], v[76:79], v[36:39], v[144:147]
    ds_read_b64_tr_b16 v[66:67], v18 offset:512
    v_mul_f32 v228, s95, v228
    v_mul_f32 v229, s95, v229
    v_mul_f32 v230, s95, v230
    v_mul_f32 v231, s95, v231
    v_mfma_f32_16x16x32_bf16 v[148:151], v[72:75], v[40:43], 0
    ds_read_b64_tr_b16 v[68:69], v18 offset:4096
    s_add_u32 s50, s50, 0x1c00
    buffer_load_dwordx4 v30, s[32:35], s50 offen offset:1024 lds
    v_mul_f32 v232, s95, v232
    v_mul_f32 v233, s95, v233
    v_mul_f32 v234, s95, v234
    v_mul_f32 v235, s95, v235
    v_mfma_f32_16x16x32_bf16 v[148:151], v[76:79], v[44:47], v[148:151]
    ds_read_b64_tr_b16 v[70:71], v18 offset:4608
    s_add_u32 s50, s50, 0x1c00
    buffer_load_dwordx4 v0, s[32:35], s50 offen offset:2048 lds
    v_mul_f32 v236, s95, v236
    v_mul_f32 v237, s95, v237
    v_mul_f32 v238, s95, v238
    v_mul_f32 v239, s95, v239
    v_mfma_f32_16x16x32_bf16 v[152:155], v[72:75], v[48:51], 0
    v_cvt_pk_bf16_f32 v224, v224, v225
    v_cvt_pk_bf16_f32 v225, v226, v227
    v_cvt_pk_bf16_f32 v226, v228, v229
    v_cvt_pk_bf16_f32 v227, v230, v231
    v_mfma_f32_16x16x32_bf16 v[152:155], v[76:79], v[52:55], v[152:155]
    s_add_u32 s50, s50, 0x1c00
    buffer_load_dwordx4 v30, s[32:35], s50 offen offset:3072 lds
    v_cvt_pk_bf16_f32 v228, v232, v233
    v_cvt_pk_bf16_f32 v229, v234, v235
    v_cvt_pk_bf16_f32 v230, v236, v237
    v_cvt_pk_bf16_f32 v231, v238, v239
    v_mfma_f32_16x16x32_bf16 v[156:159], v[72:75], v[56:59], 0
    v_cvt_pk_bf16_f32 v232, v160, v161
    v_cvt_pk_bf16_f32 v233, v162, v163
    v_cvt_pk_bf16_f32 v234, v164, v165
    v_cvt_pk_bf16_f32 v235, v166, v167
    v_mfma_f32_16x16x32_bf16 v[156:159], v[76:79], v[60:63], v[156:159]
    v_cvt_pk_bf16_f32 v236, v168, v169
    v_cvt_pk_bf16_f32 v237, v170, v171
    v_cvt_pk_bf16_f32 v238, v172, v173
    v_cvt_pk_bf16_f32 v239, v174, v175
    s_waitcnt vmcnt(8) lgkmcnt(0)
    s_barrier
    ds_read_b64_tr_b16 v[72:73], v16 offset:32768
    ds_read_b64_tr_b16 v[74:75], v16 offset:33280
    v_mfma_f32_16x16x32_bf16 v[160:163], v[32:35], v[64:67], 0
    ds_read_b64_tr_b16 v[76:77], v16 offset:36864
    ds_read_b64_tr_b16 v[78:79], v16 offset:37376
    s_add_u32 m0, s47, 98304
    s_add_u32 s50, s39, 2
    s_and_b32 s50, s50, 7
    s_mul_i32 s50, s50, 524288
    s_add_u32 s50, s50, s45
    buffer_load_dwordx4 v4, s[12:15], s50 offen offset:0 lds
    v_cvt_pk_bf16_f32 v240, v240, v241
    v_cvt_pk_bf16_f32 v241, v242, v243
    v_mfma_f32_16x16x32_bf16 v[160:163], v[36:39], v[68:71], v[160:163]
    ds_read_b128 v[32:35], v12 offset:0
    buffer_load_dwordx4 v5, s[12:15], s50 offen offset:1024 lds
    v_cvt_pk_bf16_f32 v242, v244, v245
    v_cvt_pk_bf16_f32 v243, v246, v247
    v_mfma_f32_16x16x32_bf16 v[164:167], v[40:43], v[64:67], 0
    ds_read_b128 v[36:39], v13 offset:0
    v_cvt_pk_bf16_f32 v244, v248, v249
    v_cvt_pk_bf16_f32 v245, v250, v251
    v_mfma_f32_16x16x32_bf16 v[164:167], v[44:47], v[68:71], v[164:167]
    ds_read_b128 v[40:43], v12 offset:2048
    buffer_load_dwordx4 v6, s[12:15], s50 offen offset:2048 lds
    v_cvt_pk_bf16_f32 v246, v252, v253
    v_cvt_pk_bf16_f32 v247, v254, v255
    v_mfma_f32_16x16x32_bf16 v[168:171], v[48:51], v[64:67], 0
    ds_read_b128 v[44:47], v13 offset:2048
    buffer_load_dwordx4 v7, s[12:15], s50 offen offset:3072 lds
    v_cvt_pk_bf16_f32 v248, v176, v177
    v_cvt_pk_bf16_f32 v249, v178, v179
    v_mfma_f32_16x16x32_bf16 v[168:171], v[52:55], v[68:71], v[168:171]
    ds_read_b128 v[48:51], v12 offset:16384
    v_cvt_pk_bf16_f32 v250, v180, v181
    v_cvt_pk_bf16_f32 v251, v182, v183
    v_mfma_f32_16x16x32_bf16 v[172:175], v[56:59], v[64:67], 0
    ds_read_b128 v[52:55], v13 offset:16384
    ds_write_b128 v23, v[88:91] offset:0
    v_cvt_pk_bf16_f32 v252, v184, v185
    v_cvt_pk_bf16_f32 v253, v186, v187
    v_mfma_f32_16x16x32_bf16 v[172:175], v[60:63], v[68:71], v[172:175]
    ds_read_b128 v[56:59], v12 offset:18432
    ds_read_b128 v[60:63], v13 offset:18432
    v_cvt_pk_bf16_f32 v254, v188, v189
    v_cvt_pk_bf16_f32 v255, v190, v191
    s_waitcnt lgkmcnt(8)
    v_mfma_f32_16x16x32_bf16 v[128:131], v[72:75], v[32:35], v[128:131]
    ds_read_b64_tr_b16 v[64:65], v17 offset:32768
    ds_write_b128 v23, v[92:95] offset:1024
    s_waitcnt lgkmcnt(9)
    v_mfma_f32_16x16x32_bf16 v[128:131], v[76:79], v[36:39], v[128:131]
    ds_read_b64_tr_b16 v[66:67], v17 offset:33280
    s_add_u32 m0, s63, 65536
    s_add_u32 s50, s39, 3
    s_and_b32 s50, s50, 7
    s_mul_i32 s50, s50, 128
    s_add_u32 s50, s50, s38
    buffer_load_dwordx4 v0, s[32:35], s50 offen offset:0 lds
    s_waitcnt lgkmcnt(9)
    v_mfma_f32_16x16x32_bf16 v[132:135], v[72:75], v[40:43], v[132:135]
    ds_read_b64_tr_b16 v[68:69], v17 offset:36864
    s_waitcnt lgkmcnt(9)
    v_mfma_f32_16x16x32_bf16 v[132:135], v[76:79], v[44:47], v[132:135]
    ds_read_b64_tr_b16 v[70:71], v17 offset:37376
    s_add_u32 s50, s50, 0x1c00
    buffer_load_dwordx4 v30, s[32:35], s50 offen offset:1024 lds
    s_waitcnt lgkmcnt(9)
    v_mfma_f32_16x16x32_bf16 v[136:139], v[72:75], v[48:51], v[136:139]
    s_waitcnt lgkmcnt(8)
    v_mfma_f32_16x16x32_bf16 v[136:139], v[76:79], v[52:55], v[136:139]
    s_add_u32 s50, s50, 0x1c00
    buffer_load_dwordx4 v0, s[32:35], s50 offen offset:2048 lds
    s_waitcnt lgkmcnt(6)
    v_mfma_f32_16x16x32_bf16 v[140:143], v[72:75], v[56:59], v[140:143]
    s_add_u32 s50, s50, 0x1c00
    buffer_load_dwordx4 v30, s[32:35], s50 offen offset:3072 lds
    s_waitcnt lgkmcnt(5)
    v_mfma_f32_16x16x32_bf16 v[140:143], v[76:79], v[60:63], v[140:143]
    s_waitcnt lgkmcnt(2)
    v_mfma_f32_16x16x32_bf16 v[144:147], v[64:67], v[32:35], v[144:147]
    ds_read_b64_tr_b16 v[72:73], v18 offset:32768
    s_add_u32 m0, s63, 69632
    s_add_u32 s50, s50, s90
    buffer_load_dwordx4 v0, s[32:35], s50 offen offset:0 lds
    s_waitcnt lgkmcnt(1)
    v_mfma_f32_16x16x32_bf16 v[144:147], v[68:71], v[36:39], v[144:147]
    ds_read_b64_tr_b16 v[74:75], v18 offset:33280
    v_mfma_f32_16x16x32_bf16 v[148:151], v[64:67], v[40:43], v[148:151]
    ds_read_b64_tr_b16 v[76:77], v18 offset:36864
    s_add_u32 s50, s50, 0x1c00
    buffer_load_dwordx4 v30, s[32:35], s50 offen offset:1024 lds
    v_mfma_f32_16x16x32_bf16 v[148:151], v[68:71], v[44:47], v[148:151]
    ds_read_b64_tr_b16 v[78:79], v18 offset:37376
    s_add_u32 s50, s50, 0x1c00
    buffer_load_dwordx4 v0, s[32:35], s50 offen offset:2048 lds
    v_mfma_f32_16x16x32_bf16 v[152:155], v[64:67], v[48:51], v[152:155]
    v_mfma_f32_16x16x32_bf16 v[152:155], v[68:71], v[52:55], v[152:155]
    s_add_u32 s50, s50, 0x1c00
    buffer_load_dwordx4 v30, s[32:35], s50 offen offset:3072 lds
    v_mfma_f32_16x16x32_bf16 v[156:159], v[64:67], v[56:59], v[156:159]
    v_mfma_f32_16x16x32_bf16 v[156:159], v[68:71], v[60:63], v[156:159]
    s_waitcnt vmcnt(8) lgkmcnt(0)
    s_barrier
    ds_read_b64_tr_b16 v[64:65], v16 offset:0
    ds_read_b64_tr_b16 v[66:67], v16 offset:512
    v_mfma_f32_16x16x32_bf16 v[160:163], v[32:35], v[72:75], v[160:163]
    ds_read_b64_tr_b16 v[68:69], v16 offset:4096
    ds_read_b64_tr_b16 v[70:71], v16 offset:4608
    s_add_u32 m0, s47, 131072
    s_add_u32 s50, s39, 3
    s_and_b32 s50, s50, 7
    s_mul_i32 s50, s50, 524288
    s_add_u32 s50, s50, s45
    buffer_load_dwordx4 v4, s[12:15], s50 offen offset:0 lds
    v_mfma_f32_16x16x32_bf16 v[160:163], v[36:39], v[76:79], v[160:163]
    ds_read_b128 v[32:35], v12 offset:32768
    buffer_load_dwordx4 v5, s[12:15], s50 offen offset:1024 lds
    v_mfma_f32_16x16x32_bf16 v[164:167], v[40:43], v[72:75], v[164:167]
    ds_read_b128 v[36:39], v13 offset:32768
    v_mfma_f32_16x16x32_bf16 v[164:167], v[44:47], v[76:79], v[164:167]
    ds_read_b128 v[40:43], v12 offset:34816
    buffer_load_dwordx4 v6, s[12:15], s50 offen offset:2048 lds
    v_mfma_f32_16x16x32_bf16 v[168:171], v[48:51], v[72:75], v[168:171]
    ds_read_b128 v[44:47], v13 offset:34816
    buffer_load_dwordx4 v7, s[12:15], s50 offen offset:3072 lds
    v_mfma_f32_16x16x32_bf16 v[168:171], v[52:55], v[76:79], v[168:171]
    ds_read_b128 v[48:51], v12 offset:49152
    v_mfma_f32_16x16x32_bf16 v[172:175], v[56:59], v[72:75], v[172:175]
    ds_read_b128 v[52:55], v13 offset:49152
    ds_write_b128 v23, v[96:99] offset:32768
    v_mfma_f32_16x16x32_bf16 v[172:175], v[60:63], v[76:79], v[172:175]
    ds_read_b128 v[56:59], v12 offset:51200
    ds_read_b128 v[60:63], v13 offset:51200
    s_waitcnt lgkmcnt(8)
    v_mfma_f32_16x16x32_bf16 v[128:131], v[64:67], v[32:35], v[128:131]
    ds_read_b64_tr_b16 v[72:73], v17 offset:0
    ds_write_b128 v23, v[100:103] offset:33792
    s_waitcnt lgkmcnt(9)
    v_mfma_f32_16x16x32_bf16 v[128:131], v[68:71], v[36:39], v[128:131]
    ds_read_b64_tr_b16 v[74:75], v17 offset:512
    s_add_u32 m0, s63, 0
    s_add_u32 s50, s39, 4
    s_and_b32 s50, s50, 7
    s_mul_i32 s50, s50, 128
    s_add_u32 s50, s50, s38
    buffer_load_dwordx4 v0, s[32:35], s50 offen offset:0 lds
    s_waitcnt lgkmcnt(9)
    v_mfma_f32_16x16x32_bf16 v[132:135], v[64:67], v[40:43], v[132:135]
    ds_read_b64_tr_b16 v[76:77], v17 offset:4096
    s_waitcnt lgkmcnt(9)
    v_mfma_f32_16x16x32_bf16 v[132:135], v[68:71], v[44:47], v[132:135]
    ds_read_b64_tr_b16 v[78:79], v17 offset:4608
    s_add_u32 s50, s50, 0x1c00
    buffer_load_dwordx4 v30, s[32:35], s50 offen offset:1024 lds
    s_waitcnt lgkmcnt(9)
    v_mfma_f32_16x16x32_bf16 v[136:139], v[64:67], v[48:51], v[136:139]
    s_waitcnt lgkmcnt(8)
    v_mfma_f32_16x16x32_bf16 v[136:139], v[68:71], v[52:55], v[136:139]
    s_add_u32 s50, s50, 0x1c00
    buffer_load_dwordx4 v0, s[32:35], s50 offen offset:2048 lds
    s_waitcnt lgkmcnt(6)
    v_mfma_f32_16x16x32_bf16 v[140:143], v[64:67], v[56:59], v[140:143]
    s_add_u32 s50, s50, 0x1c00
    buffer_load_dwordx4 v30, s[32:35], s50 offen offset:3072 lds
    s_waitcnt lgkmcnt(5)
    v_mfma_f32_16x16x32_bf16 v[140:143], v[68:71], v[60:63], v[140:143]
    s_waitcnt lgkmcnt(2)
    v_mfma_f32_16x16x32_bf16 v[144:147], v[72:75], v[32:35], v[144:147]
    ds_read_b64_tr_b16 v[64:65], v18 offset:0
    s_add_u32 m0, s63, 4096
    s_add_u32 s50, s50, s90
    buffer_load_dwordx4 v0, s[32:35], s50 offen offset:0 lds
    s_waitcnt lgkmcnt(1)
    v_mfma_f32_16x16x32_bf16 v[144:147], v[76:79], v[36:39], v[144:147]
    ds_read_b64_tr_b16 v[66:67], v18 offset:512
    v_mfma_f32_16x16x32_bf16 v[148:151], v[72:75], v[40:43], v[148:151]
    ds_read_b64_tr_b16 v[68:69], v18 offset:4096
    s_add_u32 s50, s50, 0x1c00
    buffer_load_dwordx4 v30, s[32:35], s50 offen offset:1024 lds
    v_mfma_f32_16x16x32_bf16 v[148:151], v[76:79], v[44:47], v[148:151]
    ds_read_b64_tr_b16 v[70:71], v18 offset:4608
    s_add_u32 s50, s50, 0x1c00
    buffer_load_dwordx4 v0, s[32:35], s50 offen offset:2048 lds
    v_mfma_f32_16x16x32_bf16 v[152:155], v[72:75], v[48:51], v[152:155]
    v_mfma_f32_16x16x32_bf16 v[152:155], v[76:79], v[52:55], v[152:155]
    s_add_u32 s50, s50, 0x1c00
    buffer_load_dwordx4 v30, s[32:35], s50 offen offset:3072 lds
    v_mfma_f32_16x16x32_bf16 v[156:159], v[72:75], v[56:59], v[156:159]
    v_mfma_f32_16x16x32_bf16 v[156:159], v[76:79], v[60:63], v[156:159]
    s_lshl_b32 s52, s43, 8
    s_add_u32 s52, s52, 156672
    v_lshlrev_b32 v28, 2, v1
    v_add_u32 v28, s52, v28
    v_mov_b32 v29, 0
    ds_write_b32 v28, v29
    s_waitcnt vmcnt(8) lgkmcnt(0)
    s_barrier
    ds_read_b64_tr_b16 v[72:73], v16 offset:32768
    ds_read_b64_tr_b16 v[74:75], v16 offset:33280
    v_mfma_f32_16x16x32_bf16 v[160:163], v[32:35], v[64:67], v[160:163]
    ds_read_b64_tr_b16 v[76:77], v16 offset:36864
    ds_read_b64_tr_b16 v[78:79], v16 offset:37376
    s_add_u32 m0, s47, 98304
    s_add_u32 s50, s39, 4
    s_and_b32 s50, s50, 7
    s_mul_i32 s50, s50, 524288
    s_add_u32 s50, s50, s45
    buffer_load_dwordx4 v4, s[12:15], s50 offen offset:0 lds
    v_mfma_f32_16x16x32_bf16 v[160:163], v[36:39], v[68:71], v[160:163]
    ds_read_b128 v[32:35], v14 offset:0
    buffer_load_dwordx4 v5, s[12:15], s50 offen offset:1024 lds
    v_mfma_f32_16x16x32_bf16 v[164:167], v[40:43], v[64:67], v[164:167]
    ds_read_b128 v[36:39], v15 offset:0
    v_mfma_f32_16x16x32_bf16 v[164:167], v[44:47], v[68:71], v[164:167]
    ds_read_b128 v[40:43], v14 offset:2048
    buffer_load_dwordx4 v6, s[12:15], s50 offen offset:2048 lds
    v_mfma_f32_16x16x32_bf16 v[168:171], v[48:51], v[64:67], v[168:171]
    ds_read_b128 v[44:47], v15 offset:2048
    buffer_load_dwordx4 v7, s[12:15], s50 offen offset:3072 lds
    v_mfma_f32_16x16x32_bf16 v[168:171], v[52:55], v[68:71], v[168:171]
    ds_read_b128 v[48:51], v14 offset:16384
    v_mfma_f32_16x16x32_bf16 v[172:175], v[56:59], v[64:67], v[172:175]
    ds_read_b128 v[52:55], v15 offset:16384
    ds_write_b128 v23, v[104:107] offset:0
    v_mfma_f32_16x16x32_bf16 v[172:175], v[60:63], v[68:71], v[172:175]
    ds_read_b128 v[56:59], v14 offset:18432
    ds_read_b128 v[60:63], v15 offset:18432
    s_waitcnt lgkmcnt(8)
    v_mfma_f32_16x16x32_bf16 v[128:131], v[72:75], v[32:35], v[128:131]
    ds_read_b64_tr_b16 v[64:65], v17 offset:32768
    ds_write_b128 v23, v[108:111] offset:1024
    s_waitcnt lgkmcnt(9)
    v_mfma_f32_16x16x32_bf16 v[128:131], v[76:79], v[36:39], v[128:131]
    ds_read_b64_tr_b16 v[66:67], v17 offset:33280
    s_add_u32 m0, s63, 32768
    s_add_u32 s50, s39, 5
    s_and_b32 s50, s50, 7
    s_mul_i32 s50, s50, 128
    s_add_u32 s50, s50, s38
    buffer_load_dwordx4 v0, s[32:35], s50 offen offset:0 lds
    s_waitcnt lgkmcnt(9)
    v_mfma_f32_16x16x32_bf16 v[132:135], v[72:75], v[40:43], v[132:135]
    ds_read_b64_tr_b16 v[68:69], v17 offset:36864
    s_waitcnt lgkmcnt(9)
    v_mfma_f32_16x16x32_bf16 v[132:135], v[76:79], v[44:47], v[132:135]
    ds_read_b64_tr_b16 v[70:71], v17 offset:37376
    s_add_u32 s50, s50, 0x1c00
    buffer_load_dwordx4 v30, s[32:35], s50 offen offset:1024 lds
    s_waitcnt lgkmcnt(9)
    v_mfma_f32_16x16x32_bf16 v[136:139], v[72:75], v[48:51], v[136:139]
    s_waitcnt lgkmcnt(8)
    v_mfma_f32_16x16x32_bf16 v[136:139], v[76:79], v[52:55], v[136:139]
    s_add_u32 s50, s50, 0x1c00
    buffer_load_dwordx4 v0, s[32:35], s50 offen offset:2048 lds
    s_waitcnt lgkmcnt(6)
    v_mfma_f32_16x16x32_bf16 v[140:143], v[72:75], v[56:59], v[140:143]
    s_add_u32 s50, s50, 0x1c00
    buffer_load_dwordx4 v30, s[32:35], s50 offen offset:3072 lds
    s_waitcnt lgkmcnt(5)
    v_mfma_f32_16x16x32_bf16 v[140:143], v[76:79], v[60:63], v[140:143]
    s_waitcnt lgkmcnt(2)
    v_mfma_f32_16x16x32_bf16 v[144:147], v[64:67], v[32:35], v[144:147]
    ds_read_b64_tr_b16 v[72:73], v18 offset:32768
    s_add_u32 m0, s63, 36864
    s_add_u32 s50, s50, s90
    buffer_load_dwordx4 v0, s[32:35], s50 offen offset:0 lds
    s_waitcnt lgkmcnt(1)
    v_mfma_f32_16x16x32_bf16 v[144:147], v[68:71], v[36:39], v[144:147]
    ds_read_b64_tr_b16 v[74:75], v18 offset:33280
    v_mfma_f32_16x16x32_bf16 v[148:151], v[64:67], v[40:43], v[148:151]
    ds_read_b64_tr_b16 v[76:77], v18 offset:36864
    s_add_u32 s50, s50, 0x1c00
    buffer_load_dwordx4 v30, s[32:35], s50 offen offset:1024 lds
    v_mfma_f32_16x16x32_bf16 v[148:151], v[68:71], v[44:47], v[148:151]
    ds_read_b64_tr_b16 v[78:79], v18 offset:37376
    s_add_u32 s50, s50, 0x1c00
    buffer_load_dwordx4 v0, s[32:35], s50 offen offset:2048 lds
    v_mfma_f32_16x16x32_bf16 v[152:155], v[64:67], v[48:51], v[152:155]
    v_mfma_f32_16x16x32_bf16 v[152:155], v[68:71], v[52:55], v[152:155]
    s_add_u32 s50, s50, 0x1c00
    buffer_load_dwordx4 v30, s[32:35], s50 offen offset:3072 lds
    v_mfma_f32_16x16x32_bf16 v[156:159], v[64:67], v[56:59], v[156:159]
    v_mfma_f32_16x16x32_bf16 v[156:159], v[68:71], v[60:63], v[156:159]
    s_mov_b32 s28, s82
    s_and_b32 s29, s83, 0xffff
    s_mov_b32 s30, 0x400
    s_mov_b32 s31, 0x20000
    s_lshl_b32 s52, s40, 3
    s_add_u32 s52, s52, s41
    s_lshl_b32 s52, s52, 2
    s_add_u32 s52, s52, s43
    s_lshl_b32 s52, s52, 11
    buffer_load_dwordx4 v[80:83], v2, s[32:35], s52 offen
    buffer_load_dwordx4 v[84:87], v2, s[32:35], s52 offen offset:1024
    buffer_load_dwordx4 v[88:91], v2, s[28:31], 0 offen
    s_waitcnt vmcnt(11) lgkmcnt(0)
    s_barrier
    ds_read_b64_tr_b16 v[64:65], v16 offset:0
    ds_read_b64_tr_b16 v[66:67], v16 offset:512
    v_mfma_f32_16x16x32_bf16 v[160:163], v[32:35], v[72:75], v[160:163]
    ds_read_b64_tr_b16 v[68:69], v16 offset:4096
    ds_read_b64_tr_b16 v[70:71], v16 offset:4608
    s_add_u32 m0, s47, 131072
    s_add_u32 s50, s39, 5
    s_and_b32 s50, s50, 7
    s_mul_i32 s50, s50, 524288
    s_add_u32 s50, s50, s45
    buffer_load_dwordx4 v4, s[12:15], s50 offen offset:0 lds
    v_mfma_f32_16x16x32_bf16 v[160:163], v[36:39], v[76:79], v[160:163]
    ds_read_b128 v[32:35], v12 offset:0
    buffer_load_dwordx4 v5, s[12:15], s50 offen offset:1024 lds
    v_mfma_f32_16x16x32_bf16 v[164:167], v[40:43], v[72:75], v[164:167]
    ds_read_b128 v[36:39], v13 offset:0
    v_mfma_f32_16x16x32_bf16 v[164:167], v[44:47], v[76:79], v[164:167]
    ds_read_b128 v[40:43], v12 offset:2048
    buffer_load_dwordx4 v6, s[12:15], s50 offen offset:2048 lds
    v_mfma_f32_16x16x32_bf16 v[168:171], v[48:51], v[72:75], v[168:171]
    ds_read_b128 v[44:47], v13 offset:2048
    buffer_load_dwordx4 v7, s[12:15], s50 offen offset:3072 lds
    v_mfma_f32_16x16x32_bf16 v[168:171], v[52:55], v[76:79], v[168:171]
    ds_read_b128 v[48:51], v12 offset:16384
    v_mfma_f32_16x16x32_bf16 v[172:175], v[56:59], v[72:75], v[172:175]
    ds_read_b128 v[52:55], v13 offset:16384
    ds_write_b128 v23, v[112:115] offset:32768
    v_mfma_f32_16x16x32_bf16 v[172:175], v[60:63], v[76:79], v[172:175]
    ds_read_b128 v[56:59], v12 offset:18432
    ds_read_b128 v[60:63], v13 offset:18432
    s_waitcnt lgkmcnt(8)
    v_mfma_f32_16x16x32_bf16 v[128:131], v[64:67], v[32:35], v[128:131]
    ds_read_b64_tr_b16 v[72:73], v17 offset:0
    ds_write_b128 v23, v[116:119] offset:33792
    s_waitcnt lgkmcnt(9)
    v_mfma_f32_16x16x32_bf16 v[128:131], v[68:71], v[36:39], v[128:131]
    ds_read_b64_tr_b16 v[74:75], v17 offset:512
    s_add_u32 m0, s63, 65536
    s_add_u32 s50, s39, 6
    s_and_b32 s50, s50, 7
    s_mul_i32 s50, s50, 128
    s_add_u32 s50, s50, s38
    buffer_load_dwordx4 v0, s[32:35], s50 offen offset:0 lds
    s_waitcnt lgkmcnt(9)
    v_mfma_f32_16x16x32_bf16 v[132:135], v[64:67], v[40:43], v[132:135]
    ds_read_b64_tr_b16 v[76:77], v17 offset:4096
    s_waitcnt lgkmcnt(9)
    v_mfma_f32_16x16x32_bf16 v[132:135], v[68:71], v[44:47], v[132:135]
    ds_read_b64_tr_b16 v[78:79], v17 offset:4608
    s_add_u32 s50, s50, 0x1c00
    buffer_load_dwordx4 v30, s[32:35], s50 offen offset:1024 lds
    s_waitcnt lgkmcnt(9)
    v_mfma_f32_16x16x32_bf16 v[136:139], v[64:67], v[48:51], v[136:139]
    s_waitcnt lgkmcnt(8)
    v_mfma_f32_16x16x32_bf16 v[136:139], v[68:71], v[52:55], v[136:139]
    s_add_u32 s50, s50, 0x1c00
    buffer_load_dwordx4 v0, s[32:35], s50 offen offset:2048 lds
    s_waitcnt lgkmcnt(6)
    v_mfma_f32_16x16x32_bf16 v[140:143], v[64:67], v[56:59], v[140:143]
    s_add_u32 s50, s50, 0x1c00
    buffer_load_dwordx4 v30, s[32:35], s50 offen offset:3072 lds
    s_waitcnt lgkmcnt(5)
    v_mfma_f32_16x16x32_bf16 v[140:143], v[68:71], v[60:63], v[140:143]
    s_waitcnt lgkmcnt(2)
    v_mfma_f32_16x16x32_bf16 v[144:147], v[72:75], v[32:35], v[144:147]
    ds_read_b64_tr_b16 v[64:65], v18 offset:0
    s_add_u32 m0, s63, 69632
    s_add_u32 s50, s50, s90
    buffer_load_dwordx4 v0, s[32:35], s50 offen offset:0 lds
    s_waitcnt lgkmcnt(1)
    v_mfma_f32_16x16x32_bf16 v[144:147], v[76:79], v[36:39], v[144:147]
    ds_read_b64_tr_b16 v[66:67], v18 offset:512
    v_mfma_f32_16x16x32_bf16 v[148:151], v[72:75], v[40:43], v[148:151]
    ds_read_b64_tr_b16 v[68:69], v18 offset:4096
    s_add_u32 s50, s50, 0x1c00
    buffer_load_dwordx4 v30, s[32:35], s50 offen offset:1024 lds
    v_mfma_f32_16x16x32_bf16 v[148:151], v[76:79], v[44:47], v[148:151]
    ds_read_b64_tr_b16 v[70:71], v18 offset:4608
    s_add_u32 s50, s50, 0x1c00
    buffer_load_dwordx4 v0, s[32:35], s50 offen offset:2048 lds
    v_mfma_f32_16x16x32_bf16 v[152:155], v[72:75], v[48:51], v[152:155]
    v_mfma_f32_16x16x32_bf16 v[152:155], v[76:79], v[52:55], v[152:155]
    s_add_u32 s50, s50, 0x1c00
    buffer_load_dwordx4 v30, s[32:35], s50 offen offset:3072 lds
    v_mfma_f32_16x16x32_bf16 v[156:159], v[72:75], v[56:59], v[156:159]
    v_mfma_f32_16x16x32_bf16 v[156:159], v[76:79], v[60:63], v[156:159]
    s_waitcnt vmcnt(8) lgkmcnt(0)
    s_barrier
    ds_read_b64_tr_b16 v[72:73], v16 offset:32768
    ds_read_b64_tr_b16 v[74:75], v16 offset:33280
    v_mfma_f32_16x16x32_bf16 v[160:163], v[32:35], v[64:67], v[160:163]
    ds_read_b64_tr_b16 v[76:77], v16 offset:36864
    ds_read_b64_tr_b16 v[78:79], v16 offset:37376
    s_add_u32 m0, s47, 98304
    s_add_u32 s50, s39, 6
    s_and_b32 s50, s50, 7
    s_mul_i32 s50, s50, 524288
    s_add_u32 s50, s50, s45
    buffer_load_dwordx4 v4, s[12:15], s50 offen offset:0 lds
    v_mfma_f32_16x16x32_bf16 v[160:163], v[36:39], v[68:71], v[160:163]
    ds_read_b128 v[32:35], v12 offset:32768
    buffer_load_dwordx4 v5, s[12:15], s50 offen offset:1024 lds
    v_mfma_f32_16x16x32_bf16 v[164:167], v[40:43], v[64:67], v[164:167]
    ds_read_b128 v[36:39], v13 offset:32768
    v_mfma_f32_16x16x32_bf16 v[164:167], v[44:47], v[68:71], v[164:167]
    ds_read_b128 v[40:43], v12 offset:34816
    buffer_load_dwordx4 v6, s[12:15], s50 offen offset:2048 lds
    v_mfma_f32_16x16x32_bf16 v[168:171], v[48:51], v[64:67], v[168:171]
    ds_read_b128 v[44:47], v13 offset:34816
    buffer_load_dwordx4 v7, s[12:15], s50 offen offset:3072 lds
    v_mfma_f32_16x16x32_bf16 v[168:171], v[52:55], v[68:71], v[168:171]
    ds_read_b128 v[48:51], v12 offset:49152
    v_mfma_f32_16x16x32_bf16 v[172:175], v[56:59], v[64:67], v[172:175]
    ds_read_b128 v[52:55], v13 offset:49152
    ds_write_b128 v23, v[120:123] offset:0
    v_mfma_f32_16x16x32_bf16 v[172:175], v[60:63], v[68:71], v[172:175]
    ds_read_b128 v[56:59], v12 offset:51200
    ds_read_b128 v[60:63], v13 offset:51200
    s_waitcnt lgkmcnt(8)
    v_mfma_f32_16x16x32_bf16 v[128:131], v[72:75], v[32:35], v[128:131]
    ds_read_b64_tr_b16 v[64:65], v17 offset:32768
    ds_write_b128 v23, v[124:127] offset:1024
    s_waitcnt lgkmcnt(9)
    v_mfma_f32_16x16x32_bf16 v[128:131], v[76:79], v[36:39], v[128:131]
    ds_read_b64_tr_b16 v[66:67], v17 offset:33280
    s_add_u32 m0, s63, 0
    s_add_u32 s50, s39, 7
    s_and_b32 s50, s50, 7
    s_mul_i32 s50, s50, 128
    s_add_u32 s50, s50, s38
    buffer_load_dwordx4 v0, s[32:35], s50 offen offset:0 lds
    s_waitcnt lgkmcnt(9)
    v_mfma_f32_16x16x32_bf16 v[132:135], v[72:75], v[40:43], v[132:135]
    ds_read_b64_tr_b16 v[68:69], v17 offset:36864
    s_waitcnt lgkmcnt(9)
    v_mfma_f32_16x16x32_bf16 v[132:135], v[76:79], v[44:47], v[132:135]
    ds_read_b64_tr_b16 v[70:71], v17 offset:37376
    s_add_u32 s50, s50, 0x1c00
    buffer_load_dwordx4 v30, s[32:35], s50 offen offset:1024 lds
    s_waitcnt lgkmcnt(9)
    v_mfma_f32_16x16x32_bf16 v[136:139], v[72:75], v[48:51], v[136:139]
    s_waitcnt lgkmcnt(8)
    v_mfma_f32_16x16x32_bf16 v[136:139], v[76:79], v[52:55], v[136:139]
    s_add_u32 s50, s50, 0x1c00
    buffer_load_dwordx4 v0, s[32:35], s50 offen offset:2048 lds
    s_waitcnt lgkmcnt(6)
    v_mfma_f32_16x16x32_bf16 v[140:143], v[72:75], v[56:59], v[140:143]
    s_add_u32 s50, s50, 0x1c00
    buffer_load_dwordx4 v30, s[32:35], s50 offen offset:3072 lds
    s_waitcnt lgkmcnt(5)
    v_mfma_f32_16x16x32_bf16 v[140:143], v[76:79], v[60:63], v[140:143]
    s_waitcnt lgkmcnt(2)
    v_mfma_f32_16x16x32_bf16 v[144:147], v[64:67], v[32:35], v[144:147]
    ds_read_b64_tr_b16 v[72:73], v18 offset:32768
    s_add_u32 m0, s63, 4096
    s_add_u32 s50, s50, s90
    buffer_load_dwordx4 v0, s[32:35], s50 offen offset:0 lds
    s_waitcnt lgkmcnt(1)
    v_mfma_f32_16x16x32_bf16 v[144:147], v[68:71], v[36:39], v[144:147]
    ds_read_b64_tr_b16 v[74:75], v18 offset:33280
    v_mfma_f32_16x16x32_bf16 v[148:151], v[64:67], v[40:43], v[148:151]
    ds_read_b64_tr_b16 v[76:77], v18 offset:36864
    s_add_u32 s50, s50, 0x1c00
    buffer_load_dwordx4 v30, s[32:35], s50 offen offset:1024 lds
    v_mfma_f32_16x16x32_bf16 v[148:151], v[68:71], v[44:47], v[148:151]
    ds_read_b64_tr_b16 v[78:79], v18 offset:37376
    s_add_u32 s50, s50, 0x1c00
    buffer_load_dwordx4 v0, s[32:35], s50 offen offset:2048 lds
    v_mfma_f32_16x16x32_bf16 v[152:155], v[64:67], v[48:51], v[152:155]
    v_mfma_f32_16x16x32_bf16 v[152:155], v[68:71], v[52:55], v[152:155]
    s_add_u32 s50, s50, 0x1c00
    buffer_load_dwordx4 v30, s[32:35], s50 offen offset:3072 lds
    v_mfma_f32_16x16x32_bf16 v[156:159], v[64:67], v[56:59], v[156:159]
    v_mfma_f32_16x16x32_bf16 v[156:159], v[68:71], v[60:63], v[156:159]
    v_lshlrev_b32 v94, 16, v88
    v_and_b32 v95, 0xffff0000, v88
    v_lshlrev_b32 v96, 16, v80
    v_and_b32 v97, 0xffff0000, v80
    v_mul_f32 v92, v94, v96
    v_fmac_f32 v92, v95, v97
    v_lshlrev_b32 v96, 16, v84
    v_and_b32 v97, 0xffff0000, v84
    v_mul_f32 v93, v94, v96
    v_fmac_f32 v93, v95, v97
    v_lshlrev_b32 v94, 16, v89
    v_and_b32 v95, 0xffff0000, v89
    v_lshlrev_b32 v96, 16, v81
    v_and_b32 v97, 0xffff0000, v81
    v_fmac_f32 v92, v94, v96
    v_fmac_f32 v92, v95, v97
    v_lshlrev_b32 v96, 16, v85
    v_and_b32 v97, 0xffff0000, v85
    v_fmac_f32 v93, v94, v96
    v_fmac_f32 v93, v95, v97
    v_lshlrev_b32 v94, 16, v90
    v_and_b32 v95, 0xffff0000, v90
    v_lshlrev_b32 v96, 16, v82
    v_and_b32 v97, 0xffff0000, v82
    v_fmac_f32 v92, v94, v96
    v_fmac_f32 v92, v95, v97
    v_lshlrev_b32 v96, 16, v86
    v_and_b32 v97, 0xffff0000, v86
    v_fmac_f32 v93, v94, v96
    v_fmac_f32 v93, v95, v97
    v_lshlrev_b32 v94, 16, v91
    v_and_b32 v95, 0xffff0000, v91
    v_lshlrev_b32 v96, 16, v83
    v_and_b32 v97, 0xffff0000, v83
    v_fmac_f32 v92, v94, v96
    v_fmac_f32 v92, v95, v97
    v_lshlrev_b32 v96, 16, v87
    v_and_b32 v97, 0xffff0000, v87
    v_fmac_f32 v93, v94, v96
    v_fmac_f32 v93, v95, v97
    s_nop 1
    v_add_f32_dpp v92, v92, v92 row_shr:1
    v_add_f32_dpp v93, v93, v93 row_shr:1
    s_nop 0
    v_add_f32_dpp v92, v92, v92 row_shr:2
    v_add_f32_dpp v93, v93, v93 row_shr:2
    s_nop 0
    v_add_f32_dpp v92, v92, v92 row_shr:4
    v_add_f32_dpp v93, v93, v93 row_shr:4
    s_nop 0
    v_add_f32_dpp v92, v92, v92 row_shr:8
    v_add_f32_dpp v93, v93, v93 row_shr:8
    s_nop 0
    v_add_f32_dpp v92, v92, v92 row_bcast:15 row_mask:0xa
    v_add_f32_dpp v93, v93, v93 row_bcast:15 row_mask:0xa
    s_nop 0
    v_add_f32_dpp v92, v92, v92 row_bcast:31 row_mask:0xc
    v_add_f32_dpp v93, v93, v93 row_bcast:31 row_mask:0xc
    s_nop 0
    s_lshl_b32 s52, s40, 3
    s_add_u32 s52, s52, s41
    s_lshl_b32 s52, s52, 2
    s_add_u32 s52, s52, s43
    s_lshl_b32 s52, s52, 3
    s_add_u32 s52, s52, 69206016
    s_mov_b64 s[92:93], exec
    s_mov_b32 exec_lo, 0
    s_mov_b32 exec_hi, 0x80000000
    buffer_store_dwordx2 v[92:93], off, s[20:23], s52 sc1
    s_mov_b64 exec, s[92:93]
    v_and_b32 v24, 33, v1
    v_bfe_u32 v25, v1, 3, 1
    v_lshl_or_b32 v24, v25, 4, v24
    v_bfe_u32 v25, v1, 1, 1
    v_lshl_or_b32 v24, v25, 3, v24
    v_bfe_u32 v25, v1, 4, 1
    v_lshl_or_b32 v24, v25, 2, v24
    v_mul_u32_u24 v109, 0xaaaa, v25
    v_add_u32 v109, 0x4444, v109
    v_bfe_u32 v25, v1, 2, 1
    v_lshl_or_b32 v24, v25, 1, v24
    v_lshlrev_b32 v24, 4, v24
    s_mul_i32 s54, s40, 132352
    s_add_u32 s54, s54, 34603008
    s_lshl_b32 s52, s43, 11
    s_add_u32 s53, s52, 131072
    v_add_u32 v27, s53, v2
    v_add_u32 v26, s53, v24
    s_add_u32 s61, s54, s52
    s_add_u32 s56, s61, 131072
    s_lshl_b32 s94, s41, 14
    s_add_u32 s94, s94, s61
    s_add_u32 s62, s94, 8192
    v_and_b32 v108, 6, v1
    v_mov_b32 v105, 0x3f803f80
    v_cmp_eq_u32 vcc, 0, v108
    v_cmp_eq_u32 s[92:93], 4, v108
    v_and_b32 v108, 1, v1
    v_mul_u32_u24 v108, 0xaaaa, v108
    v_cndmask_b32 v104, 0, v105, vcc
    v_cndmask_b32 v106, 0, v105, s[92:93]
    v_add_u32 v108, 0x4444, v108
    v_mov_b32 v105, v104
    v_mov_b32 v107, v106
    v_mov_b32 v190, 0
    v_mov_b32 v191, 0
    s_waitcnt vmcnt(9) lgkmcnt(0)
    s_barrier
    ds_read_b64_tr_b16 v[64:65], v16 offset:0
    ds_read_b64_tr_b16 v[66:67], v16 offset:512
    v_mfma_f32_16x16x32_bf16 v[160:163], v[32:35], v[72:75], v[160:163]
    ds_read_b64_tr_b16 v[68:69], v16 offset:4096
    ds_read_b64_tr_b16 v[70:71], v16 offset:4608
    s_add_u32 m0, s47, 131072
    s_add_u32 s50, s39, 7
    s_and_b32 s50, s50, 7
    s_mul_i32 s50, s50, 524288
    s_add_u32 s50, s50, s45
    buffer_load_dwordx4 v4, s[12:15], s50 offen offset:0 lds
    v_mfma_f32_16x16x32_bf16 v[160:163], v[36:39], v[76:79], v[160:163]
    ds_read_b128 v[32:35], v14 offset:0
    v_mfma_f32_16x16x32_bf16 v[164:167], v[40:43], v[72:75], v[164:167]
    ds_read_b128 v[36:39], v15 offset:0
    buffer_load_dwordx4 v5, s[12:15], s50 offen offset:1024 lds
    v_mfma_f32_16x16x32_bf16 v[164:167], v[44:47], v[76:79], v[164:167]
    ds_read_b128 v[40:43], v14 offset:2048
    v_mfma_f32_16x16x32_bf16 v[168:171], v[48:51], v[72:75], v[168:171]
    ds_read_b128 v[44:47], v15 offset:2048
    v_mfma_f32_16x16x32_bf16 v[168:171], v[52:55], v[76:79], v[168:171]
    ds_read_b128 v[48:51], v14 offset:16384
    buffer_load_dwordx4 v6, s[12:15], s50 offen offset:2048 lds
    v_mfma_f32_16x16x32_bf16 v[172:175], v[56:59], v[72:75], v[172:175]
    ds_read_b128 v[52:55], v15 offset:16384
    v_mfma_f32_16x16x32_bf16 v[172:175], v[60:63], v[76:79], v[172:175]
    ds_read_b128 v[56:59], v14 offset:18432
    ds_read_b128 v[60:63], v15 offset:18432
    buffer_load_dwordx4 v7, s[12:15], s50 offen offset:3072 lds
    s_waitcnt lgkmcnt(7)
    v_mfma_f32_16x16x32_bf16 v[128:131], v[64:67], v[32:35], v[128:131]
    ds_read_b64_tr_b16 v[72:73], v17 offset:0
    s_waitcnt lgkmcnt(7)
    v_mfma_f32_16x16x32_bf16 v[128:131], v[68:71], v[36:39], v[128:131]
    ds_read_b64_tr_b16 v[74:75], v17 offset:512
    s_waitcnt lgkmcnt(7)
    v_mfma_f32_16x16x32_bf16 v[132:135], v[64:67], v[40:43], v[132:135]
    ds_read_b64_tr_b16 v[76:77], v17 offset:4096
    s_lshl_b32 s50, s43, 11
    s_add_u32 m0, s50, 147456
    s_add_u32 s50, s39, 7
    s_and_b32 s50, s50, 7
    s_mul_i32 s50, s50, 196608
    s_add_u32 s50, s50, s46
    buffer_load_dwordx4 v8, s[16:19], s50 offen offset:0 lds
    s_waitcnt lgkmcnt(7)
    v_mfma_f32_16x16x32_bf16 v[132:135], v[68:71], v[44:47], v[132:135]
    ds_read_b64_tr_b16 v[78:79], v17 offset:4608
    s_waitcnt lgkmcnt(7)
    v_mfma_f32_16x16x32_bf16 v[136:139], v[64:67], v[48:51], v[136:139]
    buffer_load_dwordx4 v9, s[16:19], s50 offen offset:1024 lds
    s_waitcnt lgkmcnt(6)
    v_mfma_f32_16x16x32_bf16 v[136:139], v[68:71], v[52:55], v[136:139]
    s_waitcnt lgkmcnt(5)
    v_mfma_f32_16x16x32_bf16 v[140:143], v[64:67], v[56:59], v[140:143]
    s_waitcnt lgkmcnt(4)
    v_mfma_f32_16x16x32_bf16 v[140:143], v[68:71], v[60:63], v[140:143]
    s_lshl_b32 s47, s43, 11
    v_lshrrev_b32 v110, 3, v1
    v_lshlrev_b32 v110, 10, v110
    v_and_b32 v111, 7, v1
    v_lshl_add_u32 v110, v111, 4, v110
    v_bfe_u32 v111, v1, 2, 2
    v_lshrrev_b32 v25, 5, v1
    v_lshl_add_u32 v111, v25, 2, v111
    v_lshlrev_b32 v111, 7, v111
    v_and_b32 v25, 3, v1
    v_lshl_add_u32 v111, v25, 4, v111
    v_bfe_u32 v25, v1, 4, 1
    v_lshl_add_u32 v111, v25, 3, v111
    v_add_u32 v111, s47, v111
    v_add_u32 v111, 147456, v111
    s_mov_b32 s12, s74
    s_and_b32 s13, s75, 0xffff
    s_mov_b32 s14, 0x400000
    s_mov_b32 s15, 0x20000
    s_mov_b32 s16, s80
    s_and_b32 s17, s81, 0xffff
    s_mov_b32 s18, 0x80000
    s_mov_b32 s19, 0x20000
    v_mov_b32 v92, 0
    v_mov_b32 v93, 0
    v_mov_b32 v94, 0
    v_mov_b32 v95, 0
    v_mov_b32 v96, 0
    v_mov_b32 v97, 0
    v_mov_b32 v98, 0
    v_mov_b32 v99, 0
    v_mov_b32 v100, 0
    v_mov_b32 v101, 0
    v_mov_b32 v102, 0
    v_mov_b32 v103, 0
    s_add_u32 s63, s47, 131072
    s_add_u32 m0, s63, 8192
    s_xor_b32 s63, s63, m0
    s_mov_b32 s50, 0x3eb8aa3b
    s_waitcnt lgkmcnt(2)
    v_mfma_f32_16x16x32_bf16 v[144:147], v[72:75], v[32:35], v[144:147]
    ds_read_b64_tr_b16 v[64:65], v18 offset:0
    s_waitcnt lgkmcnt(1)
    v_mfma_f32_16x16x32_bf16 v[144:147], v[76:79], v[36:39], v[144:147]
    ds_read_b64_tr_b16 v[66:67], v18 offset:512
    v_mfma_f32_16x16x32_bf16 v[148:151], v[72:75], v[40:43], v[148:151]
    ds_read_b64_tr_b16 v[68:69], v18 offset:4096
    v_mfma_f32_16x16x32_bf16 v[148:151], v[76:79], v[44:47], v[148:151]
    ds_read_b64_tr_b16 v[70:71], v18 offset:4608
    v_mfma_f32_16x16x32_bf16 v[152:155], v[72:75], v[48:51], v[152:155]
    v_mfma_f32_16x16x32_bf16 v[152:155], v[76:79], v[52:55], v[152:155]
    v_mfma_f32_16x16x32_bf16 v[156:159], v[72:75], v[56:59], v[156:159]
    v_mfma_f32_16x16x32_bf16 v[156:159], v[76:79], v[60:63], v[156:159]
    s_waitcnt vmcnt(0) lgkmcnt(0)
    s_barrier
    ds_read_b64_tr_b16 v[72:73], v16 offset:32768
    ds_read_b64_tr_b16 v[74:75], v16 offset:33280
    v_mfma_f32_16x16x32_bf16 v[160:163], v[32:35], v[64:67], v[160:163]
    ds_read_b64_tr_b16 v[76:77], v16 offset:36864
    ds_read_b64_tr_b16 v[78:79], v16 offset:37376
    v_mfma_f32_16x16x32_bf16 v[160:163], v[36:39], v[68:71], v[160:163]
    ds_read_b128 v[32:35], v12 offset:0
    v_mfma_f32_16x16x32_bf16 v[164:167], v[40:43], v[64:67], v[164:167]
    ds_read_b128 v[36:39], v13 offset:0
    v_mfma_f32_16x16x32_bf16 v[164:167], v[44:47], v[68:71], v[164:167]
    ds_read_b128 v[40:43], v12 offset:2048
    v_mfma_f32_16x16x32_bf16 v[168:171], v[48:51], v[64:67], v[168:171]
    ds_read_b128 v[44:47], v13 offset:2048
    v_mfma_f32_16x16x32_bf16 v[168:171], v[52:55], v[68:71], v[168:171]
    ds_read_b128 v[48:51], v12 offset:16384
    v_mfma_f32_16x16x32_bf16 v[172:175], v[56:59], v[64:67], v[172:175]
    ds_read_b128 v[52:55], v13 offset:16384
    v_mfma_f32_16x16x32_bf16 v[172:175], v[60:63], v[68:71], v[172:175]
    ds_read_b128 v[56:59], v12 offset:18432
    ds_read_b128 v[60:63], v13 offset:18432
    s_waitcnt lgkmcnt(7)
    v_mfma_f32_16x16x32_bf16 v[128:131], v[72:75], v[32:35], v[128:131]
    ds_read_b64_tr_b16 v[64:65], v17 offset:32768
    s_waitcnt lgkmcnt(7)
    v_mfma_f32_16x16x32_bf16 v[128:131], v[76:79], v[36:39], v[128:131]
    ds_read_b64_tr_b16 v[66:67], v17 offset:33280
    s_waitcnt lgkmcnt(7)
    v_mfma_f32_16x16x32_bf16 v[132:135], v[72:75], v[40:43], v[132:135]
    ds_read_b64_tr_b16 v[68:69], v17 offset:36864
    s_waitcnt lgkmcnt(7)
    v_mfma_f32_16x16x32_bf16 v[132:135], v[76:79], v[44:47], v[132:135]
    ds_read_b64_tr_b16 v[70:71], v17 offset:37376
    s_waitcnt lgkmcnt(7)
    v_mfma_f32_16x16x32_bf16 v[136:139], v[72:75], v[48:51], v[136:139]
    s_waitcnt lgkmcnt(6)
    v_mfma_f32_16x16x32_bf16 v[136:139], v[76:79], v[52:55], v[136:139]
    s_waitcnt lgkmcnt(5)
    v_mfma_f32_16x16x32_bf16 v[140:143], v[72:75], v[56:59], v[140:143]
    s_waitcnt lgkmcnt(4)
    v_mfma_f32_16x16x32_bf16 v[140:143], v[76:79], v[60:63], v[140:143]
    s_waitcnt lgkmcnt(2)
    v_mfma_f32_16x16x32_bf16 v[144:147], v[64:67], v[32:35], v[144:147]
    ds_read_b64_tr_b16 v[72:73], v18 offset:32768
    s_waitcnt lgkmcnt(1)
    v_mfma_f32_16x16x32_bf16 v[144:147], v[68:71], v[36:39], v[144:147]
    ds_read_b64_tr_b16 v[74:75], v18 offset:33280
    v_mfma_f32_16x16x32_bf16 v[148:151], v[64:67], v[40:43], v[148:151]
    ds_read_b64_tr_b16 v[76:77], v18 offset:36864
    v_mfma_f32_16x16x32_bf16 v[148:151], v[68:71], v[44:47], v[148:151]
    ds_read_b64_tr_b16 v[78:79], v18 offset:37376
    v_mfma_f32_16x16x32_bf16 v[152:155], v[64:67], v[48:51], v[152:155]
    v_mfma_f32_16x16x32_bf16 v[152:155], v[68:71], v[52:55], v[152:155]
    v_mfma_f32_16x16x32_bf16 v[156:159], v[64:67], v[56:59], v[156:159]
    v_mfma_f32_16x16x32_bf16 v[156:159], v[68:71], v[60:63], v[156:159]
    s_waitcnt lgkmcnt(2)
    v_mfma_f32_16x16x32_bf16 v[160:163], v[32:35], v[72:75], v[160:163]
    s_waitcnt lgkmcnt(0)
    v_mfma_f32_16x16x32_bf16 v[160:163], v[36:39], v[76:79], v[160:163]
    v_mfma_f32_16x16x32_bf16 v[164:167], v[40:43], v[72:75], v[164:167]
    v_mfma_f32_16x16x32_bf16 v[164:167], v[44:47], v[76:79], v[164:167]
    v_mfma_f32_16x16x32_bf16 v[168:171], v[48:51], v[72:75], v[168:171]
    v_mfma_f32_16x16x32_bf16 v[168:171], v[52:55], v[76:79], v[168:171]
    v_mfma_f32_16x16x32_bf16 v[172:175], v[56:59], v[72:75], v[172:175]
    v_mfma_f32_16x16x32_bf16 v[172:175], v[60:63], v[76:79], v[172:175]
LB_epi:
    s_setprio 0
    v_mov_b32 v48, 0
    v_mov_b32 v49, 0
    v_mov_b32 v50, 0
    v_mov_b32 v51, 0
    v_mov_b32 v52, 0
    v_mov_b32 v53, 0
    v_mov_b32 v54, 0
    v_mov_b32 v55, 0
    v_cvt_pk_bf16_f32 v112, v144, v145
    v_cvt_pk_bf16_f32 v113, v146, v147
    v_cvt_pk_bf16_f32 v114, v148, v149
    v_cvt_pk_bf16_f32 v115, v150, v151
    v_cvt_pk_bf16_f32 v116, v160, v161
    v_cvt_pk_bf16_f32 v117, v162, v163
    v_cvt_pk_bf16_f32 v118, v164, v165
    v_cvt_pk_bf16_f32 v119, v166, v167
    v_permlane16_swap_b32 v112, v114
    v_permlane16_swap_b32 v113, v115
    buffer_store_dwordx4 v[112:115], v24, s[20:23], s94 offen sc1
    buffer_store_dwordx4 v[116:119], v2, s[20:23], s94 offen offset:1024 sc1
    v_cvt_pk_bf16_f32 v120, v152, v153
    v_cvt_pk_bf16_f32 v121, v154, v155
    v_cvt_pk_bf16_f32 v122, v156, v157
    v_cvt_pk_bf16_f32 v123, v158, v159
    v_cvt_pk_bf16_f32 v124, v168, v169
    v_cvt_pk_bf16_f32 v125, v170, v171
    v_cvt_pk_bf16_f32 v126, v172, v173
    v_cvt_pk_bf16_f32 v127, v174, v175
    v_permlane16_swap_b32 v120, v122
    v_permlane16_swap_b32 v121, v123
    buffer_store_dwordx4 v[120:123], v24, s[20:23], s62 offen sc1
    buffer_store_dwordx4 v[124:127], v2, s[20:23], s62 offen offset:1024 sc1
    v_mul_f32 v128, s50, v128
    v_mul_f32 v129, s50, v129
    v_mul_f32 v130, s50, v130
    v_mul_f32 v131, s50, v131
    v_mul_f32 v132, s50, v132
    v_mul_f32 v133, s50, v133
    v_mul_f32 v134, s50, v134
    v_mul_f32 v135, s50, v135
    v_cvt_pk_bf16_f32 v32, v128, v129
    v_cvt_pk_bf16_f32 v33, v130, v131
    v_cvt_pk_bf16_f32 v34, v132, v133
    v_cvt_pk_bf16_f32 v35, v134, v135
    s_nop 1
    v_permlane16_swap_b32 v32, v34
    v_permlane16_swap_b32 v33, v35
    v_mul_f32 v136, s50, v136
    v_mul_f32 v137, s50, v137
    v_mul_f32 v138, s50, v138
    v_mul_f32 v139, s50, v139
    v_mul_f32 v140, s50, v140
    v_mul_f32 v141, s50, v141
    v_mul_f32 v142, s50, v142
    v_mul_f32 v143, s50, v143
    v_cvt_pk_bf16_f32 v36, v136, v137
    v_cvt_pk_bf16_f32 v37, v138, v139
    v_cvt_pk_bf16_f32 v38, v140, v141
    v_cvt_pk_bf16_f32 v39, v142, v143
    s_nop 1
    v_permlane16_swap_b32 v36, v38
    v_permlane16_swap_b32 v37, v39
    v_mov_b32 v57, v28
    v_mov_b32 v59, 1
    v_and_b32 v58, 3, v1
    v_mul_u32_u24 v58, 260, v58
    v_add_u32 v58, 156672, v58
    v_add_u32 v56, 131072, v2
    v_mfma_f32_32x32x16_bf16 v[128:143], v[48:51], v[48:51], 0
    v_mfma_f32_32x32x16_bf16 v[144:159], v[48:51], v[48:51], 0
    s_barrier
    ds_write_b128 v26, v[112:115] offset:0
    ds_write_b128 v27, v[116:119] offset:1024
    ds_write_b128 v26, v[120:123] offset:8192
    ds_write_b128 v27, v[124:127] offset:9216
    ds_write_b32 v57, v59
LB_s0:
    ds_read_b32 v60, v58
    s_waitcnt lgkmcnt(0)
    v_cmp_gt_u32 vcc, v59, v60
    s_cbranch_vccnz LB_s0
    v_add_u32 v59, 1, v59
    ds_read_b128 v[64:67], v56 offset:0
    ds_read_b128 v[68:71], v56 offset:1024
    ds_read_b128 v[72:75], v56 offset:2048
    ds_read_b128 v[76:79], v56 offset:3072
    ds_read_b128 v[80:83], v56 offset:4096
    ds_read_b128 v[84:87], v56 offset:5120
    s_waitcnt lgkmcnt(5)
    v_mfma_f32_32x32x16_bf16 v[160:175], v[64:67], v[32:35], 0
    s_nop 10
    s_waitcnt lgkmcnt(5)
    s_setprio 3
    v_cvt_pk_bf16_f32 v55, v190, v191
    v_mfma_f32_32x32x16_bf16 v[176:191], v[64:67], v[36:39], 0
    v_exp_f32 v160, v160
    v_exp_f32 v161, v161
    v_smfmac_f32_32x32x32_bf16 v[144:159], v[92:95], v[48:55], v109
    v_exp_f32 v162, v162
    v_exp_f32 v163, v163
    v_smfmac_f32_16x16x64_bf16 v[100:103], v[104:107], v[48:55], v108
    s_setprio 0
    v_exp_f32 v164, v164
    v_exp_f32 v165, v165
    v_exp_f32 v166, v166
    v_exp_f32 v167, v167
    v_exp_f32 v168, v168
    v_cvt_pk_bf16_f32 v40, v160, v161
    v_exp_f32 v169, v169
    v_cvt_pk_bf16_f32 v41, v162, v163
    v_exp_f32 v170, v170
    v_cvt_pk_bf16_f32 v42, v164, v165
    v_exp_f32 v171, v171
    v_cvt_pk_bf16_f32 v43, v166, v167
    v_exp_f32 v172, v172
    v_cvt_pk_bf16_f32 v44, v168, v169
    v_exp_f32 v173, v173
    v_cvt_pk_bf16_f32 v45, v170, v171
    v_exp_f32 v174, v174
    v_cvt_pk_bf16_f32 v46, v172, v173
    v_exp_f32 v175, v175
    s_setprio 3
    v_cvt_pk_bf16_f32 v47, v174, v175
    s_waitcnt lgkmcnt(3)
    v_mfma_f32_32x32x16_bf16 v[160:175], v[72:75], v[32:35], 0
    ds_read_b128 v[88:91], v56 offset:6144
    v_exp_f32 v176, v176
    v_exp_f32 v177, v177
    v_smfmac_f32_32x32x32_bf16 v[128:143], v[68:71], v[40:47], v109
    ds_read_b128 v[92:95], v56 offset:7168
    v_exp_f32 v178, v178
    v_exp_f32 v179, v179
    v_smfmac_f32_16x16x64_bf16 v[96:99], v[104:107], v[40:47], v108
    s_setprio 0
    v_exp_f32 v180, v180
    v_exp_f32 v181, v181
    v_exp_f32 v182, v182
    v_exp_f32 v183, v183
    v_exp_f32 v184, v184
    v_cvt_pk_bf16_f32 v48, v176, v177
    v_exp_f32 v185, v185
    v_cvt_pk_bf16_f32 v49, v178, v179
    v_exp_f32 v186, v186
    v_cvt_pk_bf16_f32 v50, v180, v181
    v_exp_f32 v187, v187
    v_cvt_pk_bf16_f32 v51, v182, v183
    v_exp_f32 v188, v188
    v_cvt_pk_bf16_f32 v52, v184, v185
    v_exp_f32 v189, v189
    v_cvt_pk_bf16_f32 v53, v186, v187
    v_exp_f32 v190, v190
    v_cvt_pk_bf16_f32 v54, v188, v189
    v_exp_f32 v191, v191
    s_setprio 3
    v_cvt_pk_bf16_f32 v55, v190, v191
    v_mfma_f32_32x32x16_bf16 v[176:191], v[72:75], v[36:39], 0
    s_waitcnt vmcnt(0)
    s_and_b32 s52, s40, 31
    s_lshl_b32 s52, s52, 13
    s_lshl_b32 s53, s41, 10
    s_add_u32 s52, s52, s53
    s_add_u32 s52, s52, 70254720
    s_lshl_b32 s53, s43, 2
    s_add_u32 s52, s52, s53
    v_mov_b32 v29, 1
    s_mov_b64 s[92:93], exec
    s_mov_b64 exec, 1
    buffer_store_dword v29, off, s[20:23], s52 sc1
    s_mov_b64 exec, s[92:93]
    v_exp_f32 v160, v160
    v_exp_f32 v161, v161
    v_smfmac_f32_32x32x32_bf16 v[144:159], v[68:71], v[48:55], v109
    v_exp_f32 v162, v162
    v_exp_f32 v163, v163
    v_smfmac_f32_16x16x64_bf16 v[100:103], v[104:107], v[48:55], v108
    s_setprio 0
    v_exp_f32 v164, v164
    v_exp_f32 v165, v165
    v_exp_f32 v166, v166
    v_exp_f32 v167, v167
    v_exp_f32 v168, v168
    v_cvt_pk_bf16_f32 v40, v160, v161
    v_exp_f32 v169, v169
    v_cvt_pk_bf16_f32 v41, v162, v163
    v_exp_f32 v170, v170
    v_cvt_pk_bf16_f32 v42, v164, v165
    v_exp_f32 v171, v171
    v_cvt_pk_bf16_f32 v43, v166, v167
    v_exp_f32 v172, v172
    v_cvt_pk_bf16_f32 v44, v168, v169
    v_exp_f32 v173, v173
    v_cvt_pk_bf16_f32 v45, v170, v171
    v_exp_f32 v174, v174
    v_cvt_pk_bf16_f32 v46, v172, v173
    v_exp_f32 v175, v175
    v_xor_b32 v56, 0x2000, v56
    s_setprio 3
    v_cvt_pk_bf16_f32 v47, v174, v175
    s_waitcnt lgkmcnt(3)
    v_mfma_f32_32x32x16_bf16 v[160:175], v[80:83], v[32:35], 0
    ds_write_b32 v57, v59
    v_exp_f32 v176, v176
    v_exp_f32 v177, v177
    v_smfmac_f32_32x32x32_bf16 v[128:143], v[76:79], v[40:47], v109
    v_exp_f32 v178, v178
    v_exp_f32 v179, v179
    v_smfmac_f32_16x16x64_bf16 v[96:99], v[104:107], v[40:47], v108
    s_setprio 0
    v_exp_f32 v180, v180
    v_exp_f32 v181, v181
    v_exp_f32 v182, v182
    v_exp_f32 v183, v183
    v_exp_f32 v184, v184
    v_cvt_pk_bf16_f32 v48, v176, v177
    v_exp_f32 v185, v185
    v_cvt_pk_bf16_f32 v49, v178, v179
    v_exp_f32 v186, v186
    v_cvt_pk_bf16_f32 v50, v180, v181
    v_exp_f32 v187, v187
    v_cvt_pk_bf16_f32 v51, v182, v183
    v_exp_f32 v188, v188
    v_cvt_pk_bf16_f32 v52, v184, v185
    v_exp_f32 v189, v189
    v_cvt_pk_bf16_f32 v53, v186, v187
    v_exp_f32 v190, v190
    v_cvt_pk_bf16_f32 v54, v188, v189
    v_exp_f32 v191, v191
    s_setprio 3
    v_cvt_pk_bf16_f32 v55, v190, v191
    v_mfma_f32_32x32x16_bf16 v[176:191], v[80:83], v[36:39], 0
    v_exp_f32 v160, v160
    v_exp_f32 v161, v161
    v_smfmac_f32_32x32x32_bf16 v[144:159], v[76:79], v[48:55], v109
    ds_read_b32 v60, v58
    v_exp_f32 v162, v162
    v_exp_f32 v163, v163
    v_smfmac_f32_16x16x64_bf16 v[100:103], v[104:107], v[48:55], v108
    s_setprio 0
    v_exp_f32 v164, v164
    v_exp_f32 v165, v165
    v_exp_f32 v166, v166
    v_exp_f32 v167, v167
    v_exp_f32 v168, v168
    v_cvt_pk_bf16_f32 v40, v160, v161
    v_exp_f32 v169, v169
    v_cvt_pk_bf16_f32 v41, v162, v163
    v_exp_f32 v170, v170
    v_cvt_pk_bf16_f32 v42, v164, v165
    v_exp_f32 v171, v171
    v_cvt_pk_bf16_f32 v43, v166, v167
    v_exp_f32 v172, v172
    v_cvt_pk_bf16_f32 v44, v168, v169
    v_exp_f32 v173, v173
    v_cvt_pk_bf16_f32 v45, v170, v171
    v_exp_f32 v174, v174
    v_cvt_pk_bf16_f32 v46, v172, v173
    v_exp_f32 v175, v175
    s_waitcnt lgkmcnt(0)
    v_cmp_gt_u32 vcc, v59, v60
    s_cbranch_vccz LB_p0_ok
LB_p0_sp:
    ds_read_b32 v60, v58
    s_waitcnt lgkmcnt(0)
    v_cmp_gt_u32 vcc, v59, v60
    s_cbranch_vccnz LB_p0_sp
LB_p0_ok:
    s_setprio 3
    v_cvt_pk_bf16_f32 v47, v174, v175
    v_mfma_f32_32x32x16_bf16 v[160:175], v[88:91], v[32:35], 0
    ds_read_b128 v[64:67], v56 offset:0
    s_and_b32 s52, s40, 31
    s_lshl_b32 s52, s52, 13
    s_add_u32 s52, s52, 70254720
    v_bfe_u32 v29, v1, 2, 3
    v_lshlrev_b32 v29, 8, v29
    v_and_or_b32 v29, v1, 3, v29
    v_lshlrev_b32 v29, 2, v29
    buffer_load_dword v10, v29, s[20:23], s52 offen sc1
    v_exp_f32 v176, v176
    v_exp_f32 v177, v177
    v_smfmac_f32_32x32x32_bf16 v[128:143], v[84:87], v[40:47], v109
    ds_read_b128 v[68:71], v56 offset:1024
    v_exp_f32 v178, v178
    v_exp_f32 v179, v179
    v_smfmac_f32_16x16x64_bf16 v[96:99], v[104:107], v[40:47], v108
    s_setprio 0
    v_exp_f32 v180, v180
    v_exp_f32 v181, v181
    v_exp_f32 v182, v182
    v_exp_f32 v183, v183
    v_exp_f32 v184, v184
    v_cvt_pk_bf16_f32 v48, v176, v177
    v_exp_f32 v185, v185
    v_cvt_pk_bf16_f32 v49, v178, v179
    v_exp_f32 v186, v186
    v_cvt_pk_bf16_f32 v50, v180, v181
    v_exp_f32 v187, v187
    v_cvt_pk_bf16_f32 v51, v182, v183
    v_exp_f32 v188, v188
    v_cvt_pk_bf16_f32 v52, v184, v185
    v_exp_f32 v189, v189
    v_cvt_pk_bf16_f32 v53, v186, v187
    v_exp_f32 v190, v190
    v_cvt_pk_bf16_f32 v54, v188, v189
    v_exp_f32 v191, v191
    s_setprio 3
    v_cvt_pk_bf16_f32 v55, v190, v191
    v_mfma_f32_32x32x16_bf16 v[176:191], v[88:91], v[36:39], 0
    ds_read_b128 v[72:75], v56 offset:2048
    v_exp_f32 v160, v160
    v_exp_f32 v161, v161
    v_smfmac_f32_32x32x32_bf16 v[144:159], v[84:87], v[48:55], v109
    ds_read_b128 v[76:79], v56 offset:3072
    v_exp_f32 v162, v162
    v_exp_f32 v163, v163
    v_smfmac_f32_16x16x64_bf16 v[100:103], v[104:107], v[48:55], v108
    s_setprio 0
    v_exp_f32 v164, v164
    v_exp_f32 v165, v165
    v_exp_f32 v166, v166
    v_exp_f32 v167, v167
    v_exp_f32 v168, v168
    v_cvt_pk_bf16_f32 v40, v160, v161
    v_exp_f32 v169, v169
    v_cvt_pk_bf16_f32 v41, v162, v163
    v_exp_f32 v170, v170
    v_cvt_pk_bf16_f32 v42, v164, v165
    v_exp_f32 v171, v171
    v_cvt_pk_bf16_f32 v43, v166, v167
    v_exp_f32 v172, v172
    v_cvt_pk_bf16_f32 v44, v168, v169
    v_exp_f32 v173, v173
    v_cvt_pk_bf16_f32 v45, v170, v171
    v_exp_f32 v174, v174
    v_cvt_pk_bf16_f32 v46, v172, v173
    v_exp_f32 v175, v175
    v_add_u32 v59, 1, v59
    s_setprio 3
    v_cvt_pk_bf16_f32 v47, v174, v175
    s_waitcnt lgkmcnt(3)
    v_mfma_f32_32x32x16_bf16 v[160:175], v[64:67], v[32:35], 0
    ds_read_b128 v[80:83], v56 offset:4096
    s_waitcnt vmcnt(0)
LB_poll_loop:
    v_cmp_ne_u32 vcc, 1, v10
    s_cbranch_vccz LB_poll_ok
    s_sleep 4
    s_and_b32 s52, s40, 31
    s_lshl_b32 s52, s52, 13
    s_add_u32 s52, s52, 70254720
    v_bfe_u32 v29, v1, 2, 3
    v_lshlrev_b32 v29, 8, v29
    v_and_or_b32 v29, v1, 3, v29
    v_lshlrev_b32 v29, 2, v29
    buffer_load_dword v10, v29, s[20:23], s52 offen sc1
    s_waitcnt vmcnt(0)
    s_branch LB_poll_loop
LB_poll_ok:
    s_xor_b32 m0, m0, s63
    s_add_u32 s62, s62, 8192
    s_cmp_eq_u32 s62, s56
    s_cselect_b32 s62, s61, s62
    buffer_load_dwordx4 v2, s[20:23], s62 offen offset:0 sc1 lds
    buffer_load_dwordx4 v2, s[20:23], s62 offen offset:1024 sc1 lds
    v_exp_f32 v176, v176
    v_exp_f32 v177, v177
    v_smfmac_f32_32x32x32_bf16 v[128:143], v[92:95], v[40:47], v109
    ds_read_b128 v[84:87], v56 offset:5120
    v_exp_f32 v178, v178
    v_exp_f32 v179, v179
    v_smfmac_f32_16x16x64_bf16 v[96:99], v[104:107], v[40:47], v108
    s_setprio 0
    v_exp_f32 v180, v180
    v_exp_f32 v181, v181
    v_exp_f32 v182, v182
    v_exp_f32 v183, v183
    v_exp_f32 v184, v184
    v_cvt_pk_bf16_f32 v48, v176, v177
    v_exp_f32 v185, v185
    v_cvt_pk_bf16_f32 v49, v178, v179
    v_exp_f32 v186, v186
    v_cvt_pk_bf16_f32 v50, v180, v181
    v_exp_f32 v187, v187
    v_cvt_pk_bf16_f32 v51, v182, v183
    v_exp_f32 v188, v188
    v_cvt_pk_bf16_f32 v52, v184, v185
    v_exp_f32 v189, v189
    v_cvt_pk_bf16_f32 v53, v186, v187
    v_exp_f32 v190, v190
    v_cvt_pk_bf16_f32 v54, v188, v189
    v_exp_f32 v191, v191
    s_setprio 3
    v_cvt_pk_bf16_f32 v55, v190, v191
    v_mfma_f32_32x32x16_bf16 v[176:191], v[64:67], v[36:39], 0
    v_exp_f32 v160, v160
    v_exp_f32 v161, v161
    v_smfmac_f32_32x32x32_bf16 v[144:159], v[92:95], v[48:55], v109
    v_exp_f32 v162, v162
    v_exp_f32 v163, v163
    v_smfmac_f32_16x16x64_bf16 v[100:103], v[104:107], v[48:55], v108
    s_setprio 0
    v_exp_f32 v164, v164
    v_exp_f32 v165, v165
    v_exp_f32 v166, v166
    v_exp_f32 v167, v167
    v_exp_f32 v168, v168
    v_cvt_pk_bf16_f32 v40, v160, v161
    v_exp_f32 v169, v169
    v_cvt_pk_bf16_f32 v41, v162, v163
    v_exp_f32 v170, v170
    v_cvt_pk_bf16_f32 v42, v164, v165
    v_exp_f32 v171, v171
    v_cvt_pk_bf16_f32 v43, v166, v167
    v_exp_f32 v172, v172
    v_cvt_pk_bf16_f32 v44, v168, v169
    v_exp_f32 v173, v173
    v_cvt_pk_bf16_f32 v45, v170, v171
    v_exp_f32 v174, v174
    v_cvt_pk_bf16_f32 v46, v172, v173
    v_exp_f32 v175, v175
    s_setprio 3
    v_cvt_pk_bf16_f32 v47, v174, v175
    s_waitcnt lgkmcnt(3)
    v_mfma_f32_32x32x16_bf16 v[160:175], v[72:75], v[32:35], 0
    ds_read_b128 v[88:91], v56 offset:6144
    v_exp_f32 v176, v176
    v_exp_f32 v177, v177
    v_smfmac_f32_32x32x32_bf16 v[128:143], v[68:71], v[40:47], v109
    ds_read_b128 v[92:95], v56 offset:7168
    v_exp_f32 v178, v178
    v_exp_f32 v179, v179
    v_smfmac_f32_16x16x64_bf16 v[96:99], v[104:107], v[40:47], v108
    s_setprio 0
    v_exp_f32 v180, v180
    v_exp_f32 v181, v181
    v_exp_f32 v182, v182
    v_exp_f32 v183, v183
    v_exp_f32 v184, v184
    v_cvt_pk_bf16_f32 v48, v176, v177
    v_exp_f32 v185, v185
    v_cvt_pk_bf16_f32 v49, v178, v179
    v_exp_f32 v186, v186
    v_cvt_pk_bf16_f32 v50, v180, v181
    v_exp_f32 v187, v187
    v_cvt_pk_bf16_f32 v51, v182, v183
    v_exp_f32 v188, v188
    v_cvt_pk_bf16_f32 v52, v184, v185
    v_exp_f32 v189, v189
    v_cvt_pk_bf16_f32 v53, v186, v187
    v_exp_f32 v190, v190
    v_cvt_pk_bf16_f32 v54, v188, v189
    v_exp_f32 v191, v191
    s_setprio 3
    v_cvt_pk_bf16_f32 v55, v190, v191
    v_mfma_f32_32x32x16_bf16 v[176:191], v[72:75], v[36:39], 0
    v_exp_f32 v160, v160
    v_exp_f32 v161, v161
    v_smfmac_f32_32x32x32_bf16 v[144:159], v[68:71], v[48:55], v109
    v_exp_f32 v162, v162
    v_exp_f32 v163, v163
    v_smfmac_f32_16x16x64_bf16 v[100:103], v[104:107], v[48:55], v108
    s_setprio 0
    v_exp_f32 v164, v164
    v_exp_f32 v165, v165
    v_exp_f32 v166, v166
    v_exp_f32 v167, v167
    v_exp_f32 v168, v168
    v_cvt_pk_bf16_f32 v40, v160, v161
    v_exp_f32 v169, v169
    v_cvt_pk_bf16_f32 v41, v162, v163
    v_exp_f32 v170, v170
    v_cvt_pk_bf16_f32 v42, v164, v165
    v_exp_f32 v171, v171
    v_cvt_pk_bf16_f32 v43, v166, v167
    v_exp_f32 v172, v172
    v_cvt_pk_bf16_f32 v44, v168, v169
    v_exp_f32 v173, v173
    v_cvt_pk_bf16_f32 v45, v170, v171
    v_exp_f32 v174, v174
    v_cvt_pk_bf16_f32 v46, v172, v173
    v_exp_f32 v175, v175
    v_xor_b32 v56, 0x2000, v56
    s_setprio 3
    v_cvt_pk_bf16_f32 v47, v174, v175
    s_waitcnt lgkmcnt(3)
    v_mfma_f32_32x32x16_bf16 v[160:175], v[80:83], v[32:35], 0
    v_exp_f32 v176, v176
    v_exp_f32 v177, v177
    v_smfmac_f32_32x32x32_bf16 v[128:143], v[76:79], v[40:47], v109
    v_exp_f32 v178, v178
    v_exp_f32 v179, v179
    v_smfmac_f32_16x16x64_bf16 v[96:99], v[104:107], v[40:47], v108
    s_setprio 0
    v_exp_f32 v180, v180
    v_exp_f32 v181, v181
    v_exp_f32 v182, v182
    v_exp_f32 v183, v183
    v_exp_f32 v184, v184
    v_cvt_pk_bf16_f32 v48, v176, v177
    v_exp_f32 v185, v185
    v_cvt_pk_bf16_f32 v49, v178, v179
    v_exp_f32 v186, v186
    v_cvt_pk_bf16_f32 v50, v180, v181
    v_exp_f32 v187, v187
    v_cvt_pk_bf16_f32 v51, v182, v183
    v_exp_f32 v188, v188
    v_cvt_pk_bf16_f32 v52, v184, v185
    v_exp_f32 v189, v189
    v_cvt_pk_bf16_f32 v53, v186, v187
    v_exp_f32 v190, v190
    v_cvt_pk_bf16_f32 v54, v188, v189
    v_exp_f32 v191, v191
    s_setprio 3
    v_cvt_pk_bf16_f32 v55, v190, v191
    v_mfma_f32_32x32x16_bf16 v[176:191], v[80:83], v[36:39], 0
    s_xor_b32 m0, m0, s63
    s_add_u32 s62, s62, 8192
    s_cmp_eq_u32 s62, s56
    s_cselect_b32 s62, s61, s62
    v_exp_f32 v160, v160
    v_exp_f32 v161, v161
    v_smfmac_f32_32x32x32_bf16 v[144:159], v[76:79], v[48:55], v109
    v_exp_f32 v162, v162
    v_exp_f32 v163, v163
    v_smfmac_f32_16x16x64_bf16 v[100:103], v[104:107], v[48:55], v108
    s_setprio 0
    v_exp_f32 v164, v164
    v_exp_f32 v165, v165
    v_exp_f32 v166, v166
    v_exp_f32 v167, v167
    v_exp_f32 v168, v168
    v_cvt_pk_bf16_f32 v40, v160, v161
    v_exp_f32 v169, v169
    v_cvt_pk_bf16_f32 v41, v162, v163
    v_exp_f32 v170, v170
    v_cvt_pk_bf16_f32 v42, v164, v165
    v_exp_f32 v171, v171
    v_cvt_pk_bf16_f32 v43, v166, v167
    v_exp_f32 v172, v172
    v_cvt_pk_bf16_f32 v44, v168, v169
    v_exp_f32 v173, v173
    v_cvt_pk_bf16_f32 v45, v170, v171
    v_exp_f32 v174, v174
    v_cvt_pk_bf16_f32 v46, v172, v173
    v_exp_f32 v175, v175
    s_waitcnt vmcnt(0)
    ds_write_b32 v57, v59
LB_p1_sp:
    ds_read_b32 v60, v58
    s_waitcnt lgkmcnt(0)
    v_cmp_gt_u32 vcc, v59, v60
    s_cbranch_vccnz LB_p1_sp
    s_setprio 3
    v_cvt_pk_bf16_f32 v47, v174, v175
    s_waitcnt lgkmcnt(2)
    v_mfma_f32_32x32x16_bf16 v[160:175], v[88:91], v[32:35], 0
    ds_read_b128 v[64:67], v56 offset:0
    s_add_u32 s51, s48, 0
    buffer_store_dwordx4 v[200:203], v2, s[20:23], s51 offen offset:0 sc1
    v_exp_f32 v176, v176
    v_exp_f32 v177, v177
    v_smfmac_f32_32x32x32_bf16 v[128:143], v[84:87], v[40:47], v109
    ds_read_b128 v[68:71], v56 offset:1024
    v_exp_f32 v178, v178
    v_exp_f32 v179, v179
    v_smfmac_f32_16x16x64_bf16 v[96:99], v[104:107], v[40:47], v108
    buffer_load_dwordx4 v2, s[20:23], s62 offen offset:0 sc1 lds
    s_setprio 0
    v_exp_f32 v180, v180
    v_exp_f32 v181, v181
    v_exp_f32 v182, v182
    v_exp_f32 v183, v183
    v_exp_f32 v184, v184
    v_cvt_pk_bf16_f32 v48, v176, v177
    v_exp_f32 v185, v185
    v_cvt_pk_bf16_f32 v49, v178, v179
    v_exp_f32 v186, v186
    v_cvt_pk_bf16_f32 v50, v180, v181
    v_exp_f32 v187, v187
    v_cvt_pk_bf16_f32 v51, v182, v183
    v_exp_f32 v188, v188
    v_cvt_pk_bf16_f32 v52, v184, v185
    v_exp_f32 v189, v189
    v_cvt_pk_bf16_f32 v53, v186, v187
    v_exp_f32 v190, v190
    v_cvt_pk_bf16_f32 v54, v188, v189
    v_exp_f32 v191, v191
    s_setprio 3
    v_cvt_pk_bf16_f32 v55, v190, v191
    v_mfma_f32_32x32x16_bf16 v[176:191], v[88:91], v[36:39], 0
    ds_read_b128 v[72:75], v56 offset:2048
    s_add_u32 s51, s48, 0
    buffer_store_dwordx4 v[204:207], v11, s[20:23], s51 offen offset:0 sc1
    v_exp_f32 v160, v160
    v_exp_f32 v161, v161
    v_smfmac_f32_32x32x32_bf16 v[144:159], v[84:87], v[48:55], v109
    ds_read_b128 v[76:79], v56 offset:3072
    v_exp_f32 v162, v162
    v_exp_f32 v163, v163
    v_smfmac_f32_16x16x64_bf16 v[100:103], v[104:107], v[48:55], v108
    buffer_load_dwordx4 v2, s[20:23], s62 offen offset:1024 sc1 lds
    s_setprio 0
    v_exp_f32 v164, v164
    v_exp_f32 v165, v165
    v_exp_f32 v166, v166
    v_exp_f32 v167, v167
    v_exp_f32 v168, v168
    v_cvt_pk_bf16_f32 v40, v160, v161
    v_exp_f32 v169, v169
    v_cvt_pk_bf16_f32 v41, v162, v163
    v_exp_f32 v170, v170
    v_cvt_pk_bf16_f32 v42, v164, v165
    v_exp_f32 v171, v171
    v_cvt_pk_bf16_f32 v43, v166, v167
    v_exp_f32 v172, v172
    v_cvt_pk_bf16_f32 v44, v168, v169
    v_exp_f32 v173, v173
    v_cvt_pk_bf16_f32 v45, v170, v171
    v_exp_f32 v174, v174
    v_cvt_pk_bf16_f32 v46, v172, v173
    v_exp_f32 v175, v175
    v_add_u32 v59, 1, v59
    s_setprio 3
    v_cvt_pk_bf16_f32 v47, v174, v175
    s_waitcnt lgkmcnt(3)
    v_mfma_f32_32x32x16_bf16 v[160:175], v[64:67], v[32:35], 0
    ds_read_b128 v[80:83], v56 offset:4096
    s_add_u32 s51, s49, 0
    buffer_store_dwordx4 v[216:219], v2, s[20:23], s51 offen offset:0 sc1
    v_exp_f32 v176, v176
    v_exp_f32 v177, v177
    v_smfmac_f32_32x32x32_bf16 v[128:143], v[92:95], v[40:47], v109
    ds_read_b128 v[84:87], v56 offset:5120
    v_exp_f32 v178, v178
    v_exp_f32 v179, v179
    v_smfmac_f32_16x16x64_bf16 v[96:99], v[104:107], v[40:47], v108
    s_setprio 0
    v_exp_f32 v180, v180
    v_exp_f32 v181, v181
    v_exp_f32 v182, v182
    v_exp_f32 v183, v183
    v_exp_f32 v184, v184
    v_cvt_pk_bf16_f32 v48, v176, v177
    v_exp_f32 v185, v185
    v_cvt_pk_bf16_f32 v49, v178, v179
    v_exp_f32 v186, v186
    v_cvt_pk_bf16_f32 v50, v180, v181
    v_exp_f32 v187, v187
    v_cvt_pk_bf16_f32 v51, v182, v183
    v_exp_f32 v188, v188
    v_cvt_pk_bf16_f32 v52, v184, v185
    v_exp_f32 v189, v189
    v_cvt_pk_bf16_f32 v53, v186, v187
    v_exp_f32 v190, v190
    v_cvt_pk_bf16_f32 v54, v188, v189
    v_exp_f32 v191, v191
    s_setprio 3
    v_cvt_pk_bf16_f32 v55, v190, v191
    v_mfma_f32_32x32x16_bf16 v[176:191], v[64:67], v[36:39], 0
    s_add_u32 s51, s49, 0
    buffer_store_dwordx4 v[220:223], v2, s[20:23], s51 offen offset:1024 sc1
    v_exp_f32 v160, v160
    v_exp_f32 v161, v161
    v_smfmac_f32_32x32x32_bf16 v[144:159], v[92:95], v[48:55], v109
    v_exp_f32 v162, v162
    v_exp_f32 v163, v163
    v_smfmac_f32_16x16x64_bf16 v[100:103], v[104:107], v[48:55], v108
    s_setprio 0
    v_exp_f32 v164, v164
    v_exp_f32 v165, v165
    v_exp_f32 v166, v166
    v_exp_f32 v167, v167
    v_exp_f32 v168, v168
    v_cvt_pk_bf16_f32 v40, v160, v161
    v_exp_f32 v169, v169
    v_cvt_pk_bf16_f32 v41, v162, v163
    v_exp_f32 v170, v170
    v_cvt_pk_bf16_f32 v42, v164, v165
    v_exp_f32 v171, v171
    v_cvt_pk_bf16_f32 v43, v166, v167
    v_exp_f32 v172, v172
    v_cvt_pk_bf16_f32 v44, v168, v169
    v_exp_f32 v173, v173
    v_cvt_pk_bf16_f32 v45, v170, v171
    v_exp_f32 v174, v174
    v_cvt_pk_bf16_f32 v46, v172, v173
    v_exp_f32 v175, v175
    s_setprio 3
    v_cvt_pk_bf16_f32 v47, v174, v175
    s_waitcnt lgkmcnt(3)
    v_mfma_f32_32x32x16_bf16 v[160:175], v[72:75], v[32:35], 0
    ds_read_b128 v[88:91], v56 offset:6144
    s_add_u32 s51, s48, 16384
    buffer_store_dwordx4 v[232:235], v2, s[20:23], s51 offen offset:0 sc1
    v_exp_f32 v176, v176
    v_exp_f32 v177, v177
    v_smfmac_f32_32x32x32_bf16 v[128:143], v[68:71], v[40:47], v109
    ds_read_b128 v[92:95], v56 offset:7168
    v_exp_f32 v178, v178
    v_exp_f32 v179, v179
    v_smfmac_f32_16x16x64_bf16 v[96:99], v[104:107], v[40:47], v108
    s_setprio 0
    v_exp_f32 v180, v180
    v_exp_f32 v181, v181
    v_exp_f32 v182, v182
    v_exp_f32 v183, v183
    v_exp_f32 v184, v184
    v_cvt_pk_bf16_f32 v48, v176, v177
    v_exp_f32 v185, v185
    v_cvt_pk_bf16_f32 v49, v178, v179
    v_exp_f32 v186, v186
    v_cvt_pk_bf16_f32 v50, v180, v181
    v_exp_f32 v187, v187
    v_cvt_pk_bf16_f32 v51, v182, v183
    v_exp_f32 v188, v188
    v_cvt_pk_bf16_f32 v52, v184, v185
    v_exp_f32 v189, v189
    v_cvt_pk_bf16_f32 v53, v186, v187
    v_exp_f32 v190, v190
    v_cvt_pk_bf16_f32 v54, v188, v189
    v_exp_f32 v191, v191
    s_setprio 3
    v_cvt_pk_bf16_f32 v55, v190, v191
    v_mfma_f32_32x32x16_bf16 v[176:191], v[72:75], v[36:39], 0
    s_add_u32 s51, s48, 16384
    buffer_store_dwordx4 v[236:239], v11, s[20:23], s51 offen offset:0 sc1
    v_exp_f32 v160, v160
    v_exp_f32 v161, v161
    v_smfmac_f32_32x32x32_bf16 v[144:159], v[68:71], v[48:55], v109
    v_exp_f32 v162, v162
    v_exp_f32 v163, v163
    v_smfmac_f32_16x16x64_bf16 v[100:103], v[104:107], v[48:55], v108
    s_setprio 0
    v_exp_f32 v164, v164
    v_exp_f32 v165, v165
    v_exp_f32 v166, v166
    v_exp_f32 v167, v167
    v_exp_f32 v168, v168
    v_cvt_pk_bf16_f32 v40, v160, v161
    v_exp_f32 v169, v169
    v_cvt_pk_bf16_f32 v41, v162, v163
    v_exp_f32 v170, v170
    v_cvt_pk_bf16_f32 v42, v164, v165
    v_exp_f32 v171, v171
    v_cvt_pk_bf16_f32 v43, v166, v167
    v_exp_f32 v172, v172
    v_cvt_pk_bf16_f32 v44, v168, v169
    v_exp_f32 v173, v173
    v_cvt_pk_bf16_f32 v45, v170, v171
    v_exp_f32 v174, v174
    v_cvt_pk_bf16_f32 v46, v172, v173
    v_exp_f32 v175, v175
    v_xor_b32 v56, 0x2000, v56
    s_setprio 3
    v_cvt_pk_bf16_f32 v47, v174, v175
    s_waitcnt lgkmcnt(3)
    v_mfma_f32_32x32x16_bf16 v[160:175], v[80:83], v[32:35], 0
    s_waitcnt vmcnt(4)
    ds_write_b32 v57, v59
    v_exp_f32 v176, v176
    v_exp_f32 v177, v177
    v_smfmac_f32_32x32x32_bf16 v[128:143], v[76:79], v[40:47], v109
    v_exp_f32 v178, v178
    v_exp_f32 v179, v179
    v_smfmac_f32_16x16x64_bf16 v[96:99], v[104:107], v[40:47], v108
    s_setprio 0
    v_exp_f32 v180, v180
    v_exp_f32 v181, v181
    v_exp_f32 v182, v182
    v_exp_f32 v183, v183
    v_exp_f32 v184, v184
    v_cvt_pk_bf16_f32 v48, v176, v177
    v_exp_f32 v185, v185
    v_cvt_pk_bf16_f32 v49, v178, v179
    v_exp_f32 v186, v186
    v_cvt_pk_bf16_f32 v50, v180, v181
    v_exp_f32 v187, v187
    v_cvt_pk_bf16_f32 v51, v182, v183
    v_exp_f32 v188, v188
    v_cvt_pk_bf16_f32 v52, v184, v185
    v_exp_f32 v189, v189
    v_cvt_pk_bf16_f32 v53, v186, v187
    v_exp_f32 v190, v190
    v_cvt_pk_bf16_f32 v54, v188, v189
    v_exp_f32 v191, v191
    s_setprio 3
    v_cvt_pk_bf16_f32 v55, v190, v191
    v_mfma_f32_32x32x16_bf16 v[176:191], v[80:83], v[36:39], 0
    s_xor_b32 m0, m0, s63
    s_add_u32 s62, s62, 8192
    s_cmp_eq_u32 s62, s56
    s_cselect_b32 s62, s61, s62
    s_add_u32 s51, s49, 16384
    buffer_store_dwordx4 v[248:251], v2, s[20:23], s51 offen offset:0 sc1
    v_exp_f32 v160, v160
    v_exp_f32 v161, v161
    v_smfmac_f32_32x32x32_bf16 v[144:159], v[76:79], v[48:55], v109
    ds_read_b32 v60, v58
    v_exp_f32 v162, v162
    v_exp_f32 v163, v163
    v_smfmac_f32_16x16x64_bf16 v[100:103], v[104:107], v[48:55], v108
    s_setprio 0
    v_exp_f32 v164, v164
    v_exp_f32 v165, v165
    v_exp_f32 v166, v166
    v_exp_f32 v167, v167
    v_exp_f32 v168, v168
    v_cvt_pk_bf16_f32 v40, v160, v161
    v_exp_f32 v169, v169
    v_cvt_pk_bf16_f32 v41, v162, v163
    v_exp_f32 v170, v170
    v_cvt_pk_bf16_f32 v42, v164, v165
    v_exp_f32 v171, v171
    v_cvt_pk_bf16_f32 v43, v166, v167
    v_exp_f32 v172, v172
    v_cvt_pk_bf16_f32 v44, v168, v169
    v_exp_f32 v173, v173
    v_cvt_pk_bf16_f32 v45, v170, v171
    v_exp_f32 v174, v174
    v_cvt_pk_bf16_f32 v46, v172, v173
    v_exp_f32 v175, v175
    s_waitcnt lgkmcnt(0)
    v_cmp_gt_u32 vcc, v59, v60
    s_cbranch_vccz LB_p2_ok
LB_p2_sp:
    ds_read_b32 v60, v58
    s_waitcnt lgkmcnt(0)
    v_cmp_gt_u32 vcc, v59, v60
    s_cbranch_vccnz LB_p2_sp
LB_p2_ok:
    s_setprio 3
    v_cvt_pk_bf16_f32 v47, v174, v175
    v_mfma_f32_32x32x16_bf16 v[160:175], v[88:91], v[32:35], 0
    ds_read_b128 v[64:67], v56 offset:0
    s_add_u32 s51, s49, 16384
    buffer_store_dwordx4 v[252:255], v2, s[20:23], s51 offen offset:1024 sc1
    v_exp_f32 v176, v176
    v_exp_f32 v177, v177
    v_smfmac_f32_32x32x32_bf16 v[128:143], v[84:87], v[40:47], v109
    ds_read_b128 v[68:71], v56 offset:1024
    v_exp_f32 v178, v178
    v_exp_f32 v179, v179
    v_smfmac_f32_16x16x64_bf16 v[96:99], v[104:107], v[40:47], v108
    buffer_load_dwordx4 v2, s[20:23], s62 offen offset:0 sc1 lds
    s_setprio 0
    v_exp_f32 v180, v180
    v_exp_f32 v181, v181
    v_exp_f32 v182, v182
    v_exp_f32 v183, v183
    v_exp_f32 v184, v184
    v_cvt_pk_bf16_f32 v48, v176, v177
    v_exp_f32 v185, v185
    v_cvt_pk_bf16_f32 v49, v178, v179
    v_exp_f32 v186, v186
    v_cvt_pk_bf16_f32 v50, v180, v181
    v_exp_f32 v187, v187
    v_cvt_pk_bf16_f32 v51, v182, v183
    v_exp_f32 v188, v188
    v_cvt_pk_bf16_f32 v52, v184, v185
    v_exp_f32 v189, v189
    v_cvt_pk_bf16_f32 v53, v186, v187
    v_exp_f32 v190, v190
    v_cvt_pk_bf16_f32 v54, v188, v189
    v_exp_f32 v191, v191
    s_setprio 3
    v_cvt_pk_bf16_f32 v55, v190, v191
    v_mfma_f32_32x32x16_bf16 v[176:191], v[88:91], v[36:39], 0
    ds_read_b128 v[72:75], v56 offset:2048
    s_add_u32 s51, s48, 32768
    buffer_store_dwordx4 v[192:195], v2, s[20:23], s51 offen offset:0 sc1
    v_exp_f32 v160, v160
    v_exp_f32 v161, v161
    v_smfmac_f32_32x32x32_bf16 v[144:159], v[84:87], v[48:55], v109
    ds_read_b128 v[76:79], v56 offset:3072
    v_exp_f32 v162, v162
    v_exp_f32 v163, v163
    v_smfmac_f32_16x16x64_bf16 v[100:103], v[104:107], v[48:55], v108
    buffer_load_dwordx4 v2, s[20:23], s62 offen offset:1024 sc1 lds
    s_setprio 0
    v_exp_f32 v164, v164
    v_exp_f32 v165, v165
    v_exp_f32 v166, v166
    v_exp_f32 v167, v167
    v_exp_f32 v168, v168
    v_cvt_pk_bf16_f32 v40, v160, v161
    v_exp_f32 v169, v169
    v_cvt_pk_bf16_f32 v41, v162, v163
    v_exp_f32 v170, v170
    v_cvt_pk_bf16_f32 v42, v164, v165
    v_exp_f32 v171, v171
    v_cvt_pk_bf16_f32 v43, v166, v167
    v_exp_f32 v172, v172
    v_cvt_pk_bf16_f32 v44, v168, v169
    v_exp_f32 v173, v173
    v_cvt_pk_bf16_f32 v45, v170, v171
    v_exp_f32 v174, v174
    v_cvt_pk_bf16_f32 v46, v172, v173
    v_exp_f32 v175, v175
    v_add_u32 v59, 1, v59
    s_setprio 3
    v_cvt_pk_bf16_f32 v47, v174, v175
    s_waitcnt lgkmcnt(3)
    v_mfma_f32_32x32x16_bf16 v[160:175], v[64:67], v[32:35], 0
    ds_read_b128 v[80:83], v56 offset:4096
    s_add_u32 s51, s48, 32768
    buffer_store_dwordx4 v[196:199], v11, s[20:23], s51 offen offset:0 sc1
    v_exp_f32 v176, v176
    v_exp_f32 v177, v177
    v_smfmac_f32_32x32x32_bf16 v[128:143], v[92:95], v[40:47], v109
    ds_read_b128 v[84:87], v56 offset:5120
    v_exp_f32 v178, v178
    v_exp_f32 v179, v179
    v_smfmac_f32_16x16x64_bf16 v[96:99], v[104:107], v[40:47], v108
    s_setprio 0
    v_exp_f32 v180, v180
    v_exp_f32 v181, v181
    v_exp_f32 v182, v182
    v_exp_f32 v183, v183
    v_exp_f32 v184, v184
    v_cvt_pk_bf16_f32 v48, v176, v177
    v_exp_f32 v185, v185
    v_cvt_pk_bf16_f32 v49, v178, v179
    v_exp_f32 v186, v186
    v_cvt_pk_bf16_f32 v50, v180, v181
    v_exp_f32 v187, v187
    v_cvt_pk_bf16_f32 v51, v182, v183
    v_exp_f32 v188, v188
    v_cvt_pk_bf16_f32 v52, v184, v185
    v_exp_f32 v189, v189
    v_cvt_pk_bf16_f32 v53, v186, v187
    v_exp_f32 v190, v190
    v_cvt_pk_bf16_f32 v54, v188, v189
    v_exp_f32 v191, v191
    s_setprio 3
    v_cvt_pk_bf16_f32 v55, v190, v191
    v_mfma_f32_32x32x16_bf16 v[176:191], v[64:67], v[36:39], 0
    s_add_u32 s51, s49, 32768
    buffer_store_dwordx4 v[208:211], v2, s[20:23], s51 offen offset:0 sc1
    v_exp_f32 v160, v160
    v_exp_f32 v161, v161
    v_smfmac_f32_32x32x32_bf16 v[144:159], v[92:95], v[48:55], v109
    v_exp_f32 v162, v162
    v_exp_f32 v163, v163
    v_smfmac_f32_16x16x64_bf16 v[100:103], v[104:107], v[48:55], v108
    s_setprio 0
    v_exp_f32 v164, v164
    v_exp_f32 v165, v165
    v_exp_f32 v166, v166
    v_exp_f32 v167, v167
    v_exp_f32 v168, v168
    v_cvt_pk_bf16_f32 v40, v160, v161
    v_exp_f32 v169, v169
    v_cvt_pk_bf16_f32 v41, v162, v163
    v_exp_f32 v170, v170
    v_cvt_pk_bf16_f32 v42, v164, v165
    v_exp_f32 v171, v171
    v_cvt_pk_bf16_f32 v43, v166, v167
    v_exp_f32 v172, v172
    v_cvt_pk_bf16_f32 v44, v168, v169
    v_exp_f32 v173, v173
    v_cvt_pk_bf16_f32 v45, v170, v171
    v_exp_f32 v174, v174
    v_cvt_pk_bf16_f32 v46, v172, v173
    v_exp_f32 v175, v175
    s_setprio 3
    v_cvt_pk_bf16_f32 v47, v174, v175
    s_waitcnt lgkmcnt(3)
    v_mfma_f32_32x32x16_bf16 v[160:175], v[72:75], v[32:35], 0
    ds_read_b128 v[88:91], v56 offset:6144
    s_add_u32 s51, s49, 32768
    buffer_store_dwordx4 v[212:215], v2, s[20:23], s51 offen offset:1024 sc1
    v_exp_f32 v176, v176
    v_exp_f32 v177, v177
    v_smfmac_f32_32x32x32_bf16 v[128:143], v[68:71], v[40:47], v109
    ds_read_b128 v[92:95], v56 offset:7168
    v_exp_f32 v178, v178
    v_exp_f32 v179, v179
    v_smfmac_f32_16x16x64_bf16 v[96:99], v[104:107], v[40:47], v108
    s_setprio 0
    v_exp_f32 v180, v180
    v_exp_f32 v181, v181
    v_exp_f32 v182, v182
    v_exp_f32 v183, v183
    v_exp_f32 v184, v184
    v_cvt_pk_bf16_f32 v48, v176, v177
    v_exp_f32 v185, v185
    v_cvt_pk_bf16_f32 v49, v178, v179
    v_exp_f32 v186, v186
    v_cvt_pk_bf16_f32 v50, v180, v181
    v_exp_f32 v187, v187
    v_cvt_pk_bf16_f32 v51, v182, v183
    v_exp_f32 v188, v188
    v_cvt_pk_bf16_f32 v52, v184, v185
    v_exp_f32 v189, v189
    v_cvt_pk_bf16_f32 v53, v186, v187
    v_exp_f32 v190, v190
    v_cvt_pk_bf16_f32 v54, v188, v189
    v_exp_f32 v191, v191
    s_setprio 3
    v_cvt_pk_bf16_f32 v55, v190, v191
    v_mfma_f32_32x32x16_bf16 v[176:191], v[72:75], v[36:39], 0
    s_add_u32 s51, s48, 49152
    buffer_store_dwordx4 v[224:227], v2, s[20:23], s51 offen offset:0 sc1
    v_exp_f32 v160, v160
    v_exp_f32 v161, v161
    v_smfmac_f32_32x32x32_bf16 v[144:159], v[68:71], v[48:55], v109
    v_exp_f32 v162, v162
    v_exp_f32 v163, v163
    v_smfmac_f32_16x16x64_bf16 v[100:103], v[104:107], v[48:55], v108
    s_setprio 0
    v_exp_f32 v164, v164
    v_exp_f32 v165, v165
    v_exp_f32 v166, v166
    v_exp_f32 v167, v167
    v_exp_f32 v168, v168
    v_cvt_pk_bf16_f32 v40, v160, v161
    v_exp_f32 v169, v169
    v_cvt_pk_bf16_f32 v41, v162, v163
    v_exp_f32 v170, v170
    v_cvt_pk_bf16_f32 v42, v164, v165
    v_exp_f32 v171, v171
    v_cvt_pk_bf16_f32 v43, v166, v167
    v_exp_f32 v172, v172
    v_cvt_pk_bf16_f32 v44, v168, v169
    v_exp_f32 v173, v173
    v_cvt_pk_bf16_f32 v45, v170, v171
    v_exp_f32 v174, v174
    v_cvt_pk_bf16_f32 v46, v172, v173
    v_exp_f32 v175, v175
    v_xor_b32 v56, 0x2000, v56
    s_setprio 3
    v_cvt_pk_bf16_f32 v47, v174, v175
    s_waitcnt lgkmcnt(3)
    v_mfma_f32_32x32x16_bf16 v[160:175], v[80:83], v[32:35], 0
    s_waitcnt vmcnt(4)
    ds_write_b32 v57, v59
    s_add_u32 s51, s48, 49152
    buffer_store_dwordx4 v[228:231], v11, s[20:23], s51 offen offset:0 sc1
    v_exp_f32 v176, v176
    v_exp_f32 v177, v177
    v_smfmac_f32_32x32x32_bf16 v[128:143], v[76:79], v[40:47], v109
    v_exp_f32 v178, v178
    v_exp_f32 v179, v179
    v_smfmac_f32_16x16x64_bf16 v[96:99], v[104:107], v[40:47], v108
    s_setprio 0
    v_exp_f32 v180, v180
    v_exp_f32 v181, v181
    v_exp_f32 v182, v182
    v_exp_f32 v183, v183
    v_exp_f32 v184, v184
    v_cvt_pk_bf16_f32 v48, v176, v177
    v_exp_f32 v185, v185
    v_cvt_pk_bf16_f32 v49, v178, v179
    v_exp_f32 v186, v186
    v_cvt_pk_bf16_f32 v50, v180, v181
    v_exp_f32 v187, v187
    v_cvt_pk_bf16_f32 v51, v182, v183
    v_exp_f32 v188, v188
    v_cvt_pk_bf16_f32 v52, v184, v185
    v_exp_f32 v189, v189
    v_cvt_pk_bf16_f32 v53, v186, v187
    v_exp_f32 v190, v190
    v_cvt_pk_bf16_f32 v54, v188, v189
    v_exp_f32 v191, v191
    s_setprio 3
    v_cvt_pk_bf16_f32 v55, v190, v191
    v_mfma_f32_32x32x16_bf16 v[176:191], v[80:83], v[36:39], 0
    s_xor_b32 m0, m0, s63
    s_add_u32 s62, s62, 8192
    s_cmp_eq_u32 s62, s56
    s_cselect_b32 s62, s61, s62
    s_add_u32 s51, s49, 49152
    buffer_store_dwordx4 v[240:243], v2, s[20:23], s51 offen offset:0 sc1
    v_exp_f32 v160, v160
    v_exp_f32 v161, v161
    v_smfmac_f32_32x32x32_bf16 v[144:159], v[76:79], v[48:55], v109
    ds_read_b32 v60, v58
    v_exp_f32 v162, v162
    v_exp_f32 v163, v163
    v_smfmac_f32_16x16x64_bf16 v[100:103], v[104:107], v[48:55], v108
    s_setprio 0
    v_exp_f32 v164, v164
    v_exp_f32 v165, v165
    v_exp_f32 v166, v166
    v_exp_f32 v167, v167
    v_exp_f32 v168, v168
    v_cvt_pk_bf16_f32 v40, v160, v161
    v_exp_f32 v169, v169
    v_cvt_pk_bf16_f32 v41, v162, v163
    v_exp_f32 v170, v170
    v_cvt_pk_bf16_f32 v42, v164, v165
    v_exp_f32 v171, v171
    v_cvt_pk_bf16_f32 v43, v166, v167
    v_exp_f32 v172, v172
    v_cvt_pk_bf16_f32 v44, v168, v169
    v_exp_f32 v173, v173
    v_cvt_pk_bf16_f32 v45, v170, v171
    v_exp_f32 v174, v174
    v_cvt_pk_bf16_f32 v46, v172, v173
    v_exp_f32 v175, v175
    s_waitcnt lgkmcnt(0)
    v_cmp_gt_u32 vcc, v59, v60
    s_cbranch_vccz LB_p3_ok
LB_p3_sp:
    ds_read_b32 v60, v58
    s_waitcnt lgkmcnt(0)
    v_cmp_gt_u32 vcc, v59, v60
    s_cbranch_vccnz LB_p3_sp
LB_p3_ok:
    s_setprio 3
    v_cvt_pk_bf16_f32 v47, v174, v175
    v_mfma_f32_32x32x16_bf16 v[160:175], v[88:91], v[32:35], 0
    ds_read_b128 v[64:67], v56 offset:0
    s_add_u32 s51, s49, 49152
    buffer_store_dwordx4 v[244:247], v2, s[20:23], s51 offen offset:1024 sc1
    v_exp_f32 v176, v176
    v_exp_f32 v177, v177
    v_smfmac_f32_32x32x32_bf16 v[128:143], v[84:87], v[40:47], v109
    ds_read_b128 v[68:71], v56 offset:1024
    v_exp_f32 v178, v178
    v_exp_f32 v179, v179
    v_smfmac_f32_16x16x64_bf16 v[96:99], v[104:107], v[40:47], v108
    buffer_load_dwordx4 v2, s[20:23], s62 offen offset:0 sc1 lds
    s_setprio 0
    v_exp_f32 v180, v180
    v_exp_f32 v181, v181
    v_exp_f32 v182, v182
    v_exp_f32 v183, v183
    v_exp_f32 v184, v184
    v_cvt_pk_bf16_f32 v48, v176, v177
    v_exp_f32 v185, v185
    v_cvt_pk_bf16_f32 v49, v178, v179
    v_exp_f32 v186, v186
    v_cvt_pk_bf16_f32 v50, v180, v181
    v_exp_f32 v187, v187
    v_cvt_pk_bf16_f32 v51, v182, v183
    v_exp_f32 v188, v188
    v_cvt_pk_bf16_f32 v52, v184, v185
    v_exp_f32 v189, v189
    v_cvt_pk_bf16_f32 v53, v186, v187
    v_exp_f32 v190, v190
    v_cvt_pk_bf16_f32 v54, v188, v189
    v_exp_f32 v191, v191
    s_setprio 3
    v_cvt_pk_bf16_f32 v55, v190, v191
    v_mfma_f32_32x32x16_bf16 v[176:191], v[88:91], v[36:39], 0
    ds_read_b128 v[72:75], v56 offset:2048
    v_exp_f32 v160, v160
    v_exp_f32 v161, v161
    v_smfmac_f32_32x32x32_bf16 v[144:159], v[84:87], v[48:55], v109
    ds_read_b128 v[76:79], v56 offset:3072
    v_exp_f32 v162, v162
    v_exp_f32 v163, v163
    v_smfmac_f32_16x16x64_bf16 v[100:103], v[104:107], v[48:55], v108
    buffer_load_dwordx4 v2, s[20:23], s62 offen offset:1024 sc1 lds
    s_setprio 0
    v_exp_f32 v164, v164
    v_exp_f32 v165, v165
    v_exp_f32 v166, v166
    v_exp_f32 v167, v167
    v_exp_f32 v168, v168
    v_cvt_pk_bf16_f32 v40, v160, v161
    v_exp_f32 v169, v169
    v_cvt_pk_bf16_f32 v41, v162, v163
    v_exp_f32 v170, v170
    v_cvt_pk_bf16_f32 v42, v164, v165
    v_exp_f32 v171, v171
    v_cvt_pk_bf16_f32 v43, v166, v167
    v_exp_f32 v172, v172
    v_cvt_pk_bf16_f32 v44, v168, v169
    v_exp_f32 v173, v173
    v_cvt_pk_bf16_f32 v45, v170, v171
    v_exp_f32 v174, v174
    v_cvt_pk_bf16_f32 v46, v172, v173
    v_exp_f32 v175, v175
    v_add_u32 v59, 1, v59
    s_setprio 3
    v_cvt_pk_bf16_f32 v47, v174, v175
    s_waitcnt lgkmcnt(3)
    v_mfma_f32_32x32x16_bf16 v[160:175], v[64:67], v[32:35], 0
    ds_read_b128 v[80:83], v56 offset:4096
    v_exp_f32 v176, v176
    v_exp_f32 v177, v177
    v_smfmac_f32_32x32x32_bf16 v[128:143], v[92:95], v[40:47], v109
    ds_read_b128 v[84:87], v56 offset:5120
    v_exp_f32 v178, v178
    v_exp_f32 v179, v179
    v_smfmac_f32_16x16x64_bf16 v[96:99], v[104:107], v[40:47], v108
    s_setprio 0
    v_exp_f32 v180, v180
    v_exp_f32 v181, v181
    v_exp_f32 v182, v182
    v_exp_f32 v183, v183
    v_exp_f32 v184, v184
    v_cvt_pk_bf16_f32 v48, v176, v177
    v_exp_f32 v185, v185
    v_cvt_pk_bf16_f32 v49, v178, v179
    v_exp_f32 v186, v186
    v_cvt_pk_bf16_f32 v50, v180, v181
    v_exp_f32 v187, v187
    v_cvt_pk_bf16_f32 v51, v182, v183
    v_exp_f32 v188, v188
    v_cvt_pk_bf16_f32 v52, v184, v185
    v_exp_f32 v189, v189
    v_cvt_pk_bf16_f32 v53, v186, v187
    v_exp_f32 v190, v190
    v_cvt_pk_bf16_f32 v54, v188, v189
    v_exp_f32 v191, v191
    s_mov_b32 s57, 11
    .p2align 6
    s_nop 0
    s_nop 0
    s_nop 0
    s_nop 0
    s_nop 0
    s_nop 0
    s_nop 0
    s_nop 0
    s_nop 0
    s_nop 0
LB_loop:
    s_setprio 3
    v_cvt_pk_bf16_f32 v55, v190, v191
    v_mfma_f32_32x32x16_bf16 v[176:191], v[64:67], v[36:39], 0
    v_exp_f32 v160, v160
    v_exp_f32 v161, v161
    v_smfmac_f32_32x32x32_bf16 v[144:159], v[92:95], v[48:55], v109
    v_exp_f32 v162, v162
    v_exp_f32 v163, v163
    v_smfmac_f32_16x16x64_bf16 v[100:103], v[104:107], v[48:55], v108
    s_setprio 0
    v_exp_f32 v164, v164
    v_exp_f32 v165, v165
    v_exp_f32 v166, v166
    v_exp_f32 v167, v167
    v_exp_f32 v168, v168
    v_cvt_pk_bf16_f32 v40, v160, v161
    v_exp_f32 v169, v169
    v_cvt_pk_bf16_f32 v41, v162, v163
    v_exp_f32 v170, v170
    v_cvt_pk_bf16_f32 v42, v164, v165
    v_exp_f32 v171, v171
    v_cvt_pk_bf16_f32 v43, v166, v167
    v_exp_f32 v172, v172
    v_cvt_pk_bf16_f32 v44, v168, v169
    v_exp_f32 v173, v173
    v_cvt_pk_bf16_f32 v45, v170, v171
    v_exp_f32 v174, v174
    v_cvt_pk_bf16_f32 v46, v172, v173
    v_exp_f32 v175, v175
    s_setprio 3
    v_cvt_pk_bf16_f32 v47, v174, v175
    s_waitcnt lgkmcnt(3)
    v_mfma_f32_32x32x16_bf16 v[160:175], v[72:75], v[32:35], 0
    ds_read_b128 v[88:91], v56 offset:6144
    v_exp_f32 v176, v176
    v_exp_f32 v177, v177
    v_smfmac_f32_32x32x32_bf16 v[128:143], v[68:71], v[40:47], v109
    ds_read_b128 v[92:95], v56 offset:7168
    v_exp_f32 v178, v178
    v_exp_f32 v179, v179
    v_smfmac_f32_16x16x64_bf16 v[96:99], v[104:107], v[40:47], v108
    s_setprio 0
    v_exp_f32 v180, v180
    v_exp_f32 v181, v181
    v_exp_f32 v182, v182
    v_exp_f32 v183, v183
    v_exp_f32 v184, v184
    v_cvt_pk_bf16_f32 v48, v176, v177
    v_exp_f32 v185, v185
    v_cvt_pk_bf16_f32 v49, v178, v179
    v_exp_f32 v186, v186
    v_cvt_pk_bf16_f32 v50, v180, v181
    v_exp_f32 v187, v187
    v_cvt_pk_bf16_f32 v51, v182, v183
    v_exp_f32 v188, v188
    v_cvt_pk_bf16_f32 v52, v184, v185
    v_exp_f32 v189, v189
    v_cvt_pk_bf16_f32 v53, v186, v187
    v_exp_f32 v190, v190
    v_cvt_pk_bf16_f32 v54, v188, v189
    v_exp_f32 v191, v191
    s_setprio 3
    v_cvt_pk_bf16_f32 v55, v190, v191
    v_mfma_f32_32x32x16_bf16 v[176:191], v[72:75], v[36:39], 0
    v_exp_f32 v160, v160
    v_exp_f32 v161, v161
    v_smfmac_f32_32x32x32_bf16 v[144:159], v[68:71], v[48:55], v109
    v_exp_f32 v162, v162
    v_exp_f32 v163, v163
    v_smfmac_f32_16x16x64_bf16 v[100:103], v[104:107], v[48:55], v108
    s_setprio 0
    v_exp_f32 v164, v164
    v_exp_f32 v165, v165
    v_exp_f32 v166, v166
    v_exp_f32 v167, v167
    v_exp_f32 v168, v168
    v_cvt_pk_bf16_f32 v40, v160, v161
    v_exp_f32 v169, v169
    v_cvt_pk_bf16_f32 v41, v162, v163
    v_exp_f32 v170, v170
    v_cvt_pk_bf16_f32 v42, v164, v165
    v_exp_f32 v171, v171
    v_cvt_pk_bf16_f32 v43, v166, v167
    v_exp_f32 v172, v172
    v_cvt_pk_bf16_f32 v44, v168, v169
    v_exp_f32 v173, v173
    v_cvt_pk_bf16_f32 v45, v170, v171
    v_exp_f32 v174, v174
    v_cvt_pk_bf16_f32 v46, v172, v173
    v_exp_f32 v175, v175
    v_xor_b32 v56, 0x2000, v56
    s_setprio 3
    v_cvt_pk_bf16_f32 v47, v174, v175
    s_waitcnt lgkmcnt(3)
    v_mfma_f32_32x32x16_bf16 v[160:175], v[80:83], v[32:35], 0
    s_waitcnt vmcnt(0)
    ds_write_b32 v57, v59
    v_exp_f32 v176, v176
    v_exp_f32 v177, v177
    v_smfmac_f32_32x32x32_bf16 v[128:143], v[76:79], v[40:47], v109
    v_exp_f32 v178, v178
    v_exp_f32 v179, v179
    v_smfmac_f32_16x16x64_bf16 v[96:99], v[104:107], v[40:47], v108
    s_cmp_ge_u32 s57, 3
    s_cbranch_scc1 LB_hand
LB_ret:
    s_setprio 0
    v_exp_f32 v180, v180
    v_exp_f32 v181, v181
    v_exp_f32 v182, v182
    v_exp_f32 v183, v183
    v_exp_f32 v184, v184
    v_cvt_pk_bf16_f32 v48, v176, v177
    v_exp_f32 v185, v185
    v_cvt_pk_bf16_f32 v49, v178, v179
    v_exp_f32 v186, v186
    v_cvt_pk_bf16_f32 v50, v180, v181
    v_exp_f32 v187, v187
    v_cvt_pk_bf16_f32 v51, v182, v183
    v_exp_f32 v188, v188
    v_cvt_pk_bf16_f32 v52, v184, v185
    v_exp_f32 v189, v189
    v_cvt_pk_bf16_f32 v53, v186, v187
    v_exp_f32 v190, v190
    v_cvt_pk_bf16_f32 v54, v188, v189
    v_exp_f32 v191, v191
    s_setprio 3
    v_cvt_pk_bf16_f32 v55, v190, v191
    v_mfma_f32_32x32x16_bf16 v[176:191], v[80:83], v[36:39], 0
    s_xor_b32 m0, m0, s63
    s_add_u32 s62, s62, 8192
    s_cmp_eq_u32 s62, s56
    s_cselect_b32 s62, s61, s62
    v_exp_f32 v160, v160
    v_exp_f32 v161, v161
    v_smfmac_f32_32x32x32_bf16 v[144:159], v[76:79], v[48:55], v109
    ds_read_b32 v60, v58
    v_exp_f32 v162, v162
    v_exp_f32 v163, v163
    v_smfmac_f32_16x16x64_bf16 v[100:103], v[104:107], v[48:55], v108
    s_setprio 0
    v_exp_f32 v164, v164
    v_exp_f32 v165, v165
    v_exp_f32 v166, v166
    v_exp_f32 v167, v167
    v_exp_f32 v168, v168
    v_cvt_pk_bf16_f32 v40, v160, v161
    v_exp_f32 v169, v169
    v_cvt_pk_bf16_f32 v41, v162, v163
    v_exp_f32 v170, v170
    v_cvt_pk_bf16_f32 v42, v164, v165
    v_exp_f32 v171, v171
    v_cvt_pk_bf16_f32 v43, v166, v167
    v_exp_f32 v172, v172
    v_cvt_pk_bf16_f32 v44, v168, v169
    v_exp_f32 v173, v173
    v_cvt_pk_bf16_f32 v45, v170, v171
    v_exp_f32 v174, v174
    v_cvt_pk_bf16_f32 v46, v172, v173
    v_exp_f32 v175, v175
    s_waitcnt lgkmcnt(0)
    v_cmp_gt_u32 vcc, v59, v60
    s_cbranch_vccz LB_l_ok
LB_l_sp:
    ds_read_b32 v60, v58
    s_waitcnt lgkmcnt(0)
    v_cmp_gt_u32 vcc, v59, v60
    s_cbranch_vccnz LB_l_sp
LB_l_ok:
    s_setprio 3
    v_cvt_pk_bf16_f32 v47, v174, v175
    v_mfma_f32_32x32x16_bf16 v[160:175], v[88:91], v[32:35], 0
    ds_read_b128 v[64:67], v56 offset:0
    v_exp_f32 v176, v176
    v_exp_f32 v177, v177
    v_smfmac_f32_32x32x32_bf16 v[128:143], v[84:87], v[40:47], v109
    ds_read_b128 v[68:71], v56 offset:1024
    v_exp_f32 v178, v178
    v_exp_f32 v179, v179
    v_smfmac_f32_16x16x64_bf16 v[96:99], v[104:107], v[40:47], v108
    buffer_load_dwordx4 v2, s[20:23], s62 offen offset:0 sc1 lds
    s_setprio 0
    v_exp_f32 v180, v180
    v_exp_f32 v181, v181
    v_exp_f32 v182, v182
    v_exp_f32 v183, v183
    v_exp_f32 v184, v184
    v_cvt_pk_bf16_f32 v48, v176, v177
    v_exp_f32 v185, v185
    v_cvt_pk_bf16_f32 v49, v178, v179
    v_exp_f32 v186, v186
    v_cvt_pk_bf16_f32 v50, v180, v181
    v_exp_f32 v187, v187
    v_cvt_pk_bf16_f32 v51, v182, v183
    v_exp_f32 v188, v188
    v_cvt_pk_bf16_f32 v52, v184, v185
    v_exp_f32 v189, v189
    v_cvt_pk_bf16_f32 v53, v186, v187
    v_exp_f32 v190, v190
    v_cvt_pk_bf16_f32 v54, v188, v189
    v_exp_f32 v191, v191
    s_setprio 3
    v_cvt_pk_bf16_f32 v55, v190, v191
    v_mfma_f32_32x32x16_bf16 v[176:191], v[88:91], v[36:39], 0
    ds_read_b128 v[72:75], v56 offset:2048
    v_exp_f32 v160, v160
    v_exp_f32 v161, v161
    v_smfmac_f32_32x32x32_bf16 v[144:159], v[84:87], v[48:55], v109
    ds_read_b128 v[76:79], v56 offset:3072
    v_exp_f32 v162, v162
    v_exp_f32 v163, v163
    v_smfmac_f32_16x16x64_bf16 v[100:103], v[104:107], v[48:55], v108
    buffer_load_dwordx4 v2, s[20:23], s62 offen offset:1024 sc1 lds
    s_setprio 0
    v_exp_f32 v164, v164
    v_exp_f32 v165, v165
    v_exp_f32 v166, v166
    v_exp_f32 v167, v167
    v_exp_f32 v168, v168
    v_cvt_pk_bf16_f32 v40, v160, v161
    v_exp_f32 v169, v169
    v_cvt_pk_bf16_f32 v41, v162, v163
    v_exp_f32 v170, v170
    v_cvt_pk_bf16_f32 v42, v164, v165
    v_exp_f32 v171, v171
    v_cvt_pk_bf16_f32 v43, v166, v167
    v_exp_f32 v172, v172
    v_cvt_pk_bf16_f32 v44, v168, v169
    v_exp_f32 v173, v173
    v_cvt_pk_bf16_f32 v45, v170, v171
    v_exp_f32 v174, v174
    v_cvt_pk_bf16_f32 v46, v172, v173
    v_exp_f32 v175, v175
    v_add_u32 v59, 1, v59
    s_setprio 3
    v_cvt_pk_bf16_f32 v47, v174, v175
    s_waitcnt lgkmcnt(3)
    v_mfma_f32_32x32x16_bf16 v[160:175], v[64:67], v[32:35], 0
    ds_read_b128 v[80:83], v56 offset:4096
    v_exp_f32 v176, v176
    v_exp_f32 v177, v177
    v_smfmac_f32_32x32x32_bf16 v[128:143], v[92:95], v[40:47], v109
    ds_read_b128 v[84:87], v56 offset:5120
    s_sub_u32 s57, s57, 1
    v_exp_f32 v178, v178
    v_exp_f32 v179, v179
    v_smfmac_f32_16x16x64_bf16 v[96:99], v[104:107], v[40:47], v108
    s_setprio 0
    v_exp_f32 v180, v180
    v_exp_f32 v181, v181
    v_exp_f32 v182, v182
    v_exp_f32 v183, v183
    v_exp_f32 v184, v184
    v_cvt_pk_bf16_f32 v48, v176, v177
    v_exp_f32 v185, v185
    v_cvt_pk_bf16_f32 v49, v178, v179
    v_exp_f32 v186, v186
    v_cvt_pk_bf16_f32 v50, v180, v181
    v_exp_f32 v187, v187
    v_cvt_pk_bf16_f32 v51, v182, v183
    v_exp_f32 v188, v188
    v_cvt_pk_bf16_f32 v52, v184, v185
    v_exp_f32 v189, v189
    v_cvt_pk_bf16_f32 v53, v186, v187
    v_exp_f32 v190, v190
    v_cvt_pk_bf16_f32 v54, v188, v189
    v_exp_f32 v191, v191
    s_cbranch_scc0 LB_loop
    s_nop 0
    v_cvt_pk_bf16_f32 v55, v190, v191
    s_nop 1
    v_smfmac_f32_32x32x32_bf16 v[144:159], v[92:95], v[48:55], v109
    v_smfmac_f32_16x16x64_bf16 v[100:103], v[104:107], v[48:55], v108
    v_mov_b32 v24, 157696
    ds_read_b32 v25, v24
    s_waitcnt vmcnt(0) lgkmcnt(0)
    v_mov_b32 v59, 64
    ds_write_b32 v57, v59
    v_readfirstlane_b32 s47, v25
    s_nop 1
    s_lshr_b32 s37, s40, 3
    s_sub_u32 s47, 65, s47
    s_cmp_eq_u32 s47, 1
    s_cselect_b32 s38, s41, s44
    s_and_b32 s52, s40, 28
    s_lshl_b32 s52, s52, 13
    s_lshl_b32 s53, s41, 10
    s_add_u32 s52, s52, s53
    s_add_u32 s52, s52, 70255104
    s_lshl_b32 s53, s47, 7
    s_add_u32 s52, s52, s53
    v_bfe_u32 v29, v1, 2, 2
    v_lshlrev_b32 v29, 11, v29
    v_and_or_b32 v29, v1, 3, v29
    v_lshlrev_b32 v29, 2, v29
    buffer_load_dword v10, v29, s[20:23], s52 offen sc1
    v_add_f32 v128, v128, v136
    v_add_f32 v129, v129, v137
    v_add_f32 v130, v130, v138
    v_add_f32 v131, v131, v139
    v_add_f32 v132, v132, v140
    v_add_f32 v133, v133, v141
    v_add_f32 v134, v134, v142
    v_add_f32 v135, v135, v143
    v_add_f32 v144, v144, v152
    v_add_f32 v145, v145, v153
    v_add_f32 v146, v146, v154
    v_add_f32 v147, v147, v155
    v_add_f32 v148, v148, v156
    v_add_f32 v149, v149, v157
    v_add_f32 v150, v150, v158
    v_add_f32 v151, v151, v159
    v_add_f32 v96, v96, v97
    v_add_f32 v100, v100, v101
    v_mov_b32 v27, 0
    v_maximum3_f32 v27, abs(v128), abs(v129), v27
    v_maximum3_f32 v27, abs(v130), abs(v131), v27
    v_maximum3_f32 v27, abs(v132), abs(v133), v27
    v_maximum3_f32 v27, abs(v134), abs(v135), v27
    v_maximum3_f32 v27, abs(v144), abs(v145), v27
    v_maximum3_f32 v27, abs(v146), abs(v147), v27
    v_maximum3_f32 v27, abs(v148), abs(v149), v27
    v_maximum3_f32 v27, abs(v150), abs(v151), v27
    v_mov_b32 v24, 0x21800000
    v_mov_b32 v25, 0x71800000
    v_mov_b32 v26, 0x7e800000
    v_cmp_nge_f32 vcc, v96, v24
    v_cmp_nle_f32 s[92:93], v96, v25
    s_nop 1
    s_or_b64 s[92:93], s[92:93], vcc
    v_cmp_nlt_f32 vcc, v27, v26
    s_nop 1
    s_or_b64 vcc, s[92:93], vcc
    s_cbranch_vccnz LB_fb
    v_mov_b32 v24, 0x21800000
    v_mov_b32 v25, 0x71800000
    v_mov_b32 v26, 0x7e800000
    v_cmp_nge_f32 vcc, v100, v24
    v_cmp_nle_f32 s[92:93], v100, v25
    s_nop 1
    s_or_b64 s[92:93], s[92:93], vcc
    v_cmp_nlt_f32 vcc, v27, v26
    s_nop 1
    s_or_b64 vcc, s[92:93], vcc
    s_cbranch_vccnz LB_fb
LB_norm:
    v_rcp_f32 v24, v96
    s_lshr_b32 s50, s40, 3
    s_mul_i32 s50, s50, 72
    s_and_b32 s51, s40, 7
    s_add_u32 s51, s51, 64
    s_add_u32 s50, s50, s51
    s_lshl_b32 s50, s50, 12
    s_mul_i32 s51, s44, 1179648
    s_add_u32 s50, s50, s51
    s_lshl_b32 s51, s43, 10
    s_add_u32 s50, s50, s51
    s_add_u32 s50, s50, 41943040
    v_mul_f32 v128, v128, v24
    v_mul_f32 v129, v129, v24
    v_mul_f32 v130, v130, v24
    v_mul_f32 v131, v131, v24
    v_mul_f32 v132, v132, v24
    v_mul_f32 v133, v133, v24
    v_mul_f32 v134, v134, v24
    v_mul_f32 v135, v135, v24
    v_cvt_pk_bf16_f32 v128, v128, v129
    v_cvt_pk_bf16_f32 v129, v130, v131
    v_cvt_pk_bf16_f32 v130, v132, v133
    v_cvt_pk_bf16_f32 v131, v134, v135
    buffer_store_dwordx4 v[128:131], v2, s[20:23], s50 offen sc1
    v_rcp_f32 v24, v100
    s_lshr_b32 s50, s40, 3
    s_mul_i32 s50, s50, 72
    s_and_b32 s51, s40, 7
    s_add_u32 s51, s51, 64
    s_add_u32 s50, s50, s51
    s_lshl_b32 s50, s50, 12
    s_mul_i32 s51, s41, 1179648
    s_add_u32 s50, s50, s51
    s_lshl_b32 s51, s43, 10
    s_xor_b32 s51, s51, 3072
    s_add_u32 s50, s50, s51
    s_add_u32 s50, s50, 41943040
    v_mul_f32 v144, v144, v24
    v_mul_f32 v145, v145, v24
    v_mul_f32 v146, v146, v24
    v_mul_f32 v147, v147, v24
    v_mul_f32 v148, v148, v24
    v_mul_f32 v149, v149, v24
    v_mul_f32 v150, v150, v24
    v_mul_f32 v151, v151, v24
    v_cvt_pk_bf16_f32 v144, v144, v145
    v_cvt_pk_bf16_f32 v145, v146, v147
    v_cvt_pk_bf16_f32 v146, v148, v149
    v_cvt_pk_bf16_f32 v147, v150, v151
    buffer_store_dwordx4 v[144:147], v2, s[20:23], s50 offen sc1
    v_and_b32 v24, 7, v1
    v_mul_u32_u24 v24, 260, v24
    v_add_u32 v24, 155648, v24
    s_mul_i32 s50, s37, 294912
    s_lshl_b32 s51, s43, 12
    s_add_u32 s50, s50, s51
    s_mul_i32 s45, s38, 1179648
    s_add_u32 s45, s45, s50
    s_add_u32 s45, s45, 41943040
    s_and_b32 s46, s40, 3
    s_mul_i32 s46, s46, 1179648
    s_add_u32 s46, s46, s50
    s_add_u32 s46, s46, 62914560
    s_and_b32 s48, s40, 4
    s_lshl_b32 s48, s48, 15
    s_and_b32 s94, s40, 3
    s_lshl_b32 s94, s94, 15
    s_cmp_eq_u32 s41, 0
    s_cselect_b32 s50, 1, s47
    s_mul_i32 s94, s94, s50
    s_cmp_eq_u32 s47, 1
    s_cbranch_scc1 LP_S
    s_waitcnt vmcnt(2)
LP_c0_loop:
    v_cmp_ne_u32 vcc, 1, v10
    s_cbranch_vccz LP_c0_ok
    s_sleep 3
    s_and_b32 s52, s40, 28
    s_lshl_b32 s52, s52, 13
    s_lshl_b32 s53, s41, 10
    s_add_u32 s52, s52, s53
    s_add_u32 s52, s52, 70255104
    s_lshl_b32 s53, s47, 7
    s_add_u32 s52, s52, s53
    v_bfe_u32 v29, v1, 2, 2
    v_lshlrev_b32 v29, 11, v29
    v_and_or_b32 v29, v1, 3, v29
    v_lshlrev_b32 v29, 2, v29
    buffer_load_dword v10, v29, s[20:23], s52 offen sc1
    s_waitcnt vmcnt(0)
    s_branch LP_c0_loop
LP_c0_ok:
LP_dn:
    ds_read_b32 v25, v24
    s_waitcnt lgkmcnt(0)
    v_cmp_gt_u32 vcc, 35, v25
    s_cbranch_vccnz LP_dn
    s_and_b32 s52, s40, 28
    s_lshl_b32 s52, s52, 13
    s_lshl_b32 s53, s41, 10
    s_add_u32 s52, s52, s53
    s_add_u32 s52, s52, 70255104
    s_xor_b32 s52, s52, 0x8000
    s_lshl_b32 s53, s47, 7
    s_add_u32 s52, s52, s53
    v_bfe_u32 v29, v1, 2, 2
    v_lshlrev_b32 v29, 11, v29
    v_and_or_b32 v29, v1, 3, v29
    v_lshlrev_b32 v29, 2, v29
    buffer_load_dword v10, v29, s[20:23], s52 offen sc1
    s_add_u32 m0, s51, 65536
    s_add_u32 s50, s94, 0
    s_and_b32 s50, s50, 0x1ffff
    s_or_b32 s50, s50, s48
    s_add_u32 s50, s50, s45
    buffer_load_dwordx4 v2, s[20:23], s50 offen offset:0 sc1 lds
    buffer_load_dwordx4 v2, s[20:23], s50 offen offset:1024 sc1 lds
    buffer_load_dwordx4 v2, s[20:23], s50 offen offset:2048 sc1 lds
    buffer_load_dwordx4 v2, s[20:23], s50 offen offset:3072 sc1 lds
    s_add_u32 m0, s51, 81920
    s_add_u32 s50, s94, 16384
    s_and_b32 s50, s50, 0x1ffff
    s_or_b32 s50, s50, s48
    s_add_u32 s50, s50, s45
    buffer_load_dwordx4 v2, s[20:23], s50 offen offset:0 sc1 lds
    buffer_load_dwordx4 v2, s[20:23], s50 offen offset:1024 sc1 lds
    buffer_load_dwordx4 v2, s[20:23], s50 offen offset:2048 sc1 lds
    buffer_load_dwordx4 v2, s[20:23], s50 offen offset:3072 sc1 lds
    s_add_u32 m0, s51, 131072
    s_add_u32 s50, s94, 32768
    s_and_b32 s50, s50, 0x1ffff
    s_or_b32 s50, s50, s48
    s_add_u32 s50, s50, s45
    buffer_load_dwordx4 v2, s[20:23], s50 offen offset:0 sc1 lds
    buffer_load_dwordx4 v2, s[20:23], s50 offen offset:1024 sc1 lds
    buffer_load_dwordx4 v2, s[20:23], s50 offen offset:2048 sc1 lds
    buffer_load_dwordx4 v2, s[20:23], s50 offen offset:3072 sc1 lds
    s_waitcnt vmcnt(13)
    s_and_b32 s52, s40, 31
    s_lshl_b32 s52, s52, 13
    s_lshl_b32 s53, s41, 10
    s_add_u32 s52, s52, s53
    s_add_u32 s52, s52, 70255360
    s_lshl_b32 s53, s43, 2
    s_add_u32 s52, s52, s53
    v_mov_b32 v29, 1
    s_mov_b64 s[92:93], exec
    s_mov_b64 exec, 1
    buffer_store_dword v29, off, s[20:23], s52 sc1
    s_mov_b64 exec, s[92:93]
    s_waitcnt vmcnt(8)
    s_barrier
    s_add_u32 m0, s51, 147456
    s_add_u32 s50, s94, 49152
    s_and_b32 s50, s50, 0x1ffff
    s_or_b32 s50, s50, s48
    s_add_u32 s50, s50, s45
    buffer_load_dwordx4 v2, s[20:23], s50 offen offset:0 sc1 lds
    buffer_load_dwordx4 v2, s[20:23], s50 offen offset:1024 sc1 lds
    buffer_load_dwordx4 v2, s[20:23], s50 offen offset:2048 sc1 lds
    buffer_load_dwordx4 v2, s[20:23], s50 offen offset:3072 sc1 lds
    s_waitcnt vmcnt(8)
    s_barrier
    s_add_u32 m0, s51, 65536
    s_add_u32 s50, s94, 65536
    s_and_b32 s50, s50, 0x1ffff
    s_or_b32 s50, s50, s48
    s_add_u32 s50, s50, s45
    buffer_load_dwordx4 v2, s[20:23], s50 offen offset:0 sc1 lds
    buffer_load_dwordx4 v2, s[20:23], s50 offen offset:1024 sc1 lds
    buffer_load_dwordx4 v2, s[20:23], s50 offen offset:2048 sc1 lds
    buffer_load_dwordx4 v2, s[20:23], s50 offen offset:3072 sc1 lds
    s_add_u32 m0, s51, 98304
    s_add_u32 s50, s94, 81920
    s_and_b32 s50, s50, 0x1ffff
    s_or_b32 s50, s50, s48
    s_add_u32 s50, s50, s45
    buffer_load_dwordx4 v2, s[20:23], s50 offen offset:0 sc1 lds
    buffer_load_dwordx4 v2, s[20:23], s50 offen offset:1024 sc1 lds
    buffer_load_dwordx4 v2, s[20:23], s50 offen offset:2048 sc1 lds
    buffer_load_dwordx4 v2, s[20:23], s50 offen offset:3072 sc1 lds
    s_waitcnt vmcnt(12)
    s_barrier
    s_add_u32 m0, s51, 81920
    s_add_u32 s50, s94, 98304
    s_and_b32 s50, s50, 0x1ffff
    s_or_b32 s50, s50, s48
    s_add_u32 s50, s50, s45
    buffer_load_dwordx4 v2, s[20:23], s50 offen offset:0 sc1 lds
    buffer_load_dwordx4 v2, s[20:23], s50 offen offset:1024 sc1 lds
    buffer_load_dwordx4 v2, s[20:23], s50 offen offset:2048 sc1 lds
    buffer_load_dwordx4 v2, s[20:23], s50 offen offset:3072 sc1 lds
    s_add_u32 m0, s51, 114688
    s_add_u32 s50, s94, 98304
    s_and_b32 s50, s50, 0x1ffff
    s_or_b32 s50, s50, s48
    s_add_u32 s50, s50, s46
    buffer_load_dwordx4 v2, s[20:23], s50 offen offset:0 sc1 lds
    buffer_load_dwordx4 v2, s[20:23], s50 offen offset:1024 sc1 lds
    buffer_load_dwordx4 v2, s[20:23], s50 offen offset:2048 sc1 lds
    buffer_load_dwordx4 v2, s[20:23], s50 offen offset:3072 sc1 lds
    s_waitcnt vmcnt(16)
    s_barrier
    s_add_u32 m0, s51, 131072
    s_add_u32 s50, s94, 114688
    s_and_b32 s50, s50, 0x1ffff
    s_or_b32 s50, s50, s48
    s_add_u32 s50, s50, s45
    buffer_load_dwordx4 v2, s[20:23], s50 offen offset:0 sc1 lds
    buffer_load_dwordx4 v2, s[20:23], s50 offen offset:1024 sc1 lds
    buffer_load_dwordx4 v2, s[20:23], s50 offen offset:2048 sc1 lds
    buffer_load_dwordx4 v2, s[20:23], s50 offen offset:3072 sc1 lds
    s_add_u32 m0, s51, 0
    s_add_u32 s50, s94, 114688
    s_and_b32 s50, s50, 0x1ffff
    s_or_b32 s50, s50, s48
    s_add_u32 s50, s50, s46
    buffer_load_dwordx4 v2, s[20:23], s50 offen offset:0 sc1 lds
    buffer_load_dwordx4 v2, s[20:23], s50 offen offset:1024 sc1 lds
    buffer_load_dwordx4 v2, s[20:23], s50 offen offset:2048 sc1 lds
    buffer_load_dwordx4 v2, s[20:23], s50 offen offset:3072 sc1 lds
    s_waitcnt vmcnt(20)
    s_barrier
LP_c1l_loop:
    v_cmp_ne_u32 vcc, 1, v10
    s_cbranch_vccz LP_c1l_ok
    s_sleep 3
    s_and_b32 s52, s40, 28
    s_lshl_b32 s52, s52, 13
    s_lshl_b32 s53, s41, 10
    s_add_u32 s52, s52, s53
    s_add_u32 s52, s52, 70255104
    s_xor_b32 s52, s52, 0x8000
    s_lshl_b32 s53, s47, 7
    s_add_u32 s52, s52, s53
    v_bfe_u32 v29, v1, 2, 2
    v_lshlrev_b32 v29, 11, v29
    v_and_or_b32 v29, v1, 3, v29
    v_lshlrev_b32 v29, 2, v29
    buffer_load_dword v10, v29, s[20:23], s52 offen sc1
    s_waitcnt vmcnt(0)
    s_branch LP_c1l_loop
LP_c1l_ok:
    s_and_b32 s52, s40, 24
    s_lshl_b32 s52, s52, 13
    s_lshl_b32 s53, s41, 10
    s_add_u32 s52, s52, s53
    s_add_u32 s52, s52, 70255360
    v_bfe_u32 v29, v1, 2, 3
    v_lshlrev_b32 v29, 11, v29
    v_and_or_b32 v29, v1, 3, v29
    v_lshlrev_b32 v29, 2, v29
    buffer_load_dword v10, v29, s[20:23], s52 offen sc1
    s_add_u32 m0, s51, 147456
    s_add_u32 s50, s94, 0
    s_and_b32 s50, s50, 0x1ffff
    s_or_b32 s50, s50, s48
    s_xor_b32 s50, s50, 0x20000
    s_add_u32 s50, s50, s45
    buffer_load_dwordx4 v2, s[20:23], s50 offen offset:0 sc1 lds
    buffer_load_dwordx4 v2, s[20:23], s50 offen offset:1024 sc1 lds
    buffer_load_dwordx4 v2, s[20:23], s50 offen offset:2048 sc1 lds
    buffer_load_dwordx4 v2, s[20:23], s50 offen offset:3072 sc1 lds
    s_add_u32 m0, s51, 16384
    s_add_u32 s50, s94, 0
    s_and_b32 s50, s50, 0x1ffff
    s_or_b32 s50, s50, s48
    s_xor_b32 s50, s50, 0x20000
    s_add_u32 s50, s50, s46
    buffer_load_dwordx4 v2, s[20:23], s50 offen offset:0 sc1 lds
    buffer_load_dwordx4 v2, s[20:23], s50 offen offset:1024 sc1 lds
    buffer_load_dwordx4 v2, s[20:23], s50 offen offset:2048 sc1 lds
    buffer_load_dwordx4 v2, s[20:23], s50 offen offset:3072 sc1 lds
    s_waitcnt vmcnt(25)
    s_barrier
    s_add_u32 m0, s51, 65536
    s_add_u32 s50, s94, 16384
    s_and_b32 s50, s50, 0x1ffff
    s_or_b32 s50, s50, s48
    s_xor_b32 s50, s50, 0x20000
    s_add_u32 s50, s50, s45
    buffer_load_dwordx4 v2, s[20:23], s50 offen offset:0 sc1 lds
    buffer_load_dwordx4 v2, s[20:23], s50 offen offset:1024 sc1 lds
    buffer_load_dwordx4 v2, s[20:23], s50 offen offset:2048 sc1 lds
    buffer_load_dwordx4 v2, s[20:23], s50 offen offset:3072 sc1 lds
    s_add_u32 m0, s51, 32768
    s_add_u32 s50, s94, 16384
    s_and_b32 s50, s50, 0x1ffff
    s_or_b32 s50, s50, s48
    s_xor_b32 s50, s50, 0x20000
    s_add_u32 s50, s50, s46
    buffer_load_dwordx4 v2, s[20:23], s50 offen offset:0 sc1 lds
    buffer_load_dwordx4 v2, s[20:23], s50 offen offset:1024 sc1 lds
    buffer_load_dwordx4 v2, s[20:23], s50 offen offset:2048 sc1 lds
    buffer_load_dwordx4 v2, s[20:23], s50 offen offset:3072 sc1 lds
    s_waitcnt vmcnt(25)
    s_barrier
    s_add_u32 m0, s51, 98304
    s_add_u32 s50, s94, 32768
    s_and_b32 s50, s50, 0x1ffff
    s_or_b32 s50, s50, s48
    s_xor_b32 s50, s50, 0x20000
    s_add_u32 s50, s50, s45
    buffer_load_dwordx4 v2, s[20:23], s50 offen offset:0 sc1 lds
    buffer_load_dwordx4 v2, s[20:23], s50 offen offset:1024 sc1 lds
    buffer_load_dwordx4 v2, s[20:23], s50 offen offset:2048 sc1 lds
    buffer_load_dwordx4 v2, s[20:23], s50 offen offset:3072 sc1 lds
    s_add_u32 m0, s51, 49152
    s_add_u32 s50, s94, 32768
    s_and_b32 s50, s50, 0x1ffff
    s_or_b32 s50, s50, s48
    s_xor_b32 s50, s50, 0x20000
    s_add_u32 s50, s50, s46
    buffer_load_dwordx4 v2, s[20:23], s50 offen offset:0 sc1 lds
    buffer_load_dwordx4 v2, s[20:23], s50 offen offset:1024 sc1 lds
    buffer_load_dwordx4 v2, s[20:23], s50 offen offset:2048 sc1 lds
    buffer_load_dwordx4 v2, s[20:23], s50 offen offset:3072 sc1 lds
    s_waitcnt vmcnt(25)
    s_barrier
    s_add_u32 m0, s51, 81920
    s_add_u32 s50, s94, 49152
    s_and_b32 s50, s50, 0x1ffff
    s_or_b32 s50, s50, s48
    s_xor_b32 s50, s50, 0x20000
    s_add_u32 s50, s50, s45
    buffer_load_dwordx4 v2, s[20:23], s50 offen offset:0 sc1 lds
    buffer_load_dwordx4 v2, s[20:23], s50 offen offset:1024 sc1 lds
    buffer_load_dwordx4 v2, s[20:23], s50 offen offset:2048 sc1 lds
    buffer_load_dwordx4 v2, s[20:23], s50 offen offset:3072 sc1 lds
    s_add_u32 m0, s51, 114688
    s_add_u32 s50, s94, 49152
    s_and_b32 s50, s50, 0x1ffff
    s_or_b32 s50, s50, s48
    s_xor_b32 s50, s50, 0x20000
    s_add_u32 s50, s50, s46
    buffer_load_dwordx4 v2, s[20:23], s50 offen offset:0 sc1 lds
    buffer_load_dwordx4 v2, s[20:23], s50 offen offset:1024 sc1 lds
    buffer_load_dwordx4 v2, s[20:23], s50 offen offset:2048 sc1 lds
    buffer_load_dwordx4 v2, s[20:23], s50 offen offset:3072 sc1 lds
    s_waitcnt vmcnt(24)
    s_barrier
    s_add_u32 m0, s51, 131072
    s_add_u32 s50, s94, 65536
    s_and_b32 s50, s50, 0x1ffff
    s_or_b32 s50, s50, s48
    s_xor_b32 s50, s50, 0x20000
    s_add_u32 s50, s50, s45
    buffer_load_dwordx4 v2, s[20:23], s50 offen offset:0 sc1 lds
    buffer_load_dwordx4 v2, s[20:23], s50 offen offset:1024 sc1 lds
    buffer_load_dwordx4 v2, s[20:23], s50 offen offset:2048 sc1 lds
    buffer_load_dwordx4 v2, s[20:23], s50 offen offset:3072 sc1 lds
    s_add_u32 m0, s51, 0
    s_add_u32 s50, s94, 65536
    s_and_b32 s50, s50, 0x1ffff
    s_or_b32 s50, s50, s48
    s_xor_b32 s50, s50, 0x20000
    s_add_u32 s50, s50, s46
    buffer_load_dwordx4 v2, s[20:23], s50 offen offset:0 sc1 lds
    buffer_load_dwordx4 v2, s[20:23], s50 offen offset:1024 sc1 lds
    buffer_load_dwordx4 v2, s[20:23], s50 offen offset:2048 sc1 lds
    buffer_load_dwordx4 v2, s[20:23], s50 offen offset:3072 sc1 lds
    s_waitcnt vmcnt(24)
    s_barrier
    s_add_u32 m0, s51, 147456
    s_add_u32 s50, s94, 81920
    s_and_b32 s50, s50, 0x1ffff
    s_or_b32 s50, s50, s48
    s_xor_b32 s50, s50, 0x20000
    s_add_u32 s50, s50, s45
    buffer_load_dwordx4 v2, s[20:23], s50 offen offset:0 sc1 lds
    buffer_load_dwordx4 v2, s[20:23], s50 offen offset:1024 sc1 lds
    buffer_load_dwordx4 v2, s[20:23], s50 offen offset:2048 sc1 lds
    buffer_load_dwordx4 v2, s[20:23], s50 offen offset:3072 sc1 lds
    s_add_u32 m0, s51, 16384
    s_add_u32 s50, s94, 81920
    s_and_b32 s50, s50, 0x1ffff
    s_or_b32 s50, s50, s48
    s_xor_b32 s50, s50, 0x20000
    s_add_u32 s50, s50, s46
    buffer_load_dwordx4 v2, s[20:23], s50 offen offset:0 sc1 lds
    buffer_load_dwordx4 v2, s[20:23], s50 offen offset:1024 sc1 lds
    buffer_load_dwordx4 v2, s[20:23], s50 offen offset:2048 sc1 lds
    buffer_load_dwordx4 v2, s[20:23], s50 offen offset:3072 sc1 lds
    s_waitcnt vmcnt(24)
    s_barrier
    s_add_u32 m0, s51, 65536
    s_add_u32 s50, s94, 98304
    s_and_b32 s50, s50, 0x1ffff
    s_or_b32 s50, s50, s48
    s_xor_b32 s50, s50, 0x20000
    s_add_u32 s50, s50, s45
    buffer_load_dwordx4 v2, s[20:23], s50 offen offset:0 sc1 lds
    buffer_load_dwordx4 v2, s[20:23], s50 offen offset:1024 sc1 lds
    buffer_load_dwordx4 v2, s[20:23], s50 offen offset:2048 sc1 lds
    buffer_load_dwordx4 v2, s[20:23], s50 offen offset:3072 sc1 lds
    s_add_u32 m0, s51, 32768
    s_add_u32 s50, s94, 98304
    s_and_b32 s50, s50, 0x1ffff
    s_or_b32 s50, s50, s48
    s_xor_b32 s50, s50, 0x20000
    s_add_u32 s50, s50, s46
    buffer_load_dwordx4 v2, s[20:23], s50 offen offset:0 sc1 lds
    buffer_load_dwordx4 v2, s[20:23], s50 offen offset:1024 sc1 lds
    buffer_load_dwordx4 v2, s[20:23], s50 offen offset:2048 sc1 lds
    buffer_load_dwordx4 v2, s[20:23], s50 offen offset:3072 sc1 lds
    s_waitcnt vmcnt(24)
    s_barrier
    s_add_u32 m0, s51, 98304
    s_add_u32 s50, s94, 114688
    s_and_b32 s50, s50, 0x1ffff
    s_or_b32 s50, s50, s48
    s_xor_b32 s50, s50, 0x20000
    s_add_u32 s50, s50, s45
    buffer_load_dwordx4 v2, s[20:23], s50 offen offset:0 sc1 lds
    buffer_load_dwordx4 v2, s[20:23], s50 offen offset:1024 sc1 lds
    buffer_load_dwordx4 v2, s[20:23], s50 offen offset:2048 sc1 lds
    buffer_load_dwordx4 v2, s[20:23], s50 offen offset:3072 sc1 lds
    s_add_u32 m0, s51, 49152
    s_add_u32 s50, s94, 114688
    s_and_b32 s50, s50, 0x1ffff
    s_or_b32 s50, s50, s48
    s_xor_b32 s50, s50, 0x20000
    s_add_u32 s50, s50, s46
    buffer_load_dwordx4 v2, s[20:23], s50 offen offset:0 sc1 lds
    buffer_load_dwordx4 v2, s[20:23], s50 offen offset:1024 sc1 lds
    buffer_load_dwordx4 v2, s[20:23], s50 offen offset:2048 sc1 lds
    buffer_load_dwordx4 v2, s[20:23], s50 offen offset:3072 sc1 lds
    s_waitcnt vmcnt(24)
    s_barrier
LP_cbl_loop:
    v_cmp_ne_u32 vcc, 1, v10
    s_cbranch_vccz LP_cbl_ok
    s_sleep 3
    s_and_b32 s52, s40, 24
    s_lshl_b32 s52, s52, 13
    s_lshl_b32 s53, s41, 10
    s_add_u32 s52, s52, s53
    s_add_u32 s52, s52, 70255360
    v_bfe_u32 v29, v1, 2, 3
    v_lshlrev_b32 v29, 11, v29
    v_and_or_b32 v29, v1, 3, v29
    v_lshlrev_b32 v29, 2, v29
    buffer_load_dword v10, v29, s[20:23], s52 offen sc1
    s_waitcnt vmcnt(0)
    s_branch LP_cbl_loop
LP_cbl_ok:
    s_add_u32 m0, s51, 81920
    s_add_u32 s50, s45, 262144
    buffer_load_dwordx4 v2, s[20:23], s50 offen offset:0 sc1 lds
    buffer_load_dwordx4 v2, s[20:23], s50 offen offset:1024 sc1 lds
    buffer_load_dwordx4 v2, s[20:23], s50 offen offset:2048 sc1 lds
    buffer_load_dwordx4 v2, s[20:23], s50 offen offset:3072 sc1 lds
    s_add_u32 m0, s51, 114688
    s_add_u32 s50, s46, 262144
    buffer_load_dwordx4 v2, s[20:23], s50 offen offset:0 sc1 lds
    buffer_load_dwordx4 v2, s[20:23], s50 offen offset:1024 sc1 lds
    buffer_load_dwordx4 v2, s[20:23], s50 offen offset:2048 sc1 lds
    buffer_load_dwordx4 v2, s[20:23], s50 offen offset:3072 sc1 lds
    s_waitcnt vmcnt(24)
    s_barrier
    s_add_u32 m0, s51, 131072
    s_add_u32 s50, s45, 278528
    buffer_load_dwordx4 v2, s[20:23], s50 offen offset:0 sc1 lds
    buffer_load_dwordx4 v2, s[20:23], s50 offen offset:1024 sc1 lds
    buffer_load_dwordx4 v2, s[20:23], s50 offen offset:2048 sc1 lds
    buffer_load_dwordx4 v2, s[20:23], s50 offen offset:3072 sc1 lds
    s_add_u32 m0, s51, 0
    s_add_u32 s50, s46, 278528
    buffer_load_dwordx4 v2, s[20:23], s50 offen offset:0 sc1 lds
    buffer_load_dwordx4 v2, s[20:23], s50 offen offset:1024 sc1 lds
    buffer_load_dwordx4 v2, s[20:23], s50 offen offset:2048 sc1 lds
    buffer_load_dwordx4 v2, s[20:23], s50 offen offset:3072 sc1 lds
    s_waitcnt vmcnt(24)
    s_barrier
    s_waitcnt vmcnt(16)
    s_barrier
    s_waitcnt vmcnt(8)
    s_barrier
    s_waitcnt vmcnt(0)
    s_barrier
    s_branch LP_end
LP_S:
    s_barrier
    s_waitcnt vmcnt(0)
    s_and_b32 s52, s40, 31
    s_lshl_b32 s52, s52, 13
    s_lshl_b32 s53, s41, 10
    s_add_u32 s52, s52, s53
    s_add_u32 s52, s52, 70255360
    s_lshl_b32 s53, s43, 2
    s_add_u32 s52, s52, s53
    v_mov_b32 v29, 1
    s_mov_b64 s[92:93], exec
    s_mov_b64 exec, 1
    buffer_store_dword v29, off, s[20:23], s52 sc1
    s_mov_b64 exec, s[92:93]
    s_barrier
    s_and_b32 s52, s40, 28
    s_lshl_b32 s52, s52, 13
    s_lshl_b32 s53, s41, 10
    s_add_u32 s52, s52, s53
    s_add_u32 s52, s52, 70255104
    s_lshl_b32 s53, s47, 7
    s_add_u32 s52, s52, s53
    v_bfe_u32 v29, v1, 2, 2
    v_lshlrev_b32 v29, 11, v29
    v_and_or_b32 v29, v1, 3, v29
    v_lshlrev_b32 v29, 2, v29
    buffer_load_dword v10, v29, s[20:23], s52 offen sc1
    s_waitcnt vmcnt(0)
LP_c0s_loop:
    v_cmp_ne_u32 vcc, 1, v10
    s_cbranch_vccz LP_c0s_ok
    s_sleep 3
    s_and_b32 s52, s40, 28
    s_lshl_b32 s52, s52, 13
    s_lshl_b32 s53, s41, 10
    s_add_u32 s52, s52, s53
    s_add_u32 s52, s52, 70255104
    s_lshl_b32 s53, s47, 7
    s_add_u32 s52, s52, s53
    v_bfe_u32 v29, v1, 2, 2
    v_lshlrev_b32 v29, 11, v29
    v_and_or_b32 v29, v1, 3, v29
    v_lshlrev_b32 v29, 2, v29
    buffer_load_dword v10, v29, s[20:23], s52 offen sc1
    s_waitcnt vmcnt(0)
    s_branch LP_c0s_loop
LP_c0s_ok:
    s_and_b32 s52, s40, 28
    s_lshl_b32 s52, s52, 13
    s_lshl_b32 s53, s41, 10
    s_add_u32 s52, s52, s53
    s_add_u32 s52, s52, 70255104
    s_xor_b32 s52, s52, 0x8000
    s_lshl_b32 s53, s47, 7
    s_add_u32 s52, s52, s53
    v_bfe_u32 v29, v1, 2, 2
    v_lshlrev_b32 v29, 11, v29
    v_and_or_b32 v29, v1, 3, v29
    v_lshlrev_b32 v29, 2, v29
    buffer_load_dword v10, v29, s[20:23], s52 offen sc1
    s_add_u32 m0, s51, 131072
    s_add_u32 s50, s94, 32768
    s_and_b32 s50, s50, 0x1ffff
    s_or_b32 s50, s50, s48
    s_add_u32 s50, s50, s45
    buffer_load_dwordx4 v2, s[20:23], s50 offen offset:0 sc1 lds
    buffer_load_dwordx4 v2, s[20:23], s50 offen offset:1024 sc1 lds
    buffer_load_dwordx4 v2, s[20:23], s50 offen offset:2048 sc1 lds
    buffer_load_dwordx4 v2, s[20:23], s50 offen offset:3072 sc1 lds
    s_add_u32 m0, s51, 147456
    s_add_u32 s50, s94, 49152
    s_and_b32 s50, s50, 0x1ffff
    s_or_b32 s50, s50, s48
    s_add_u32 s50, s50, s45
    buffer_load_dwordx4 v2, s[20:23], s50 offen offset:0 sc1 lds
    buffer_load_dwordx4 v2, s[20:23], s50 offen offset:1024 sc1 lds
    buffer_load_dwordx4 v2, s[20:23], s50 offen offset:2048 sc1 lds
    buffer_load_dwordx4 v2, s[20:23], s50 offen offset:3072 sc1 lds
    s_add_u32 m0, s51, 65536
    s_add_u32 s50, s94, 65536
    s_and_b32 s50, s50, 0x1ffff
    s_or_b32 s50, s50, s48
    s_add_u32 s50, s50, s45
    buffer_load_dwordx4 v2, s[20:23], s50 offen offset:0 sc1 lds
    buffer_load_dwordx4 v2, s[20:23], s50 offen offset:1024 sc1 lds
    buffer_load_dwordx4 v2, s[20:23], s50 offen offset:2048 sc1 lds
    buffer_load_dwordx4 v2, s[20:23], s50 offen offset:3072 sc1 lds
    s_add_u32 m0, s51, 98304
    s_add_u32 s50, s94, 81920
    s_and_b32 s50, s50, 0x1ffff
    s_or_b32 s50, s50, s48
    s_add_u32 s50, s50, s45
    buffer_load_dwordx4 v2, s[20:23], s50 offen offset:0 sc1 lds
    buffer_load_dwordx4 v2, s[20:23], s50 offen offset:1024 sc1 lds
    buffer_load_dwordx4 v2, s[20:23], s50 offen offset:2048 sc1 lds
    buffer_load_dwordx4 v2, s[20:23], s50 offen offset:3072 sc1 lds
    s_waitcnt vmcnt(12)
    s_barrier
    s_add_u32 m0, s51, 81920
    s_add_u32 s50, s94, 98304
    s_and_b32 s50, s50, 0x1ffff
    s_or_b32 s50, s50, s48
    s_add_u32 s50, s50, s45
    buffer_load_dwordx4 v2, s[20:23], s50 offen offset:0 sc1 lds
    buffer_load_dwordx4 v2, s[20:23], s50 offen offset:1024 sc1 lds
    buffer_load_dwordx4 v2, s[20:23], s50 offen offset:2048 sc1 lds
    buffer_load_dwordx4 v2, s[20:23], s50 offen offset:3072 sc1 lds
    s_add_u32 m0, s51, 114688
    s_add_u32 s50, s94, 98304
    s_and_b32 s50, s50, 0x1ffff
    s_or_b32 s50, s50, s48
    s_add_u32 s50, s50, s46
    buffer_load_dwordx4 v2, s[20:23], s50 offen offset:0 sc1 lds
    buffer_load_dwordx4 v2, s[20:23], s50 offen offset:1024 sc1 lds
    buffer_load_dwordx4 v2, s[20:23], s50 offen offset:2048 sc1 lds
    buffer_load_dwordx4 v2, s[20:23], s50 offen offset:3072 sc1 lds
    s_waitcnt vmcnt(16)
    s_barrier
    s_add_u32 m0, s51, 131072
    s_add_u32 s50, s94, 114688
    s_and_b32 s50, s50, 0x1ffff
    s_or_b32 s50, s50, s48
    s_add_u32 s50, s50, s45
    buffer_load_dwordx4 v2, s[20:23], s50 offen offset:0 sc1 lds
    buffer_load_dwordx4 v2, s[20:23], s50 offen offset:1024 sc1 lds
    buffer_load_dwordx4 v2, s[20:23], s50 offen offset:2048 sc1 lds
    buffer_load_dwordx4 v2, s[20:23], s50 offen offset:3072 sc1 lds
    s_add_u32 m0, s51, 0
    s_add_u32 s50, s94, 114688
    s_and_b32 s50, s50, 0x1ffff
    s_or_b32 s50, s50, s48
    s_add_u32 s50, s50, s46
    buffer_load_dwordx4 v2, s[20:23], s50 offen offset:0 sc1 lds
    buffer_load_dwordx4 v2, s[20:23], s50 offen offset:1024 sc1 lds
    buffer_load_dwordx4 v2, s[20:23], s50 offen offset:2048 sc1 lds
    buffer_load_dwordx4 v2, s[20:23], s50 offen offset:3072 sc1 lds
    s_waitcnt vmcnt(20)
    s_barrier
LP_c1s_loop:
    v_cmp_ne_u32 vcc, 1, v10
    s_cbranch_vccz LP_c1s_ok
    s_sleep 3
    s_and_b32 s52, s40, 28
    s_lshl_b32 s52, s52, 13
    s_lshl_b32 s53, s41, 10
    s_add_u32 s52, s52, s53
    s_add_u32 s52, s52, 70255104
    s_xor_b32 s52, s52, 0x8000
    s_lshl_b32 s53, s47, 7
    s_add_u32 s52, s52, s53
    v_bfe_u32 v29, v1, 2, 2
    v_lshlrev_b32 v29, 11, v29
    v_and_or_b32 v29, v1, 3, v29
    v_lshlrev_b32 v29, 2, v29
    buffer_load_dword v10, v29, s[20:23], s52 offen sc1
    s_waitcnt vmcnt(0)
    s_branch LP_c1s_loop
LP_c1s_ok:
    s_and_b32 s52, s40, 24
    s_lshl_b32 s52, s52, 13
    s_lshl_b32 s53, s41, 10
    s_add_u32 s52, s52, s53
    s_add_u32 s52, s52, 70255360
    v_bfe_u32 v29, v1, 2, 3
    v_lshlrev_b32 v29, 11, v29
    v_and_or_b32 v29, v1, 3, v29
    v_lshlrev_b32 v29, 2, v29
    buffer_load_dword v10, v29, s[20:23], s52 offen sc1
    s_add_u32 m0, s51, 147456
    s_add_u32 s50, s94, 0
    s_and_b32 s50, s50, 0x1ffff
    s_or_b32 s50, s50, s48
    s_xor_b32 s50, s50, 0x20000
    s_add_u32 s50, s50, s45
    buffer_load_dwordx4 v2, s[20:23], s50 offen offset:0 sc1 lds
    buffer_load_dwordx4 v2, s[20:23], s50 offen offset:1024 sc1 lds
    buffer_load_dwordx4 v2, s[20:23], s50 offen offset:2048 sc1 lds
    buffer_load_dwordx4 v2, s[20:23], s50 offen offset:3072 sc1 lds
    s_add_u32 m0, s51, 16384
    s_add_u32 s50, s94, 0
    s_and_b32 s50, s50, 0x1ffff
    s_or_b32 s50, s50, s48
    s_xor_b32 s50, s50, 0x20000
    s_add_u32 s50, s50, s46
    buffer_load_dwordx4 v2, s[20:23], s50 offen offset:0 sc1 lds
    buffer_load_dwordx4 v2, s[20:23], s50 offen offset:1024 sc1 lds
    buffer_load_dwordx4 v2, s[20:23], s50 offen offset:2048 sc1 lds
    buffer_load_dwordx4 v2, s[20:23], s50 offen offset:3072 sc1 lds
    s_waitcnt vmcnt(25)
    s_barrier
    s_add_u32 m0, s51, 65536
    s_add_u32 s50, s94, 16384
    s_and_b32 s50, s50, 0x1ffff
    s_or_b32 s50, s50, s48
    s_xor_b32 s50, s50, 0x20000
    s_add_u32 s50, s50, s45
    buffer_load_dwordx4 v2, s[20:23], s50 offen offset:0 sc1 lds
    buffer_load_dwordx4 v2, s[20:23], s50 offen offset:1024 sc1 lds
    buffer_load_dwordx4 v2, s[20:23], s50 offen offset:2048 sc1 lds
    buffer_load_dwordx4 v2, s[20:23], s50 offen offset:3072 sc1 lds
    s_add_u32 m0, s51, 32768
    s_add_u32 s50, s94, 16384
    s_and_b32 s50, s50, 0x1ffff
    s_or_b32 s50, s50, s48
    s_xor_b32 s50, s50, 0x20000
    s_add_u32 s50, s50, s46
    buffer_load_dwordx4 v2, s[20:23], s50 offen offset:0 sc1 lds
    buffer_load_dwordx4 v2, s[20:23], s50 offen offset:1024 sc1 lds
    buffer_load_dwordx4 v2, s[20:23], s50 offen offset:2048 sc1 lds
    buffer_load_dwordx4 v2, s[20:23], s50 offen offset:3072 sc1 lds
    s_waitcnt vmcnt(25)
    s_barrier
    s_add_u32 m0, s51, 98304
    s_add_u32 s50, s94, 32768
    s_and_b32 s50, s50, 0x1ffff
    s_or_b32 s50, s50, s48
    s_xor_b32 s50, s50, 0x20000
    s_add_u32 s50, s50, s45
    buffer_load_dwordx4 v2, s[20:23], s50 offen offset:0 sc1 lds
    buffer_load_dwordx4 v2, s[20:23], s50 offen offset:1024 sc1 lds
    buffer_load_dwordx4 v2, s[20:23], s50 offen offset:2048 sc1 lds
    buffer_load_dwordx4 v2, s[20:23], s50 offen offset:3072 sc1 lds
    s_add_u32 m0, s51, 49152
    s_add_u32 s50, s94, 32768
    s_and_b32 s50, s50, 0x1ffff
    s_or_b32 s50, s50, s48
    s_xor_b32 s50, s50, 0x20000
    s_add_u32 s50, s50, s46
    buffer_load_dwordx4 v2, s[20:23], s50 offen offset:0 sc1 lds
    buffer_load_dwordx4 v2, s[20:23], s50 offen offset:1024 sc1 lds
    buffer_load_dwordx4 v2, s[20:23], s50 offen offset:2048 sc1 lds
    buffer_load_dwordx4 v2, s[20:23], s50 offen offset:3072 sc1 lds
    s_waitcnt vmcnt(25)
    s_barrier
    s_add_u32 m0, s51, 81920
    s_add_u32 s50, s94, 49152
    s_and_b32 s50, s50, 0x1ffff
    s_or_b32 s50, s50, s48
    s_xor_b32 s50, s50, 0x20000
    s_add_u32 s50, s50, s45
    buffer_load_dwordx4 v2, s[20:23], s50 offen offset:0 sc1 lds
    buffer_load_dwordx4 v2, s[20:23], s50 offen offset:1024 sc1 lds
    buffer_load_dwordx4 v2, s[20:23], s50 offen offset:2048 sc1 lds
    buffer_load_dwordx4 v2, s[20:23], s50 offen offset:3072 sc1 lds
    s_add_u32 m0, s51, 114688
    s_add_u32 s50, s94, 49152
    s_and_b32 s50, s50, 0x1ffff
    s_or_b32 s50, s50, s48
    s_xor_b32 s50, s50, 0x20000
    s_add_u32 s50, s50, s46
    buffer_load_dwordx4 v2, s[20:23], s50 offen offset:0 sc1 lds
    buffer_load_dwordx4 v2, s[20:23], s50 offen offset:1024 sc1 lds
    buffer_load_dwordx4 v2, s[20:23], s50 offen offset:2048 sc1 lds
    buffer_load_dwordx4 v2, s[20:23], s50 offen offset:3072 sc1 lds
    s_waitcnt vmcnt(24)
    s_barrier
    s_add_u32 m0, s51, 131072
    s_add_u32 s50, s94, 65536
    s_and_b32 s50, s50, 0x1ffff
    s_or_b32 s50, s50, s48
    s_xor_b32 s50, s50, 0x20000
    s_add_u32 s50, s50, s45
    buffer_load_dwordx4 v2, s[20:23], s50 offen offset:0 sc1 lds
    buffer_load_dwordx4 v2, s[20:23], s50 offen offset:1024 sc1 lds
    buffer_load_dwordx4 v2, s[20:23], s50 offen offset:2048 sc1 lds
    buffer_load_dwordx4 v2, s[20:23], s50 offen offset:3072 sc1 lds
    s_add_u32 m0, s51, 0
    s_add_u32 s50, s94, 65536
    s_and_b32 s50, s50, 0x1ffff
    s_or_b32 s50, s50, s48
    s_xor_b32 s50, s50, 0x20000
    s_add_u32 s50, s50, s46
    buffer_load_dwordx4 v2, s[20:23], s50 offen offset:0 sc1 lds
    buffer_load_dwordx4 v2, s[20:23], s50 offen offset:1024 sc1 lds
    buffer_load_dwordx4 v2, s[20:23], s50 offen offset:2048 sc1 lds
    buffer_load_dwordx4 v2, s[20:23], s50 offen offset:3072 sc1 lds
    s_waitcnt vmcnt(24)
    s_barrier
    s_add_u32 m0, s51, 147456
    s_add_u32 s50, s94, 81920
    s_and_b32 s50, s50, 0x1ffff
    s_or_b32 s50, s50, s48
    s_xor_b32 s50, s50, 0x20000
    s_add_u32 s50, s50, s45
    buffer_load_dwordx4 v2, s[20:23], s50 offen offset:0 sc1 lds
    buffer_load_dwordx4 v2, s[20:23], s50 offen offset:1024 sc1 lds
    buffer_load_dwordx4 v2, s[20:23], s50 offen offset:2048 sc1 lds
    buffer_load_dwordx4 v2, s[20:23], s50 offen offset:3072 sc1 lds
    s_add_u32 m0, s51, 16384
    s_add_u32 s50, s94, 81920
    s_and_b32 s50, s50, 0x1ffff
    s_or_b32 s50, s50, s48
    s_xor_b32 s50, s50, 0x20000
    s_add_u32 s50, s50, s46
    buffer_load_dwordx4 v2, s[20:23], s50 offen offset:0 sc1 lds
    buffer_load_dwordx4 v2, s[20:23], s50 offen offset:1024 sc1 lds
    buffer_load_dwordx4 v2, s[20:23], s50 offen offset:2048 sc1 lds
    buffer_load_dwordx4 v2, s[20:23], s50 offen offset:3072 sc1 lds
    s_waitcnt vmcnt(24)
    s_barrier
    s_add_u32 m0, s51, 65536
    s_add_u32 s50, s94, 98304
    s_and_b32 s50, s50, 0x1ffff
    s_or_b32 s50, s50, s48
    s_xor_b32 s50, s50, 0x20000
    s_add_u32 s50, s50, s45
    buffer_load_dwordx4 v2, s[20:23], s50 offen offset:0 sc1 lds
    buffer_load_dwordx4 v2, s[20:23], s50 offen offset:1024 sc1 lds
    buffer_load_dwordx4 v2, s[20:23], s50 offen offset:2048 sc1 lds
    buffer_load_dwordx4 v2, s[20:23], s50 offen offset:3072 sc1 lds
    s_add_u32 m0, s51, 32768
    s_add_u32 s50, s94, 98304
    s_and_b32 s50, s50, 0x1ffff
    s_or_b32 s50, s50, s48
    s_xor_b32 s50, s50, 0x20000
    s_add_u32 s50, s50, s46
    buffer_load_dwordx4 v2, s[20:23], s50 offen offset:0 sc1 lds
    buffer_load_dwordx4 v2, s[20:23], s50 offen offset:1024 sc1 lds
    buffer_load_dwordx4 v2, s[20:23], s50 offen offset:2048 sc1 lds
    buffer_load_dwordx4 v2, s[20:23], s50 offen offset:3072 sc1 lds
    s_waitcnt vmcnt(24)
    s_barrier
    s_add_u32 m0, s51, 98304
    s_add_u32 s50, s94, 114688
    s_and_b32 s50, s50, 0x1ffff
    s_or_b32 s50, s50, s48
    s_xor_b32 s50, s50, 0x20000
    s_add_u32 s50, s50, s45
    buffer_load_dwordx4 v2, s[20:23], s50 offen offset:0 sc1 lds
    buffer_load_dwordx4 v2, s[20:23], s50 offen offset:1024 sc1 lds
    buffer_load_dwordx4 v2, s[20:23], s50 offen offset:2048 sc1 lds
    buffer_load_dwordx4 v2, s[20:23], s50 offen offset:3072 sc1 lds
    s_add_u32 m0, s51, 49152
    s_add_u32 s50, s94, 114688
    s_and_b32 s50, s50, 0x1ffff
    s_or_b32 s50, s50, s48
    s_xor_b32 s50, s50, 0x20000
    s_add_u32 s50, s50, s46
    buffer_load_dwordx4 v2, s[20:23], s50 offen offset:0 sc1 lds
    buffer_load_dwordx4 v2, s[20:23], s50 offen offset:1024 sc1 lds
    buffer_load_dwordx4 v2, s[20:23], s50 offen offset:2048 sc1 lds
    buffer_load_dwordx4 v2, s[20:23], s50 offen offset:3072 sc1 lds
    s_waitcnt vmcnt(24)
    s_barrier
LP_cbs_loop:
    v_cmp_ne_u32 vcc, 1, v10
    s_cbranch_vccz LP_cbs_ok
    s_sleep 3
    s_and_b32 s52, s40, 24
    s_lshl_b32 s52, s52, 13
    s_lshl_b32 s53, s41, 10
    s_add_u32 s52, s52, s53
    s_add_u32 s52, s52, 70255360
    v_bfe_u32 v29, v1, 2, 3
    v_lshlrev_b32 v29, 11, v29
    v_and_or_b32 v29, v1, 3, v29
    v_lshlrev_b32 v29, 2, v29
    buffer_load_dword v10, v29, s[20:23], s52 offen sc1
    s_waitcnt vmcnt(0)
    s_branch LP_cbs_loop
LP_cbs_ok:
    s_add_u32 m0, s51, 81920
    s_add_u32 s50, s45, 262144
    buffer_load_dwordx4 v2, s[20:23], s50 offen offset:0 sc1 lds
    buffer_load_dwordx4 v2, s[20:23], s50 offen offset:1024 sc1 lds
    buffer_load_dwordx4 v2, s[20:23], s50 offen offset:2048 sc1 lds
    buffer_load_dwordx4 v2, s[20:23], s50 offen offset:3072 sc1 lds
    s_add_u32 m0, s51, 114688
    s_add_u32 s50, s46, 262144
    buffer_load_dwordx4 v2, s[20:23], s50 offen offset:0 sc1 lds
    buffer_load_dwordx4 v2, s[20:23], s50 offen offset:1024 sc1 lds
    buffer_load_dwordx4 v2, s[20:23], s50 offen offset:2048 sc1 lds
    buffer_load_dwordx4 v2, s[20:23], s50 offen offset:3072 sc1 lds
    s_waitcnt vmcnt(24)
    s_barrier
    s_add_u32 m0, s51, 131072
    s_add_u32 s50, s45, 278528
    buffer_load_dwordx4 v2, s[20:23], s50 offen offset:0 sc1 lds
    buffer_load_dwordx4 v2, s[20:23], s50 offen offset:1024 sc1 lds
    buffer_load_dwordx4 v2, s[20:23], s50 offen offset:2048 sc1 lds
    buffer_load_dwordx4 v2, s[20:23], s50 offen offset:3072 sc1 lds
    s_add_u32 m0, s51, 0
    s_add_u32 s50, s46, 278528
    buffer_load_dwordx4 v2, s[20:23], s50 offen offset:0 sc1 lds
    buffer_load_dwordx4 v2, s[20:23], s50 offen offset:1024 sc1 lds
    buffer_load_dwordx4 v2, s[20:23], s50 offen offset:2048 sc1 lds
    buffer_load_dwordx4 v2, s[20:23], s50 offen offset:3072 sc1 lds
    s_waitcnt vmcnt(24)
    s_barrier
    s_waitcnt vmcnt(16)
    s_barrier
    s_waitcnt vmcnt(8)
    s_barrier
    s_waitcnt vmcnt(0)
    s_barrier
LP_end:
    s_endpgm
LB_hand:
    s_setprio 0
    s_cmp_eq_u32 s57, 11
    s_cbranch_scc1 LB_a11
    s_cmp_eq_u32 s57, 10
    s_cbranch_scc1 LB_a10
    s_cmp_eq_u32 s57, 9
    s_cbranch_scc1 LB_a9
    s_cmp_eq_u32 s57, 8
    s_cbranch_scc1 LB_a8
    s_cmp_eq_u32 s57, 7
    s_cbranch_scc1 LB_a7
    s_cmp_eq_u32 s57, 4
    s_cbranch_scc1 LB_a4
    s_cmp_eq_u32 s57, 3
    s_cbranch_scc1 LB_a3
    s_branch LB_ret
LB_a11:
    s_and_b32 s52, s40, 31
    s_lshl_b32 s52, s52, 13
    s_lshl_b32 s53, s41, 10
    s_add_u32 s52, s52, s53
    s_add_u32 s52, s52, 70254848
    s_lshl_b32 s53, s43, 2
    s_add_u32 s52, s52, s53
    v_mov_b32 v29, 1
    s_mov_b64 s[92:93], exec
    s_mov_b64 exec, 1
    buffer_store_dword v29, off, s[20:23], s52 sc1
    s_mov_b64 exec, s[92:93]
    s_lshl_b32 s52, s40, 3
    s_add_u32 s52, s52, s41
    s_lshl_b32 s52, s52, 14
    s_and_b32 s53, s41, 1
    s_lshl_b32 s53, s53, 13
    s_sub_u32 s52, s52, s53
    s_lshl_b32 s53, s43, 8
    s_add_u32 s52, s52, s53
    s_add_u32 s52, s52, 0
    s_add_u32 s53, s52, 15360
    s_mov_b32 s50, m0
    s_add_u32 m0, s47, 147456
    s_nop 0
    buffer_load_dwordx4 v110, s[12:15], s52 offen lds
    buffer_load_dwordx4 v110, s[12:15], s53 offen offset:1024 lds
    s_mov_b32 m0, s50
    s_bfe_u32 s52, s40, 0x10002
    s_lshl_b32 s53, s52, 2
    s_and_b32 s50, s40, 3
    s_add_u32 s53, s53, s50
    s_lshl_b32 s53, s53, 3
    s_add_u32 s53, s53, s41
    s_lshl_b32 s53, s53, 17
    s_lshl_b32 s50, s43, 11
    s_add_u32 s53, s53, s50
    s_add_u32 s53, s53, 100663296
    s_lshr_b32 s50, s40, 3
    s_lshl_b32 s50, s50, 15
    s_add_u32 s53, s53, s50
    v_mov_b32 v248, -1
    v_mov_b32 v249, -1
    v_mov_b32 v250, -1
    v_mov_b32 v251, -1
    s_add_u32 s53, s53, 8192
    buffer_store_dwordx4 v[248:251], v2, s[20:23], s53 offen offset:0 sc1
    buffer_store_dwordx4 v[248:251], v2, s[20:23], s53 offen offset:1024 sc1
    s_branch LB_ret
LB_a10:
    s_cmp_lg_u32 s43, 0
    s_cbranch_scc1 LB_h10
    s_and_b32 s52, s40, 31
    s_lshl_b32 s52, s52, 13
    s_add_u32 s52, s52, 70254848
    v_bfe_u32 v29, v1, 2, 3
    v_lshlrev_b32 v29, 8, v29
    v_and_or_b32 v29, v1, 3, v29
    v_lshlrev_b32 v29, 2, v29
    buffer_load_dword v10, v29, s[20:23], s52 offen sc1
    s_waitcnt vmcnt(0)
LB_pl_loop:
    v_cmp_ne_u32 vcc, 1, v10
    s_cbranch_vccz LB_pl_ok
    s_sleep 4
    s_and_b32 s52, s40, 31
    s_lshl_b32 s52, s52, 13
    s_add_u32 s52, s52, 70254848
    v_bfe_u32 v29, v1, 2, 3
    v_lshlrev_b32 v29, 8, v29
    v_and_or_b32 v29, v1, 3, v29
    v_lshlrev_b32 v29, 2, v29
    buffer_load_dword v10, v29, s[20:23], s52 offen sc1
    s_waitcnt vmcnt(0)
    s_branch LB_pl_loop
LB_pl_ok:
    v_lshlrev_b32 v24, 2, v1
    v_add_u32 v24, 157696, v24
    v_mov_b32 v25, 30
    ds_write_b32 v24, v25
LB_h10:
    ds_read_b64_tr_b16 v[192:193], v111 offset:0
    ds_read_b64_tr_b16 v[194:195], v111 offset:1024
    ds_read_b64_tr_b16 v[196:197], v111 offset:64
    ds_read_b64_tr_b16 v[198:199], v111 offset:1088
    s_lshr_b32 s52, s40, 3
    s_mul_i32 s52, s52, 72
    s_and_b32 s53, s40, 7
    s_lshl_b32 s53, s53, 3
    s_add_u32 s52, s52, s53
    s_lshl_b32 s52, s52, 12
    s_lshl_b32 s53, s41, 12
    s_add_u32 s52, s52, s53
    s_mul_i32 s53, s43, 1179648
    s_add_u32 s52, s52, s53
    s_add_u32 s52, s52, 62914560
    s_waitcnt lgkmcnt(0)
    buffer_store_dwordx4 v[192:195], v2, s[20:23], s52 offen offset:0 sc1
    buffer_store_dwordx4 v[196:199], v2, s[20:23], s52 offen offset:1024 sc1
    s_lshl_b32 s52, s40, 3
    s_add_u32 s52, s52, s41
    s_lshl_b32 s52, s52, 14
    s_and_b32 s53, s41, 1
    s_lshl_b32 s53, s53, 13
    s_sub_u32 s52, s52, s53
    s_lshl_b32 s53, s43, 8
    s_add_u32 s52, s52, s53
    s_add_u32 s52, s52, 128
    s_add_u32 s53, s52, 15360
    s_mov_b32 s50, m0
    s_add_u32 m0, s47, 147456
    s_nop 0
    buffer_load_dwordx4 v110, s[12:15], s52 offen lds
    buffer_load_dwordx4 v110, s[12:15], s53 offen offset:1024 lds
    s_mov_b32 m0, s50
    s_branch LB_ret
LB_a9:
    ds_read_b64_tr_b16 v[192:193], v111 offset:0
    ds_read_b64_tr_b16 v[194:195], v111 offset:1024
    ds_read_b64_tr_b16 v[196:197], v111 offset:64
    ds_read_b64_tr_b16 v[198:199], v111 offset:1088
    s_lshr_b32 s52, s40, 3
    s_mul_i32 s52, s52, 72
    s_and_b32 s53, s40, 7
    s_lshl_b32 s53, s53, 3
    s_add_u32 s52, s52, s53
    s_lshl_b32 s52, s52, 12
    s_lshl_b32 s53, s41, 12
    s_add_u32 s52, s52, s53
    s_mul_i32 s53, s43, 1179648
    s_add_u32 s52, s52, s53
    s_add_u32 s52, s52, 62916608
    s_waitcnt lgkmcnt(0)
    buffer_store_dwordx4 v[192:195], v2, s[20:23], s52 offen offset:0 sc1
    buffer_store_dwordx4 v[196:199], v2, s[20:23], s52 offen offset:1024 sc1
    s_cmp_lg_u32 s43, 0
    s_cbranch_scc1 LB_h9
    s_lshl_b32 s52, s40, 14
    s_lshl_b32 s53, s41, 7
    s_add_u32 s52, s52, s53
    s_add_u32 s53, s52, 7168
    s_mov_b32 s50, m0
    s_add_u32 m0, s47, 147456
    s_nop 0
    buffer_load_dwordx4 v110, s[16:19], s52 offen lds
    buffer_load_dwordx4 v110, s[16:19], s53 offen offset:1024 lds
    s_mov_b32 m0, s50
LB_h9:
    s_bfe_u32 s52, s40, 0x10002
    s_lshl_b32 s53, s52, 2
    s_and_b32 s50, s40, 3
    s_add_u32 s53, s53, s50
    s_lshl_b32 s53, s53, 3
    s_add_u32 s53, s53, s41
    s_lshl_b32 s53, s53, 17
    s_lshl_b32 s50, s43, 11
    s_add_u32 s53, s53, s50
    s_add_u32 s53, s53, 100663296
    s_lshr_b32 s50, s40, 3
    s_lshl_b32 s50, s50, 15
    s_add_u32 s53, s53, s50
    v_mov_b32 v248, -1
    v_mov_b32 v249, -1
    v_mov_b32 v250, -1
    v_mov_b32 v251, -1
    s_add_u32 s53, s53, 16384
    buffer_store_dwordx4 v[248:251], v2, s[20:23], s53 offen offset:0 sc1
    buffer_store_dwordx4 v[248:251], v2, s[20:23], s53 offen offset:1024 sc1
    s_branch LB_ret
LB_a8:
    s_cmp_lg_u32 s43, 0
    s_cbranch_scc1 LB_h8
    ds_read_b64_tr_b16 v[192:193], v111 offset:0
    ds_read_b64_tr_b16 v[194:195], v111 offset:1024
    ds_read_b64_tr_b16 v[196:197], v111 offset:64
    ds_read_b64_tr_b16 v[198:199], v111 offset:1088
    s_lshr_b32 s52, s40, 3
    s_mul_i32 s52, s52, 72
    s_and_b32 s53, s40, 7
    s_add_u32 s53, s53, 64
    s_add_u32 s52, s52, s53
    s_lshl_b32 s52, s52, 12
    s_lshr_b32 s53, s41, 1
    s_mul_i32 s53, s53, 1179648
    s_add_u32 s52, s52, s53
    s_and_b32 s53, s41, 1
    s_lshl_b32 s53, s53, 11
    s_add_u32 s52, s52, s53
    s_add_u32 s52, s52, 62914560
    s_waitcnt lgkmcnt(0)
    buffer_store_dwordx4 v[192:195], v2, s[20:23], s52 offen offset:0 sc1
    buffer_store_dwordx4 v[196:199], v2, s[20:23], s52 offen offset:1024 sc1
LB_h8:
    s_bfe_u32 s52, s40, 0x10002
    s_lshl_b32 s53, s52, 2
    s_and_b32 s50, s40, 3
    s_add_u32 s53, s53, s50
    s_lshl_b32 s53, s53, 3
    s_add_u32 s53, s53, s41
    s_lshl_b32 s53, s53, 17
    s_lshl_b32 s50, s43, 11
    s_add_u32 s53, s53, s50
    s_add_u32 s53, s53, 100663296
    s_lshr_b32 s50, s40, 3
    s_lshl_b32 s50, s50, 15
    s_add_u32 s53, s53, s50
    v_mov_b32 v248, -1
    v_mov_b32 v249, -1
    v_mov_b32 v250, -1
    v_mov_b32 v251, -1
    s_add_u32 s53, s53, 24576
    buffer_store_dwordx4 v[248:251], v2, s[20:23], s53 offen offset:0 sc1
    buffer_store_dwordx4 v[248:251], v2, s[20:23], s53 offen offset:1024 sc1
    s_branch LB_ret
LB_a7:
    s_and_b32 s52, s40, 31
    s_lshl_b32 s52, s52, 13
    s_lshl_b32 s53, s41, 10
    s_add_u32 s52, s52, s53
    s_add_u32 s52, s52, 70254976
    s_lshl_b32 s53, s43, 2
    s_add_u32 s52, s52, s53
    v_mov_b32 v29, 1
    s_mov_b64 s[92:93], exec
    s_mov_b64 exec, 1
    buffer_store_dword v29, off, s[20:23], s52 sc1
    s_mov_b64 exec, s[92:93]
    s_branch LB_ret
LB_a4:
    s_cmp_lg_u32 s43, 0
    s_cbranch_scc1 LB_h4
    v_lshlrev_b32 v29, 10, v1
    s_mov_b32 s52, 70254976
    buffer_load_dwordx4 v[192:195], v29, s[20:23], s52 offen sc1
    s_mov_b32 s52, 70320512
    buffer_load_dwordx4 v[196:199], v29, s[20:23], s52 offen sc1
    s_mov_b32 s52, 70386048
    buffer_load_dwordx4 v[200:203], v29, s[20:23], s52 offen sc1
    s_mov_b32 s52, 70451584
    buffer_load_dwordx4 v[204:207], v29, s[20:23], s52 offen sc1
    s_and_b32 s52, s40, 27
    s_lshl_b32 s52, s52, 13
    s_lshl_b32 s53, s41, 10
    s_add_u32 s52, s52, s53
    s_add_u32 s52, s52, 70255488
    v_mov_b32 v10, 1
    s_mov_b64 s[92:93], exec
    s_mov_b64 exec, 1
    buffer_atomic_add v10, off, s[20:23], s52 sc0 sc1
    s_mov_b64 exec, s[92:93]
LB_h4:
    s_branch LB_ret
LB_a3:
    s_cmp_lg_u32 s43, 0
    s_cbranch_scc1 LB_h3
LB_wc:
    v_and_b32 v192, v192, v193
    v_and_b32 v192, v192, v194
    v_and_b32 v192, v192, v195
    v_and_b32 v192, v192, v196
    v_and_b32 v192, v192, v197
    v_and_b32 v192, v192, v198
    v_and_b32 v192, v192, v199
    v_and_b32 v192, v192, v200
    v_and_b32 v192, v192, v201
    v_and_b32 v192, v192, v202
    v_and_b32 v192, v192, v203
    v_and_b32 v192, v192, v204
    v_and_b32 v192, v192, v205
    v_and_b32 v192, v192, v206
    v_and_b32 v192, v192, v207
    v_cmp_ne_u32 vcc, 1, v192
    s_cbranch_vccz LB_wok
    s_sleep 8
    v_lshlrev_b32 v29, 10, v1
    s_mov_b32 s52, 70254976
    buffer_load_dwordx4 v[192:195], v29, s[20:23], s52 offen sc1
    s_mov_b32 s52, 70320512
    buffer_load_dwordx4 v[196:199], v29, s[20:23], s52 offen sc1
    s_mov_b32 s52, 70386048
    buffer_load_dwordx4 v[200:203], v29, s[20:23], s52 offen sc1
    s_mov_b32 s52, 70451584
    buffer_load_dwordx4 v[204:207], v29, s[20:23], s52 offen sc1
    s_waitcnt vmcnt(0)
    s_branch LB_wc
LB_wok:
    v_lshlrev_b32 v24, 2, v1
    v_add_u32 v24, 157696, v24
    v_readfirstlane_b32 s52, v10
    s_nop 1
    v_mov_b32 v25, s52
    v_add_u32 v25, 64, v25
    ds_write_b32 v24, v25
    s_lshr_b32 s52, s2, 3
    s_mul_i32 s52, s52, 512
    s_add_u32 s52, s52, LA_end-L12_pc
    v_min_u32 v29, 3, v1
    v_lshlrev_b32 v29, 7, v29
    v_add_u32 v29, s52, v29
    v_min_u32 v29, L12_end-L12_pc, v29
    global_load_dword v31, v29, s[100:101]
    s_lshr_b32 s52, s2, 3
    s_mul_i32 s52, s52, 256
    s_add_u32 s52, s52, LB_norm-L12_pc
    v_min_u32 v29, 1, v1
    v_lshlrev_b32 v29, 7, v29
    v_add_u32 v29, s52, v29
    v_min_u32 v29, L12_end-L12_pc, v29
    global_load_dword v31, v29, s[100:101]
LB_h3:
    s_branch LB_ret
LB_fb:
    s_mov_b32 s94, s54
    s_mov_b32 s95, 64
    v_mov_b32 v29, 0xff800000
    v_mov_b32 v30, 0xff800000
LB_fb1:
    buffer_load_dwordx4 v[64:67], v2, s[20:23], s94 offen offset:0 sc1
    s_waitcnt vmcnt(0)
    v_mfma_f32_32x32x16_bf16 v[160:175], v[64:67], v[32:35], 0
    v_mfma_f32_32x32x16_bf16 v[176:191], v[64:67], v[36:39], 0
    s_nop 15
    v_max3_f32 v29, v160, v161, v29
    v_max3_f32 v29, v162, v163, v29
    v_max3_f32 v29, v164, v165, v29
    v_max3_f32 v29, v166, v167, v29
    v_max3_f32 v29, v168, v169, v29
    v_max3_f32 v29, v170, v171, v29
    v_max3_f32 v29, v172, v173, v29
    v_max3_f32 v29, v174, v175, v29
    v_max3_f32 v30, v176, v177, v30
    v_max3_f32 v30, v178, v179, v30
    v_max3_f32 v30, v180, v181, v30
    v_max3_f32 v30, v182, v183, v30
    v_max3_f32 v30, v184, v185, v30
    v_max3_f32 v30, v186, v187, v30
    v_max3_f32 v30, v188, v189, v30
    v_max3_f32 v30, v190, v191, v30
    s_add_u32 s94, s94, 2048
    s_sub_u32 s95, s95, 1
    s_cmp_lg_u32 s95, 0
    s_cbranch_scc1 LB_fb1
    v_mov_b32 v24, v29
    s_nop 1
    v_permlane32_swap_b32 v29, v24
    s_nop 1
    v_max_f32 v29, v29, v24
    v_mov_b32 v24, v30
    s_nop 1
    v_permlane32_swap_b32 v30, v24
    s_nop 1
    v_max_f32 v30, v30, v24
    s_mov_b32 s94, s54
    s_mov_b32 s95, 64
    v_mov_b32 v128, 0
    v_mov_b32 v129, 0
    v_mov_b32 v130, 0
    v_mov_b32 v131, 0
    v_mov_b32 v132, 0
    v_mov_b32 v133, 0
    v_mov_b32 v134, 0
    v_mov_b32 v135, 0
    v_mov_b32 v136, 0
    v_mov_b32 v137, 0
    v_mov_b32 v138, 0
    v_mov_b32 v139, 0
    v_mov_b32 v140, 0
    v_mov_b32 v141, 0
    v_mov_b32 v142, 0
    v_mov_b32 v143, 0
    v_mov_b32 v144, 0
    v_mov_b32 v145, 0
    v_mov_b32 v146, 0
    v_mov_b32 v147, 0
    v_mov_b32 v148, 0
    v_mov_b32 v149, 0
    v_mov_b32 v150, 0
    v_mov_b32 v151, 0
    v_mov_b32 v152, 0
    v_mov_b32 v153, 0
    v_mov_b32 v154, 0
    v_mov_b32 v155, 0
    v_mov_b32 v156, 0
    v_mov_b32 v157, 0
    v_mov_b32 v158, 0
    v_mov_b32 v159, 0
    v_mov_b32 v96, 0
    v_mov_b32 v100, 0
LB_fb2:
    buffer_load_dwordx4 v[64:67], v2, s[20:23], s94 offen offset:0 sc1
    buffer_load_dwordx4 v[68:71], v2, s[20:23], s94 offen offset:1024 sc1
    s_waitcnt vmcnt(0)
    v_mfma_f32_32x32x16_bf16 v[160:175], v[64:67], v[32:35], 0
    v_mfma_f32_32x32x16_bf16 v[176:191], v[64:67], v[36:39], 0
    s_nop 15
    v_sub_f32 v160, v160, v29
    v_sub_f32 v161, v161, v29
    v_sub_f32 v162, v162, v29
    v_sub_f32 v163, v163, v29
    v_sub_f32 v164, v164, v29
    v_sub_f32 v165, v165, v29
    v_sub_f32 v166, v166, v29
    v_sub_f32 v167, v167, v29
    v_sub_f32 v168, v168, v29
    v_sub_f32 v169, v169, v29
    v_sub_f32 v170, v170, v29
    v_sub_f32 v171, v171, v29
    v_sub_f32 v172, v172, v29
    v_sub_f32 v173, v173, v29
    v_sub_f32 v174, v174, v29
    v_sub_f32 v175, v175, v29
    v_exp_f32 v160, v160
    v_exp_f32 v161, v161
    v_exp_f32 v162, v162
    v_exp_f32 v163, v163
    v_exp_f32 v164, v164
    v_exp_f32 v165, v165
    v_exp_f32 v166, v166
    v_exp_f32 v167, v167
    v_exp_f32 v168, v168
    v_exp_f32 v169, v169
    v_exp_f32 v170, v170
    v_exp_f32 v171, v171
    v_exp_f32 v172, v172
    v_exp_f32 v173, v173
    v_exp_f32 v174, v174
    v_exp_f32 v175, v175
    s_nop 0
    v_cvt_pk_bf16_f32 v40, v160, v161
    v_cvt_pk_bf16_f32 v41, v162, v163
    v_cvt_pk_bf16_f32 v42, v164, v165
    v_cvt_pk_bf16_f32 v43, v166, v167
    v_cvt_pk_bf16_f32 v44, v168, v169
    v_cvt_pk_bf16_f32 v45, v170, v171
    v_cvt_pk_bf16_f32 v46, v172, v173
    v_cvt_pk_bf16_f32 v47, v174, v175
    v_add_f32 v96, v96, v160
    v_add_f32 v96, v96, v161
    v_add_f32 v96, v96, v162
    v_add_f32 v96, v96, v163
    v_add_f32 v96, v96, v164
    v_add_f32 v96, v96, v165
    v_add_f32 v96, v96, v166
    v_add_f32 v96, v96, v167
    v_add_f32 v96, v96, v168
    v_add_f32 v96, v96, v169
    v_add_f32 v96, v96, v170
    v_add_f32 v96, v96, v171
    v_add_f32 v96, v96, v172
    v_add_f32 v96, v96, v173
    v_add_f32 v96, v96, v174
    v_add_f32 v96, v96, v175
    v_smfmac_f32_32x32x32_bf16 v[128:143], v[68:71], v[40:47], v109
    v_sub_f32 v176, v176, v30
    v_sub_f32 v177, v177, v30
    v_sub_f32 v178, v178, v30
    v_sub_f32 v179, v179, v30
    v_sub_f32 v180, v180, v30
    v_sub_f32 v181, v181, v30
    v_sub_f32 v182, v182, v30
    v_sub_f32 v183, v183, v30
    v_sub_f32 v184, v184, v30
    v_sub_f32 v185, v185, v30
    v_sub_f32 v186, v186, v30
    v_sub_f32 v187, v187, v30
    v_sub_f32 v188, v188, v30
    v_sub_f32 v189, v189, v30
    v_sub_f32 v190, v190, v30
    v_sub_f32 v191, v191, v30
    v_exp_f32 v176, v176
    v_exp_f32 v177, v177
    v_exp_f32 v178, v178
    v_exp_f32 v179, v179
    v_exp_f32 v180, v180
    v_exp_f32 v181, v181
    v_exp_f32 v182, v182
    v_exp_f32 v183, v183
    v_exp_f32 v184, v184
    v_exp_f32 v185, v185
    v_exp_f32 v186, v186
    v_exp_f32 v187, v187
    v_exp_f32 v188, v188
    v_exp_f32 v189, v189
    v_exp_f32 v190, v190
    v_exp_f32 v191, v191
    s_nop 0
    v_cvt_pk_bf16_f32 v40, v176, v177
    v_cvt_pk_bf16_f32 v41, v178, v179
    v_cvt_pk_bf16_f32 v42, v180, v181
    v_cvt_pk_bf16_f32 v43, v182, v183
    v_cvt_pk_bf16_f32 v44, v184, v185
    v_cvt_pk_bf16_f32 v45, v186, v187
    v_cvt_pk_bf16_f32 v46, v188, v189
    v_cvt_pk_bf16_f32 v47, v190, v191
    v_add_f32 v100, v100, v176
    v_add_f32 v100, v100, v177
    v_add_f32 v100, v100, v178
    v_add_f32 v100, v100, v179
    v_add_f32 v100, v100, v180
    v_add_f32 v100, v100, v181
    v_add_f32 v100, v100, v182
    v_add_f32 v100, v100, v183
    v_add_f32 v100, v100, v184
    v_add_f32 v100, v100, v185
    v_add_f32 v100, v100, v186
    v_add_f32 v100, v100, v187
    v_add_f32 v100, v100, v188
    v_add_f32 v100, v100, v189
    v_add_f32 v100, v100, v190
    v_add_f32 v100, v100, v191
    v_smfmac_f32_32x32x32_bf16 v[144:159], v[68:71], v[40:47], v109
    s_add_u32 s94, s94, 2048
    s_sub_u32 s95, s95, 1
    s_cmp_lg_u32 s95, 0
    s_cbranch_scc1 LB_fb2
    s_nop 15
    v_mov_b32 v24, v96
    s_nop 1
    v_permlane32_swap_b32 v96, v24
    s_nop 1
    v_add_f32 v96, v96, v24
    v_add_f32 v128, v128, v136
    v_add_f32 v129, v129, v137
    v_add_f32 v130, v130, v138
    v_add_f32 v131, v131, v139
    v_add_f32 v132, v132, v140
    v_add_f32 v133, v133, v141
    v_add_f32 v134, v134, v142
    v_add_f32 v135, v135, v143
    v_mov_b32 v24, v100
    s_nop 1
    v_permlane32_swap_b32 v100, v24
    s_nop 1
    v_add_f32 v100, v100, v24
    v_add_f32 v144, v144, v152
    v_add_f32 v145, v145, v153
    v_add_f32 v146, v146, v154
    v_add_f32 v147, v147, v155
    v_add_f32 v148, v148, v156
    v_add_f32 v149, v149, v157
    v_add_f32 v150, v150, v158
    v_add_f32 v151, v151, v159
    s_branch LB_norm
L12_roleA:
    s_cmp_lg_u32 s43, 0
    s_cbranch_scc1 LA_ct0
    s_lshr_b32 s52, s2, 3
    s_mul_i32 s52, s52, 2688
    s_add_u32 s52, s52, L12_pc-L12_pc
    v_min_u32 v29, 20, v1
    v_lshlrev_b32 v29, 7, v29
    v_add_u32 v29, s52, v29
    v_min_u32 v29, L12_end-L12_pc, v29
    global_load_dword v31, v29, s[100:101]
LA_ct0:
    s_waitcnt lgkmcnt(0)
    s_mov_b32 s20, s88
    s_and_b32 s21, s89, 0xffff
    s_mov_b32 s22, 0x7000000
    s_mov_b32 s23, 0x20000
    s_mov_b32 s24, s86
    s_and_b32 s25, s87, 0xffff
    s_mov_b32 s26, 0x100
    s_mov_b32 s27, 0x20000
    s_lshl_b32 s63, s43, 13
    s_mul_i32 s54, s40, 1050880
    s_add_u32 s54, s54, s63
    s_lshl_b32 s50, s41, 16
    s_add_u32 s62, s54, s50
    s_mov_b32 s56, -1
    s_add_u32 s61, s62, 65536
    s_mov_b32 s52, 16384
    v_and_b32 v24, 15, v1
    v_lshrrev_b32 v25, 4, v1
    v_lshrrev_b32 v26, 1, v24
    v_xor_b32 v25, v25, v26
    v_lshlrev_b32 v24, 7, v24
    v_add_u32 v24, s52, v24
    v_lshl_add_u32 v12, v25, 4, v24
    v_xor_b32 v13, 64, v12
    v_add_u32 v14, 0x10000, v12
    v_add_u32 v15, 0x10000, v13
    v_and_b32 v28, 15, v1
    v_lshlrev_b32 v9, 4, v28
    v_and_b32 v29, 8, v28
    v_add_u32 v28, v28, v29
    v_lshlrev_b32 v8, 4, v28
    v_bfe_u32 v28, v1, 4, 1
    v_lshrrev_b32 v29, 5, v1
    v_lshl_add_u32 v8, v28, 10, v8
    v_lshl_add_u32 v8, v29, 9, v8
    v_lshl_add_u32 v9, v28, 9, v9
    v_lshl_add_u32 v9, v29, 12, v9
    s_lshl_b32 s53, s43, 6
    v_bfe_u32 v24, v1, 2, 2
    v_lshrrev_b32 v25, 4, v1
    v_lshl_add_u32 v26, v25, 3, v24
    v_lshlrev_b32 v26, 8, v26
    v_and_b32 v25, 1, v25
    v_lshlrev_b32 v24, 6, v24
    v_lshl_add_u32 v24, v25, 5, v24
    v_add_u32 v26, v26, v24
    v_and_b32 v24, 3, v1
    v_lshl_add_u32 v26, v24, 3, v26
    v_add_u32 v26, 98304, v26
    v_xor_b32 v26, s53, v26
    v_xor_b32 v8, 0, v26
    v_xor_b32 v0, 32, v26
    s_lshl_b32 s48, s41, 16
    s_mul_i32 s53, s40, 1050880
    s_add_u32 s48, s48, s53
    s_lshl_b32 s53, s43, 10
    s_add_u32 s48, s48, s53
    s_add_u32 s49, s48, 8192
    s_add_u32 s49, s49, s53
    s_mov_b32 s4, s78
    s_and_b32 s5, s79, 0xffff
    s_mov_b32 s6, 0x180000
    s_mov_b32 s7, 0x20000
    s_and_b32 s52, s40, 3
    s_cmp_lg_u32 s52, s43
    s_cbranch_scc1 LA_wbt
    s_lshl_b32 s53, s41, 2
    s_add_u32 s52, s52, s53
    s_mul_i32 s52, s52, 49152
    s_lshl_b32 s53, s40, 5
    s_add_u32 s52, s52, s53
    v_and_b32 v24, 15, v1
    v_mul_u32_u24 v24, 3072, v24
    v_lshrrev_b32 v25, 4, v1
    v_lshl_add_u32 v24, v25, 10, v24
    buffer_load_dword v31, v24, s[4:7], s52 offen
LA_wbt:
    s_and_b32 s52, s40, 31
    s_lshl_b32 s52, s52, 13
    s_lshl_b32 s53, s41, 10
    s_add_u32 s52, s52, s53
    s_add_u32 s52, s52, 70254592
    v_mov_b32 v4, 0
    v_mov_b32 v5, 0
    v_mov_b32 v6, 0
    v_mov_b32 v7, 0
    s_cmp_lg_u32 s43, 0
    s_cbranch_scc1 LA_z0
    buffer_store_dwordx4 v[4:7], v2, s[20:23], s52 offen sc1
LA_z0:
    s_barrier
    ds_read_b64_tr_b16 v[32:33], v8 offset:0
    ds_read_b64_tr_b16 v[34:35], v8 offset:1024
    ds_read_b128 v[4:7], v12 offset:0
    ds_read_b64_tr_b16 v[36:37], v8 offset:8192
    ds_read_b64_tr_b16 v[38:39], v8 offset:9216
    ds_read_b128 v[16:19], v13 offset:0
    ds_read_b64_tr_b16 v[40:41], v0 offset:0
    ds_read_b64_tr_b16 v[42:43], v0 offset:1024
    ds_read_b64_tr_b16 v[44:45], v0 offset:8192
    ds_read_b64_tr_b16 v[46:47], v0 offset:9216
    ds_read_b64_tr_b16 v[48:49], v8 offset:16384
    ds_read_b64_tr_b16 v[50:51], v8 offset:17408
    ds_read_b64_tr_b16 v[52:53], v8 offset:24576
    ds_read_b64_tr_b16 v[54:55], v8 offset:25600
    ds_read_b64_tr_b16 v[56:57], v0 offset:16384
    s_waitcnt lgkmcnt(14)
    ds_read_b64_tr_b16 v[58:59], v0 offset:17408
    s_waitcnt lgkmcnt(14)
    ds_read_b64_tr_b16 v[60:61], v0 offset:24576
    s_waitcnt lgkmcnt(14)
    ds_read_b64_tr_b16 v[62:63], v0 offset:25600
    s_mov_b32 s95, 0x3e0293ee
    v_mfma_f32_16x16x32_bf16 v[128:131], v[32:35], v[4:7], 0
    s_waitcnt lgkmcnt(14)
    ds_read_b128 v[20:23], v12 offset:2048
    s_waitcnt lgkmcnt(13)
    v_mfma_f32_16x16x32_bf16 v[128:131], v[36:39], v[16:19], v[128:131]
    ds_read_b128 v[24:27], v13 offset:2048
    s_waitcnt lgkmcnt(12)
    v_mfma_f32_16x16x32_bf16 v[132:135], v[40:43], v[4:7], 0
    s_waitcnt lgkmcnt(10)
    v_mfma_f32_16x16x32_bf16 v[132:135], v[44:47], v[16:19], v[132:135]
    s_waitcnt lgkmcnt(8)
    v_mfma_f32_16x16x32_bf16 v[144:147], v[4:7], v[48:51], 0
    s_waitcnt lgkmcnt(6)
    v_mfma_f32_16x16x32_bf16 v[144:147], v[16:19], v[52:55], v[144:147]
    s_waitcnt lgkmcnt(4)
    v_mfma_f32_16x16x32_bf16 v[152:155], v[4:7], v[56:59], 0
    s_waitcnt lgkmcnt(2)
    v_mfma_f32_16x16x32_bf16 v[152:155], v[16:19], v[60:63], v[152:155]
    s_waitcnt lgkmcnt(1)
    v_mfma_f32_16x16x32_bf16 v[136:139], v[32:35], v[20:23], 0
    ds_read_b128 v[4:7], v12 offset:4096
    s_waitcnt lgkmcnt(1)
    v_mfma_f32_16x16x32_bf16 v[136:139], v[36:39], v[24:27], v[136:139]
    ds_read_b128 v[16:19], v13 offset:4096
    v_mfma_f32_16x16x32_bf16 v[140:143], v[40:43], v[20:23], 0
    v_mfma_f32_16x16x32_bf16 v[140:143], v[44:47], v[24:27], v[140:143]
    v_mfma_f32_16x16x32_bf16 v[148:151], v[20:23], v[48:51], 0
    v_mfma_f32_16x16x32_bf16 v[148:151], v[24:27], v[52:55], v[148:151]
    v_mfma_f32_16x16x32_bf16 v[156:159], v[20:23], v[56:59], 0
    v_mfma_f32_16x16x32_bf16 v[156:159], v[24:27], v[60:63], v[156:159]
    s_waitcnt lgkmcnt(1)
    v_mfma_f32_16x16x32_bf16 v[160:163], v[32:35], v[4:7], 0
    ds_read_b128 v[20:23], v12 offset:6144
    s_waitcnt lgkmcnt(1)
    v_mfma_f32_16x16x32_bf16 v[160:163], v[36:39], v[16:19], v[160:163]
    ds_read_b128 v[24:27], v13 offset:6144
    v_mfma_f32_16x16x32_bf16 v[164:167], v[40:43], v[4:7], 0
    v_mfma_f32_16x16x32_bf16 v[164:167], v[44:47], v[16:19], v[164:167]
    v_mfma_f32_16x16x32_bf16 v[176:179], v[4:7], v[48:51], 0
    v_mfma_f32_16x16x32_bf16 v[176:179], v[16:19], v[52:55], v[176:179]
    v_mfma_f32_16x16x32_bf16 v[184:187], v[4:7], v[56:59], 0
    v_mfma_f32_16x16x32_bf16 v[184:187], v[16:19], v[60:63], v[184:187]
    s_waitcnt lgkmcnt(1)
    v_mfma_f32_16x16x32_bf16 v[168:171], v[32:35], v[20:23], 0
    ds_read_b128 v[4:7], v12 offset:8192
    s_waitcnt lgkmcnt(1)
    v_mfma_f32_16x16x32_bf16 v[168:171], v[36:39], v[24:27], v[168:171]
    ds_read_b128 v[16:19], v13 offset:8192
    v_mfma_f32_16x16x32_bf16 v[172:175], v[40:43], v[20:23], 0
    v_mfma_f32_16x16x32_bf16 v[172:175], v[44:47], v[24:27], v[172:175]
    v_mfma_f32_16x16x32_bf16 v[180:183], v[20:23], v[48:51], 0
    v_mfma_f32_16x16x32_bf16 v[180:183], v[24:27], v[52:55], v[180:183]
    v_mfma_f32_16x16x32_bf16 v[188:191], v[20:23], v[56:59], 0
    v_mfma_f32_16x16x32_bf16 v[188:191], v[24:27], v[60:63], v[188:191]
    s_waitcnt lgkmcnt(1)
    v_mfma_f32_16x16x32_bf16 v[192:195], v[32:35], v[4:7], 0
    ds_read_b128 v[20:23], v12 offset:10240
    s_waitcnt lgkmcnt(1)
    v_mfma_f32_16x16x32_bf16 v[192:195], v[36:39], v[16:19], v[192:195]
    ds_read_b128 v[24:27], v13 offset:10240
    v_mfma_f32_16x16x32_bf16 v[196:199], v[40:43], v[4:7], 0
    v_mfma_f32_16x16x32_bf16 v[196:199], v[44:47], v[16:19], v[196:199]
    v_mfma_f32_16x16x32_bf16 v[208:211], v[4:7], v[48:51], 0
    v_mfma_f32_16x16x32_bf16 v[208:211], v[16:19], v[52:55], v[208:211]
    v_mfma_f32_16x16x32_bf16 v[216:219], v[4:7], v[56:59], 0
    v_mfma_f32_16x16x32_bf16 v[216:219], v[16:19], v[60:63], v[216:219]
    s_waitcnt lgkmcnt(1)
    v_mfma_f32_16x16x32_bf16 v[200:203], v[32:35], v[20:23], 0
    ds_read_b128 v[4:7], v12 offset:12288
    s_waitcnt lgkmcnt(1)
    v_mfma_f32_16x16x32_bf16 v[200:203], v[36:39], v[24:27], v[200:203]
    ds_read_b128 v[16:19], v13 offset:12288
    v_mfma_f32_16x16x32_bf16 v[204:207], v[40:43], v[20:23], 0
    v_mfma_f32_16x16x32_bf16 v[204:207], v[44:47], v[24:27], v[204:207]
    v_mfma_f32_16x16x32_bf16 v[212:215], v[20:23], v[48:51], 0
    v_mfma_f32_16x16x32_bf16 v[212:215], v[24:27], v[52:55], v[212:215]
    v_mfma_f32_16x16x32_bf16 v[220:223], v[20:23], v[56:59], 0
    v_mfma_f32_16x16x32_bf16 v[220:223], v[24:27], v[60:63], v[220:223]
    s_waitcnt lgkmcnt(1)
    v_mfma_f32_16x16x32_bf16 v[224:227], v[32:35], v[4:7], 0
    ds_read_b128 v[20:23], v12 offset:14336
    s_waitcnt lgkmcnt(1)
    v_mfma_f32_16x16x32_bf16 v[224:227], v[36:39], v[16:19], v[224:227]
    ds_read_b128 v[24:27], v13 offset:14336
    v_mfma_f32_16x16x32_bf16 v[228:231], v[40:43], v[4:7], 0
    v_mfma_f32_16x16x32_bf16 v[228:231], v[44:47], v[16:19], v[228:231]
    v_mfma_f32_16x16x32_bf16 v[240:243], v[4:7], v[48:51], 0
    v_mfma_f32_16x16x32_bf16 v[240:243], v[16:19], v[52:55], v[240:243]
    v_mfma_f32_16x16x32_bf16 v[248:251], v[4:7], v[56:59], 0
    v_mfma_f32_16x16x32_bf16 v[248:251], v[16:19], v[60:63], v[248:251]
    s_waitcnt vmcnt(0) lgkmcnt(0)
    s_barrier
    ds_read_b128 v[4:7], v12 offset:32768
    v_mfma_f32_16x16x32_bf16 v[232:235], v[32:35], v[20:23], 0
    ds_read_b128 v[16:19], v13 offset:32768
    s_cmp_lg_u32 s43, 0
    s_cbranch_scc1 LA_zd0
    s_mov_b32 s52, 17
    s_bitcmp0_b32 s52, s41
    s_cbranch_scc1 LA_zd0
    s_lshl_b32 s52, s40, 2
    v_mov_b32 v29, 1
    s_mov_b64 s[92:93], exec
    s_mov_b64 exec, 1
    buffer_store_byte v29, off, s[24:27], s2 sc1
    s_mov_b64 exec, s[92:93]
LA_zd0:
    v_mfma_f32_16x16x32_bf16 v[232:235], v[36:39], v[24:27], v[232:235]
    ds_read_b64_tr_b16 v[32:33], v8 offset:32768
    ds_read_b64_tr_b16 v[34:35], v8 offset:33792
    v_mfma_f32_16x16x32_bf16 v[236:239], v[40:43], v[20:23], 0
    ds_read_b64_tr_b16 v[36:37], v8 offset:40960
    ds_read_b64_tr_b16 v[38:39], v8 offset:41984
    v_mfma_f32_16x16x32_bf16 v[236:239], v[44:47], v[24:27], v[236:239]
    ds_read_b64_tr_b16 v[40:41], v0 offset:32768
    ds_read_b64_tr_b16 v[42:43], v0 offset:33792
    v_mfma_f32_16x16x32_bf16 v[244:247], v[20:23], v[48:51], 0
    ds_read_b64_tr_b16 v[44:45], v0 offset:40960
    ds_read_b64_tr_b16 v[46:47], v0 offset:41984
    v_mfma_f32_16x16x32_bf16 v[244:247], v[24:27], v[52:55], v[244:247]
    ds_read_b64_tr_b16 v[48:49], v8 offset:49152
    ds_read_b64_tr_b16 v[50:51], v8 offset:50176
    v_mfma_f32_16x16x32_bf16 v[252:255], v[20:23], v[56:59], 0
    ds_read_b64_tr_b16 v[52:53], v8 offset:57344
    ds_read_b64_tr_b16 v[54:55], v8 offset:58368
    v_mfma_f32_16x16x32_bf16 v[252:255], v[24:27], v[60:63], v[252:255]
    ds_read_b64_tr_b16 v[56:57], v0 offset:49152
    s_waitcnt lgkmcnt(14)
    ds_read_b64_tr_b16 v[58:59], v0 offset:50176
    s_waitcnt lgkmcnt(14)
    ds_read_b64_tr_b16 v[60:61], v0 offset:57344
    s_waitcnt lgkmcnt(14)
    ds_read_b64_tr_b16 v[62:63], v0 offset:58368
    s_waitcnt lgkmcnt(14)
    v_mfma_f32_16x16x32_bf16 v[128:131], v[32:35], v[4:7], v[128:131]
    ds_read_b128 v[20:23], v12 offset:34816
    s_waitcnt lgkmcnt(13)
    v_mfma_f32_16x16x32_bf16 v[128:131], v[36:39], v[16:19], v[128:131]
    ds_read_b128 v[24:27], v13 offset:34816
    s_waitcnt lgkmcnt(12)
    v_mfma_f32_16x16x32_bf16 v[132:135], v[40:43], v[4:7], v[132:135]
    s_waitcnt lgkmcnt(10)
    v_mfma_f32_16x16x32_bf16 v[132:135], v[44:47], v[16:19], v[132:135]
    s_waitcnt lgkmcnt(8)
    v_mfma_f32_16x16x32_bf16 v[144:147], v[4:7], v[48:51], v[144:147]
    s_waitcnt lgkmcnt(6)
    v_mfma_f32_16x16x32_bf16 v[144:147], v[16:19], v[52:55], v[144:147]
    s_waitcnt lgkmcnt(4)
    v_mfma_f32_16x16x32_bf16 v[152:155], v[4:7], v[56:59], v[152:155]
    s_waitcnt lgkmcnt(2)
    v_mfma_f32_16x16x32_bf16 v[152:155], v[16:19], v[60:63], v[152:155]
    s_waitcnt lgkmcnt(1)
    v_mfma_f32_16x16x32_bf16 v[136:139], v[32:35], v[20:23], v[136:139]
    ds_read_b128 v[4:7], v12 offset:36864
    s_waitcnt lgkmcnt(1)
    v_mfma_f32_16x16x32_bf16 v[136:139], v[36:39], v[24:27], v[136:139]
    ds_read_b128 v[16:19], v13 offset:36864
    v_mfma_f32_16x16x32_bf16 v[140:143], v[40:43], v[20:23], v[140:143]
    v_mfma_f32_16x16x32_bf16 v[140:143], v[44:47], v[24:27], v[140:143]
    v_mfma_f32_16x16x32_bf16 v[148:151], v[20:23], v[48:51], v[148:151]
    v_mfma_f32_16x16x32_bf16 v[148:151], v[24:27], v[52:55], v[148:151]
    v_mfma_f32_16x16x32_bf16 v[156:159], v[20:23], v[56:59], v[156:159]
    v_mfma_f32_16x16x32_bf16 v[156:159], v[24:27], v[60:63], v[156:159]
    s_waitcnt lgkmcnt(1)
    v_mfma_f32_16x16x32_bf16 v[160:163], v[32:35], v[4:7], v[160:163]
    ds_read_b128 v[20:23], v12 offset:38912
    s_waitcnt lgkmcnt(1)
    v_mfma_f32_16x16x32_bf16 v[160:163], v[36:39], v[16:19], v[160:163]
    ds_read_b128 v[24:27], v13 offset:38912
    v_mfma_f32_16x16x32_bf16 v[164:167], v[40:43], v[4:7], v[164:167]
    v_mfma_f32_16x16x32_bf16 v[164:167], v[44:47], v[16:19], v[164:167]
    v_mfma_f32_16x16x32_bf16 v[176:179], v[4:7], v[48:51], v[176:179]
    v_mfma_f32_16x16x32_bf16 v[176:179], v[16:19], v[52:55], v[176:179]
    v_mfma_f32_16x16x32_bf16 v[184:187], v[4:7], v[56:59], v[184:187]
    v_mfma_f32_16x16x32_bf16 v[184:187], v[16:19], v[60:63], v[184:187]
    s_waitcnt lgkmcnt(1)
    v_mfma_f32_16x16x32_bf16 v[168:171], v[32:35], v[20:23], v[168:171]
    ds_read_b128 v[4:7], v12 offset:40960
    s_waitcnt lgkmcnt(1)
    v_mfma_f32_16x16x32_bf16 v[168:171], v[36:39], v[24:27], v[168:171]
    ds_read_b128 v[16:19], v13 offset:40960
    v_mfma_f32_16x16x32_bf16 v[172:175], v[40:43], v[20:23], v[172:175]
    v_mfma_f32_16x16x32_bf16 v[172:175], v[44:47], v[24:27], v[172:175]
    v_mfma_f32_16x16x32_bf16 v[180:183], v[20:23], v[48:51], v[180:183]
    v_mfma_f32_16x16x32_bf16 v[180:183], v[24:27], v[52:55], v[180:183]
    v_mfma_f32_16x16x32_bf16 v[188:191], v[20:23], v[56:59], v[188:191]
    v_mfma_f32_16x16x32_bf16 v[188:191], v[24:27], v[60:63], v[188:191]
    s_waitcnt lgkmcnt(1)
    v_mfma_f32_16x16x32_bf16 v[192:195], v[32:35], v[4:7], v[192:195]
    ds_read_b128 v[20:23], v12 offset:43008
    s_waitcnt lgkmcnt(1)
    v_mfma_f32_16x16x32_bf16 v[192:195], v[36:39], v[16:19], v[192:195]
    ds_read_b128 v[24:27], v13 offset:43008
    v_mfma_f32_16x16x32_bf16 v[196:199], v[40:43], v[4:7], v[196:199]
    v_mfma_f32_16x16x32_bf16 v[196:199], v[44:47], v[16:19], v[196:199]
    v_mfma_f32_16x16x32_bf16 v[208:211], v[4:7], v[48:51], v[208:211]
    v_mfma_f32_16x16x32_bf16 v[208:211], v[16:19], v[52:55], v[208:211]
    v_mfma_f32_16x16x32_bf16 v[216:219], v[4:7], v[56:59], v[216:219]
    v_mfma_f32_16x16x32_bf16 v[216:219], v[16:19], v[60:63], v[216:219]
    s_waitcnt lgkmcnt(1)
    v_mfma_f32_16x16x32_bf16 v[200:203], v[32:35], v[20:23], v[200:203]
    ds_read_b128 v[4:7], v12 offset:45056
    s_waitcnt lgkmcnt(1)
    v_mfma_f32_16x16x32_bf16 v[200:203], v[36:39], v[24:27], v[200:203]
    ds_read_b128 v[16:19], v13 offset:45056
    v_mfma_f32_16x16x32_bf16 v[204:207], v[40:43], v[20:23], v[204:207]
    v_mfma_f32_16x16x32_bf16 v[204:207], v[44:47], v[24:27], v[204:207]
    v_mfma_f32_16x16x32_bf16 v[212:215], v[20:23], v[48:51], v[212:215]
    v_mfma_f32_16x16x32_bf16 v[212:215], v[24:27], v[52:55], v[212:215]
    v_mfma_f32_16x16x32_bf16 v[220:223], v[20:23], v[56:59], v[220:223]
    v_mfma_f32_16x16x32_bf16 v[220:223], v[24:27], v[60:63], v[220:223]
    s_waitcnt lgkmcnt(1)
    v_mfma_f32_16x16x32_bf16 v[224:227], v[32:35], v[4:7], v[224:227]
    ds_read_b128 v[20:23], v12 offset:47104
    s_waitcnt lgkmcnt(1)
    v_mfma_f32_16x16x32_bf16 v[224:227], v[36:39], v[16:19], v[224:227]
    ds_read_b128 v[24:27], v13 offset:47104
    v_mfma_f32_16x16x32_bf16 v[228:231], v[40:43], v[4:7], v[228:231]
    v_mfma_f32_16x16x32_bf16 v[228:231], v[44:47], v[16:19], v[228:231]
    v_mfma_f32_16x16x32_bf16 v[240:243], v[4:7], v[48:51], v[240:243]
    v_mfma_f32_16x16x32_bf16 v[240:243], v[16:19], v[52:55], v[240:243]
    v_mfma_f32_16x16x32_bf16 v[248:251], v[4:7], v[56:59], v[248:251]
    v_mfma_f32_16x16x32_bf16 v[248:251], v[16:19], v[60:63], v[248:251]
    s_waitcnt lgkmcnt(0)
    s_barrier
    ds_read_b128 v[4:7], v14 offset:0
    v_mfma_f32_16x16x32_bf16 v[232:235], v[32:35], v[20:23], v[232:235]
    ds_read_b128 v[16:19], v15 offset:0
    s_cmp_lg_u32 s43, 0
    s_cbranch_scc1 LA_zd1
    s_mov_b32 s52, 34
    s_bitcmp0_b32 s52, s41
    s_cbranch_scc1 LA_zd1
    s_lshl_b32 s52, s40, 2
    v_mov_b32 v29, 1
    s_mov_b64 s[92:93], exec
    s_mov_b64 exec, 1
    buffer_store_byte v29, off, s[24:27], s2 sc1
    s_mov_b64 exec, s[92:93]
LA_zd1:
    v_mfma_f32_16x16x32_bf16 v[232:235], v[36:39], v[24:27], v[232:235]
    ds_read_b64_tr_b16 v[32:33], v8 offset:0
    ds_read_b64_tr_b16 v[34:35], v8 offset:1024
    v_mfma_f32_16x16x32_bf16 v[236:239], v[40:43], v[20:23], v[236:239]
    ds_read_b64_tr_b16 v[36:37], v8 offset:8192
    ds_read_b64_tr_b16 v[38:39], v8 offset:9216
    v_mfma_f32_16x16x32_bf16 v[236:239], v[44:47], v[24:27], v[236:239]
    ds_read_b64_tr_b16 v[40:41], v0 offset:0
    ds_read_b64_tr_b16 v[42:43], v0 offset:1024
    v_mfma_f32_16x16x32_bf16 v[244:247], v[20:23], v[48:51], v[244:247]
    ds_read_b64_tr_b16 v[44:45], v0 offset:8192
    ds_read_b64_tr_b16 v[46:47], v0 offset:9216
    v_mfma_f32_16x16x32_bf16 v[244:247], v[24:27], v[52:55], v[244:247]
    ds_read_b64_tr_b16 v[48:49], v8 offset:16384
    ds_read_b64_tr_b16 v[50:51], v8 offset:17408
    v_mfma_f32_16x16x32_bf16 v[252:255], v[20:23], v[56:59], v[252:255]
    ds_read_b64_tr_b16 v[52:53], v8 offset:24576
    ds_read_b64_tr_b16 v[54:55], v8 offset:25600
    v_mfma_f32_16x16x32_bf16 v[252:255], v[24:27], v[60:63], v[252:255]
    ds_read_b64_tr_b16 v[56:57], v0 offset:16384
    s_waitcnt lgkmcnt(14)
    ds_read_b64_tr_b16 v[58:59], v0 offset:17408
    s_waitcnt lgkmcnt(14)
    ds_read_b64_tr_b16 v[60:61], v0 offset:24576
    s_waitcnt lgkmcnt(14)
    ds_read_b64_tr_b16 v[62:63], v0 offset:25600
    s_waitcnt lgkmcnt(14)
    v_mfma_f32_16x16x32_bf16 v[128:131], v[32:35], v[4:7], v[128:131]
    ds_read_b128 v[20:23], v14 offset:2048
    s_waitcnt lgkmcnt(13)
    v_mfma_f32_16x16x32_bf16 v[128:131], v[36:39], v[16:19], v[128:131]
    ds_read_b128 v[24:27], v15 offset:2048
    s_waitcnt lgkmcnt(12)
    v_mfma_f32_16x16x32_bf16 v[132:135], v[40:43], v[4:7], v[132:135]
    s_waitcnt lgkmcnt(10)
    v_mfma_f32_16x16x32_bf16 v[132:135], v[44:47], v[16:19], v[132:135]
    s_waitcnt lgkmcnt(8)
    v_mfma_f32_16x16x32_bf16 v[144:147], v[4:7], v[48:51], v[144:147]
    s_waitcnt lgkmcnt(6)
    v_mfma_f32_16x16x32_bf16 v[144:147], v[16:19], v[52:55], v[144:147]
    s_waitcnt lgkmcnt(4)
    v_mfma_f32_16x16x32_bf16 v[152:155], v[4:7], v[56:59], v[152:155]
    s_waitcnt lgkmcnt(2)
    v_mfma_f32_16x16x32_bf16 v[152:155], v[16:19], v[60:63], v[152:155]
    s_waitcnt lgkmcnt(1)
    v_mfma_f32_16x16x32_bf16 v[136:139], v[32:35], v[20:23], v[136:139]
    ds_read_b128 v[4:7], v14 offset:4096
    s_waitcnt lgkmcnt(1)
    v_mfma_f32_16x16x32_bf16 v[136:139], v[36:39], v[24:27], v[136:139]
    ds_read_b128 v[16:19], v15 offset:4096
    v_mfma_f32_16x16x32_bf16 v[140:143], v[40:43], v[20:23], v[140:143]
    v_mfma_f32_16x16x32_bf16 v[140:143], v[44:47], v[24:27], v[140:143]
    v_mfma_f32_16x16x32_bf16 v[148:151], v[20:23], v[48:51], v[148:151]
    v_mfma_f32_16x16x32_bf16 v[148:151], v[24:27], v[52:55], v[148:151]
    v_mfma_f32_16x16x32_bf16 v[156:159], v[20:23], v[56:59], v[156:159]
    v_mfma_f32_16x16x32_bf16 v[156:159], v[24:27], v[60:63], v[156:159]
    s_waitcnt lgkmcnt(1)
    v_mfma_f32_16x16x32_bf16 v[160:163], v[32:35], v[4:7], v[160:163]
    ds_read_b128 v[20:23], v14 offset:6144
    s_waitcnt lgkmcnt(1)
    v_mfma_f32_16x16x32_bf16 v[160:163], v[36:39], v[16:19], v[160:163]
    ds_read_b128 v[24:27], v15 offset:6144
    v_mfma_f32_16x16x32_bf16 v[164:167], v[40:43], v[4:7], v[164:167]
    v_mfma_f32_16x16x32_bf16 v[164:167], v[44:47], v[16:19], v[164:167]
    v_mfma_f32_16x16x32_bf16 v[176:179], v[4:7], v[48:51], v[176:179]
    v_mfma_f32_16x16x32_bf16 v[176:179], v[16:19], v[52:55], v[176:179]
    v_mfma_f32_16x16x32_bf16 v[184:187], v[4:7], v[56:59], v[184:187]
    v_mfma_f32_16x16x32_bf16 v[184:187], v[16:19], v[60:63], v[184:187]
    s_waitcnt lgkmcnt(1)
    v_mfma_f32_16x16x32_bf16 v[168:171], v[32:35], v[20:23], v[168:171]
    ds_read_b128 v[4:7], v14 offset:8192
    s_waitcnt lgkmcnt(1)
    v_mfma_f32_16x16x32_bf16 v[168:171], v[36:39], v[24:27], v[168:171]
    ds_read_b128 v[16:19], v15 offset:8192
    v_mfma_f32_16x16x32_bf16 v[172:175], v[40:43], v[20:23], v[172:175]
    v_mfma_f32_16x16x32_bf16 v[172:175], v[44:47], v[24:27], v[172:175]
    v_mfma_f32_16x16x32_bf16 v[180:183], v[20:23], v[48:51], v[180:183]
    v_mfma_f32_16x16x32_bf16 v[180:183], v[24:27], v[52:55], v[180:183]
    v_mfma_f32_16x16x32_bf16 v[188:191], v[20:23], v[56:59], v[188:191]
    v_mfma_f32_16x16x32_bf16 v[188:191], v[24:27], v[60:63], v[188:191]
    s_waitcnt lgkmcnt(1)
    v_mfma_f32_16x16x32_bf16 v[192:195], v[32:35], v[4:7], v[192:195]
    ds_read_b128 v[20:23], v14 offset:10240
    s_waitcnt lgkmcnt(1)
    v_mfma_f32_16x16x32_bf16 v[192:195], v[36:39], v[16:19], v[192:195]
    ds_read_b128 v[24:27], v15 offset:10240
    v_mfma_f32_16x16x32_bf16 v[196:199], v[40:43], v[4:7], v[196:199]
    v_mfma_f32_16x16x32_bf16 v[196:199], v[44:47], v[16:19], v[196:199]
    v_mfma_f32_16x16x32_bf16 v[208:211], v[4:7], v[48:51], v[208:211]
    v_mfma_f32_16x16x32_bf16 v[208:211], v[16:19], v[52:55], v[208:211]
    v_mfma_f32_16x16x32_bf16 v[216:219], v[4:7], v[56:59], v[216:219]
    v_mfma_f32_16x16x32_bf16 v[216:219], v[16:19], v[60:63], v[216:219]
    s_waitcnt lgkmcnt(1)
    v_mfma_f32_16x16x32_bf16 v[200:203], v[32:35], v[20:23], v[200:203]
    ds_read_b128 v[4:7], v14 offset:12288
    s_waitcnt lgkmcnt(1)
    v_mfma_f32_16x16x32_bf16 v[200:203], v[36:39], v[24:27], v[200:203]
    ds_read_b128 v[16:19], v15 offset:12288
    v_mfma_f32_16x16x32_bf16 v[204:207], v[40:43], v[20:23], v[204:207]
    v_mfma_f32_16x16x32_bf16 v[204:207], v[44:47], v[24:27], v[204:207]
    v_mfma_f32_16x16x32_bf16 v[212:215], v[20:23], v[48:51], v[212:215]
    v_mfma_f32_16x16x32_bf16 v[212:215], v[24:27], v[52:55], v[212:215]
    v_mfma_f32_16x16x32_bf16 v[220:223], v[20:23], v[56:59], v[220:223]
    v_mfma_f32_16x16x32_bf16 v[220:223], v[24:27], v[60:63], v[220:223]
    s_waitcnt lgkmcnt(1)
    v_mfma_f32_16x16x32_bf16 v[224:227], v[32:35], v[4:7], v[224:227]
    ds_read_b128 v[20:23], v14 offset:14336
    s_waitcnt lgkmcnt(1)
    v_mfma_f32_16x16x32_bf16 v[224:227], v[36:39], v[16:19], v[224:227]
    ds_read_b128 v[24:27], v15 offset:14336
    v_mfma_f32_16x16x32_bf16 v[228:231], v[40:43], v[4:7], v[228:231]
    v_mfma_f32_16x16x32_bf16 v[228:231], v[44:47], v[16:19], v[228:231]
    v_mfma_f32_16x16x32_bf16 v[240:243], v[4:7], v[48:51], v[240:243]
    v_mfma_f32_16x16x32_bf16 v[240:243], v[16:19], v[52:55], v[240:243]
    v_mfma_f32_16x16x32_bf16 v[248:251], v[4:7], v[56:59], v[248:251]
    v_mfma_f32_16x16x32_bf16 v[248:251], v[16:19], v[60:63], v[248:251]
    s_waitcnt lgkmcnt(0)
    s_barrier
    ds_read_b128 v[4:7], v12 offset:0
    v_mfma_f32_16x16x32_bf16 v[232:235], v[32:35], v[20:23], v[232:235]
    ds_read_b128 v[16:19], v13 offset:0
    s_cmp_lg_u32 s43, 0
    s_cbranch_scc1 LA_zd2
    s_mov_b32 s52, 68
    s_bitcmp0_b32 s52, s41
    s_cbranch_scc1 LA_zd2
    s_lshl_b32 s52, s40, 2
    v_mov_b32 v29, 1
    s_mov_b64 s[92:93], exec
    s_mov_b64 exec, 1
    buffer_store_byte v29, off, s[24:27], s2 sc1
    s_mov_b64 exec, s[92:93]
LA_zd2:
    v_mfma_f32_16x16x32_bf16 v[232:235], v[36:39], v[24:27], v[232:235]
    ds_read_b64_tr_b16 v[32:33], v8 offset:32768
    ds_read_b64_tr_b16 v[34:35], v8 offset:33792
    v_mfma_f32_16x16x32_bf16 v[236:239], v[40:43], v[20:23], v[236:239]
    ds_read_b64_tr_b16 v[36:37], v8 offset:40960
    ds_read_b64_tr_b16 v[38:39], v8 offset:41984
    v_mfma_f32_16x16x32_bf16 v[236:239], v[44:47], v[24:27], v[236:239]
    ds_read_b64_tr_b16 v[40:41], v0 offset:32768
    ds_read_b64_tr_b16 v[42:43], v0 offset:33792
    v_mfma_f32_16x16x32_bf16 v[244:247], v[20:23], v[48:51], v[244:247]
    ds_read_b64_tr_b16 v[44:45], v0 offset:40960
    ds_read_b64_tr_b16 v[46:47], v0 offset:41984
    v_mfma_f32_16x16x32_bf16 v[244:247], v[24:27], v[52:55], v[244:247]
    ds_read_b64_tr_b16 v[48:49], v8 offset:49152
    ds_read_b64_tr_b16 v[50:51], v8 offset:50176
    v_mfma_f32_16x16x32_bf16 v[252:255], v[20:23], v[56:59], v[252:255]
    ds_read_b64_tr_b16 v[52:53], v8 offset:57344
    ds_read_b64_tr_b16 v[54:55], v8 offset:58368
    v_mfma_f32_16x16x32_bf16 v[252:255], v[24:27], v[60:63], v[252:255]
    ds_read_b64_tr_b16 v[56:57], v0 offset:49152
    s_waitcnt lgkmcnt(14)
    ds_read_b64_tr_b16 v[58:59], v0 offset:50176
    s_waitcnt lgkmcnt(14)
    ds_read_b64_tr_b16 v[60:61], v0 offset:57344
    s_waitcnt lgkmcnt(14)
    ds_read_b64_tr_b16 v[62:63], v0 offset:58368
    s_waitcnt lgkmcnt(14)
    v_mfma_f32_16x16x32_bf16 v[128:131], v[32:35], v[4:7], v[128:131]
    ds_read_b128 v[20:23], v12 offset:2048
    s_waitcnt lgkmcnt(13)
    v_mfma_f32_16x16x32_bf16 v[128:131], v[36:39], v[16:19], v[128:131]
    ds_read_b128 v[24:27], v13 offset:2048
    s_waitcnt lgkmcnt(12)
    v_mfma_f32_16x16x32_bf16 v[132:135], v[40:43], v[4:7], v[132:135]
    s_waitcnt lgkmcnt(10)
    v_mfma_f32_16x16x32_bf16 v[132:135], v[44:47], v[16:19], v[132:135]
    s_waitcnt lgkmcnt(8)
    v_mfma_f32_16x16x32_bf16 v[144:147], v[4:7], v[48:51], v[144:147]
    s_waitcnt lgkmcnt(6)
    v_mfma_f32_16x16x32_bf16 v[144:147], v[16:19], v[52:55], v[144:147]
    s_waitcnt lgkmcnt(4)
    v_mfma_f32_16x16x32_bf16 v[152:155], v[4:7], v[56:59], v[152:155]
    s_waitcnt lgkmcnt(2)
    v_mfma_f32_16x16x32_bf16 v[152:155], v[16:19], v[60:63], v[152:155]
    s_waitcnt lgkmcnt(1)
    v_mfma_f32_16x16x32_bf16 v[136:139], v[32:35], v[20:23], v[136:139]
    ds_read_b128 v[4:7], v12 offset:4096
    s_waitcnt lgkmcnt(1)
    v_mfma_f32_16x16x32_bf16 v[136:139], v[36:39], v[24:27], v[136:139]
    ds_read_b128 v[16:19], v13 offset:4096
    v_mfma_f32_16x16x32_bf16 v[140:143], v[40:43], v[20:23], v[140:143]
    v_mfma_f32_16x16x32_bf16 v[140:143], v[44:47], v[24:27], v[140:143]
    v_mfma_f32_16x16x32_bf16 v[148:151], v[20:23], v[48:51], v[148:151]
    v_mfma_f32_16x16x32_bf16 v[148:151], v[24:27], v[52:55], v[148:151]
    v_mfma_f32_16x16x32_bf16 v[156:159], v[20:23], v[56:59], v[156:159]
    v_mfma_f32_16x16x32_bf16 v[156:159], v[24:27], v[60:63], v[156:159]
    s_waitcnt lgkmcnt(1)
    v_mfma_f32_16x16x32_bf16 v[160:163], v[32:35], v[4:7], v[160:163]
    ds_read_b128 v[20:23], v12 offset:6144
    s_waitcnt lgkmcnt(1)
    v_mfma_f32_16x16x32_bf16 v[160:163], v[36:39], v[16:19], v[160:163]
    ds_read_b128 v[24:27], v13 offset:6144
    v_mfma_f32_16x16x32_bf16 v[164:167], v[40:43], v[4:7], v[164:167]
    v_mfma_f32_16x16x32_bf16 v[164:167], v[44:47], v[16:19], v[164:167]
    v_mfma_f32_16x16x32_bf16 v[176:179], v[4:7], v[48:51], v[176:179]
    v_mfma_f32_16x16x32_bf16 v[176:179], v[16:19], v[52:55], v[176:179]
    v_mfma_f32_16x16x32_bf16 v[184:187], v[4:7], v[56:59], v[184:187]
    v_mfma_f32_16x16x32_bf16 v[184:187], v[16:19], v[60:63], v[184:187]
    s_waitcnt lgkmcnt(1)
    v_mfma_f32_16x16x32_bf16 v[168:171], v[32:35], v[20:23], v[168:171]
    ds_read_b128 v[4:7], v12 offset:8192
    s_waitcnt lgkmcnt(1)
    v_mfma_f32_16x16x32_bf16 v[168:171], v[36:39], v[24:27], v[168:171]
    ds_read_b128 v[16:19], v13 offset:8192
    v_mfma_f32_16x16x32_bf16 v[172:175], v[40:43], v[20:23], v[172:175]
    v_mfma_f32_16x16x32_bf16 v[172:175], v[44:47], v[24:27], v[172:175]
    v_mfma_f32_16x16x32_bf16 v[180:183], v[20:23], v[48:51], v[180:183]
    v_mfma_f32_16x16x32_bf16 v[180:183], v[24:27], v[52:55], v[180:183]
    v_mfma_f32_16x16x32_bf16 v[188:191], v[20:23], v[56:59], v[188:191]
    v_mfma_f32_16x16x32_bf16 v[188:191], v[24:27], v[60:63], v[188:191]
    s_waitcnt lgkmcnt(1)
    v_mfma_f32_16x16x32_bf16 v[192:195], v[32:35], v[4:7], v[192:195]
    ds_read_b128 v[20:23], v12 offset:10240
    s_waitcnt lgkmcnt(1)
    v_mfma_f32_16x16x32_bf16 v[192:195], v[36:39], v[16:19], v[192:195]
    ds_read_b128 v[24:27], v13 offset:10240
    v_mfma_f32_16x16x32_bf16 v[196:199], v[40:43], v[4:7], v[196:199]
    v_mfma_f32_16x16x32_bf16 v[196:199], v[44:47], v[16:19], v[196:199]
    v_mfma_f32_16x16x32_bf16 v[208:211], v[4:7], v[48:51], v[208:211]
    v_mfma_f32_16x16x32_bf16 v[208:211], v[16:19], v[52:55], v[208:211]
    v_mfma_f32_16x16x32_bf16 v[216:219], v[4:7], v[56:59], v[216:219]
    v_mfma_f32_16x16x32_bf16 v[216:219], v[16:19], v[60:63], v[216:219]
    s_waitcnt lgkmcnt(1)
    v_mfma_f32_16x16x32_bf16 v[200:203], v[32:35], v[20:23], v[200:203]
    ds_read_b128 v[4:7], v12 offset:12288
    s_waitcnt lgkmcnt(1)
    v_mfma_f32_16x16x32_bf16 v[200:203], v[36:39], v[24:27], v[200:203]
    ds_read_b128 v[16:19], v13 offset:12288
    v_mfma_f32_16x16x32_bf16 v[204:207], v[40:43], v[20:23], v[204:207]
    v_mfma_f32_16x16x32_bf16 v[204:207], v[44:47], v[24:27], v[204:207]
    v_mfma_f32_16x16x32_bf16 v[212:215], v[20:23], v[48:51], v[212:215]
    v_mfma_f32_16x16x32_bf16 v[212:215], v[24:27], v[52:55], v[212:215]
    v_mfma_f32_16x16x32_bf16 v[220:223], v[20:23], v[56:59], v[220:223]
    v_mfma_f32_16x16x32_bf16 v[220:223], v[24:27], v[60:63], v[220:223]
    s_waitcnt lgkmcnt(1)
    v_mfma_f32_16x16x32_bf16 v[224:227], v[32:35], v[4:7], v[224:227]
    ds_read_b128 v[20:23], v12 offset:14336
    s_waitcnt lgkmcnt(1)
    v_mfma_f32_16x16x32_bf16 v[224:227], v[36:39], v[16:19], v[224:227]
    ds_read_b128 v[24:27], v13 offset:14336
    v_mfma_f32_16x16x32_bf16 v[228:231], v[40:43], v[4:7], v[228:231]
    v_mfma_f32_16x16x32_bf16 v[228:231], v[44:47], v[16:19], v[228:231]
    v_mfma_f32_16x16x32_bf16 v[240:243], v[4:7], v[48:51], v[240:243]
    v_mfma_f32_16x16x32_bf16 v[240:243], v[16:19], v[52:55], v[240:243]
    v_mfma_f32_16x16x32_bf16 v[248:251], v[4:7], v[56:59], v[248:251]
    v_mfma_f32_16x16x32_bf16 v[248:251], v[16:19], v[60:63], v[248:251]
    s_waitcnt lgkmcnt(0)
    s_barrier
    ds_read_b128 v[4:7], v12 offset:32768
    v_mfma_f32_16x16x32_bf16 v[232:235], v[32:35], v[20:23], v[232:235]
    ds_read_b128 v[16:19], v13 offset:32768
    s_cmp_lg_u32 s43, 0
    s_cbranch_scc1 LA_zd3
    s_mov_b32 s52, 136
    s_bitcmp0_b32 s52, s41
    s_cbranch_scc1 LA_zd3
    s_lshl_b32 s52, s40, 2
    v_mov_b32 v29, 1
    s_mov_b64 s[92:93], exec
    s_mov_b64 exec, 1
    buffer_store_byte v29, off, s[24:27], s2 sc1
    s_mov_b64 exec, s[92:93]
LA_zd3:
    v_mfma_f32_16x16x32_bf16 v[232:235], v[36:39], v[24:27], v[232:235]
    ds_read_b64_tr_b16 v[32:33], v8 offset:0
    ds_read_b64_tr_b16 v[34:35], v8 offset:1024
    v_mfma_f32_16x16x32_bf16 v[236:239], v[40:43], v[20:23], v[236:239]
    ds_read_b64_tr_b16 v[36:37], v8 offset:8192
    ds_read_b64_tr_b16 v[38:39], v8 offset:9216
    v_mfma_f32_16x16x32_bf16 v[236:239], v[44:47], v[24:27], v[236:239]
    ds_read_b64_tr_b16 v[40:41], v0 offset:0
    ds_read_b64_tr_b16 v[42:43], v0 offset:1024
    v_mfma_f32_16x16x32_bf16 v[244:247], v[20:23], v[48:51], v[244:247]
    ds_read_b64_tr_b16 v[44:45], v0 offset:8192
    ds_read_b64_tr_b16 v[46:47], v0 offset:9216
    v_mfma_f32_16x16x32_bf16 v[244:247], v[24:27], v[52:55], v[244:247]
    ds_read_b64_tr_b16 v[48:49], v8 offset:16384
    ds_read_b64_tr_b16 v[50:51], v8 offset:17408
    v_mfma_f32_16x16x32_bf16 v[252:255], v[20:23], v[56:59], v[252:255]
    ds_read_b64_tr_b16 v[52:53], v8 offset:24576
    ds_read_b64_tr_b16 v[54:55], v8 offset:25600
    v_mfma_f32_16x16x32_bf16 v[252:255], v[24:27], v[60:63], v[252:255]
    ds_read_b64_tr_b16 v[56:57], v0 offset:16384
    s_waitcnt lgkmcnt(14)
    ds_read_b64_tr_b16 v[58:59], v0 offset:17408
    s_waitcnt lgkmcnt(14)
    ds_read_b64_tr_b16 v[60:61], v0 offset:24576
    s_waitcnt lgkmcnt(14)
    ds_read_b64_tr_b16 v[62:63], v0 offset:25600
    s_waitcnt lgkmcnt(14)
    v_mfma_f32_16x16x32_bf16 v[128:131], v[32:35], v[4:7], v[128:131]
    ds_read_b128 v[20:23], v12 offset:34816
    s_waitcnt lgkmcnt(13)
    v_mfma_f32_16x16x32_bf16 v[128:131], v[36:39], v[16:19], v[128:131]
    ds_read_b128 v[24:27], v13 offset:34816
    s_waitcnt lgkmcnt(12)
    v_mfma_f32_16x16x32_bf16 v[132:135], v[40:43], v[4:7], v[132:135]
    s_waitcnt lgkmcnt(10)
    v_mfma_f32_16x16x32_bf16 v[132:135], v[44:47], v[16:19], v[132:135]
    s_waitcnt lgkmcnt(8)
    v_mfma_f32_16x16x32_bf16 v[144:147], v[4:7], v[48:51], v[144:147]
    s_waitcnt lgkmcnt(6)
    v_mfma_f32_16x16x32_bf16 v[144:147], v[16:19], v[52:55], v[144:147]
    s_waitcnt lgkmcnt(4)
    v_mfma_f32_16x16x32_bf16 v[152:155], v[4:7], v[56:59], v[152:155]
    s_waitcnt lgkmcnt(2)
    v_mfma_f32_16x16x32_bf16 v[152:155], v[16:19], v[60:63], v[152:155]
    s_waitcnt lgkmcnt(1)
    v_mfma_f32_16x16x32_bf16 v[136:139], v[32:35], v[20:23], v[136:139]
    ds_read_b128 v[4:7], v12 offset:36864
    s_waitcnt lgkmcnt(1)
    v_mfma_f32_16x16x32_bf16 v[136:139], v[36:39], v[24:27], v[136:139]
    ds_read_b128 v[16:19], v13 offset:36864
    v_mfma_f32_16x16x32_bf16 v[140:143], v[40:43], v[20:23], v[140:143]
    v_mfma_f32_16x16x32_bf16 v[140:143], v[44:47], v[24:27], v[140:143]
    v_mfma_f32_16x16x32_bf16 v[148:151], v[20:23], v[48:51], v[148:151]
    v_mfma_f32_16x16x32_bf16 v[148:151], v[24:27], v[52:55], v[148:151]
    v_mfma_f32_16x16x32_bf16 v[156:159], v[20:23], v[56:59], v[156:159]
    v_mfma_f32_16x16x32_bf16 v[156:159], v[24:27], v[60:63], v[156:159]
    s_waitcnt lgkmcnt(1)
    v_mfma_f32_16x16x32_bf16 v[160:163], v[32:35], v[4:7], v[160:163]
    ds_read_b128 v[20:23], v12 offset:38912
    s_waitcnt lgkmcnt(1)
    v_mfma_f32_16x16x32_bf16 v[160:163], v[36:39], v[16:19], v[160:163]
    ds_read_b128 v[24:27], v13 offset:38912
    v_mfma_f32_16x16x32_bf16 v[164:167], v[40:43], v[4:7], v[164:167]
    v_mfma_f32_16x16x32_bf16 v[164:167], v[44:47], v[16:19], v[164:167]
    v_mfma_f32_16x16x32_bf16 v[176:179], v[4:7], v[48:51], v[176:179]
    v_mfma_f32_16x16x32_bf16 v[176:179], v[16:19], v[52:55], v[176:179]
    v_mfma_f32_16x16x32_bf16 v[184:187], v[4:7], v[56:59], v[184:187]
    v_mfma_f32_16x16x32_bf16 v[184:187], v[16:19], v[60:63], v[184:187]
    s_waitcnt lgkmcnt(1)
    v_mfma_f32_16x16x32_bf16 v[168:171], v[32:35], v[20:23], v[168:171]
    ds_read_b128 v[4:7], v12 offset:40960
    s_waitcnt lgkmcnt(1)
    v_mfma_f32_16x16x32_bf16 v[168:171], v[36:39], v[24:27], v[168:171]
    ds_read_b128 v[16:19], v13 offset:40960
    v_mfma_f32_16x16x32_bf16 v[172:175], v[40:43], v[20:23], v[172:175]
    v_mfma_f32_16x16x32_bf16 v[172:175], v[44:47], v[24:27], v[172:175]
    v_mfma_f32_16x16x32_bf16 v[180:183], v[20:23], v[48:51], v[180:183]
    v_mfma_f32_16x16x32_bf16 v[180:183], v[24:27], v[52:55], v[180:183]
    v_mfma_f32_16x16x32_bf16 v[188:191], v[20:23], v[56:59], v[188:191]
    v_mfma_f32_16x16x32_bf16 v[188:191], v[24:27], v[60:63], v[188:191]
    s_waitcnt lgkmcnt(1)
    v_mfma_f32_16x16x32_bf16 v[192:195], v[32:35], v[4:7], v[192:195]
    ds_read_b128 v[20:23], v12 offset:43008
    s_waitcnt lgkmcnt(1)
    v_mfma_f32_16x16x32_bf16 v[192:195], v[36:39], v[16:19], v[192:195]
    ds_read_b128 v[24:27], v13 offset:43008
    v_mfma_f32_16x16x32_bf16 v[196:199], v[40:43], v[4:7], v[196:199]
    v_mfma_f32_16x16x32_bf16 v[196:199], v[44:47], v[16:19], v[196:199]
    v_mfma_f32_16x16x32_bf16 v[208:211], v[4:7], v[48:51], v[208:211]
    v_mfma_f32_16x16x32_bf16 v[208:211], v[16:19], v[52:55], v[208:211]
    v_mfma_f32_16x16x32_bf16 v[216:219], v[4:7], v[56:59], v[216:219]
    v_mfma_f32_16x16x32_bf16 v[216:219], v[16:19], v[60:63], v[216:219]
    s_waitcnt lgkmcnt(1)
    v_mfma_f32_16x16x32_bf16 v[200:203], v[32:35], v[20:23], v[200:203]
    ds_read_b128 v[4:7], v12 offset:45056
    s_waitcnt lgkmcnt(1)
    v_mfma_f32_16x16x32_bf16 v[200:203], v[36:39], v[24:27], v[200:203]
    ds_read_b128 v[16:19], v13 offset:45056
    v_mfma_f32_16x16x32_bf16 v[204:207], v[40:43], v[20:23], v[204:207]
    v_mfma_f32_16x16x32_bf16 v[204:207], v[44:47], v[24:27], v[204:207]
    v_mfma_f32_16x16x32_bf16 v[212:215], v[20:23], v[48:51], v[212:215]
    v_mfma_f32_16x16x32_bf16 v[212:215], v[24:27], v[52:55], v[212:215]
    v_mfma_f32_16x16x32_bf16 v[220:223], v[20:23], v[56:59], v[220:223]
    v_mfma_f32_16x16x32_bf16 v[220:223], v[24:27], v[60:63], v[220:223]
    s_waitcnt lgkmcnt(1)
    v_mfma_f32_16x16x32_bf16 v[224:227], v[32:35], v[4:7], v[224:227]
    ds_read_b128 v[20:23], v12 offset:47104
    s_waitcnt lgkmcnt(1)
    v_mfma_f32_16x16x32_bf16 v[224:227], v[36:39], v[16:19], v[224:227]
    ds_read_b128 v[24:27], v13 offset:47104
    v_mfma_f32_16x16x32_bf16 v[228:231], v[40:43], v[4:7], v[228:231]
    v_mfma_f32_16x16x32_bf16 v[228:231], v[44:47], v[16:19], v[228:231]
    v_mfma_f32_16x16x32_bf16 v[240:243], v[4:7], v[48:51], v[240:243]
    v_mfma_f32_16x16x32_bf16 v[240:243], v[16:19], v[52:55], v[240:243]
    v_mfma_f32_16x16x32_bf16 v[248:251], v[4:7], v[56:59], v[248:251]
    v_mfma_f32_16x16x32_bf16 v[248:251], v[16:19], v[60:63], v[248:251]
    s_waitcnt lgkmcnt(0)
    s_barrier
    ds_read_b128 v[4:7], v14 offset:0
    v_mfma_f32_16x16x32_bf16 v[232:235], v[32:35], v[20:23], v[232:235]
    ds_read_b128 v[16:19], v15 offset:0
    s_cmp_lg_u32 s43, 0
    s_cbranch_scc1 LA_ct2
    s_lshr_b32 s52, s2, 3
    s_mul_i32 s52, s52, 384
    s_add_u32 s52, s52, LA_g23-L12_pc
    v_min_u32 v29, 2, v1
    v_lshlrev_b32 v29, 7, v29
    v_add_u32 v29, s52, v29
    v_min_u32 v29, L12_end-L12_pc, v29
    global_load_dword v31, v29, s[100:101]
    s_lshr_b32 s52, s2, 3
    s_mul_i32 s52, s52, 256
    s_add_u32 s52, s52, LB_g23-L12_pc
    v_min_u32 v29, 1, v1
    v_lshlrev_b32 v29, 7, v29
    v_add_u32 v29, s52, v29
    v_min_u32 v29, L12_end-L12_pc, v29
    global_load_dword v31, v29, s[100:101]
LA_ct2:
    v_mfma_f32_16x16x32_bf16 v[232:235], v[36:39], v[24:27], v[232:235]
    ds_read_b64_tr_b16 v[32:33], v8 offset:32768
    ds_read_b64_tr_b16 v[34:35], v8 offset:33792
    v_mfma_f32_16x16x32_bf16 v[236:239], v[40:43], v[20:23], v[236:239]
    ds_read_b64_tr_b16 v[36:37], v8 offset:40960
    ds_read_b64_tr_b16 v[38:39], v8 offset:41984
    v_mfma_f32_16x16x32_bf16 v[236:239], v[44:47], v[24:27], v[236:239]
    ds_read_b64_tr_b16 v[40:41], v0 offset:32768
    ds_read_b64_tr_b16 v[42:43], v0 offset:33792
    v_mfma_f32_16x16x32_bf16 v[244:247], v[20:23], v[48:51], v[244:247]
    ds_read_b64_tr_b16 v[44:45], v0 offset:40960
    ds_read_b64_tr_b16 v[46:47], v0 offset:41984
    v_mfma_f32_16x16x32_bf16 v[244:247], v[24:27], v[52:55], v[244:247]
    ds_read_b64_tr_b16 v[48:49], v8 offset:49152
    ds_read_b64_tr_b16 v[50:51], v8 offset:50176
    v_mfma_f32_16x16x32_bf16 v[252:255], v[20:23], v[56:59], v[252:255]
    ds_read_b64_tr_b16 v[52:53], v8 offset:57344
    ds_read_b64_tr_b16 v[54:55], v8 offset:58368
    v_mfma_f32_16x16x32_bf16 v[252:255], v[24:27], v[60:63], v[252:255]
    ds_read_b64_tr_b16 v[56:57], v0 offset:49152
    s_waitcnt lgkmcnt(14)
    ds_read_b64_tr_b16 v[58:59], v0 offset:50176
    s_waitcnt lgkmcnt(14)
    ds_read_b64_tr_b16 v[60:61], v0 offset:57344
    s_waitcnt lgkmcnt(14)
    ds_read_b64_tr_b16 v[62:63], v0 offset:58368
    s_waitcnt lgkmcnt(14)
    v_mfma_f32_16x16x32_bf16 v[128:131], v[32:35], v[4:7], v[128:131]
    ds_read_b128 v[20:23], v14 offset:2048
    s_waitcnt lgkmcnt(13)
    v_mfma_f32_16x16x32_bf16 v[128:131], v[36:39], v[16:19], v[128:131]
    ds_read_b128 v[24:27], v15 offset:2048
    s_waitcnt lgkmcnt(12)
    v_mfma_f32_16x16x32_bf16 v[132:135], v[40:43], v[4:7], v[132:135]
    s_waitcnt lgkmcnt(10)
    v_mfma_f32_16x16x32_bf16 v[132:135], v[44:47], v[16:19], v[132:135]
    s_waitcnt lgkmcnt(8)
    v_mfma_f32_16x16x32_bf16 v[144:147], v[4:7], v[48:51], v[144:147]
    s_waitcnt lgkmcnt(6)
    v_mfma_f32_16x16x32_bf16 v[144:147], v[16:19], v[52:55], v[144:147]
    s_waitcnt lgkmcnt(4)
    v_mfma_f32_16x16x32_bf16 v[152:155], v[4:7], v[56:59], v[152:155]
    s_waitcnt lgkmcnt(2)
    v_mfma_f32_16x16x32_bf16 v[152:155], v[16:19], v[60:63], v[152:155]
    s_waitcnt lgkmcnt(1)
    v_mfma_f32_16x16x32_bf16 v[136:139], v[32:35], v[20:23], v[136:139]
    ds_read_b128 v[4:7], v14 offset:4096
    s_waitcnt lgkmcnt(1)
    v_mfma_f32_16x16x32_bf16 v[136:139], v[36:39], v[24:27], v[136:139]
    ds_read_b128 v[16:19], v15 offset:4096
    v_mfma_f32_16x16x32_bf16 v[140:143], v[40:43], v[20:23], v[140:143]
    v_mfma_f32_16x16x32_bf16 v[140:143], v[44:47], v[24:27], v[140:143]
    v_mfma_f32_16x16x32_bf16 v[148:151], v[20:23], v[48:51], v[148:151]
    v_mfma_f32_16x16x32_bf16 v[148:151], v[24:27], v[52:55], v[148:151]
    v_mfma_f32_16x16x32_bf16 v[156:159], v[20:23], v[56:59], v[156:159]
    v_mfma_f32_16x16x32_bf16 v[156:159], v[24:27], v[60:63], v[156:159]
    s_waitcnt lgkmcnt(1)
    v_mfma_f32_16x16x32_bf16 v[160:163], v[32:35], v[4:7], v[160:163]
    ds_read_b128 v[20:23], v14 offset:6144
    s_waitcnt lgkmcnt(1)
    v_mfma_f32_16x16x32_bf16 v[160:163], v[36:39], v[16:19], v[160:163]
    ds_read_b128 v[24:27], v15 offset:6144
    v_mfma_f32_16x16x32_bf16 v[164:167], v[40:43], v[4:7], v[164:167]
    v_mfma_f32_16x16x32_bf16 v[164:167], v[44:47], v[16:19], v[164:167]
    v_mfma_f32_16x16x32_bf16 v[176:179], v[4:7], v[48:51], v[176:179]
    v_mfma_f32_16x16x32_bf16 v[176:179], v[16:19], v[52:55], v[176:179]
    v_mfma_f32_16x16x32_bf16 v[184:187], v[4:7], v[56:59], v[184:187]
    v_mfma_f32_16x16x32_bf16 v[184:187], v[16:19], v[60:63], v[184:187]
    s_waitcnt lgkmcnt(1)
    v_mfma_f32_16x16x32_bf16 v[168:171], v[32:35], v[20:23], v[168:171]
    ds_read_b128 v[4:7], v14 offset:8192
    s_waitcnt lgkmcnt(1)
    v_mfma_f32_16x16x32_bf16 v[168:171], v[36:39], v[24:27], v[168:171]
    ds_read_b128 v[16:19], v15 offset:8192
    v_mfma_f32_16x16x32_bf16 v[172:175], v[40:43], v[20:23], v[172:175]
    v_mfma_f32_16x16x32_bf16 v[172:175], v[44:47], v[24:27], v[172:175]
    v_mfma_f32_16x16x32_bf16 v[180:183], v[20:23], v[48:51], v[180:183]
    v_mfma_f32_16x16x32_bf16 v[180:183], v[24:27], v[52:55], v[180:183]
    v_mfma_f32_16x16x32_bf16 v[188:191], v[20:23], v[56:59], v[188:191]
    v_mfma_f32_16x16x32_bf16 v[188:191], v[24:27], v[60:63], v[188:191]
    s_waitcnt lgkmcnt(1)
    v_mfma_f32_16x16x32_bf16 v[192:195], v[32:35], v[4:7], v[192:195]
    ds_read_b128 v[20:23], v14 offset:10240
    s_waitcnt lgkmcnt(1)
    v_mfma_f32_16x16x32_bf16 v[192:195], v[36:39], v[16:19], v[192:195]
    ds_read_b128 v[24:27], v15 offset:10240
    v_mfma_f32_16x16x32_bf16 v[196:199], v[40:43], v[4:7], v[196:199]
    v_mfma_f32_16x16x32_bf16 v[196:199], v[44:47], v[16:19], v[196:199]
    v_mfma_f32_16x16x32_bf16 v[208:211], v[4:7], v[48:51], v[208:211]
    v_mfma_f32_16x16x32_bf16 v[208:211], v[16:19], v[52:55], v[208:211]
    v_mfma_f32_16x16x32_bf16 v[216:219], v[4:7], v[56:59], v[216:219]
    v_mfma_f32_16x16x32_bf16 v[216:219], v[16:19], v[60:63], v[216:219]
    s_waitcnt lgkmcnt(1)
    v_mfma_f32_16x16x32_bf16 v[200:203], v[32:35], v[20:23], v[200:203]
    ds_read_b128 v[4:7], v14 offset:12288
    s_waitcnt lgkmcnt(1)
    v_mfma_f32_16x16x32_bf16 v[200:203], v[36:39], v[24:27], v[200:203]
    ds_read_b128 v[16:19], v15 offset:12288
    v_mfma_f32_16x16x32_bf16 v[204:207], v[40:43], v[20:23], v[204:207]
    v_mfma_f32_16x16x32_bf16 v[204:207], v[44:47], v[24:27], v[204:207]
    v_mfma_f32_16x16x32_bf16 v[212:215], v[20:23], v[48:51], v[212:215]
    v_mfma_f32_16x16x32_bf16 v[212:215], v[24:27], v[52:55], v[212:215]
    v_mfma_f32_16x16x32_bf16 v[220:223], v[20:23], v[56:59], v[220:223]
    v_mfma_f32_16x16x32_bf16 v[220:223], v[24:27], v[60:63], v[220:223]
    s_waitcnt lgkmcnt(1)
    v_mfma_f32_16x16x32_bf16 v[224:227], v[32:35], v[4:7], v[224:227]
    ds_read_b128 v[20:23], v14 offset:14336
    s_waitcnt lgkmcnt(1)
    v_mfma_f32_16x16x32_bf16 v[224:227], v[36:39], v[16:19], v[224:227]
    ds_read_b128 v[24:27], v15 offset:14336
    v_mfma_f32_16x16x32_bf16 v[228:231], v[40:43], v[4:7], v[228:231]
    v_mfma_f32_16x16x32_bf16 v[228:231], v[44:47], v[16:19], v[228:231]
    v_mfma_f32_16x16x32_bf16 v[240:243], v[4:7], v[48:51], v[240:243]
    v_mfma_f32_16x16x32_bf16 v[240:243], v[16:19], v[52:55], v[240:243]
    v_mfma_f32_16x16x32_bf16 v[248:251], v[4:7], v[56:59], v[248:251]
    v_mfma_f32_16x16x32_bf16 v[248:251], v[16:19], v[60:63], v[248:251]
    s_waitcnt lgkmcnt(0)
    s_barrier
    ds_read_b128 v[4:7], v12 offset:0
    v_mfma_f32_16x16x32_bf16 v[232:235], v[32:35], v[20:23], v[232:235]
    ds_read_b128 v[16:19], v13 offset:0
    s_cmp_lg_u32 s43, 0
    s_cbranch_scc1 LA_zl
    v_and_b32 v29, 63, v1
    v_lshlrev_b32 v29, 2, v29
    buffer_load_dword v10, v29, s[24:27], 0 offen sc1
LA_zl:
    v_mfma_f32_16x16x32_bf16 v[232:235], v[36:39], v[24:27], v[232:235]
    ds_read_b64_tr_b16 v[32:33], v8 offset:0
    ds_read_b64_tr_b16 v[34:35], v8 offset:1024
    v_mfma_f32_16x16x32_bf16 v[236:239], v[40:43], v[20:23], v[236:239]
    ds_read_b64_tr_b16 v[36:37], v8 offset:8192
    ds_read_b64_tr_b16 v[38:39], v8 offset:9216
    v_mfma_f32_16x16x32_bf16 v[236:239], v[44:47], v[24:27], v[236:239]
    ds_read_b64_tr_b16 v[40:41], v0 offset:0
    ds_read_b64_tr_b16 v[42:43], v0 offset:1024
    v_mfma_f32_16x16x32_bf16 v[244:247], v[20:23], v[48:51], v[244:247]
    ds_read_b64_tr_b16 v[44:45], v0 offset:8192
    ds_read_b64_tr_b16 v[46:47], v0 offset:9216
    v_mfma_f32_16x16x32_bf16 v[244:247], v[24:27], v[52:55], v[244:247]
    ds_read_b64_tr_b16 v[48:49], v8 offset:16384
    ds_read_b64_tr_b16 v[50:51], v8 offset:17408
    v_mfma_f32_16x16x32_bf16 v[252:255], v[20:23], v[56:59], v[252:255]
    ds_read_b64_tr_b16 v[52:53], v8 offset:24576
    ds_read_b64_tr_b16 v[54:55], v8 offset:25600
    v_mfma_f32_16x16x32_bf16 v[252:255], v[24:27], v[60:63], v[252:255]
    ds_read_b64_tr_b16 v[56:57], v0 offset:16384
    s_waitcnt lgkmcnt(14)
    ds_read_b64_tr_b16 v[58:59], v0 offset:17408
    s_waitcnt lgkmcnt(14)
    ds_read_b64_tr_b16 v[60:61], v0 offset:24576
    s_waitcnt lgkmcnt(14)
    ds_read_b64_tr_b16 v[62:63], v0 offset:25600
    s_waitcnt lgkmcnt(14)
    v_mfma_f32_16x16x32_bf16 v[128:131], v[32:35], v[4:7], v[128:131]
    ds_read_b128 v[20:23], v12 offset:2048
    s_waitcnt lgkmcnt(13)
    v_mfma_f32_16x16x32_bf16 v[128:131], v[36:39], v[16:19], v[128:131]
    ds_read_b128 v[24:27], v13 offset:2048
    s_waitcnt lgkmcnt(12)
    v_mfma_f32_16x16x32_bf16 v[132:135], v[40:43], v[4:7], v[132:135]
    s_waitcnt lgkmcnt(10)
    v_mfma_f32_16x16x32_bf16 v[132:135], v[44:47], v[16:19], v[132:135]
    s_waitcnt lgkmcnt(8)
    v_mfma_f32_16x16x32_bf16 v[144:147], v[4:7], v[48:51], v[144:147]
    s_waitcnt lgkmcnt(6)
    v_mfma_f32_16x16x32_bf16 v[144:147], v[16:19], v[52:55], v[144:147]
    s_waitcnt lgkmcnt(4)
    v_mfma_f32_16x16x32_bf16 v[152:155], v[4:7], v[56:59], v[152:155]
    s_waitcnt lgkmcnt(2)
    v_mfma_f32_16x16x32_bf16 v[152:155], v[16:19], v[60:63], v[152:155]
    s_waitcnt lgkmcnt(1)
    v_mfma_f32_16x16x32_bf16 v[136:139], v[32:35], v[20:23], v[136:139]
    ds_read_b128 v[4:7], v12 offset:4096
    s_waitcnt lgkmcnt(1)
    v_mfma_f32_16x16x32_bf16 v[136:139], v[36:39], v[24:27], v[136:139]
    ds_read_b128 v[16:19], v13 offset:4096
    v_mfma_f32_16x16x32_bf16 v[140:143], v[40:43], v[20:23], v[140:143]
    v_mfma_f32_16x16x32_bf16 v[140:143], v[44:47], v[24:27], v[140:143]
    v_mfma_f32_16x16x32_bf16 v[148:151], v[20:23], v[48:51], v[148:151]
    v_mfma_f32_16x16x32_bf16 v[148:151], v[24:27], v[52:55], v[148:151]
    v_mfma_f32_16x16x32_bf16 v[156:159], v[20:23], v[56:59], v[156:159]
    v_mfma_f32_16x16x32_bf16 v[156:159], v[24:27], v[60:63], v[156:159]
    s_waitcnt lgkmcnt(1)
    v_mfma_f32_16x16x32_bf16 v[160:163], v[32:35], v[4:7], v[160:163]
    ds_read_b128 v[20:23], v12 offset:6144
    s_waitcnt lgkmcnt(1)
    v_mfma_f32_16x16x32_bf16 v[160:163], v[36:39], v[16:19], v[160:163]
    ds_read_b128 v[24:27], v13 offset:6144
    v_mfma_f32_16x16x32_bf16 v[164:167], v[40:43], v[4:7], v[164:167]
    v_mfma_f32_16x16x32_bf16 v[164:167], v[44:47], v[16:19], v[164:167]
    v_mfma_f32_16x16x32_bf16 v[176:179], v[4:7], v[48:51], v[176:179]
    v_mfma_f32_16x16x32_bf16 v[176:179], v[16:19], v[52:55], v[176:179]
    v_mfma_f32_16x16x32_bf16 v[184:187], v[4:7], v[56:59], v[184:187]
    v_mfma_f32_16x16x32_bf16 v[184:187], v[16:19], v[60:63], v[184:187]
    s_waitcnt lgkmcnt(1)
    v_mfma_f32_16x16x32_bf16 v[168:171], v[32:35], v[20:23], v[168:171]
    ds_read_b128 v[4:7], v12 offset:8192
    s_waitcnt lgkmcnt(1)
    v_mfma_f32_16x16x32_bf16 v[168:171], v[36:39], v[24:27], v[168:171]
    ds_read_b128 v[16:19], v13 offset:8192
    v_mfma_f32_16x16x32_bf16 v[172:175], v[40:43], v[20:23], v[172:175]
    v_mfma_f32_16x16x32_bf16 v[172:175], v[44:47], v[24:27], v[172:175]
    v_mfma_f32_16x16x32_bf16 v[180:183], v[20:23], v[48:51], v[180:183]
    v_mfma_f32_16x16x32_bf16 v[180:183], v[24:27], v[52:55], v[180:183]
    v_mfma_f32_16x16x32_bf16 v[188:191], v[20:23], v[56:59], v[188:191]
    v_mfma_f32_16x16x32_bf16 v[188:191], v[24:27], v[60:63], v[188:191]
    s_waitcnt lgkmcnt(1)
    v_mfma_f32_16x16x32_bf16 v[192:195], v[32:35], v[4:7], v[192:195]
    ds_read_b128 v[20:23], v12 offset:10240
    s_waitcnt lgkmcnt(1)
    v_mfma_f32_16x16x32_bf16 v[192:195], v[36:39], v[16:19], v[192:195]
    ds_read_b128 v[24:27], v13 offset:10240
    v_mfma_f32_16x16x32_bf16 v[196:199], v[40:43], v[4:7], v[196:199]
    v_mfma_f32_16x16x32_bf16 v[196:199], v[44:47], v[16:19], v[196:199]
    v_mfma_f32_16x16x32_bf16 v[208:211], v[4:7], v[48:51], v[208:211]
    v_mfma_f32_16x16x32_bf16 v[208:211], v[16:19], v[52:55], v[208:211]
    v_mfma_f32_16x16x32_bf16 v[216:219], v[4:7], v[56:59], v[216:219]
    v_mfma_f32_16x16x32_bf16 v[216:219], v[16:19], v[60:63], v[216:219]
    s_waitcnt lgkmcnt(1)
    v_mfma_f32_16x16x32_bf16 v[200:203], v[32:35], v[20:23], v[200:203]
    ds_read_b128 v[4:7], v12 offset:12288
    s_waitcnt lgkmcnt(1)
    v_mfma_f32_16x16x32_bf16 v[200:203], v[36:39], v[24:27], v[200:203]
    ds_read_b128 v[16:19], v13 offset:12288
    v_mfma_f32_16x16x32_bf16 v[204:207], v[40:43], v[20:23], v[204:207]
    v_mfma_f32_16x16x32_bf16 v[204:207], v[44:47], v[24:27], v[204:207]
    v_mfma_f32_16x16x32_bf16 v[212:215], v[20:23], v[48:51], v[212:215]
    v_mfma_f32_16x16x32_bf16 v[212:215], v[24:27], v[52:55], v[212:215]
    v_mfma_f32_16x16x32_bf16 v[220:223], v[20:23], v[56:59], v[220:223]
    v_mfma_f32_16x16x32_bf16 v[220:223], v[24:27], v[60:63], v[220:223]
    s_waitcnt lgkmcnt(1)
    v_mfma_f32_16x16x32_bf16 v[224:227], v[32:35], v[4:7], v[224:227]
    ds_read_b128 v[20:23], v12 offset:14336
    s_waitcnt lgkmcnt(1)
    v_mfma_f32_16x16x32_bf16 v[224:227], v[36:39], v[16:19], v[224:227]
    ds_read_b128 v[24:27], v13 offset:14336
    v_mfma_f32_16x16x32_bf16 v[228:231], v[40:43], v[4:7], v[228:231]
    v_mfma_f32_16x16x32_bf16 v[228:231], v[44:47], v[16:19], v[228:231]
    v_mfma_f32_16x16x32_bf16 v[240:243], v[4:7], v[48:51], v[240:243]
    v_mfma_f32_16x16x32_bf16 v[240:243], v[16:19], v[52:55], v[240:243]
    v_mfma_f32_16x16x32_bf16 v[248:251], v[4:7], v[56:59], v[248:251]
    v_mfma_f32_16x16x32_bf16 v[248:251], v[16:19], v[60:63], v[248:251]
    s_waitcnt lgkmcnt(0)
    s_barrier
    ds_read_b128 v[4:7], v12 offset:32768
    v_mfma_f32_16x16x32_bf16 v[232:235], v[32:35], v[20:23], v[232:235]
    ds_read_b128 v[16:19], v13 offset:32768
    s_cmp_lg_u32 s43, 0
    s_cbranch_scc1 LA_zc
    s_waitcnt vmcnt(0)
LA_zc_loop:
    v_cmp_ne_u32 vcc, 0x01010101, v10
    s_cbranch_vccz LA_zc
    s_sleep 8
    buffer_load_dword v10, v29, s[24:27], 0 offen sc1
    s_waitcnt vmcnt(0)
    s_branch LA_zc_loop
LA_zc:
    v_mfma_f32_16x16x32_bf16 v[232:235], v[36:39], v[24:27], v[232:235]
    ds_read_b64_tr_b16 v[32:33], v8 offset:32768
    ds_read_b64_tr_b16 v[34:35], v8 offset:33792
    v_mfma_f32_16x16x32_bf16 v[236:239], v[40:43], v[20:23], v[236:239]
    ds_read_b64_tr_b16 v[36:37], v8 offset:40960
    ds_read_b64_tr_b16 v[38:39], v8 offset:41984
    v_mfma_f32_16x16x32_bf16 v[236:239], v[44:47], v[24:27], v[236:239]
    ds_read_b64_tr_b16 v[40:41], v0 offset:32768
    ds_read_b64_tr_b16 v[42:43], v0 offset:33792
    v_mfma_f32_16x16x32_bf16 v[244:247], v[20:23], v[48:51], v[244:247]
    ds_read_b64_tr_b16 v[44:45], v0 offset:40960
    ds_read_b64_tr_b16 v[46:47], v0 offset:41984
    v_mfma_f32_16x16x32_bf16 v[244:247], v[24:27], v[52:55], v[244:247]
    ds_read_b64_tr_b16 v[48:49], v8 offset:49152
    ds_read_b64_tr_b16 v[50:51], v8 offset:50176
    v_mfma_f32_16x16x32_bf16 v[252:255], v[20:23], v[56:59], v[252:255]
    ds_read_b64_tr_b16 v[52:53], v8 offset:57344
    ds_read_b64_tr_b16 v[54:55], v8 offset:58368
    v_mfma_f32_16x16x32_bf16 v[252:255], v[24:27], v[60:63], v[252:255]
    ds_read_b64_tr_b16 v[56:57], v0 offset:49152
    s_waitcnt lgkmcnt(14)
    ds_read_b64_tr_b16 v[58:59], v0 offset:50176
    s_waitcnt lgkmcnt(14)
    ds_read_b64_tr_b16 v[60:61], v0 offset:57344
    s_waitcnt lgkmcnt(14)
    ds_read_b64_tr_b16 v[62:63], v0 offset:58368
    s_waitcnt lgkmcnt(14)
    v_mfma_f32_16x16x32_bf16 v[128:131], v[32:35], v[4:7], v[128:131]
    ds_read_b128 v[20:23], v12 offset:34816
    s_waitcnt lgkmcnt(13)
    v_mfma_f32_16x16x32_bf16 v[128:131], v[36:39], v[16:19], v[128:131]
    ds_read_b128 v[24:27], v13 offset:34816
    s_waitcnt lgkmcnt(12)
    v_mfma_f32_16x16x32_bf16 v[132:135], v[40:43], v[4:7], v[132:135]
    s_waitcnt lgkmcnt(10)
    v_mfma_f32_16x16x32_bf16 v[132:135], v[44:47], v[16:19], v[132:135]
    s_waitcnt lgkmcnt(8)
    v_mfma_f32_16x16x32_bf16 v[144:147], v[4:7], v[48:51], v[144:147]
    s_waitcnt lgkmcnt(6)
    v_mfma_f32_16x16x32_bf16 v[144:147], v[16:19], v[52:55], v[144:147]
    s_waitcnt lgkmcnt(4)
    v_mfma_f32_16x16x32_bf16 v[152:155], v[4:7], v[56:59], v[152:155]
    s_waitcnt lgkmcnt(2)
    v_mfma_f32_16x16x32_bf16 v[152:155], v[16:19], v[60:63], v[152:155]
    s_waitcnt lgkmcnt(1)
    v_mfma_f32_16x16x32_bf16 v[136:139], v[32:35], v[20:23], v[136:139]
    ds_read_b128 v[4:7], v12 offset:36864
    s_waitcnt lgkmcnt(1)
    v_mfma_f32_16x16x32_bf16 v[136:139], v[36:39], v[24:27], v[136:139]
    ds_read_b128 v[16:19], v13 offset:36864
    v_mfma_f32_16x16x32_bf16 v[140:143], v[40:43], v[20:23], v[140:143]
    v_mfma_f32_16x16x32_bf16 v[140:143], v[44:47], v[24:27], v[140:143]
    v_mfma_f32_16x16x32_bf16 v[148:151], v[20:23], v[48:51], v[148:151]
    v_mfma_f32_16x16x32_bf16 v[148:151], v[24:27], v[52:55], v[148:151]
    v_mfma_f32_16x16x32_bf16 v[156:159], v[20:23], v[56:59], v[156:159]
    v_mfma_f32_16x16x32_bf16 v[156:159], v[24:27], v[60:63], v[156:159]
    s_waitcnt lgkmcnt(1)
    v_mfma_f32_16x16x32_bf16 v[160:163], v[32:35], v[4:7], v[160:163]
    ds_read_b128 v[20:23], v12 offset:38912
    s_waitcnt lgkmcnt(1)
    v_mfma_f32_16x16x32_bf16 v[160:163], v[36:39], v[16:19], v[160:163]
    ds_read_b128 v[24:27], v13 offset:38912
    v_mfma_f32_16x16x32_bf16 v[164:167], v[40:43], v[4:7], v[164:167]
    v_mfma_f32_16x16x32_bf16 v[164:167], v[44:47], v[16:19], v[164:167]
    v_mfma_f32_16x16x32_bf16 v[176:179], v[4:7], v[48:51], v[176:179]
    v_mul_f32 v128, s95, v128
    v_mul_f32 v129, s95, v129
    v_mfma_f32_16x16x32_bf16 v[176:179], v[16:19], v[52:55], v[176:179]
    v_mul_f32 v130, s95, v130
    v_mul_f32 v131, s95, v131
    v_mfma_f32_16x16x32_bf16 v[184:187], v[4:7], v[56:59], v[184:187]
    v_mul_f32 v132, s95, v132
    v_mul_f32 v133, s95, v133
    v_mfma_f32_16x16x32_bf16 v[184:187], v[16:19], v[60:63], v[184:187]
    v_mul_f32 v134, s95, v134
    v_mul_f32 v135, s95, v135
    s_waitcnt lgkmcnt(1)
    v_mfma_f32_16x16x32_bf16 v[168:171], v[32:35], v[20:23], v[168:171]
    ds_read_b128 v[4:7], v12 offset:40960
    v_mul_f32 v136, s95, v136
    v_mul_f32 v137, s95, v137
    s_waitcnt lgkmcnt(1)
    v_mfma_f32_16x16x32_bf16 v[168:171], v[36:39], v[24:27], v[168:171]
    ds_read_b128 v[16:19], v13 offset:40960
    v_mul_f32 v138, s95, v138
    v_mul_f32 v139, s95, v139
    v_mfma_f32_16x16x32_bf16 v[172:175], v[40:43], v[20:23], v[172:175]
    v_mul_f32 v140, s95, v140
    v_mul_f32 v141, s95, v141
    v_mfma_f32_16x16x32_bf16 v[172:175], v[44:47], v[24:27], v[172:175]
    v_mul_f32 v142, s95, v142
    v_mul_f32 v143, s95, v143
    v_mfma_f32_16x16x32_bf16 v[180:183], v[20:23], v[48:51], v[180:183]
    v_cvt_pk_bf16_f32 v64, v128, v129
    v_cvt_pk_bf16_f32 v65, v130, v131
    v_mfma_f32_16x16x32_bf16 v[180:183], v[24:27], v[52:55], v[180:183]
    v_cvt_pk_bf16_f32 v66, v132, v133
    v_cvt_pk_bf16_f32 v67, v134, v135
    v_mfma_f32_16x16x32_bf16 v[188:191], v[20:23], v[56:59], v[188:191]
    v_cvt_pk_bf16_f32 v68, v136, v137
    v_cvt_pk_bf16_f32 v69, v138, v139
    v_mfma_f32_16x16x32_bf16 v[188:191], v[24:27], v[60:63], v[188:191]
    v_cvt_pk_bf16_f32 v70, v140, v141
    v_cvt_pk_bf16_f32 v71, v142, v143
LA_g23:
    s_waitcnt lgkmcnt(1)
    v_mfma_f32_16x16x32_bf16 v[192:195], v[32:35], v[4:7], v[192:195]
    ds_read_b128 v[20:23], v12 offset:43008
    v_cvt_pk_bf16_f32 v72, v144, v145
    v_cvt_pk_bf16_f32 v73, v146, v147
    s_waitcnt lgkmcnt(1)
    v_mfma_f32_16x16x32_bf16 v[192:195], v[36:39], v[16:19], v[192:195]
    ds_read_b128 v[24:27], v13 offset:43008
    v_cvt_pk_bf16_f32 v74, v148, v149
    v_cvt_pk_bf16_f32 v75, v150, v151
    v_mfma_f32_16x16x32_bf16 v[196:199], v[40:43], v[4:7], v[196:199]
    v_cvt_pk_bf16_f32 v76, v152, v153
    v_cvt_pk_bf16_f32 v77, v154, v155
    v_mfma_f32_16x16x32_bf16 v[196:199], v[44:47], v[16:19], v[196:199]
    v_cvt_pk_bf16_f32 v78, v156, v157
    v_cvt_pk_bf16_f32 v79, v158, v159
    v_mfma_f32_16x16x32_bf16 v[208:211], v[4:7], v[48:51], v[208:211]
    v_mul_f32 v160, s95, v160
    v_mul_f32 v161, s95, v161
    v_mfma_f32_16x16x32_bf16 v[208:211], v[16:19], v[52:55], v[208:211]
    v_mul_f32 v162, s95, v162
    v_mul_f32 v163, s95, v163
    v_mfma_f32_16x16x32_bf16 v[216:219], v[4:7], v[56:59], v[216:219]
    v_mul_f32 v164, s95, v164
    v_mul_f32 v165, s95, v165
    v_mfma_f32_16x16x32_bf16 v[216:219], v[16:19], v[60:63], v[216:219]
    v_mul_f32 v166, s95, v166
    v_mul_f32 v167, s95, v167
    s_waitcnt lgkmcnt(1)
    v_mfma_f32_16x16x32_bf16 v[200:203], v[32:35], v[20:23], v[200:203]
    ds_read_b128 v[4:7], v12 offset:45056
    v_mul_f32 v168, s95, v168
    v_mul_f32 v169, s95, v169
    s_waitcnt lgkmcnt(1)
    v_mfma_f32_16x16x32_bf16 v[200:203], v[36:39], v[24:27], v[200:203]
    ds_read_b128 v[16:19], v13 offset:45056
    v_mul_f32 v170, s95, v170
    v_mul_f32 v171, s95, v171
    v_mfma_f32_16x16x32_bf16 v[204:207], v[40:43], v[20:23], v[204:207]
    v_mul_f32 v172, s95, v172
    v_mul_f32 v173, s95, v173
    v_mfma_f32_16x16x32_bf16 v[204:207], v[44:47], v[24:27], v[204:207]
    v_mul_f32 v174, s95, v174
    v_mul_f32 v175, s95, v175
    v_mfma_f32_16x16x32_bf16 v[212:215], v[20:23], v[48:51], v[212:215]
    v_cvt_pk_bf16_f32 v80, v160, v161
    v_cvt_pk_bf16_f32 v81, v162, v163
    v_mfma_f32_16x16x32_bf16 v[212:215], v[24:27], v[52:55], v[212:215]
    v_cvt_pk_bf16_f32 v82, v164, v165
    v_cvt_pk_bf16_f32 v83, v166, v167
    v_mfma_f32_16x16x32_bf16 v[220:223], v[20:23], v[56:59], v[220:223]
    v_cvt_pk_bf16_f32 v84, v168, v169
    v_cvt_pk_bf16_f32 v85, v170, v171
    v_mfma_f32_16x16x32_bf16 v[220:223], v[24:27], v[60:63], v[220:223]
    v_cvt_pk_bf16_f32 v86, v172, v173
    v_cvt_pk_bf16_f32 v87, v174, v175
    s_waitcnt lgkmcnt(1)
    v_mfma_f32_16x16x32_bf16 v[224:227], v[32:35], v[4:7], v[224:227]
    ds_read_b128 v[20:23], v12 offset:47104
    v_cvt_pk_bf16_f32 v88, v176, v177
    v_cvt_pk_bf16_f32 v89, v178, v179
    s_waitcnt lgkmcnt(1)
    v_mfma_f32_16x16x32_bf16 v[224:227], v[36:39], v[16:19], v[224:227]
    ds_read_b128 v[24:27], v13 offset:47104
    v_cvt_pk_bf16_f32 v90, v180, v181
    v_cvt_pk_bf16_f32 v91, v182, v183
    v_mfma_f32_16x16x32_bf16 v[228:231], v[40:43], v[4:7], v[228:231]
    v_cvt_pk_bf16_f32 v92, v184, v185
    v_cvt_pk_bf16_f32 v93, v186, v187
    v_mfma_f32_16x16x32_bf16 v[228:231], v[44:47], v[16:19], v[228:231]
    v_cvt_pk_bf16_f32 v94, v188, v189
    v_cvt_pk_bf16_f32 v95, v190, v191
    v_mfma_f32_16x16x32_bf16 v[240:243], v[4:7], v[48:51], v[240:243]
    s_lshl_b32 s52, s43, 12
    s_sub_u32 s52, s52, 16384
    s_lshl_b32 s53, s43, 6
    v_add_u32 v12, s52, v12
    v_add_u32 v13, s52, v13
    v_add_u32 v14, s52, v14
    v_add_u32 v15, s52, v15
    v_xor_b32 v8, s53, v8
    v_mul_f32 v192, s95, v192
    v_mul_f32 v193, s95, v193
    v_mfma_f32_16x16x32_bf16 v[240:243], v[16:19], v[52:55], v[240:243]
    v_mul_f32 v194, s95, v194
    v_mul_f32 v195, s95, v195
    v_mfma_f32_16x16x32_bf16 v[248:251], v[4:7], v[56:59], v[248:251]
    v_mul_f32 v196, s95, v196
    v_mul_f32 v197, s95, v197
    v_mfma_f32_16x16x32_bf16 v[248:251], v[16:19], v[60:63], v[248:251]
    v_mul_f32 v198, s95, v198
    v_mul_f32 v199, s95, v199
    s_waitcnt lgkmcnt(0)
    s_barrier
    ds_read_b64_tr_b16 v[4:5], v8 offset:0
    ds_read_b64_tr_b16 v[6:7], v8 offset:1024
    v_mfma_f32_16x16x32_bf16 v[232:235], v[32:35], v[20:23], v[232:235]
    ds_read_b64_tr_b16 v[16:17], v8 offset:8192
    ds_read_b64_tr_b16 v[18:19], v8 offset:9216
    s_add_u32 s51, s48, 0
    buffer_store_dwordx4 v[64:67], v2, s[20:23], s51 offen offset:0 sc1
    v_xor_b32 v8, 32, v8
    v_mul_f32 v200, s95, v200
    v_mul_f32 v201, s95, v201
    v_mfma_f32_16x16x32_bf16 v[232:235], v[36:39], v[24:27], v[232:235]
    ds_read_b128 v[32:35], v14 offset:0
    v_mul_f32 v202, s95, v202
    v_mul_f32 v203, s95, v203
    v_mfma_f32_16x16x32_bf16 v[236:239], v[40:43], v[20:23], v[236:239]
    ds_read_b128 v[36:39], v15 offset:0
    v_mul_f32 v204, s95, v204
    v_mul_f32 v205, s95, v205
    v_mfma_f32_16x16x32_bf16 v[236:239], v[44:47], v[24:27], v[236:239]
    ds_read_b128 v[40:43], v14 offset:2048
    v_mul_f32 v206, s95, v206
    v_mul_f32 v207, s95, v207
    v_mfma_f32_16x16x32_bf16 v[244:247], v[20:23], v[48:51], v[244:247]
    ds_read_b128 v[44:47], v15 offset:2048
    v_cvt_pk_bf16_f32 v96, v192, v193
    v_cvt_pk_bf16_f32 v97, v194, v195
    v_mfma_f32_16x16x32_bf16 v[244:247], v[24:27], v[52:55], v[244:247]
    ds_read_b128 v[48:51], v14 offset:16384
    v_cvt_pk_bf16_f32 v98, v196, v197
    v_cvt_pk_bf16_f32 v99, v198, v199
    v_mfma_f32_16x16x32_bf16 v[252:255], v[20:23], v[56:59], v[252:255]
    ds_read_b128 v[52:55], v15 offset:16384
    v_cvt_pk_bf16_f32 v100, v200, v201
    v_cvt_pk_bf16_f32 v101, v202, v203
    v_mfma_f32_16x16x32_bf16 v[252:255], v[24:27], v[60:63], v[252:255]
    ds_read_b128 v[56:59], v14 offset:18432
    ds_read_b128 v[60:63], v15 offset:18432
    v_cvt_pk_bf16_f32 v102, v204, v205
    v_cvt_pk_bf16_f32 v103, v206, v207
    s_waitcnt lgkmcnt(7)
    v_mfma_f32_16x16x32_bf16 v[128:131], v[4:7], v[32:35], 0
    ds_read_b64_tr_b16 v[20:21], v8 offset:0
    v_cvt_pk_bf16_f32 v104, v208, v209
    v_cvt_pk_bf16_f32 v105, v210, v211
    s_waitcnt lgkmcnt(7)
    v_mfma_f32_16x16x32_bf16 v[128:131], v[16:19], v[36:39], v[128:131]
    ds_read_b64_tr_b16 v[22:23], v8 offset:1024
    v_cvt_pk_bf16_f32 v106, v212, v213
    v_cvt_pk_bf16_f32 v107, v214, v215
    s_waitcnt lgkmcnt(7)
    v_mfma_f32_16x16x32_bf16 v[136:139], v[4:7], v[40:43], 0
    ds_read_b64_tr_b16 v[24:25], v8 offset:8192
    v_cvt_pk_bf16_f32 v108, v216, v217
    v_cvt_pk_bf16_f32 v109, v218, v219
    s_waitcnt lgkmcnt(7)
    v_mfma_f32_16x16x32_bf16 v[136:139], v[16:19], v[44:47], v[136:139]
    ds_read_b64_tr_b16 v[26:27], v8 offset:9216
    v_cvt_pk_bf16_f32 v110, v220, v221
    v_cvt_pk_bf16_f32 v111, v222, v223
    s_waitcnt lgkmcnt(7)
    v_mfma_f32_16x16x32_bf16 v[144:147], v[4:7], v[48:51], 0
    v_xor_b32 v8, 96, v8
    v_mul_f32 v224, s95, v224
    v_mul_f32 v225, s95, v225
    s_waitcnt lgkmcnt(6)
    v_mfma_f32_16x16x32_bf16 v[144:147], v[16:19], v[52:55], v[144:147]
    v_mul_f32 v226, s95, v226
    v_mul_f32 v227, s95, v227
    s_waitcnt lgkmcnt(5)
    v_mfma_f32_16x16x32_bf16 v[152:155], v[4:7], v[56:59], 0
    v_mul_f32 v228, s95, v228
    v_mul_f32 v229, s95, v229
    s_waitcnt lgkmcnt(4)
    v_mfma_f32_16x16x32_bf16 v[152:155], v[16:19], v[60:63], v[152:155]
    v_mul_f32 v230, s95, v230
    v_mul_f32 v231, s95, v231
    s_waitcnt lgkmcnt(2)
    v_mfma_f32_16x16x32_bf16 v[132:135], v[20:23], v[32:35], 0
    ds_read_b64_tr_b16 v[4:5], v8 offset:0
    s_add_u32 s51, s48, 0
    buffer_store_dwordx4 v[68:71], v11, s[20:23], s51 offen offset:0 sc1
    v_mul_f32 v232, s95, v232
    v_mul_f32 v233, s95, v233
    s_waitcnt lgkmcnt(1)
    v_mfma_f32_16x16x32_bf16 v[132:135], v[24:27], v[36:39], v[132:135]
    ds_read_b64_tr_b16 v[6:7], v8 offset:1024
    v_mul_f32 v234, s95, v234
    v_mul_f32 v235, s95, v235
    v_mfma_f32_16x16x32_bf16 v[140:143], v[20:23], v[40:43], 0
    ds_read_b64_tr_b16 v[16:17], v8 offset:8192
    v_mul_f32 v236, s95, v236
    v_mul_f32 v237, s95, v237
    v_mfma_f32_16x16x32_bf16 v[140:143], v[24:27], v[44:47], v[140:143]
    ds_read_b64_tr_b16 v[18:19], v8 offset:9216
    v_mul_f32 v238, s95, v238
    v_mul_f32 v239, s95, v239
    v_mfma_f32_16x16x32_bf16 v[148:151], v[20:23], v[48:51], 0
    v_xor_b32 v8, 32, v8
    v_cvt_pk_bf16_f32 v112, v224, v225
    v_cvt_pk_bf16_f32 v113, v226, v227
    v_mfma_f32_16x16x32_bf16 v[148:151], v[24:27], v[52:55], v[148:151]
    v_cvt_pk_bf16_f32 v114, v228, v229
    v_cvt_pk_bf16_f32 v115, v230, v231
    v_mfma_f32_16x16x32_bf16 v[156:159], v[20:23], v[56:59], 0
    v_cvt_pk_bf16_f32 v116, v232, v233
    v_cvt_pk_bf16_f32 v117, v234, v235
    v_mfma_f32_16x16x32_bf16 v[156:159], v[24:27], v[60:63], v[156:159]
    v_cvt_pk_bf16_f32 v118, v236, v237
    v_cvt_pk_bf16_f32 v119, v238, v239
    s_waitcnt lgkmcnt(2)
    v_mfma_f32_16x16x32_bf16 v[160:163], v[4:7], v[32:35], 0
    ds_read_b64_tr_b16 v[20:21], v8 offset:0
    v_cvt_pk_bf16_f32 v120, v240, v241
    v_cvt_pk_bf16_f32 v121, v242, v243
    s_waitcnt lgkmcnt(1)
    v_mfma_f32_16x16x32_bf16 v[160:163], v[16:19], v[36:39], v[160:163]
    ds_read_b64_tr_b16 v[22:23], v8 offset:1024
    v_cvt_pk_bf16_f32 v122, v244, v245
    v_cvt_pk_bf16_f32 v123, v246, v247
    v_mfma_f32_16x16x32_bf16 v[168:171], v[4:7], v[40:43], 0
    ds_read_b64_tr_b16 v[24:25], v8 offset:8192
    v_cvt_pk_bf16_f32 v124, v248, v249
    v_cvt_pk_bf16_f32 v125, v250, v251
    v_mfma_f32_16x16x32_bf16 v[168:171], v[16:19], v[44:47], v[168:171]
    ds_read_b64_tr_b16 v[26:27], v8 offset:9216
    v_cvt_pk_bf16_f32 v126, v252, v253
    v_cvt_pk_bf16_f32 v127, v254, v255
    v_mfma_f32_16x16x32_bf16 v[176:179], v[4:7], v[48:51], 0
    v_xor_b32 v8, 224, v8
    v_mfma_f32_16x16x32_bf16 v[176:179], v[16:19], v[52:55], v[176:179]
    v_mfma_f32_16x16x32_bf16 v[184:187], v[4:7], v[56:59], 0
    v_mfma_f32_16x16x32_bf16 v[184:187], v[16:19], v[60:63], v[184:187]
    s_waitcnt lgkmcnt(2)
    v_mfma_f32_16x16x32_bf16 v[164:167], v[20:23], v[32:35], 0
    ds_read_b64_tr_b16 v[4:5], v8 offset:0
    s_add_u32 s51, s49, 0
    buffer_store_dwordx4 v[72:75], v2, s[20:23], s51 offen offset:0 sc1
    s_waitcnt lgkmcnt(1)
    v_mfma_f32_16x16x32_bf16 v[164:167], v[24:27], v[36:39], v[164:167]
    ds_read_b64_tr_b16 v[6:7], v8 offset:1024
    v_mfma_f32_16x16x32_bf16 v[172:175], v[20:23], v[40:43], 0
    ds_read_b64_tr_b16 v[16:17], v8 offset:8192
    v_mfma_f32_16x16x32_bf16 v[172:175], v[24:27], v[44:47], v[172:175]
    ds_read_b64_tr_b16 v[18:19], v8 offset:9216
    v_mfma_f32_16x16x32_bf16 v[180:183], v[20:23], v[48:51], 0
    v_xor_b32 v8, 32, v8
    v_mfma_f32_16x16x32_bf16 v[180:183], v[24:27], v[52:55], v[180:183]
    v_mfma_f32_16x16x32_bf16 v[188:191], v[20:23], v[56:59], 0
    v_mfma_f32_16x16x32_bf16 v[188:191], v[24:27], v[60:63], v[188:191]
    s_waitcnt lgkmcnt(2)
    v_mfma_f32_16x16x32_bf16 v[192:195], v[4:7], v[32:35], 0
    ds_read_b64_tr_b16 v[20:21], v8 offset:0
    s_waitcnt lgkmcnt(1)
    v_mfma_f32_16x16x32_bf16 v[192:195], v[16:19], v[36:39], v[192:195]
    ds_read_b64_tr_b16 v[22:23], v8 offset:1024
    v_mfma_f32_16x16x32_bf16 v[200:203], v[4:7], v[40:43], 0
    ds_read_b64_tr_b16 v[24:25], v8 offset:8192
    v_mfma_f32_16x16x32_bf16 v[200:203], v[16:19], v[44:47], v[200:203]
    ds_read_b64_tr_b16 v[26:27], v8 offset:9216
    v_mfma_f32_16x16x32_bf16 v[208:211], v[4:7], v[48:51], 0
    v_xor_b32 v8, 96, v8
    v_mfma_f32_16x16x32_bf16 v[208:211], v[16:19], v[52:55], v[208:211]
    v_mfma_f32_16x16x32_bf16 v[216:219], v[4:7], v[56:59], 0
    v_mfma_f32_16x16x32_bf16 v[216:219], v[16:19], v[60:63], v[216:219]
    s_waitcnt lgkmcnt(2)
    v_mfma_f32_16x16x32_bf16 v[196:199], v[20:23], v[32:35], 0
    ds_read_b64_tr_b16 v[4:5], v8 offset:0
    s_add_u32 s51, s49, 0
    buffer_store_dwordx4 v[76:79], v2, s[20:23], s51 offen offset:1024 sc1
    s_waitcnt lgkmcnt(1)
    v_mfma_f32_16x16x32_bf16 v[196:199], v[24:27], v[36:39], v[196:199]
    ds_read_b64_tr_b16 v[6:7], v8 offset:1024
    v_mfma_f32_16x16x32_bf16 v[204:207], v[20:23], v[40:43], 0
    ds_read_b64_tr_b16 v[16:17], v8 offset:8192
    v_mfma_f32_16x16x32_bf16 v[204:207], v[24:27], v[44:47], v[204:207]
    ds_read_b64_tr_b16 v[18:19], v8 offset:9216
    v_mfma_f32_16x16x32_bf16 v[212:215], v[20:23], v[48:51], 0
    v_xor_b32 v8, 32, v8
    v_mfma_f32_16x16x32_bf16 v[212:215], v[24:27], v[52:55], v[212:215]
    v_mfma_f32_16x16x32_bf16 v[220:223], v[20:23], v[56:59], 0
    v_mfma_f32_16x16x32_bf16 v[220:223], v[24:27], v[60:63], v[220:223]
    s_waitcnt lgkmcnt(2)
    v_mfma_f32_16x16x32_bf16 v[224:227], v[4:7], v[32:35], 0
    ds_read_b64_tr_b16 v[20:21], v8 offset:0
    s_waitcnt lgkmcnt(1)
    v_mfma_f32_16x16x32_bf16 v[224:227], v[16:19], v[36:39], v[224:227]
    ds_read_b64_tr_b16 v[22:23], v8 offset:1024
    v_mfma_f32_16x16x32_bf16 v[232:235], v[4:7], v[40:43], 0
    ds_read_b64_tr_b16 v[24:25], v8 offset:8192
    v_mfma_f32_16x16x32_bf16 v[232:235], v[16:19], v[44:47], v[232:235]
    ds_read_b64_tr_b16 v[26:27], v8 offset:9216
    v_mfma_f32_16x16x32_bf16 v[240:243], v[4:7], v[48:51], 0
    v_xor_b32 v8, 224, v8
    v_mfma_f32_16x16x32_bf16 v[240:243], v[16:19], v[52:55], v[240:243]
    v_mfma_f32_16x16x32_bf16 v[248:251], v[4:7], v[56:59], 0
    v_mfma_f32_16x16x32_bf16 v[248:251], v[16:19], v[60:63], v[248:251]
    s_waitcnt lgkmcnt(0)
    s_barrier
    ds_read_b64_tr_b16 v[4:5], v8 offset:32768
    ds_read_b64_tr_b16 v[6:7], v8 offset:33792
    v_mfma_f32_16x16x32_bf16 v[228:231], v[20:23], v[32:35], 0
    ds_read_b64_tr_b16 v[16:17], v8 offset:40960
    ds_read_b64_tr_b16 v[18:19], v8 offset:41984
    s_add_u32 s51, s48, 16384
    buffer_store_dwordx4 v[80:83], v2, s[20:23], s51 offen offset:0 sc1
    v_xor_b32 v8, 32, v8
    v_mfma_f32_16x16x32_bf16 v[228:231], v[24:27], v[36:39], v[228:231]
    ds_read_b128 v[32:35], v12 offset:0
    v_mfma_f32_16x16x32_bf16 v[236:239], v[20:23], v[40:43], 0
    ds_read_b128 v[36:39], v13 offset:0
    v_mfma_f32_16x16x32_bf16 v[236:239], v[24:27], v[44:47], v[236:239]
    ds_read_b128 v[40:43], v12 offset:2048
    v_mfma_f32_16x16x32_bf16 v[244:247], v[20:23], v[48:51], 0
    ds_read_b128 v[44:47], v13 offset:2048
    v_mfma_f32_16x16x32_bf16 v[244:247], v[24:27], v[52:55], v[244:247]
    ds_read_b128 v[48:51], v12 offset:16384
    v_mfma_f32_16x16x32_bf16 v[252:255], v[20:23], v[56:59], 0
    ds_read_b128 v[52:55], v13 offset:16384
    v_mfma_f32_16x16x32_bf16 v[252:255], v[24:27], v[60:63], v[252:255]
    ds_read_b128 v[56:59], v12 offset:18432
    ds_read_b128 v[60:63], v13 offset:18432
    s_waitcnt lgkmcnt(7)
    v_mfma_f32_16x16x32_bf16 v[128:131], v[4:7], v[32:35], v[128:131]
    ds_read_b64_tr_b16 v[20:21], v8 offset:32768
    s_waitcnt lgkmcnt(7)
    v_mfma_f32_16x16x32_bf16 v[128:131], v[16:19], v[36:39], v[128:131]
    ds_read_b64_tr_b16 v[22:23], v8 offset:33792
    s_waitcnt lgkmcnt(7)
    v_mfma_f32_16x16x32_bf16 v[136:139], v[4:7], v[40:43], v[136:139]
    ds_read_b64_tr_b16 v[24:25], v8 offset:40960
    s_waitcnt lgkmcnt(7)
    v_mfma_f32_16x16x32_bf16 v[136:139], v[16:19], v[44:47], v[136:139]
    ds_read_b64_tr_b16 v[26:27], v8 offset:41984
    s_waitcnt lgkmcnt(7)
    v_mfma_f32_16x16x32_bf16 v[144:147], v[4:7], v[48:51], v[144:147]
    v_xor_b32 v8, 96, v8
    s_waitcnt lgkmcnt(6)
    v_mfma_f32_16x16x32_bf16 v[144:147], v[16:19], v[52:55], v[144:147]
    s_waitcnt lgkmcnt(5)
    v_mfma_f32_16x16x32_bf16 v[152:155], v[4:7], v[56:59], v[152:155]
    s_waitcnt lgkmcnt(4)
    v_mfma_f32_16x16x32_bf16 v[152:155], v[16:19], v[60:63], v[152:155]
    s_waitcnt lgkmcnt(2)
    v_mfma_f32_16x16x32_bf16 v[132:135], v[20:23], v[32:35], v[132:135]
    ds_read_b64_tr_b16 v[4:5], v8 offset:32768
    s_waitcnt lgkmcnt(1)
    v_mfma_f32_16x16x32_bf16 v[132:135], v[24:27], v[36:39], v[132:135]
    ds_read_b64_tr_b16 v[6:7], v8 offset:33792
    v_mfma_f32_16x16x32_bf16 v[140:143], v[20:23], v[40:43], v[140:143]
    ds_read_b64_tr_b16 v[16:17], v8 offset:40960
    v_mfma_f32_16x16x32_bf16 v[140:143], v[24:27], v[44:47], v[140:143]
    ds_read_b64_tr_b16 v[18:19], v8 offset:41984
    v_mfma_f32_16x16x32_bf16 v[148:151], v[20:23], v[48:51], v[148:151]
    v_xor_b32 v8, 32, v8
    v_mfma_f32_16x16x32_bf16 v[148:151], v[24:27], v[52:55], v[148:151]
    s_add_u32 s51, s48, 16384
    buffer_store_dwordx4 v[84:87], v11, s[20:23], s51 offen offset:0 sc1
    v_mfma_f32_16x16x32_bf16 v[156:159], v[20:23], v[56:59], v[156:159]
    v_mfma_f32_16x16x32_bf16 v[156:159], v[24:27], v[60:63], v[156:159]
    s_waitcnt lgkmcnt(2)
    v_mfma_f32_16x16x32_bf16 v[160:163], v[4:7], v[32:35], v[160:163]
    ds_read_b64_tr_b16 v[20:21], v8 offset:32768
    s_waitcnt lgkmcnt(1)
    v_mfma_f32_16x16x32_bf16 v[160:163], v[16:19], v[36:39], v[160:163]
    ds_read_b64_tr_b16 v[22:23], v8 offset:33792
    v_mfma_f32_16x16x32_bf16 v[168:171], v[4:7], v[40:43], v[168:171]
    ds_read_b64_tr_b16 v[24:25], v8 offset:40960
    v_mfma_f32_16x16x32_bf16 v[168:171], v[16:19], v[44:47], v[168:171]
    ds_read_b64_tr_b16 v[26:27], v8 offset:41984
    v_mfma_f32_16x16x32_bf16 v[176:179], v[4:7], v[48:51], v[176:179]
    v_xor_b32 v8, 224, v8
    v_mfma_f32_16x16x32_bf16 v[176:179], v[16:19], v[52:55], v[176:179]
    v_mfma_f32_16x16x32_bf16 v[184:187], v[4:7], v[56:59], v[184:187]
    v_mfma_f32_16x16x32_bf16 v[184:187], v[16:19], v[60:63], v[184:187]
    s_waitcnt lgkmcnt(2)
    v_mfma_f32_16x16x32_bf16 v[164:167], v[20:23], v[32:35], v[164:167]
    ds_read_b64_tr_b16 v[4:5], v8 offset:32768
    s_waitcnt lgkmcnt(1)
    v_mfma_f32_16x16x32_bf16 v[164:167], v[24:27], v[36:39], v[164:167]
    ds_read_b64_tr_b16 v[6:7], v8 offset:33792
    v_mfma_f32_16x16x32_bf16 v[172:175], v[20:23], v[40:43], v[172:175]
    ds_read_b64_tr_b16 v[16:17], v8 offset:40960
    v_mfma_f32_16x16x32_bf16 v[172:175], v[24:27], v[44:47], v[172:175]
    ds_read_b64_tr_b16 v[18:19], v8 offset:41984
    v_mfma_f32_16x16x32_bf16 v[180:183], v[20:23], v[48:51], v[180:183]
    v_xor_b32 v8, 32, v8
    v_mfma_f32_16x16x32_bf16 v[180:183], v[24:27], v[52:55], v[180:183]
    v_mfma_f32_16x16x32_bf16 v[188:191], v[20:23], v[56:59], v[188:191]
    v_mfma_f32_16x16x32_bf16 v[188:191], v[24:27], v[60:63], v[188:191]
    s_waitcnt lgkmcnt(2)
    v_mfma_f32_16x16x32_bf16 v[192:195], v[4:7], v[32:35], v[192:195]
    ds_read_b64_tr_b16 v[20:21], v8 offset:32768
    s_waitcnt lgkmcnt(1)
    v_mfma_f32_16x16x32_bf16 v[192:195], v[16:19], v[36:39], v[192:195]
    ds_read_b64_tr_b16 v[22:23], v8 offset:33792
    v_mfma_f32_16x16x32_bf16 v[200:203], v[4:7], v[40:43], v[200:203]
    ds_read_b64_tr_b16 v[24:25], v8 offset:40960
    s_add_u32 s51, s49, 16384
    buffer_store_dwordx4 v[88:91], v2, s[20:23], s51 offen offset:0 sc1
    v_mfma_f32_16x16x32_bf16 v[200:203], v[16:19], v[44:47], v[200:203]
    ds_read_b64_tr_b16 v[26:27], v8 offset:41984
    v_mfma_f32_16x16x32_bf16 v[208:211], v[4:7], v[48:51], v[208:211]
    v_xor_b32 v8, 96, v8
    v_mfma_f32_16x16x32_bf16 v[208:211], v[16:19], v[52:55], v[208:211]
    v_mfma_f32_16x16x32_bf16 v[216:219], v[4:7], v[56:59], v[216:219]
    v_mfma_f32_16x16x32_bf16 v[216:219], v[16:19], v[60:63], v[216:219]
    s_waitcnt lgkmcnt(2)
    v_mfma_f32_16x16x32_bf16 v[196:199], v[20:23], v[32:35], v[196:199]
    ds_read_b64_tr_b16 v[4:5], v8 offset:32768
    s_waitcnt lgkmcnt(1)
    v_mfma_f32_16x16x32_bf16 v[196:199], v[24:27], v[36:39], v[196:199]
    ds_read_b64_tr_b16 v[6:7], v8 offset:33792
    v_mfma_f32_16x16x32_bf16 v[204:207], v[20:23], v[40:43], v[204:207]
    ds_read_b64_tr_b16 v[16:17], v8 offset:40960
    v_mfma_f32_16x16x32_bf16 v[204:207], v[24:27], v[44:47], v[204:207]
    ds_read_b64_tr_b16 v[18:19], v8 offset:41984
    v_mfma_f32_16x16x32_bf16 v[212:215], v[20:23], v[48:51], v[212:215]
    v_xor_b32 v8, 32, v8
    v_mfma_f32_16x16x32_bf16 v[212:215], v[24:27], v[52:55], v[212:215]
    v_mfma_f32_16x16x32_bf16 v[220:223], v[20:23], v[56:59], v[220:223]
    v_mfma_f32_16x16x32_bf16 v[220:223], v[24:27], v[60:63], v[220:223]
    s_waitcnt lgkmcnt(2)
    v_mfma_f32_16x16x32_bf16 v[224:227], v[4:7], v[32:35], v[224:227]
    ds_read_b64_tr_b16 v[20:21], v8 offset:32768
    s_waitcnt lgkmcnt(1)
    v_mfma_f32_16x16x32_bf16 v[224:227], v[16:19], v[36:39], v[224:227]
    ds_read_b64_tr_b16 v[22:23], v8 offset:33792
    v_mfma_f32_16x16x32_bf16 v[232:235], v[4:7], v[40:43], v[232:235]
    ds_read_b64_tr_b16 v[24:25], v8 offset:40960
    v_mfma_f32_16x16x32_bf16 v[232:235], v[16:19], v[44:47], v[232:235]
    ds_read_b64_tr_b16 v[26:27], v8 offset:41984
    v_mfma_f32_16x16x32_bf16 v[240:243], v[4:7], v[48:51], v[240:243]
    v_xor_b32 v8, 224, v8
    v_mfma_f32_16x16x32_bf16 v[240:243], v[16:19], v[52:55], v[240:243]
    v_mfma_f32_16x16x32_bf16 v[248:251], v[4:7], v[56:59], v[248:251]
    v_mfma_f32_16x16x32_bf16 v[248:251], v[16:19], v[60:63], v[248:251]
    s_waitcnt lgkmcnt(0)
    s_barrier
    ds_read_b64_tr_b16 v[4:5], v8 offset:0
    ds_read_b64_tr_b16 v[6:7], v8 offset:1024
    v_mfma_f32_16x16x32_bf16 v[228:231], v[20:23], v[32:35], v[228:231]
    ds_read_b64_tr_b16 v[16:17], v8 offset:8192
    ds_read_b64_tr_b16 v[18:19], v8 offset:9216
    s_add_u32 s51, s49, 16384
    buffer_store_dwordx4 v[92:95], v2, s[20:23], s51 offen offset:1024 sc1
    v_xor_b32 v8, 32, v8
    v_mfma_f32_16x16x32_bf16 v[228:231], v[24:27], v[36:39], v[228:231]
    ds_read_b128 v[32:35], v12 offset:32768
    v_mfma_f32_16x16x32_bf16 v[236:239], v[20:23], v[40:43], v[236:239]
    ds_read_b128 v[36:39], v13 offset:32768
    v_mfma_f32_16x16x32_bf16 v[236:239], v[24:27], v[44:47], v[236:239]
    ds_read_b128 v[40:43], v12 offset:34816
    v_mfma_f32_16x16x32_bf16 v[244:247], v[20:23], v[48:51], v[244:247]
    ds_read_b128 v[44:47], v13 offset:34816
    v_mfma_f32_16x16x32_bf16 v[244:247], v[24:27], v[52:55], v[244:247]
    ds_read_b128 v[48:51], v12 offset:49152
    v_mfma_f32_16x16x32_bf16 v[252:255], v[20:23], v[56:59], v[252:255]
    ds_read_b128 v[52:55], v13 offset:49152
    v_mfma_f32_16x16x32_bf16 v[252:255], v[24:27], v[60:63], v[252:255]
    ds_read_b128 v[56:59], v12 offset:51200
    ds_read_b128 v[60:63], v13 offset:51200
    s_waitcnt lgkmcnt(7)
    v_mfma_f32_16x16x32_bf16 v[128:131], v[4:7], v[32:35], v[128:131]
    ds_read_b64_tr_b16 v[20:21], v8 offset:0
    s_waitcnt lgkmcnt(7)
    v_mfma_f32_16x16x32_bf16 v[128:131], v[16:19], v[36:39], v[128:131]
    ds_read_b64_tr_b16 v[22:23], v8 offset:1024
    s_waitcnt lgkmcnt(7)
    v_mfma_f32_16x16x32_bf16 v[136:139], v[4:7], v[40:43], v[136:139]
    ds_read_b64_tr_b16 v[24:25], v8 offset:8192
    s_waitcnt lgkmcnt(7)
    v_mfma_f32_16x16x32_bf16 v[136:139], v[16:19], v[44:47], v[136:139]
    ds_read_b64_tr_b16 v[26:27], v8 offset:9216
    s_waitcnt lgkmcnt(7)
    v_mfma_f32_16x16x32_bf16 v[144:147], v[4:7], v[48:51], v[144:147]
    v_xor_b32 v8, 96, v8
    s_waitcnt lgkmcnt(6)
    v_mfma_f32_16x16x32_bf16 v[144:147], v[16:19], v[52:55], v[144:147]
    s_waitcnt lgkmcnt(5)
    v_mfma_f32_16x16x32_bf16 v[152:155], v[4:7], v[56:59], v[152:155]
    s_waitcnt lgkmcnt(4)
    v_mfma_f32_16x16x32_bf16 v[152:155], v[16:19], v[60:63], v[152:155]
    s_waitcnt lgkmcnt(2)
    v_mfma_f32_16x16x32_bf16 v[132:135], v[20:23], v[32:35], v[132:135]
    ds_read_b64_tr_b16 v[4:5], v8 offset:0
    s_waitcnt lgkmcnt(1)
    v_mfma_f32_16x16x32_bf16 v[132:135], v[24:27], v[36:39], v[132:135]
    ds_read_b64_tr_b16 v[6:7], v8 offset:1024
    v_mfma_f32_16x16x32_bf16 v[140:143], v[20:23], v[40:43], v[140:143]
    ds_read_b64_tr_b16 v[16:17], v8 offset:8192
    v_mfma_f32_16x16x32_bf16 v[140:143], v[24:27], v[44:47], v[140:143]
    ds_read_b64_tr_b16 v[18:19], v8 offset:9216
    v_mfma_f32_16x16x32_bf16 v[148:151], v[20:23], v[48:51], v[148:151]
    v_xor_b32 v8, 32, v8
    v_mfma_f32_16x16x32_bf16 v[148:151], v[24:27], v[52:55], v[148:151]
    s_add_u32 s51, s48, 32768
    buffer_store_dwordx4 v[96:99], v2, s[20:23], s51 offen offset:0 sc1
    v_mfma_f32_16x16x32_bf16 v[156:159], v[20:23], v[56:59], v[156:159]
    v_mfma_f32_16x16x32_bf16 v[156:159], v[24:27], v[60:63], v[156:159]
    s_waitcnt lgkmcnt(2)
    v_mfma_f32_16x16x32_bf16 v[160:163], v[4:7], v[32:35], v[160:163]
    ds_read_b64_tr_b16 v[20:21], v8 offset:0
    s_waitcnt lgkmcnt(1)
    v_mfma_f32_16x16x32_bf16 v[160:163], v[16:19], v[36:39], v[160:163]
    ds_read_b64_tr_b16 v[22:23], v8 offset:1024
    v_mfma_f32_16x16x32_bf16 v[168:171], v[4:7], v[40:43], v[168:171]
    ds_read_b64_tr_b16 v[24:25], v8 offset:8192
    v_mfma_f32_16x16x32_bf16 v[168:171], v[16:19], v[44:47], v[168:171]
    ds_read_b64_tr_b16 v[26:27], v8 offset:9216
    v_mfma_f32_16x16x32_bf16 v[176:179], v[4:7], v[48:51], v[176:179]
    v_xor_b32 v8, 224, v8
    v_mfma_f32_16x16x32_bf16 v[176:179], v[16:19], v[52:55], v[176:179]
    v_mfma_f32_16x16x32_bf16 v[184:187], v[4:7], v[56:59], v[184:187]
    v_mfma_f32_16x16x32_bf16 v[184:187], v[16:19], v[60:63], v[184:187]
    s_waitcnt lgkmcnt(2)
    v_mfma_f32_16x16x32_bf16 v[164:167], v[20:23], v[32:35], v[164:167]
    ds_read_b64_tr_b16 v[4:5], v8 offset:0
    s_waitcnt lgkmcnt(1)
    v_mfma_f32_16x16x32_bf16 v[164:167], v[24:27], v[36:39], v[164:167]
    ds_read_b64_tr_b16 v[6:7], v8 offset:1024
    v_mfma_f32_16x16x32_bf16 v[172:175], v[20:23], v[40:43], v[172:175]
    ds_read_b64_tr_b16 v[16:17], v8 offset:8192
    v_mfma_f32_16x16x32_bf16 v[172:175], v[24:27], v[44:47], v[172:175]
    ds_read_b64_tr_b16 v[18:19], v8 offset:9216
    v_mfma_f32_16x16x32_bf16 v[180:183], v[20:23], v[48:51], v[180:183]
    v_xor_b32 v8, 32, v8
    v_mfma_f32_16x16x32_bf16 v[180:183], v[24:27], v[52:55], v[180:183]
    v_mfma_f32_16x16x32_bf16 v[188:191], v[20:23], v[56:59], v[188:191]
    v_mfma_f32_16x16x32_bf16 v[188:191], v[24:27], v[60:63], v[188:191]
    s_waitcnt lgkmcnt(2)
    v_mfma_f32_16x16x32_bf16 v[192:195], v[4:7], v[32:35], v[192:195]
    ds_read_b64_tr_b16 v[20:21], v8 offset:0
    s_waitcnt lgkmcnt(1)
    v_mfma_f32_16x16x32_bf16 v[192:195], v[16:19], v[36:39], v[192:195]
    ds_read_b64_tr_b16 v[22:23], v8 offset:1024
    v_mfma_f32_16x16x32_bf16 v[200:203], v[4:7], v[40:43], v[200:203]
    ds_read_b64_tr_b16 v[24:25], v8 offset:8192
    s_add_u32 s51, s48, 32768
    buffer_store_dwordx4 v[100:103], v11, s[20:23], s51 offen offset:0 sc1
    v_mfma_f32_16x16x32_bf16 v[200:203], v[16:19], v[44:47], v[200:203]
    ds_read_b64_tr_b16 v[26:27], v8 offset:9216
    v_mfma_f32_16x16x32_bf16 v[208:211], v[4:7], v[48:51], v[208:211]
    v_xor_b32 v8, 96, v8
    v_mfma_f32_16x16x32_bf16 v[208:211], v[16:19], v[52:55], v[208:211]
    v_mfma_f32_16x16x32_bf16 v[216:219], v[4:7], v[56:59], v[216:219]
    v_mfma_f32_16x16x32_bf16 v[216:219], v[16:19], v[60:63], v[216:219]
    s_waitcnt lgkmcnt(2)
    v_mfma_f32_16x16x32_bf16 v[196:199], v[20:23], v[32:35], v[196:199]
    ds_read_b64_tr_b16 v[4:5], v8 offset:0
    s_waitcnt lgkmcnt(1)
    v_mfma_f32_16x16x32_bf16 v[196:199], v[24:27], v[36:39], v[196:199]
    ds_read_b64_tr_b16 v[6:7], v8 offset:1024
    v_mfma_f32_16x16x32_bf16 v[204:207], v[20:23], v[40:43], v[204:207]
    ds_read_b64_tr_b16 v[16:17], v8 offset:8192
    v_mfma_f32_16x16x32_bf16 v[204:207], v[24:27], v[44:47], v[204:207]
    ds_read_b64_tr_b16 v[18:19], v8 offset:9216
    v_mfma_f32_16x16x32_bf16 v[212:215], v[20:23], v[48:51], v[212:215]
    v_xor_b32 v8, 32, v8
    v_mfma_f32_16x16x32_bf16 v[212:215], v[24:27], v[52:55], v[212:215]
    v_mfma_f32_16x16x32_bf16 v[220:223], v[20:23], v[56:59], v[220:223]
    v_mfma_f32_16x16x32_bf16 v[220:223], v[24:27], v[60:63], v[220:223]
    s_waitcnt lgkmcnt(2)
    v_mfma_f32_16x16x32_bf16 v[224:227], v[4:7], v[32:35], v[224:227]
    ds_read_b64_tr_b16 v[20:21], v8 offset:0
    s_waitcnt lgkmcnt(1)
    v_mfma_f32_16x16x32_bf16 v[224:227], v[16:19], v[36:39], v[224:227]
    ds_read_b64_tr_b16 v[22:23], v8 offset:1024
    v_mfma_f32_16x16x32_bf16 v[232:235], v[4:7], v[40:43], v[232:235]
    ds_read_b64_tr_b16 v[24:25], v8 offset:8192
    v_mfma_f32_16x16x32_bf16 v[232:235], v[16:19], v[44:47], v[232:235]
    ds_read_b64_tr_b16 v[26:27], v8 offset:9216
    v_mfma_f32_16x16x32_bf16 v[240:243], v[4:7], v[48:51], v[240:243]
    v_xor_b32 v8, 224, v8
    v_mfma_f32_16x16x32_bf16 v[240:243], v[16:19], v[52:55], v[240:243]
    v_mfma_f32_16x16x32_bf16 v[248:251], v[4:7], v[56:59], v[248:251]
    v_mfma_f32_16x16x32_bf16 v[248:251], v[16:19], v[60:63], v[248:251]
    s_waitcnt lgkmcnt(0)
    s_barrier
    ds_read_b64_tr_b16 v[4:5], v8 offset:32768
    ds_read_b64_tr_b16 v[6:7], v8 offset:33792
    v_mfma_f32_16x16x32_bf16 v[228:231], v[20:23], v[32:35], v[228:231]
    ds_read_b64_tr_b16 v[16:17], v8 offset:40960
    ds_read_b64_tr_b16 v[18:19], v8 offset:41984
    s_add_u32 s51, s49, 32768
    buffer_store_dwordx4 v[104:107], v2, s[20:23], s51 offen offset:0 sc1
    v_xor_b32 v8, 32, v8
    v_mfma_f32_16x16x32_bf16 v[228:231], v[24:27], v[36:39], v[228:231]
    ds_read_b128 v[32:35], v14 offset:0
    v_mfma_f32_16x16x32_bf16 v[236:239], v[20:23], v[40:43], v[236:239]
    ds_read_b128 v[36:39], v15 offset:0
    v_mfma_f32_16x16x32_bf16 v[236:239], v[24:27], v[44:47], v[236:239]
    ds_read_b128 v[40:43], v14 offset:2048
    v_mfma_f32_16x16x32_bf16 v[244:247], v[20:23], v[48:51], v[244:247]
    ds_read_b128 v[44:47], v15 offset:2048
    v_mfma_f32_16x16x32_bf16 v[244:247], v[24:27], v[52:55], v[244:247]
    ds_read_b128 v[48:51], v14 offset:16384
    v_mfma_f32_16x16x32_bf16 v[252:255], v[20:23], v[56:59], v[252:255]
    ds_read_b128 v[52:55], v15 offset:16384
    v_mfma_f32_16x16x32_bf16 v[252:255], v[24:27], v[60:63], v[252:255]
    ds_read_b128 v[56:59], v14 offset:18432
    ds_read_b128 v[60:63], v15 offset:18432
    s_waitcnt lgkmcnt(7)
    v_mfma_f32_16x16x32_bf16 v[128:131], v[4:7], v[32:35], v[128:131]
    ds_read_b64_tr_b16 v[20:21], v8 offset:32768
    s_waitcnt lgkmcnt(7)
    v_mfma_f32_16x16x32_bf16 v[128:131], v[16:19], v[36:39], v[128:131]
    ds_read_b64_tr_b16 v[22:23], v8 offset:33792
    s_waitcnt lgkmcnt(7)
    v_mfma_f32_16x16x32_bf16 v[136:139], v[4:7], v[40:43], v[136:139]
    ds_read_b64_tr_b16 v[24:25], v8 offset:40960
    s_waitcnt lgkmcnt(7)
    v_mfma_f32_16x16x32_bf16 v[136:139], v[16:19], v[44:47], v[136:139]
    ds_read_b64_tr_b16 v[26:27], v8 offset:41984
    s_waitcnt lgkmcnt(7)
    v_mfma_f32_16x16x32_bf16 v[144:147], v[4:7], v[48:51], v[144:147]
    v_xor_b32 v8, 96, v8
    s_waitcnt lgkmcnt(6)
    v_mfma_f32_16x16x32_bf16 v[144:147], v[16:19], v[52:55], v[144:147]
    s_waitcnt lgkmcnt(5)
    v_mfma_f32_16x16x32_bf16 v[152:155], v[4:7], v[56:59], v[152:155]
    s_waitcnt lgkmcnt(4)
    v_mfma_f32_16x16x32_bf16 v[152:155], v[16:19], v[60:63], v[152:155]
    s_waitcnt lgkmcnt(2)
    v_mfma_f32_16x16x32_bf16 v[132:135], v[20:23], v[32:35], v[132:135]
    ds_read_b64_tr_b16 v[4:5], v8 offset:32768
    s_waitcnt lgkmcnt(1)
    v_mfma_f32_16x16x32_bf16 v[132:135], v[24:27], v[36:39], v[132:135]
    ds_read_b64_tr_b16 v[6:7], v8 offset:33792
    v_mfma_f32_16x16x32_bf16 v[140:143], v[20:23], v[40:43], v[140:143]
    ds_read_b64_tr_b16 v[16:17], v8 offset:40960
    v_mfma_f32_16x16x32_bf16 v[140:143], v[24:27], v[44:47], v[140:143]
    ds_read_b64_tr_b16 v[18:19], v8 offset:41984
    v_mfma_f32_16x16x32_bf16 v[148:151], v[20:23], v[48:51], v[148:151]
    v_xor_b32 v8, 32, v8
    v_mfma_f32_16x16x32_bf16 v[148:151], v[24:27], v[52:55], v[148:151]
    s_add_u32 s51, s49, 32768
    buffer_store_dwordx4 v[108:111], v2, s[20:23], s51 offen offset:1024 sc1
    v_mfma_f32_16x16x32_bf16 v[156:159], v[20:23], v[56:59], v[156:159]
    v_mfma_f32_16x16x32_bf16 v[156:159], v[24:27], v[60:63], v[156:159]
    s_waitcnt lgkmcnt(2)
    v_mfma_f32_16x16x32_bf16 v[160:163], v[4:7], v[32:35], v[160:163]
    ds_read_b64_tr_b16 v[20:21], v8 offset:32768
    s_waitcnt lgkmcnt(1)
    v_mfma_f32_16x16x32_bf16 v[160:163], v[16:19], v[36:39], v[160:163]
    ds_read_b64_tr_b16 v[22:23], v8 offset:33792
    v_mfma_f32_16x16x32_bf16 v[168:171], v[4:7], v[40:43], v[168:171]
    ds_read_b64_tr_b16 v[24:25], v8 offset:40960
    v_mfma_f32_16x16x32_bf16 v[168:171], v[16:19], v[44:47], v[168:171]
    ds_read_b64_tr_b16 v[26:27], v8 offset:41984
    v_mfma_f32_16x16x32_bf16 v[176:179], v[4:7], v[48:51], v[176:179]
    v_xor_b32 v8, 224, v8
    v_mfma_f32_16x16x32_bf16 v[176:179], v[16:19], v[52:55], v[176:179]
    v_mfma_f32_16x16x32_bf16 v[184:187], v[4:7], v[56:59], v[184:187]
    v_mfma_f32_16x16x32_bf16 v[184:187], v[16:19], v[60:63], v[184:187]
    s_waitcnt lgkmcnt(2)
    v_mfma_f32_16x16x32_bf16 v[164:167], v[20:23], v[32:35], v[164:167]
    ds_read_b64_tr_b16 v[4:5], v8 offset:32768
    s_waitcnt lgkmcnt(1)
    v_mfma_f32_16x16x32_bf16 v[164:167], v[24:27], v[36:39], v[164:167]
    ds_read_b64_tr_b16 v[6:7], v8 offset:33792
    v_mfma_f32_16x16x32_bf16 v[172:175], v[20:23], v[40:43], v[172:175]
    ds_read_b64_tr_b16 v[16:17], v8 offset:40960
    v_mfma_f32_16x16x32_bf16 v[172:175], v[24:27], v[44:47], v[172:175]
    ds_read_b64_tr_b16 v[18:19], v8 offset:41984
    v_mfma_f32_16x16x32_bf16 v[180:183], v[20:23], v[48:51], v[180:183]
    v_xor_b32 v8, 32, v8
    v_mfma_f32_16x16x32_bf16 v[180:183], v[24:27], v[52:55], v[180:183]
    v_mfma_f32_16x16x32_bf16 v[188:191], v[20:23], v[56:59], v[188:191]
    v_mfma_f32_16x16x32_bf16 v[188:191], v[24:27], v[60:63], v[188:191]
    s_waitcnt lgkmcnt(2)
    v_mfma_f32_16x16x32_bf16 v[192:195], v[4:7], v[32:35], v[192:195]
    ds_read_b64_tr_b16 v[20:21], v8 offset:32768
    s_waitcnt lgkmcnt(1)
    v_mfma_f32_16x16x32_bf16 v[192:195], v[16:19], v[36:39], v[192:195]
    ds_read_b64_tr_b16 v[22:23], v8 offset:33792
    v_mfma_f32_16x16x32_bf16 v[200:203], v[4:7], v[40:43], v[200:203]
    ds_read_b64_tr_b16 v[24:25], v8 offset:40960
    s_add_u32 s51, s48, 49152
    buffer_store_dwordx4 v[112:115], v2, s[20:23], s51 offen offset:0 sc1
    v_mfma_f32_16x16x32_bf16 v[200:203], v[16:19], v[44:47], v[200:203]
    ds_read_b64_tr_b16 v[26:27], v8 offset:41984
    v_mfma_f32_16x16x32_bf16 v[208:211], v[4:7], v[48:51], v[208:211]
    v_xor_b32 v8, 96, v8
    v_mfma_f32_16x16x32_bf16 v[208:211], v[16:19], v[52:55], v[208:211]
    v_mfma_f32_16x16x32_bf16 v[216:219], v[4:7], v[56:59], v[216:219]
    v_mfma_f32_16x16x32_bf16 v[216:219], v[16:19], v[60:63], v[216:219]
    s_waitcnt lgkmcnt(2)
    v_mfma_f32_16x16x32_bf16 v[196:199], v[20:23], v[32:35], v[196:199]
    ds_read_b64_tr_b16 v[4:5], v8 offset:32768
    s_waitcnt lgkmcnt(1)
    v_mfma_f32_16x16x32_bf16 v[196:199], v[24:27], v[36:39], v[196:199]
    ds_read_b64_tr_b16 v[6:7], v8 offset:33792
    v_mfma_f32_16x16x32_bf16 v[204:207], v[20:23], v[40:43], v[204:207]
    ds_read_b64_tr_b16 v[16:17], v8 offset:40960
    v_mfma_f32_16x16x32_bf16 v[204:207], v[24:27], v[44:47], v[204:207]
    ds_read_b64_tr_b16 v[18:19], v8 offset:41984
    v_mfma_f32_16x16x32_bf16 v[212:215], v[20:23], v[48:51], v[212:215]
    v_xor_b32 v8, 32, v8
    v_mfma_f32_16x16x32_bf16 v[212:215], v[24:27], v[52:55], v[212:215]
    v_mfma_f32_16x16x32_bf16 v[220:223], v[20:23], v[56:59], v[220:223]
    v_mfma_f32_16x16x32_bf16 v[220:223], v[24:27], v[60:63], v[220:223]
    s_waitcnt lgkmcnt(2)
    v_mfma_f32_16x16x32_bf16 v[224:227], v[4:7], v[32:35], v[224:227]
    ds_read_b64_tr_b16 v[20:21], v8 offset:32768
    s_waitcnt lgkmcnt(1)
    v_mfma_f32_16x16x32_bf16 v[224:227], v[16:19], v[36:39], v[224:227]
    ds_read_b64_tr_b16 v[22:23], v8 offset:33792
    v_mfma_f32_16x16x32_bf16 v[232:235], v[4:7], v[40:43], v[232:235]
    ds_read_b64_tr_b16 v[24:25], v8 offset:40960
    v_mfma_f32_16x16x32_bf16 v[232:235], v[16:19], v[44:47], v[232:235]
    ds_read_b64_tr_b16 v[26:27], v8 offset:41984
    v_mfma_f32_16x16x32_bf16 v[240:243], v[4:7], v[48:51], v[240:243]
    v_xor_b32 v8, 224, v8
    v_mfma_f32_16x16x32_bf16 v[240:243], v[16:19], v[52:55], v[240:243]
    v_mfma_f32_16x16x32_bf16 v[248:251], v[4:7], v[56:59], v[248:251]
    v_mfma_f32_16x16x32_bf16 v[248:251], v[16:19], v[60:63], v[248:251]
    s_waitcnt lgkmcnt(0)
    s_barrier
    ds_read_b64_tr_b16 v[4:5], v8 offset:0
    ds_read_b64_tr_b16 v[6:7], v8 offset:1024
    v_mfma_f32_16x16x32_bf16 v[228:231], v[20:23], v[32:35], v[228:231]
    ds_read_b64_tr_b16 v[16:17], v8 offset:8192
    ds_read_b64_tr_b16 v[18:19], v8 offset:9216
    s_add_u32 s51, s48, 49152
    buffer_store_dwordx4 v[116:119], v11, s[20:23], s51 offen offset:0 sc1
    v_xor_b32 v8, 32, v8
    v_mfma_f32_16x16x32_bf16 v[228:231], v[24:27], v[36:39], v[228:231]
    ds_read_b128 v[32:35], v12 offset:0
    v_mfma_f32_16x16x32_bf16 v[236:239], v[20:23], v[40:43], v[236:239]
    ds_read_b128 v[36:39], v13 offset:0
    v_mfma_f32_16x16x32_bf16 v[236:239], v[24:27], v[44:47], v[236:239]
    ds_read_b128 v[40:43], v12 offset:2048
    v_mfma_f32_16x16x32_bf16 v[244:247], v[20:23], v[48:51], v[244:247]
    ds_read_b128 v[44:47], v13 offset:2048
    v_mfma_f32_16x16x32_bf16 v[244:247], v[24:27], v[52:55], v[244:247]
    ds_read_b128 v[48:51], v12 offset:16384
    v_mfma_f32_16x16x32_bf16 v[252:255], v[20:23], v[56:59], v[252:255]
    ds_read_b128 v[52:55], v13 offset:16384
    v_mfma_f32_16x16x32_bf16 v[252:255], v[24:27], v[60:63], v[252:255]
    ds_read_b128 v[56:59], v12 offset:18432
    ds_read_b128 v[60:63], v13 offset:18432
    s_waitcnt lgkmcnt(7)
    v_mfma_f32_16x16x32_bf16 v[128:131], v[4:7], v[32:35], v[128:131]
    ds_read_b64_tr_b16 v[20:21], v8 offset:0
    s_waitcnt lgkmcnt(7)
    v_mfma_f32_16x16x32_bf16 v[128:131], v[16:19], v[36:39], v[128:131]
    ds_read_b64_tr_b16 v[22:23], v8 offset:1024
    s_waitcnt lgkmcnt(7)
    v_mfma_f32_16x16x32_bf16 v[136:139], v[4:7], v[40:43], v[136:139]
    ds_read_b64_tr_b16 v[24:25], v8 offset:8192
    s_waitcnt lgkmcnt(7)
    v_mfma_f32_16x16x32_bf16 v[136:139], v[16:19], v[44:47], v[136:139]
    ds_read_b64_tr_b16 v[26:27], v8 offset:9216
    s_waitcnt lgkmcnt(7)
    v_mfma_f32_16x16x32_bf16 v[144:147], v[4:7], v[48:51], v[144:147]
    v_xor_b32 v8, 96, v8
    s_waitcnt lgkmcnt(6)
    v_mfma_f32_16x16x32_bf16 v[144:147], v[16:19], v[52:55], v[144:147]
    s_waitcnt lgkmcnt(5)
    v_mfma_f32_16x16x32_bf16 v[152:155], v[4:7], v[56:59], v[152:155]
    s_waitcnt lgkmcnt(4)
    v_mfma_f32_16x16x32_bf16 v[152:155], v[16:19], v[60:63], v[152:155]
    s_waitcnt lgkmcnt(2)
    v_mfma_f32_16x16x32_bf16 v[132:135], v[20:23], v[32:35], v[132:135]
    ds_read_b64_tr_b16 v[4:5], v8 offset:0
    s_waitcnt lgkmcnt(1)
    v_mfma_f32_16x16x32_bf16 v[132:135], v[24:27], v[36:39], v[132:135]
    ds_read_b64_tr_b16 v[6:7], v8 offset:1024
    v_mfma_f32_16x16x32_bf16 v[140:143], v[20:23], v[40:43], v[140:143]
    ds_read_b64_tr_b16 v[16:17], v8 offset:8192
    v_mfma_f32_16x16x32_bf16 v[140:143], v[24:27], v[44:47], v[140:143]
    ds_read_b64_tr_b16 v[18:19], v8 offset:9216
    v_mfma_f32_16x16x32_bf16 v[148:151], v[20:23], v[48:51], v[148:151]
    v_xor_b32 v8, 32, v8
    v_mfma_f32_16x16x32_bf16 v[148:151], v[24:27], v[52:55], v[148:151]
    s_add_u32 s51, s49, 49152
    buffer_store_dwordx4 v[120:123], v2, s[20:23], s51 offen offset:0 sc1
    v_mfma_f32_16x16x32_bf16 v[156:159], v[20:23], v[56:59], v[156:159]
    v_mfma_f32_16x16x32_bf16 v[156:159], v[24:27], v[60:63], v[156:159]
    s_waitcnt lgkmcnt(2)
    v_mfma_f32_16x16x32_bf16 v[160:163], v[4:7], v[32:35], v[160:163]
    ds_read_b64_tr_b16 v[20:21], v8 offset:0
    s_waitcnt lgkmcnt(1)
    v_mfma_f32_16x16x32_bf16 v[160:163], v[16:19], v[36:39], v[160:163]
    ds_read_b64_tr_b16 v[22:23], v8 offset:1024
    v_mfma_f32_16x16x32_bf16 v[168:171], v[4:7], v[40:43], v[168:171]
    ds_read_b64_tr_b16 v[24:25], v8 offset:8192
    v_mfma_f32_16x16x32_bf16 v[168:171], v[16:19], v[44:47], v[168:171]
    ds_read_b64_tr_b16 v[26:27], v8 offset:9216
    v_mfma_f32_16x16x32_bf16 v[176:179], v[4:7], v[48:51], v[176:179]
    v_xor_b32 v8, 224, v8
    v_mfma_f32_16x16x32_bf16 v[176:179], v[16:19], v[52:55], v[176:179]
    v_mfma_f32_16x16x32_bf16 v[184:187], v[4:7], v[56:59], v[184:187]
    v_mfma_f32_16x16x32_bf16 v[184:187], v[16:19], v[60:63], v[184:187]
    s_waitcnt lgkmcnt(2)
    v_mfma_f32_16x16x32_bf16 v[164:167], v[20:23], v[32:35], v[164:167]
    ds_read_b64_tr_b16 v[4:5], v8 offset:0
    s_waitcnt lgkmcnt(1)
    v_mfma_f32_16x16x32_bf16 v[164:167], v[24:27], v[36:39], v[164:167]
    ds_read_b64_tr_b16 v[6:7], v8 offset:1024
    v_mfma_f32_16x16x32_bf16 v[172:175], v[20:23], v[40:43], v[172:175]
    ds_read_b64_tr_b16 v[16:17], v8 offset:8192
    v_mfma_f32_16x16x32_bf16 v[172:175], v[24:27], v[44:47], v[172:175]
    ds_read_b64_tr_b16 v[18:19], v8 offset:9216
    v_mfma_f32_16x16x32_bf16 v[180:183], v[20:23], v[48:51], v[180:183]
    v_xor_b32 v8, 32, v8
    v_mfma_f32_16x16x32_bf16 v[180:183], v[24:27], v[52:55], v[180:183]
    v_mfma_f32_16x16x32_bf16 v[188:191], v[20:23], v[56:59], v[188:191]
    v_mfma_f32_16x16x32_bf16 v[188:191], v[24:27], v[60:63], v[188:191]
    s_waitcnt lgkmcnt(2)
    v_mfma_f32_16x16x32_bf16 v[192:195], v[4:7], v[32:35], v[192:195]
    ds_read_b64_tr_b16 v[20:21], v8 offset:0
    s_waitcnt lgkmcnt(1)
    v_mfma_f32_16x16x32_bf16 v[192:195], v[16:19], v[36:39], v[192:195]
    ds_read_b64_tr_b16 v[22:23], v8 offset:1024
    v_mfma_f32_16x16x32_bf16 v[200:203], v[4:7], v[40:43], v[200:203]
    ds_read_b64_tr_b16 v[24:25], v8 offset:8192
    s_add_u32 s51, s49, 49152
    buffer_store_dwordx4 v[124:127], v2, s[20:23], s51 offen offset:1024 sc1
    v_mfma_f32_16x16x32_bf16 v[200:203], v[16:19], v[44:47], v[200:203]
    ds_read_b64_tr_b16 v[26:27], v8 offset:9216
    v_mfma_f32_16x16x32_bf16 v[208:211], v[4:7], v[48:51], v[208:211]
    v_xor_b32 v8, 96, v8
    v_mfma_f32_16x16x32_bf16 v[208:211], v[16:19], v[52:55], v[208:211]
    v_mfma_f32_16x16x32_bf16 v[216:219], v[4:7], v[56:59], v[216:219]
    v_mfma_f32_16x16x32_bf16 v[216:219], v[16:19], v[60:63], v[216:219]
    s_waitcnt lgkmcnt(2)
    v_mfma_f32_16x16x32_bf16 v[196:199], v[20:23], v[32:35], v[196:199]
    ds_read_b64_tr_b16 v[4:5], v8 offset:0
    s_waitcnt lgkmcnt(1)
    v_mfma_f32_16x16x32_bf16 v[196:199], v[24:27], v[36:39], v[196:199]
    ds_read_b64_tr_b16 v[6:7], v8 offset:1024
    v_mfma_f32_16x16x32_bf16 v[204:207], v[20:23], v[40:43], v[204:207]
    ds_read_b64_tr_b16 v[16:17], v8 offset:8192
    v_mfma_f32_16x16x32_bf16 v[204:207], v[24:27], v[44:47], v[204:207]
    ds_read_b64_tr_b16 v[18:19], v8 offset:9216
    v_mfma_f32_16x16x32_bf16 v[212:215], v[20:23], v[48:51], v[212:215]
    v_xor_b32 v8, 32, v8
    v_mfma_f32_16x16x32_bf16 v[212:215], v[24:27], v[52:55], v[212:215]
    v_mfma_f32_16x16x32_bf16 v[220:223], v[20:23], v[56:59], v[220:223]
    v_mfma_f32_16x16x32_bf16 v[220:223], v[24:27], v[60:63], v[220:223]
    s_waitcnt lgkmcnt(2)
    v_mfma_f32_16x16x32_bf16 v[224:227], v[4:7], v[32:35], v[224:227]
    ds_read_b64_tr_b16 v[20:21], v8 offset:0
    s_waitcnt lgkmcnt(1)
    v_mfma_f32_16x16x32_bf16 v[224:227], v[16:19], v[36:39], v[224:227]
    ds_read_b64_tr_b16 v[22:23], v8 offset:1024
    v_mfma_f32_16x16x32_bf16 v[232:235], v[4:7], v[40:43], v[232:235]
    ds_read_b64_tr_b16 v[24:25], v8 offset:8192
    v_mfma_f32_16x16x32_bf16 v[232:235], v[16:19], v[44:47], v[232:235]
    ds_read_b64_tr_b16 v[26:27], v8 offset:9216
    v_mfma_f32_16x16x32_bf16 v[240:243], v[4:7], v[48:51], v[240:243]
    v_xor_b32 v8, 224, v8
    v_mfma_f32_16x16x32_bf16 v[240:243], v[16:19], v[52:55], v[240:243]
    v_mfma_f32_16x16x32_bf16 v[248:251], v[4:7], v[56:59], v[248:251]
    v_mfma_f32_16x16x32_bf16 v[248:251], v[16:19], v[60:63], v[248:251]
    s_waitcnt lgkmcnt(0)
    s_barrier
    ds_read_b64_tr_b16 v[4:5], v8 offset:32768
    ds_read_b64_tr_b16 v[6:7], v8 offset:33792
    v_mfma_f32_16x16x32_bf16 v[228:231], v[20:23], v[32:35], v[228:231]
    ds_read_b64_tr_b16 v[16:17], v8 offset:40960
    ds_read_b64_tr_b16 v[18:19], v8 offset:41984
    s_cmp_lg_u32 s43, 0
    s_cbranch_scc1 LA_ct1
    s_lshr_b32 s52, s2, 3
    s_mul_i32 s52, s52, 512
    s_add_u32 s52, s52, LA_qepi-L12_pc
    v_min_u32 v29, 3, v1
    v_lshlrev_b32 v29, 7, v29
    v_add_u32 v29, s52, v29
    v_min_u32 v29, L12_end-L12_pc, v29
    global_load_dword v31, v29, s[100:101]
    s_lshr_b32 s52, s2, 3
    s_mul_i32 s52, s52, 512
    s_add_u32 s52, s52, LB_epi-L12_pc
    v_min_u32 v29, 3, v1
    v_lshlrev_b32 v29, 7, v29
    v_add_u32 v29, s52, v29
    v_min_u32 v29, L12_end-L12_pc, v29
    global_load_dword v31, v29, s[100:101]
LA_ct1:
    v_xor_b32 v8, 32, v8
    v_mfma_f32_16x16x32_bf16 v[228:231], v[24:27], v[36:39], v[228:231]
    ds_read_b128 v[32:35], v12 offset:32768
    v_mfma_f32_16x16x32_bf16 v[236:239], v[20:23], v[40:43], v[236:239]
    ds_read_b128 v[36:39], v13 offset:32768
    v_mfma_f32_16x16x32_bf16 v[236:239], v[24:27], v[44:47], v[236:239]
    ds_read_b128 v[40:43], v12 offset:34816
    v_mfma_f32_16x16x32_bf16 v[244:247], v[20:23], v[48:51], v[244:247]
    ds_read_b128 v[44:47], v13 offset:34816
    v_mfma_f32_16x16x32_bf16 v[244:247], v[24:27], v[52:55], v[244:247]
    ds_read_b128 v[48:51], v12 offset:49152
    v_mfma_f32_16x16x32_bf16 v[252:255], v[20:23], v[56:59], v[252:255]
    ds_read_b128 v[52:55], v13 offset:49152
    v_mfma_f32_16x16x32_bf16 v[252:255], v[24:27], v[60:63], v[252:255]
    ds_read_b128 v[56:59], v12 offset:51200
    ds_read_b128 v[60:63], v13 offset:51200
    s_waitcnt lgkmcnt(7)
    v_mfma_f32_16x16x32_bf16 v[128:131], v[4:7], v[32:35], v[128:131]
    ds_read_b64_tr_b16 v[20:21], v8 offset:32768
    s_waitcnt lgkmcnt(7)
    v_mfma_f32_16x16x32_bf16 v[128:131], v[16:19], v[36:39], v[128:131]
    ds_read_b64_tr_b16 v[22:23], v8 offset:33792
    s_waitcnt lgkmcnt(7)
    v_mfma_f32_16x16x32_bf16 v[136:139], v[4:7], v[40:43], v[136:139]
    ds_read_b64_tr_b16 v[24:25], v8 offset:40960
    s_waitcnt lgkmcnt(7)
    v_mfma_f32_16x16x32_bf16 v[136:139], v[16:19], v[44:47], v[136:139]
    ds_read_b64_tr_b16 v[26:27], v8 offset:41984
    s_waitcnt lgkmcnt(7)
    v_mfma_f32_16x16x32_bf16 v[144:147], v[4:7], v[48:51], v[144:147]
    v_xor_b32 v8, 96, v8
    s_waitcnt lgkmcnt(6)
    v_mfma_f32_16x16x32_bf16 v[144:147], v[16:19], v[52:55], v[144:147]
    s_waitcnt lgkmcnt(5)
    v_mfma_f32_16x16x32_bf16 v[152:155], v[4:7], v[56:59], v[152:155]
    s_waitcnt lgkmcnt(4)
    v_mfma_f32_16x16x32_bf16 v[152:155], v[16:19], v[60:63], v[152:155]
    s_waitcnt lgkmcnt(2)
    v_mfma_f32_16x16x32_bf16 v[132:135], v[20:23], v[32:35], v[132:135]
    ds_read_b64_tr_b16 v[4:5], v8 offset:32768
    s_waitcnt lgkmcnt(1)
    v_mfma_f32_16x16x32_bf16 v[132:135], v[24:27], v[36:39], v[132:135]
    ds_read_b64_tr_b16 v[6:7], v8 offset:33792
    v_mfma_f32_16x16x32_bf16 v[140:143], v[20:23], v[40:43], v[140:143]
    ds_read_b64_tr_b16 v[16:17], v8 offset:40960
    v_mfma_f32_16x16x32_bf16 v[140:143], v[24:27], v[44:47], v[140:143]
    ds_read_b64_tr_b16 v[18:19], v8 offset:41984
    v_mfma_f32_16x16x32_bf16 v[148:151], v[20:23], v[48:51], v[148:151]
    v_xor_b32 v8, 32, v8
    v_mfma_f32_16x16x32_bf16 v[148:151], v[24:27], v[52:55], v[148:151]
    v_mfma_f32_16x16x32_bf16 v[156:159], v[20:23], v[56:59], v[156:159]
    v_mfma_f32_16x16x32_bf16 v[156:159], v[24:27], v[60:63], v[156:159]
    s_waitcnt lgkmcnt(2)
    v_mfma_f32_16x16x32_bf16 v[160:163], v[4:7], v[32:35], v[160:163]
    ds_read_b64_tr_b16 v[20:21], v8 offset:32768
    s_waitcnt lgkmcnt(1)
    v_mfma_f32_16x16x32_bf16 v[160:163], v[16:19], v[36:39], v[160:163]
    ds_read_b64_tr_b16 v[22:23], v8 offset:33792
    v_mfma_f32_16x16x32_bf16 v[168:171], v[4:7], v[40:43], v[168:171]
    ds_read_b64_tr_b16 v[24:25], v8 offset:40960
    v_mfma_f32_16x16x32_bf16 v[168:171], v[16:19], v[44:47], v[168:171]
    ds_read_b64_tr_b16 v[26:27], v8 offset:41984
    v_mfma_f32_16x16x32_bf16 v[176:179], v[4:7], v[48:51], v[176:179]
    v_xor_b32 v8, 224, v8
    v_mfma_f32_16x16x32_bf16 v[176:179], v[16:19], v[52:55], v[176:179]
    v_mfma_f32_16x16x32_bf16 v[184:187], v[4:7], v[56:59], v[184:187]
    v_mfma_f32_16x16x32_bf16 v[184:187], v[16:19], v[60:63], v[184:187]
    s_waitcnt lgkmcnt(2)
    v_mfma_f32_16x16x32_bf16 v[164:167], v[20:23], v[32:35], v[164:167]
    ds_read_b64_tr_b16 v[4:5], v8 offset:32768
    s_lshl_b32 s52, s43, 8
    s_add_u32 s52, s52, 155648
    v_lshlrev_b32 v28, 2, v1
    v_add_u32 v28, s52, v28
    v_mov_b32 v29, 0
    ds_write_b32 v28, v29
    v_lshlrev_b32 v30, 2, v1
    v_add_u32 v30, 157696, v30
    v_mov_b32 v29, 13
    ds_write_b32 v30, v29
    s_waitcnt lgkmcnt(3)
    v_mfma_f32_16x16x32_bf16 v[164:167], v[24:27], v[36:39], v[164:167]
    ds_read_b64_tr_b16 v[6:7], v8 offset:33792
    v_mfma_f32_16x16x32_bf16 v[172:175], v[20:23], v[40:43], v[172:175]
    ds_read_b64_tr_b16 v[16:17], v8 offset:40960
    v_mfma_f32_16x16x32_bf16 v[172:175], v[24:27], v[44:47], v[172:175]
    ds_read_b64_tr_b16 v[18:19], v8 offset:41984
    v_mfma_f32_16x16x32_bf16 v[180:183], v[20:23], v[48:51], v[180:183]
    v_xor_b32 v8, 32, v8
    v_mfma_f32_16x16x32_bf16 v[180:183], v[24:27], v[52:55], v[180:183]
    v_mfma_f32_16x16x32_bf16 v[188:191], v[20:23], v[56:59], v[188:191]
    v_mfma_f32_16x16x32_bf16 v[188:191], v[24:27], v[60:63], v[188:191]
    s_waitcnt lgkmcnt(2)
    v_mfma_f32_16x16x32_bf16 v[192:195], v[4:7], v[32:35], v[192:195]
    ds_read_b64_tr_b16 v[20:21], v8 offset:32768
    s_waitcnt lgkmcnt(1)
    v_mfma_f32_16x16x32_bf16 v[192:195], v[16:19], v[36:39], v[192:195]
    ds_read_b64_tr_b16 v[22:23], v8 offset:33792
    v_mfma_f32_16x16x32_bf16 v[200:203], v[4:7], v[40:43], v[200:203]
    ds_read_b64_tr_b16 v[24:25], v8 offset:40960
    v_mfma_f32_16x16x32_bf16 v[200:203], v[16:19], v[44:47], v[200:203]
    ds_read_b64_tr_b16 v[26:27], v8 offset:41984
    v_mfma_f32_16x16x32_bf16 v[208:211], v[4:7], v[48:51], v[208:211]
    v_xor_b32 v8, 96, v8
    v_mfma_f32_16x16x32_bf16 v[208:211], v[16:19], v[52:55], v[208:211]
    v_mfma_f32_16x16x32_bf16 v[216:219], v[4:7], v[56:59], v[216:219]
    v_mfma_f32_16x16x32_bf16 v[216:219], v[16:19], v[60:63], v[216:219]
    s_waitcnt lgkmcnt(2)
    v_mfma_f32_16x16x32_bf16 v[196:199], v[20:23], v[32:35], v[196:199]
    ds_read_b64_tr_b16 v[4:5], v8 offset:32768
    s_waitcnt lgkmcnt(1)
    v_mfma_f32_16x16x32_bf16 v[196:199], v[24:27], v[36:39], v[196:199]
    ds_read_b64_tr_b16 v[6:7], v8 offset:33792
    v_mfma_f32_16x16x32_bf16 v[204:207], v[20:23], v[40:43], v[204:207]
    ds_read_b64_tr_b16 v[16:17], v8 offset:40960
    v_mfma_f32_16x16x32_bf16 v[204:207], v[24:27], v[44:47], v[204:207]
    ds_read_b64_tr_b16 v[18:19], v8 offset:41984
    v_mfma_f32_16x16x32_bf16 v[212:215], v[20:23], v[48:51], v[212:215]
    v_xor_b32 v8, 32, v8
    v_mfma_f32_16x16x32_bf16 v[212:215], v[24:27], v[52:55], v[212:215]
    v_mfma_f32_16x16x32_bf16 v[220:223], v[20:23], v[56:59], v[220:223]
    v_mfma_f32_16x16x32_bf16 v[220:223], v[24:27], v[60:63], v[220:223]
    s_waitcnt lgkmcnt(2)
    v_mfma_f32_16x16x32_bf16 v[224:227], v[4:7], v[32:35], v[224:227]
    ds_read_b64_tr_b16 v[20:21], v8 offset:32768
    s_waitcnt lgkmcnt(1)
    v_mfma_f32_16x16x32_bf16 v[224:227], v[16:19], v[36:39], v[224:227]
    ds_read_b64_tr_b16 v[22:23], v8 offset:33792
    v_mfma_f32_16x16x32_bf16 v[232:235], v[4:7], v[40:43], v[232:235]
    ds_read_b64_tr_b16 v[24:25], v8 offset:40960
    v_mfma_f32_16x16x32_bf16 v[232:235], v[16:19], v[44:47], v[232:235]
    ds_read_b64_tr_b16 v[26:27], v8 offset:41984
    v_mfma_f32_16x16x32_bf16 v[240:243], v[4:7], v[48:51], v[240:243]
    v_xor_b32 v8, 224, v8
    v_mfma_f32_16x16x32_bf16 v[240:243], v[16:19], v[52:55], v[240:243]
    v_mfma_f32_16x16x32_bf16 v[248:251], v[4:7], v[56:59], v[248:251]
    v_mfma_f32_16x16x32_bf16 v[248:251], v[16:19], v[60:63], v[248:251]
    s_waitcnt vmcnt(0) lgkmcnt(0)
    s_barrier
    ds_read_b64_tr_b16 v[4:5], v8 offset:0
    ds_read_b64_tr_b16 v[6:7], v8 offset:1024
    v_mfma_f32_16x16x32_bf16 v[228:231], v[20:23], v[32:35], v[228:231]
    ds_read_b64_tr_b16 v[16:17], v8 offset:8192
    ds_read_b64_tr_b16 v[18:19], v8 offset:9216
    s_cmp_lg_u32 s43, 0
    s_cbranch_scc1 LA_sig
    s_and_b32 s52, s40, 31
    s_lshl_b32 s52, s52, 13
    s_lshl_b32 s53, s41, 10
    s_add_u32 s52, s52, s53
    s_add_u32 s52, s52, 70254592
    s_lshl_b32 s53, s43, 2
    s_add_u32 s52, s52, s53
    v_mov_b32 v29, 1
    s_mov_b64 s[92:93], exec
    s_mov_b64 exec, 1
    buffer_store_dword v29, off, s[20:23], s52 sc1
    s_mov_b64 exec, s[92:93]
LA_sig:
    v_xor_b32 v8, 32, v8
    v_mfma_f32_16x16x32_bf16 v[228:231], v[24:27], v[36:39], v[228:231]
    ds_read_b128 v[32:35], v14 offset:0
    v_mfma_f32_16x16x32_bf16 v[236:239], v[20:23], v[40:43], v[236:239]
    ds_read_b128 v[36:39], v15 offset:0
    v_mfma_f32_16x16x32_bf16 v[236:239], v[24:27], v[44:47], v[236:239]
    ds_read_b128 v[40:43], v14 offset:2048
    v_mfma_f32_16x16x32_bf16 v[244:247], v[20:23], v[48:51], v[244:247]
    ds_read_b128 v[44:47], v15 offset:2048
    v_mfma_f32_16x16x32_bf16 v[244:247], v[24:27], v[52:55], v[244:247]
    ds_read_b128 v[48:51], v14 offset:16384
    v_mfma_f32_16x16x32_bf16 v[252:255], v[20:23], v[56:59], v[252:255]
    ds_read_b128 v[52:55], v15 offset:16384
    s_lshl_b32 s52, s43, 10
    s_add_u32 s53, s52, 32768
    v_add_u32 v0, s53, v2
    v_add_u32 v30, s52, v0
    s_add_u32 m0, s63, 98304
    v_mfma_f32_16x16x32_bf16 v[252:255], v[24:27], v[60:63], v[252:255]
    ds_read_b128 v[56:59], v14 offset:18432
    ds_read_b128 v[60:63], v15 offset:18432
    s_waitcnt lgkmcnt(7)
    v_mfma_f32_16x16x32_bf16 v[128:131], v[4:7], v[32:35], v[128:131]
    ds_read_b64_tr_b16 v[20:21], v8 offset:0
    s_waitcnt lgkmcnt(7)
    v_mfma_f32_16x16x32_bf16 v[128:131], v[16:19], v[36:39], v[128:131]
    ds_read_b64_tr_b16 v[22:23], v8 offset:1024
    s_waitcnt lgkmcnt(7)
    v_mfma_f32_16x16x32_bf16 v[136:139], v[4:7], v[40:43], v[136:139]
    ds_read_b64_tr_b16 v[24:25], v8 offset:8192
    s_waitcnt lgkmcnt(7)
    v_mfma_f32_16x16x32_bf16 v[136:139], v[16:19], v[44:47], v[136:139]
    ds_read_b64_tr_b16 v[26:27], v8 offset:9216
    s_waitcnt lgkmcnt(7)
    v_mfma_f32_16x16x32_bf16 v[144:147], v[4:7], v[48:51], v[144:147]
    ds_write_b128 v0, v[64:67] offset:0
    v_xor_b32 v8, 96, v8
    s_waitcnt lgkmcnt(7)
    v_mfma_f32_16x16x32_bf16 v[144:147], v[16:19], v[52:55], v[144:147]
    s_waitcnt lgkmcnt(6)
    v_mfma_f32_16x16x32_bf16 v[152:155], v[4:7], v[56:59], v[152:155]
    s_waitcnt lgkmcnt(5)
    v_mfma_f32_16x16x32_bf16 v[152:155], v[16:19], v[60:63], v[152:155]
    s_waitcnt lgkmcnt(3)
    v_mfma_f32_16x16x32_bf16 v[132:135], v[20:23], v[32:35], v[132:135]
    ds_read_b64_tr_b16 v[4:5], v8 offset:0
    s_waitcnt lgkmcnt(2)
    v_mfma_f32_16x16x32_bf16 v[132:135], v[24:27], v[36:39], v[132:135]
    ds_read_b64_tr_b16 v[6:7], v8 offset:1024
    v_mfma_f32_16x16x32_bf16 v[140:143], v[20:23], v[40:43], v[140:143]
    ds_read_b64_tr_b16 v[16:17], v8 offset:8192
    v_mfma_f32_16x16x32_bf16 v[140:143], v[24:27], v[44:47], v[140:143]
    ds_read_b64_tr_b16 v[18:19], v8 offset:9216
    ds_write_b128 v0, v[68:71] offset:4096
    v_mfma_f32_16x16x32_bf16 v[148:151], v[20:23], v[48:51], v[148:151]
    v_xor_b32 v8, 32, v8
    v_mfma_f32_16x16x32_bf16 v[148:151], v[24:27], v[52:55], v[148:151]
    v_mfma_f32_16x16x32_bf16 v[156:159], v[20:23], v[56:59], v[156:159]
    v_mfma_f32_16x16x32_bf16 v[156:159], v[24:27], v[60:63], v[156:159]
    s_waitcnt lgkmcnt(3)
    v_mfma_f32_16x16x32_bf16 v[160:163], v[4:7], v[32:35], v[160:163]
    ds_read_b64_tr_b16 v[20:21], v8 offset:0
    s_waitcnt lgkmcnt(2)
    v_mfma_f32_16x16x32_bf16 v[160:163], v[16:19], v[36:39], v[160:163]
    ds_read_b64_tr_b16 v[22:23], v8 offset:1024
    ds_write_b128 v30, v[72:75] offset:8192
    v_mfma_f32_16x16x32_bf16 v[168:171], v[4:7], v[40:43], v[168:171]
    ds_read_b64_tr_b16 v[24:25], v8 offset:8192
    v_mfma_f32_16x16x32_bf16 v[168:171], v[16:19], v[44:47], v[168:171]
    ds_read_b64_tr_b16 v[26:27], v8 offset:9216
    v_mfma_f32_16x16x32_bf16 v[176:179], v[4:7], v[48:51], v[176:179]
    v_xor_b32 v8, 224, v8
    v_mfma_f32_16x16x32_bf16 v[176:179], v[16:19], v[52:55], v[176:179]
    v_mfma_f32_16x16x32_bf16 v[184:187], v[4:7], v[56:59], v[184:187]
    v_mfma_f32_16x16x32_bf16 v[184:187], v[16:19], v[60:63], v[184:187]
    s_waitcnt lgkmcnt(3)
    v_mfma_f32_16x16x32_bf16 v[164:167], v[20:23], v[32:35], v[164:167]
    ds_read_b64_tr_b16 v[4:5], v8 offset:0
    ds_write_b128 v30, v[76:79] offset:9216
    s_waitcnt lgkmcnt(2)
    v_mfma_f32_16x16x32_bf16 v[164:167], v[24:27], v[36:39], v[164:167]
    ds_read_b64_tr_b16 v[6:7], v8 offset:1024
    v_mfma_f32_16x16x32_bf16 v[172:175], v[20:23], v[40:43], v[172:175]
    ds_read_b64_tr_b16 v[16:17], v8 offset:8192
    v_mfma_f32_16x16x32_bf16 v[172:175], v[24:27], v[44:47], v[172:175]
    ds_read_b64_tr_b16 v[18:19], v8 offset:9216
    v_mfma_f32_16x16x32_bf16 v[180:183], v[20:23], v[48:51], v[180:183]
    v_xor_b32 v8, 32, v8
    v_mfma_f32_16x16x32_bf16 v[180:183], v[24:27], v[52:55], v[180:183]
    v_mfma_f32_16x16x32_bf16 v[188:191], v[20:23], v[56:59], v[188:191]
    ds_write_b128 v0, v[80:83] offset:16384
    v_mfma_f32_16x16x32_bf16 v[188:191], v[24:27], v[60:63], v[188:191]
    s_waitcnt lgkmcnt(3)
    v_mfma_f32_16x16x32_bf16 v[192:195], v[4:7], v[32:35], v[192:195]
    ds_read_b64_tr_b16 v[20:21], v8 offset:0
    s_waitcnt lgkmcnt(2)
    v_mfma_f32_16x16x32_bf16 v[192:195], v[16:19], v[36:39], v[192:195]
    ds_read_b64_tr_b16 v[22:23], v8 offset:1024
    v_mfma_f32_16x16x32_bf16 v[200:203], v[4:7], v[40:43], v[200:203]
    ds_read_b64_tr_b16 v[24:25], v8 offset:8192
    v_mfma_f32_16x16x32_bf16 v[200:203], v[16:19], v[44:47], v[200:203]
    ds_read_b64_tr_b16 v[26:27], v8 offset:9216
    v_mfma_f32_16x16x32_bf16 v[208:211], v[4:7], v[48:51], v[208:211]
    ds_write_b128 v0, v[84:87] offset:20480
    v_xor_b32 v8, 96, v8
    v_mfma_f32_16x16x32_bf16 v[208:211], v[16:19], v[52:55], v[208:211]
    v_mfma_f32_16x16x32_bf16 v[216:219], v[4:7], v[56:59], v[216:219]
    v_mfma_f32_16x16x32_bf16 v[216:219], v[16:19], v[60:63], v[216:219]
    s_waitcnt lgkmcnt(3)
    v_mfma_f32_16x16x32_bf16 v[196:199], v[20:23], v[32:35], v[196:199]
    ds_read_b64_tr_b16 v[4:5], v8 offset:0
    s_waitcnt lgkmcnt(2)
    v_mfma_f32_16x16x32_bf16 v[196:199], v[24:27], v[36:39], v[196:199]
    ds_read_b64_tr_b16 v[6:7], v8 offset:1024
    v_mfma_f32_16x16x32_bf16 v[204:207], v[20:23], v[40:43], v[204:207]
    ds_read_b64_tr_b16 v[16:17], v8 offset:8192
    v_mfma_f32_16x16x32_bf16 v[204:207], v[24:27], v[44:47], v[204:207]
    ds_read_b64_tr_b16 v[18:19], v8 offset:9216
    ds_write_b128 v30, v[88:91] offset:24576
    v_mfma_f32_16x16x32_bf16 v[212:215], v[20:23], v[48:51], v[212:215]
    v_xor_b32 v8, 32, v8
    v_mfma_f32_16x16x32_bf16 v[212:215], v[24:27], v[52:55], v[212:215]
    v_mfma_f32_16x16x32_bf16 v[220:223], v[20:23], v[56:59], v[220:223]
    v_mfma_f32_16x16x32_bf16 v[220:223], v[24:27], v[60:63], v[220:223]
    s_waitcnt lgkmcnt(3)
    v_mfma_f32_16x16x32_bf16 v[224:227], v[4:7], v[32:35], v[224:227]
    ds_read_b64_tr_b16 v[20:21], v8 offset:0
    s_waitcnt lgkmcnt(2)
    v_mfma_f32_16x16x32_bf16 v[224:227], v[16:19], v[36:39], v[224:227]
    ds_read_b64_tr_b16 v[22:23], v8 offset:1024
    ds_write_b128 v30, v[92:95] offset:25600
    v_mfma_f32_16x16x32_bf16 v[232:235], v[4:7], v[40:43], v[232:235]
    ds_read_b64_tr_b16 v[24:25], v8 offset:8192
    v_mfma_f32_16x16x32_bf16 v[232:235], v[16:19], v[44:47], v[232:235]
    ds_read_b64_tr_b16 v[26:27], v8 offset:9216
    v_mfma_f32_16x16x32_bf16 v[240:243], v[4:7], v[48:51], v[240:243]
    v_xor_b32 v8, 224, v8
    v_mfma_f32_16x16x32_bf16 v[240:243], v[16:19], v[52:55], v[240:243]
    v_mfma_f32_16x16x32_bf16 v[248:251], v[4:7], v[56:59], v[248:251]
    v_mfma_f32_16x16x32_bf16 v[248:251], v[16:19], v[60:63], v[248:251]
    s_waitcnt lgkmcnt(0)
    s_barrier
    ds_read_b64_tr_b16 v[4:5], v8 offset:32768
    ds_read_b64_tr_b16 v[6:7], v8 offset:33792
    v_mfma_f32_16x16x32_bf16 v[228:231], v[20:23], v[32:35], v[228:231]
    ds_read_b64_tr_b16 v[16:17], v8 offset:40960
    ds_read_b64_tr_b16 v[18:19], v8 offset:41984
    s_and_b32 s52, s40, 31
    s_lshl_b32 s52, s52, 13
    s_add_u32 s52, s52, 70254592
    v_bfe_u32 v29, v1, 2, 3
    v_lshlrev_b32 v29, 8, v29
    v_lshlrev_b32 v29, 2, v29
    buffer_load_dword v10, v29, s[20:23], s52 offen sc1
    v_xor_b32 v8, 32, v8
    v_mfma_f32_16x16x32_bf16 v[228:231], v[24:27], v[36:39], v[228:231]
    ds_read_b128 v[32:35], v12 offset:0
    v_mfma_f32_16x16x32_bf16 v[236:239], v[20:23], v[40:43], v[236:239]
    ds_read_b128 v[36:39], v13 offset:0
    v_mfma_f32_16x16x32_bf16 v[236:239], v[24:27], v[44:47], v[236:239]
    ds_read_b128 v[40:43], v12 offset:2048
    v_mfma_f32_16x16x32_bf16 v[244:247], v[20:23], v[48:51], v[244:247]
    ds_read_b128 v[44:47], v13 offset:2048
    v_mfma_f32_16x16x32_bf16 v[244:247], v[24:27], v[52:55], v[244:247]
    ds_read_b128 v[48:51], v12 offset:16384
    v_mfma_f32_16x16x32_bf16 v[252:255], v[20:23], v[56:59], v[252:255]
    ds_read_b128 v[52:55], v13 offset:16384
    v_mfma_f32_16x16x32_bf16 v[252:255], v[24:27], v[60:63], v[252:255]
    ds_read_b128 v[56:59], v12 offset:18432
    ds_read_b128 v[60:63], v13 offset:18432
    s_waitcnt lgkmcnt(7)
    v_mfma_f32_16x16x32_bf16 v[128:131], v[4:7], v[32:35], v[128:131]
    ds_read_b64_tr_b16 v[20:21], v8 offset:32768
    s_waitcnt lgkmcnt(7)
    v_mfma_f32_16x16x32_bf16 v[128:131], v[16:19], v[36:39], v[128:131]
    ds_read_b64_tr_b16 v[22:23], v8 offset:33792
    s_waitcnt lgkmcnt(7)
    v_mfma_f32_16x16x32_bf16 v[136:139], v[4:7], v[40:43], v[136:139]
    ds_read_b64_tr_b16 v[24:25], v8 offset:40960
    ds_write_b128 v0, v[96:99] offset:32768
    s_waitcnt lgkmcnt(8)
    v_mfma_f32_16x16x32_bf16 v[136:139], v[16:19], v[44:47], v[136:139]
    ds_read_b64_tr_b16 v[26:27], v8 offset:41984
    s_waitcnt lgkmcnt(8)
    v_mfma_f32_16x16x32_bf16 v[144:147], v[4:7], v[48:51], v[144:147]
    ds_write_b128 v0, v[100:103] offset:36864
    v_xor_b32 v8, 96, v8
    s_waitcnt lgkmcnt(8)
    v_mfma_f32_16x16x32_bf16 v[144:147], v[16:19], v[52:55], v[144:147]
    s_waitcnt lgkmcnt(7)
    v_mfma_f32_16x16x32_bf16 v[152:155], v[4:7], v[56:59], v[152:155]
    s_waitcnt lgkmcnt(6)
    v_mfma_f32_16x16x32_bf16 v[152:155], v[16:19], v[60:63], v[152:155]
    ds_write_b128 v30, v[104:107] offset:40960
    s_waitcnt lgkmcnt(5)
    v_mfma_f32_16x16x32_bf16 v[132:135], v[20:23], v[32:35], v[132:135]
    ds_read_b64_tr_b16 v[4:5], v8 offset:32768
    s_waitcnt lgkmcnt(3)
    v_mfma_f32_16x16x32_bf16 v[132:135], v[24:27], v[36:39], v[132:135]
    ds_read_b64_tr_b16 v[6:7], v8 offset:33792
    ds_write_b128 v30, v[108:111] offset:41984
    v_mfma_f32_16x16x32_bf16 v[140:143], v[20:23], v[40:43], v[140:143]
    ds_read_b64_tr_b16 v[16:17], v8 offset:40960
    v_mfma_f32_16x16x32_bf16 v[140:143], v[24:27], v[44:47], v[140:143]
    ds_read_b64_tr_b16 v[18:19], v8 offset:41984
    v_mfma_f32_16x16x32_bf16 v[148:151], v[20:23], v[48:51], v[148:151]
    ds_write_b128 v0, v[112:115] offset:49152
    v_xor_b32 v8, 32, v8
    v_mfma_f32_16x16x32_bf16 v[148:151], v[24:27], v[52:55], v[148:151]
    v_mfma_f32_16x16x32_bf16 v[156:159], v[20:23], v[56:59], v[156:159]
    ds_write_b128 v0, v[116:119] offset:53248
    v_mfma_f32_16x16x32_bf16 v[156:159], v[24:27], v[60:63], v[156:159]
    s_waitcnt lgkmcnt(5)
    v_mfma_f32_16x16x32_bf16 v[160:163], v[4:7], v[32:35], v[160:163]
    ds_read_b64_tr_b16 v[20:21], v8 offset:32768
    s_waitcnt lgkmcnt(3)
    v_mfma_f32_16x16x32_bf16 v[160:163], v[16:19], v[36:39], v[160:163]
    ds_read_b64_tr_b16 v[22:23], v8 offset:33792
    ds_write_b128 v30, v[120:123] offset:57344
    v_mfma_f32_16x16x32_bf16 v[168:171], v[4:7], v[40:43], v[168:171]
    ds_read_b64_tr_b16 v[24:25], v8 offset:40960
    v_mfma_f32_16x16x32_bf16 v[168:171], v[16:19], v[44:47], v[168:171]
    ds_read_b64_tr_b16 v[26:27], v8 offset:41984
    ds_write_b128 v30, v[124:127] offset:58368
    v_mfma_f32_16x16x32_bf16 v[176:179], v[4:7], v[48:51], v[176:179]
    v_xor_b32 v8, 224, v8
    v_mfma_f32_16x16x32_bf16 v[176:179], v[16:19], v[52:55], v[176:179]
    v_mfma_f32_16x16x32_bf16 v[184:187], v[4:7], v[56:59], v[184:187]
    v_cvt_pk_bf16_f32 v64, v128, v129
    v_cvt_pk_bf16_f32 v65, v130, v131
    v_mfma_f32_16x16x32_bf16 v[184:187], v[16:19], v[60:63], v[184:187]
    v_cvt_pk_bf16_f32 v66, v132, v133
    v_cvt_pk_bf16_f32 v67, v134, v135
    s_waitcnt lgkmcnt(4)
    v_mfma_f32_16x16x32_bf16 v[164:167], v[20:23], v[32:35], v[164:167]
    ds_read_b64_tr_b16 v[4:5], v8 offset:32768
    v_cvt_pk_bf16_f32 v68, v136, v137
    v_cvt_pk_bf16_f32 v69, v138, v139
    s_waitcnt lgkmcnt(2)
    v_mfma_f32_16x16x32_bf16 v[164:167], v[24:27], v[36:39], v[164:167]
    ds_read_b64_tr_b16 v[6:7], v8 offset:33792
    v_cvt_pk_bf16_f32 v70, v140, v141
    v_cvt_pk_bf16_f32 v71, v142, v143
    v_mfma_f32_16x16x32_bf16 v[172:175], v[20:23], v[40:43], v[172:175]
    ds_read_b64_tr_b16 v[16:17], v8 offset:40960
    v_cvt_pk_bf16_f32 v96, v144, v145
    v_cvt_pk_bf16_f32 v97, v146, v147
    v_mfma_f32_16x16x32_bf16 v[172:175], v[24:27], v[44:47], v[172:175]
    ds_read_b64_tr_b16 v[18:19], v8 offset:41984
    v_cvt_pk_bf16_f32 v98, v148, v149
    v_cvt_pk_bf16_f32 v99, v150, v151
    v_mfma_f32_16x16x32_bf16 v[180:183], v[20:23], v[48:51], v[180:183]
    v_xor_b32 v8, 32, v8
    v_cvt_pk_bf16_f32 v100, v152, v153
    v_cvt_pk_bf16_f32 v101, v154, v155
    v_mfma_f32_16x16x32_bf16 v[180:183], v[24:27], v[52:55], v[180:183]
    v_cvt_pk_bf16_f32 v102, v156, v157
    v_cvt_pk_bf16_f32 v103, v158, v159
    v_mfma_f32_16x16x32_bf16 v[188:191], v[20:23], v[56:59], v[188:191]
    v_mfma_f32_16x16x32_bf16 v[188:191], v[24:27], v[60:63], v[188:191]
    s_waitcnt lgkmcnt(2)
    v_mfma_f32_16x16x32_bf16 v[192:195], v[4:7], v[32:35], v[192:195]
    ds_read_b64_tr_b16 v[20:21], v8 offset:32768
    s_waitcnt lgkmcnt(1)
    v_mfma_f32_16x16x32_bf16 v[192:195], v[16:19], v[36:39], v[192:195]
    ds_read_b64_tr_b16 v[22:23], v8 offset:33792
    v_mfma_f32_16x16x32_bf16 v[200:203], v[4:7], v[40:43], v[200:203]
    ds_read_b64_tr_b16 v[24:25], v8 offset:40960
    v_mfma_f32_16x16x32_bf16 v[200:203], v[16:19], v[44:47], v[200:203]
    ds_read_b64_tr_b16 v[26:27], v8 offset:41984
    v_mfma_f32_16x16x32_bf16 v[208:211], v[4:7], v[48:51], v[208:211]
    v_xor_b32 v8, 96, v8
    v_mfma_f32_16x16x32_bf16 v[208:211], v[16:19], v[52:55], v[208:211]
    v_mfma_f32_16x16x32_bf16 v[216:219], v[4:7], v[56:59], v[216:219]
    v_cvt_pk_bf16_f32 v72, v160, v161
    v_cvt_pk_bf16_f32 v73, v162, v163
    v_mfma_f32_16x16x32_bf16 v[216:219], v[16:19], v[60:63], v[216:219]
    v_cvt_pk_bf16_f32 v74, v164, v165
    v_cvt_pk_bf16_f32 v75, v166, v167
    s_waitcnt lgkmcnt(2)
    v_mfma_f32_16x16x32_bf16 v[196:199], v[20:23], v[32:35], v[196:199]
    ds_read_b64_tr_b16 v[4:5], v8 offset:32768
    v_cvt_pk_bf16_f32 v76, v168, v169
    v_cvt_pk_bf16_f32 v77, v170, v171
    s_waitcnt lgkmcnt(1)
    v_mfma_f32_16x16x32_bf16 v[196:199], v[24:27], v[36:39], v[196:199]
    ds_read_b64_tr_b16 v[6:7], v8 offset:33792
    v_cvt_pk_bf16_f32 v78, v172, v173
    v_cvt_pk_bf16_f32 v79, v174, v175
    v_mfma_f32_16x16x32_bf16 v[204:207], v[20:23], v[40:43], v[204:207]
    ds_read_b64_tr_b16 v[16:17], v8 offset:40960
    v_cvt_pk_bf16_f32 v104, v176, v177
    v_cvt_pk_bf16_f32 v105, v178, v179
    v_mfma_f32_16x16x32_bf16 v[204:207], v[24:27], v[44:47], v[204:207]
    ds_read_b64_tr_b16 v[18:19], v8 offset:41984
    v_cvt_pk_bf16_f32 v106, v180, v181
    v_cvt_pk_bf16_f32 v107, v182, v183
    v_mfma_f32_16x16x32_bf16 v[212:215], v[20:23], v[48:51], v[212:215]
    v_xor_b32 v8, 32, v8
    v_cvt_pk_bf16_f32 v108, v184, v185
    v_cvt_pk_bf16_f32 v109, v186, v187
    v_mfma_f32_16x16x32_bf16 v[212:215], v[24:27], v[52:55], v[212:215]
    v_cvt_pk_bf16_f32 v110, v188, v189
    v_cvt_pk_bf16_f32 v111, v190, v191
    v_mfma_f32_16x16x32_bf16 v[220:223], v[20:23], v[56:59], v[220:223]
    v_mfma_f32_16x16x32_bf16 v[220:223], v[24:27], v[60:63], v[220:223]
    s_waitcnt lgkmcnt(2)
    v_mfma_f32_16x16x32_bf16 v[224:227], v[4:7], v[32:35], v[224:227]
    ds_read_b64_tr_b16 v[20:21], v8 offset:32768
    s_waitcnt lgkmcnt(1)
    v_mfma_f32_16x16x32_bf16 v[224:227], v[16:19], v[36:39], v[224:227]
    ds_read_b64_tr_b16 v[22:23], v8 offset:33792
    v_mfma_f32_16x16x32_bf16 v[232:235], v[4:7], v[40:43], v[232:235]
    ds_read_b64_tr_b16 v[24:25], v8 offset:40960
    v_mfma_f32_16x16x32_bf16 v[232:235], v[16:19], v[44:47], v[232:235]
    ds_read_b64_tr_b16 v[26:27], v8 offset:41984
    v_mfma_f32_16x16x32_bf16 v[240:243], v[4:7], v[48:51], v[240:243]
    v_xor_b32 v8, 224, v8
    v_mfma_f32_16x16x32_bf16 v[240:243], v[16:19], v[52:55], v[240:243]
    v_mfma_f32_16x16x32_bf16 v[248:251], v[4:7], v[56:59], v[248:251]
    v_cvt_pk_bf16_f32 v80, v192, v193
    v_cvt_pk_bf16_f32 v81, v194, v195
    v_mfma_f32_16x16x32_bf16 v[248:251], v[16:19], v[60:63], v[248:251]
    v_cvt_pk_bf16_f32 v82, v196, v197
    v_cvt_pk_bf16_f32 v83, v198, v199
    s_waitcnt vmcnt(0) lgkmcnt(0)
    s_barrier
    v_mfma_f32_16x16x32_bf16 v[228:231], v[20:23], v[32:35], v[228:231]
    v_cvt_pk_bf16_f32 v84, v200, v201
    v_cvt_pk_bf16_f32 v85, v202, v203
    v_mfma_f32_16x16x32_bf16 v[228:231], v[24:27], v[36:39], v[228:231]
    v_cvt_pk_bf16_f32 v86, v204, v205
    v_cvt_pk_bf16_f32 v87, v206, v207
    v_mfma_f32_16x16x32_bf16 v[236:239], v[20:23], v[40:43], v[236:239]
    v_cvt_pk_bf16_f32 v112, v208, v209
    v_cvt_pk_bf16_f32 v113, v210, v211
    v_mfma_f32_16x16x32_bf16 v[236:239], v[24:27], v[44:47], v[236:239]
    v_cvt_pk_bf16_f32 v114, v212, v213
    v_cvt_pk_bf16_f32 v115, v214, v215
    v_mfma_f32_16x16x32_bf16 v[244:247], v[20:23], v[48:51], v[244:247]
    v_cvt_pk_bf16_f32 v116, v216, v217
    v_cvt_pk_bf16_f32 v117, v218, v219
    v_mfma_f32_16x16x32_bf16 v[244:247], v[24:27], v[52:55], v[244:247]
    v_cvt_pk_bf16_f32 v118, v220, v221
    v_cvt_pk_bf16_f32 v119, v222, v223
    v_mfma_f32_16x16x32_bf16 v[252:255], v[20:23], v[56:59], v[252:255]
    v_mfma_f32_16x16x32_bf16 v[252:255], v[24:27], v[60:63], v[252:255]
LA_qepi:
    v_cmp_ne_u32 vcc, 1, v10
    s_sub_u32 s56, s61, 65536
    s_cmp_eq_u32 s41, 0
    s_cselect_b32 s94, s61, s54
    s_cmp_eq_u64 vcc, 0
    s_cselect_b32 s62, s94, 0x80000000
    v_lshrrev_b32 v52, 4, v1
    v_xor_b32 v52, v52, v1
    v_and_b32 v52, 2, v52
    v_mov_b32 v49, 0x3f803f80
    v_cmp_eq_u32 vcc, 0, v52
    v_and_b32 v52, 1, v1
    v_mul_u32_u24 v52, 0xaaaa, v52
    v_cndmask_b32 v48, 0, v49, vcc
    v_add_u32 v52, 0x4444, v52
    v_mov_b32 v49, v48
    v_mov_b32 v50, v48
    v_mov_b32 v51, v48
    s_mov_b32 s50, 0x3e0293ee
    v_and_b32 v36, 15, v1
    v_lshrrev_b32 v24, 4, v1
    v_lshlrev_b32 v24, 2, v24
    v_sub_u32 v36, v36, v24
    s_lshl_b32 s52, s43, 5
    v_add_u32 v36, s52, v36
    s_mov_b32 s90, s43
    v_add_u32 v33, 32768, v2
    v_add_u32 v34, 65536, v2
    v_mov_b32 v38, v28
    v_and_b32 v39, 3, v1
    v_mul_u32_u24 v39, 260, v39
    v_add_u32 v39, 155648, v39
    v_mov_b32 v40, 1
    v_mov_b32 v42, 157712
    v_cmp_lt_u32 vcc, 31, v1
    s_and_b32 s91, s40, 3
    s_mul_i32 s91, s91, 1179648
    v_cndmask_b32 v39, v39, v42, vcc
    s_lshr_b32 s52, s40, 3
    s_mul_i32 s52, s52, 294912
    s_add_u32 s91, s91, s52
    s_add_u32 s91, s91, s63
    s_add_u32 s91, s91, 62914560
    s_and_b32 s52, s40, 4
    s_lshl_b32 s52, s52, 15
    s_add_u32 s35, s91, s52
    s_and_b32 s52, s40, 3
    s_lshl_b32 s52, s52, 15
    s_add_u32 s91, s35, s52
    v_mov_b32 v42, 0x10000
    v_subrev_u32 v43, s63, v2
    s_mov_b32 s58, s44
    s_mov_b32 s59, 0
    s_lshl_b32 s57, s44, 1
    s_sub_u32 s57, s57, 2
    buffer_load_dwordx4 v2, s[20:23], s62 offen offset:0 sc1 lds
    buffer_load_dwordx4 v2, s[20:23], s62 offen offset:1024 sc1 lds
    buffer_load_dwordx4 v2, s[20:23], s62 offen offset:2048 sc1 lds
    buffer_load_dwordx4 v2, s[20:23], s62 offen offset:3072 sc1 lds
    v_cvt_pk_bf16_f32 v88, v224, v225
    v_cvt_pk_bf16_f32 v89, v226, v227
    v_cvt_pk_bf16_f32 v90, v228, v229
    v_cvt_pk_bf16_f32 v91, v230, v231
    v_cvt_pk_bf16_f32 v92, v232, v233
    v_cvt_pk_bf16_f32 v93, v234, v235
    v_cvt_pk_bf16_f32 v94, v236, v237
    v_cvt_pk_bf16_f32 v95, v238, v239
    s_add_u32 m0, m0, 4096
    s_nop 0
    buffer_load_dwordx4 v11, s[20:23], s62 offen offset:0 sc1 lds
    buffer_load_dwordx4 v11, s[20:23], s62 offen offset:1024 sc1 lds
    buffer_load_dwordx4 v11, s[20:23], s62 offen offset:2048 sc1 lds
    buffer_load_dwordx4 v11, s[20:23], s62 offen offset:3072 sc1 lds
    v_cvt_pk_bf16_f32 v120, v240, v241
    v_cvt_pk_bf16_f32 v121, v242, v243
    v_cvt_pk_bf16_f32 v122, v244, v245
    v_cvt_pk_bf16_f32 v123, v246, v247
    v_cvt_pk_bf16_f32 v124, v248, v249
    v_cvt_pk_bf16_f32 v125, v250, v251
    v_cvt_pk_bf16_f32 v126, v252, v253
    v_cvt_pk_bf16_f32 v127, v254, v255
    s_cmp_eq_u32 s62, s94
    s_cbranch_scc1 LA_u2
    s_and_b32 s52, s40, 31
    s_lshl_b32 s52, s52, 13
    s_add_u32 s52, s52, 70254592
    v_bfe_u32 v29, v1, 2, 3
    v_lshlrev_b32 v29, 8, v29
    v_lshlrev_b32 v29, 2, v29
    buffer_load_dword v10, v29, s[20:23], s52 offen sc1
    s_waitcnt vmcnt(0)
LA_poll_loop:
    v_cmp_ne_u32 vcc, 1, v10
    s_cbranch_vccz LA_poll_ok
    s_sleep 4
    s_and_b32 s52, s40, 31
    s_lshl_b32 s52, s52, 13
    s_add_u32 s52, s52, 70254592
    v_bfe_u32 v29, v1, 2, 3
    v_lshlrev_b32 v29, 8, v29
    v_lshlrev_b32 v29, 2, v29
    buffer_load_dword v10, v29, s[20:23], s52 offen sc1
    s_waitcnt vmcnt(0)
    s_branch LA_poll_loop
LA_poll_ok:
    s_mov_b32 s62, s94
    s_sub_u32 m0, m0, 4096
    s_nop 0
    buffer_load_dwordx4 v2, s[20:23], s62 offen offset:0 sc1 lds
    buffer_load_dwordx4 v2, s[20:23], s62 offen offset:1024 sc1 lds
    buffer_load_dwordx4 v2, s[20:23], s62 offen offset:2048 sc1 lds
    buffer_load_dwordx4 v2, s[20:23], s62 offen offset:3072 sc1 lds
    s_add_u32 m0, m0, 4096
    s_nop 0
    buffer_load_dwordx4 v11, s[20:23], s62 offen offset:0 sc1 lds
    buffer_load_dwordx4 v11, s[20:23], s62 offen offset:1024 sc1 lds
    buffer_load_dwordx4 v11, s[20:23], s62 offen offset:2048 sc1 lds
    buffer_load_dwordx4 v11, s[20:23], s62 offen offset:3072 sc1 lds
LA_u2:
    s_add_u32 m0, m0, 28672
    s_and_b32 m0, m0, 0x1ffff
    s_add_u32 s62, s62, 32768
    s_cmp_eq_u32 s62, s56
    s_cselect_b32 s62, s61, s62
    s_setprio 1
LA_block:
    s_mov_b32 s99, 0
    s_lshl_b32 s50, s58, 2
    s_add_u32 s50, s50, s90
    s_cmp_lt_u32 s50, 2
    s_cbranch_scc1 LA_pro0
    ds_read_b128 v[224:227], v33 offset:0
    ds_read_b128 v[228:231], v33 offset:1024
    ds_read_b128 v[232:235], v33 offset:2048
    ds_read_b128 v[236:239], v33 offset:3072
    ds_read_b128 v[240:243], v33 offset:4096
    ds_read_b128 v[244:247], v33 offset:5120
    ds_read_b128 v[248:251], v33 offset:6144
    ds_read_b128 v[252:255], v33 offset:7168
    v_mov_b32 v56, 0
    v_mov_b32 v57, 0
    v_mov_b32 v58, 0
    v_mov_b32 v59, 0
    v_mov_b32 v44, 0
    v_mov_b32 v45, 0
    v_mov_b32 v46, 0
    v_mov_b32 v47, 0
    s_mov_b32 s60, 0
    v_mfma_f32_32x32x16_bf16 v[128:143], v[56:59], v[56:59], 0
    v_mfma_f32_32x32x16_bf16 v[144:159], v[56:59], v[56:59], 0
    v_mfma_f32_32x32x16_bf16 v[160:175], v[56:59], v[56:59], 0
    v_mfma_f32_32x32x16_bf16 v[176:191], v[56:59], v[56:59], 0
    s_waitcnt lgkmcnt(7)
    v_mfma_f32_16x16x32_bf16 v[192:195], v[224:227], v[64:67], 0
    v_mfma_f32_16x16x32_bf16 v[196:199], v[224:227], v[68:71], 0
    ds_read_b128 v[224:227], v33 offset:16384
    s_waitcnt lgkmcnt(7)
    v_mfma_f32_16x16x32_bf16 v[192:195], v[228:231], v[72:75], v[192:195]
    v_mfma_f32_16x16x32_bf16 v[196:199], v[228:231], v[76:79], v[196:199]
    ds_read_b128 v[228:231], v33 offset:17408
    s_waitcnt lgkmcnt(7)
    v_mfma_f32_16x16x32_bf16 v[192:195], v[232:235], v[80:83], v[192:195]
    v_mfma_f32_16x16x32_bf16 v[196:199], v[232:235], v[84:87], v[196:199]
    ds_read_b128 v[232:235], v33 offset:18432
    s_waitcnt lgkmcnt(7)
    v_mfma_f32_16x16x32_bf16 v[192:195], v[236:239], v[88:91], v[192:195]
    v_mfma_f32_16x16x32_bf16 v[196:199], v[236:239], v[92:95], v[196:199]
    ds_read_b128 v[236:239], v33 offset:19456
    s_waitcnt lgkmcnt(7)
    v_mfma_f32_16x16x32_bf16 v[200:203], v[240:243], v[64:67], 0
    v_mfma_f32_16x16x32_bf16 v[204:207], v[240:243], v[68:71], 0
    ds_read_b128 v[240:243], v33 offset:20480
    s_waitcnt lgkmcnt(7)
    v_mfma_f32_16x16x32_bf16 v[200:203], v[244:247], v[72:75], v[200:203]
    v_mfma_f32_16x16x32_bf16 v[204:207], v[244:247], v[76:79], v[204:207]
    ds_read_b128 v[244:247], v33 offset:21504
    s_waitcnt lgkmcnt(7)
    v_mfma_f32_16x16x32_bf16 v[200:203], v[248:251], v[80:83], v[200:203]
    v_mfma_f32_16x16x32_bf16 v[204:207], v[248:251], v[84:87], v[204:207]
    ds_read_b128 v[248:251], v33 offset:22528
    s_waitcnt lgkmcnt(7)
    v_mfma_f32_16x16x32_bf16 v[200:203], v[252:255], v[88:91], v[200:203]
    v_mfma_f32_16x16x32_bf16 v[204:207], v[252:255], v[92:95], v[204:207]
    v_exp_f32 v192, v192
    v_exp_f32 v193, v193
    v_exp_f32 v194, v194
    v_cvt_pk_bf16_f32 v56, v192, v193
    v_exp_f32 v195, v195
    v_exp_f32 v196, v196
    v_cvt_pk_bf16_f32 v57, v194, v195
    v_exp_f32 v197, v197
    v_exp_f32 v198, v198
    v_cvt_pk_bf16_f32 v60, v196, v197
    v_exp_f32 v199, v199
    v_exp_f32 v200, v200
    v_cvt_pk_bf16_f32 v61, v198, v199
    s_waitcnt lgkmcnt(4)
    s_cmp_eq_u32 s58, 0
    s_cbranch_scc1 LA_D
    .p2align 6
    s_nop 0
    s_nop 0
LA_P:
    v_mfma_f32_16x16x32_bf16 v[208:211], v[224:227], v[64:67], 0
    ds_read_b128 v[252:255], v33 offset:23552
    v_mfma_f32_16x16x32_bf16 v[212:215], v[224:227], v[68:71], 0
    s_waitcnt vmcnt(8)
    ds_write_b32 v38, v40
    v_exp_f32 v201, v201
    v_mfma_f32_16x16x32_bf16 v[208:211], v[228:231], v[72:75], v[208:211]
    ds_read_b128 v[224:227], v33 offset:8192
    v_cvt_pk_bf16_f32 v58, v200, v201
    v_mfma_f32_16x16x32_bf16 v[212:215], v[228:231], v[76:79], v[212:215]
    s_waitcnt lgkmcnt(5)
    v_exp_f32 v202, v202
    v_mfma_f32_16x16x32_bf16 v[208:211], v[232:235], v[80:83], v[208:211]
    ds_read_b128 v[228:231], v33 offset:9216
    v_mfma_f32_16x16x32_bf16 v[212:215], v[232:235], v[84:87], v[212:215]
    v_exp_f32 v203, v203
    v_mfma_f32_16x16x32_bf16 v[208:211], v[236:239], v[88:91], v[208:211]
    ds_read_b128 v[232:235], v33 offset:10240
    v_cvt_pk_bf16_f32 v59, v202, v203
    v_mfma_f32_16x16x32_bf16 v[212:215], v[236:239], v[92:95], v[212:215]
    v_exp_f32 v204, v204
    v_mfma_f32_16x16x32_bf16 v[216:219], v[240:243], v[64:67], 0
    ds_read_b128 v[236:239], v33 offset:11264
    v_mfma_f32_16x16x32_bf16 v[220:223], v[240:243], v[68:71], 0
    ds_read_b32 v41, v39
    s_waitcnt lgkmcnt(6)
    v_exp_f32 v205, v205
    v_mfma_f32_16x16x32_bf16 v[216:219], v[244:247], v[72:75], v[216:219]
    ds_read_b128 v[240:243], v33 offset:12288
    v_cvt_pk_bf16_f32 v62, v204, v205
    v_mfma_f32_16x16x32_bf16 v[220:223], v[244:247], v[76:79], v[220:223]
    v_exp_f32 v206, v206
    v_mfma_f32_16x16x32_bf16 v[216:219], v[248:251], v[80:83], v[216:219]
    ds_read_b128 v[244:247], v33 offset:13312
    v_mfma_f32_16x16x32_bf16 v[220:223], v[248:251], v[84:87], v[220:223]
    v_exp_f32 v207, v207
    v_mfma_f32_16x16x32_bf16 v[216:219], v[252:255], v[88:91], v[216:219]
    ds_read_b128 v[248:251], v33 offset:14336
    v_cvt_pk_bf16_f32 v63, v206, v207
    v_mfma_f32_16x16x32_bf16 v[220:223], v[252:255], v[92:95], v[220:223]
    s_waitcnt lgkmcnt(5)
    v_exp_f32 v208, v208
    v_mfma_f32_16x16x32_bf16 v[128:131], v[224:227], v[56:59], v[128:131]
    ds_read_b128 v[252:255], v33 offset:15360
    v_mfma_f32_16x16x32_bf16 v[136:139], v[224:227], v[60:63], v[136:139]
    s_waitcnt lgkmcnt(4)
    v_cmp_gt_u32 vcc, v40, v41
    v_exp_f32 v209, v209
    s_cbranch_vccz LA_P_s_ok
LA_P_s_sp:
    ds_read_b32 v41, v39
    s_waitcnt lgkmcnt(0)
    v_cmp_gt_u32 vcc, v40, v41
    s_cbranch_vccnz LA_P_s_sp
LA_P_s_ok:
    v_mfma_f32_16x16x32_bf16 v[132:135], v[228:231], v[56:59], v[132:135]
    ds_read_b128 v[224:227], v34 offset:0
    v_cvt_pk_bf16_f32 v12, v208, v209
    v_mfma_f32_16x16x32_bf16 v[140:143], v[228:231], v[60:63], v[140:143]
    v_exp_f32 v210, v210
    v_mfma_f32_16x16x32_bf16 v[144:147], v[232:235], v[56:59], v[144:147]
    ds_read_b128 v[228:231], v34 offset:1024
    v_mfma_f32_16x16x32_bf16 v[152:155], v[232:235], v[60:63], v[152:155]
    buffer_load_dwordx4 v2, s[20:23], s62 offen offset:0 sc1 lds
    s_waitcnt lgkmcnt(4)
    v_add_u32 v40, 1, v40
    v_exp_f32 v211, v211
    v_smfmac_f32_16x16x64_bf16 v[44:47], v[48:51], v[56:63], v52
    v_mfma_f32_16x16x32_bf16 v[148:151], v[236:239], v[56:59], v[148:151]
    ds_read_b128 v[232:235], v34 offset:2048
    v_cvt_pk_bf16_f32 v13, v210, v211
    v_mfma_f32_16x16x32_bf16 v[156:159], v[236:239], v[60:63], v[156:159]
    v_exp_f32 v212, v212
    v_mfma_f32_16x16x32_bf16 v[160:163], v[240:243], v[56:59], v[160:163]
    ds_read_b128 v[236:239], v34 offset:3072
    v_mfma_f32_16x16x32_bf16 v[168:171], v[240:243], v[60:63], v[168:171]
    buffer_load_dwordx4 v2, s[20:23], s62 offen offset:1024 sc1 lds
    v_exp_f32 v213, v213
    v_mfma_f32_16x16x32_bf16 v[164:167], v[244:247], v[56:59], v[164:167]
    ds_read_b128 v[240:243], v34 offset:4096
    v_cvt_pk_bf16_f32 v16, v212, v213
    v_mfma_f32_16x16x32_bf16 v[172:175], v[244:247], v[60:63], v[172:175]
    s_waitcnt lgkmcnt(4)
    v_exp_f32 v214, v214
    v_mfma_f32_16x16x32_bf16 v[176:179], v[248:251], v[56:59], v[176:179]
    ds_read_b128 v[244:247], v34 offset:5120
    v_mfma_f32_16x16x32_bf16 v[184:187], v[248:251], v[60:63], v[184:187]
    buffer_load_dwordx4 v2, s[20:23], s62 offen offset:2048 sc1 lds
    v_exp_f32 v215, v215
    v_mfma_f32_16x16x32_bf16 v[180:183], v[252:255], v[56:59], v[180:183]
    ds_read_b128 v[248:251], v34 offset:6144
    v_cvt_pk_bf16_f32 v17, v214, v215
    v_mfma_f32_16x16x32_bf16 v[188:191], v[252:255], v[60:63], v[188:191]
    v_exp_f32 v216, v216
    v_mfma_f32_16x16x32_bf16 v[192:195], v[224:227], v[64:67], 0
    ds_read_b128 v[252:255], v34 offset:7168
    v_mfma_f32_16x16x32_bf16 v[196:199], v[224:227], v[68:71], 0
    buffer_load_dwordx4 v2, s[20:23], s62 offen offset:3072 sc1 lds
    s_waitcnt lgkmcnt(4)
    v_exp_f32 v217, v217
    v_mfma_f32_16x16x32_bf16 v[192:195], v[228:231], v[72:75], v[192:195]
    ds_read_b128 v[224:227], v33 offset:24576
    v_cvt_pk_bf16_f32 v14, v216, v217
    v_mfma_f32_16x16x32_bf16 v[196:199], v[228:231], v[76:79], v[196:199]
    v_exp_f32 v218, v218
    v_mfma_f32_16x16x32_bf16 v[192:195], v[232:235], v[80:83], v[192:195]
    ds_read_b128 v[228:231], v33 offset:25600
    v_mfma_f32_16x16x32_bf16 v[196:199], v[232:235], v[84:87], v[196:199]
    s_add_u32 m0, m0, 4096
    v_exp_f32 v219, v219
    v_mfma_f32_16x16x32_bf16 v[192:195], v[236:239], v[88:91], v[192:195]
    ds_read_b128 v[232:235], v33 offset:26624
    v_cvt_pk_bf16_f32 v15, v218, v219
    v_mfma_f32_16x16x32_bf16 v[196:199], v[236:239], v[92:95], v[196:199]
    s_waitcnt lgkmcnt(4)
    v_exp_f32 v220, v220
    v_mfma_f32_16x16x32_bf16 v[200:203], v[240:243], v[64:67], 0
    ds_read_b128 v[236:239], v33 offset:27648
    v_mfma_f32_16x16x32_bf16 v[204:207], v[240:243], v[68:71], 0
    buffer_load_dwordx4 v11, s[20:23], s62 offen offset:0 sc1 lds
    v_exp_f32 v221, v221
    v_mfma_f32_16x16x32_bf16 v[200:203], v[244:247], v[72:75], v[200:203]
    ds_read_b128 v[240:243], v33 offset:28672
    v_cvt_pk_bf16_f32 v18, v220, v221
    v_mfma_f32_16x16x32_bf16 v[204:207], v[244:247], v[76:79], v[204:207]
    v_exp_f32 v222, v222
    v_mfma_f32_16x16x32_bf16 v[200:203], v[248:251], v[80:83], v[200:203]
    ds_read_b128 v[244:247], v33 offset:29696
    v_mfma_f32_16x16x32_bf16 v[204:207], v[248:251], v[84:87], v[204:207]
    buffer_load_dwordx4 v11, s[20:23], s62 offen offset:1024 sc1 lds
    s_waitcnt lgkmcnt(4)
    v_exp_f32 v223, v223
    v_mfma_f32_16x16x32_bf16 v[200:203], v[252:255], v[88:91], v[200:203]
    ds_read_b128 v[248:251], v33 offset:30720
    v_cvt_pk_bf16_f32 v19, v222, v223
    v_mfma_f32_16x16x32_bf16 v[204:207], v[252:255], v[92:95], v[204:207]
    v_exp_f32 v192, v192
    v_mfma_f32_16x16x32_bf16 v[128:131], v[224:227], v[12:15], v[128:131]
    ds_read_b128 v[252:255], v33 offset:31744
    v_mfma_f32_16x16x32_bf16 v[136:139], v[224:227], v[16:19], v[136:139]
    buffer_load_dwordx4 v11, s[20:23], s62 offen offset:2048 sc1 lds
    v_exp_f32 v193, v193
    v_mfma_f32_16x16x32_bf16 v[132:135], v[228:231], v[12:15], v[132:135]
    ds_read_b128 v[224:227], v34 offset:16384
    v_cvt_pk_bf16_f32 v56, v192, v193
    v_mfma_f32_16x16x32_bf16 v[140:143], v[228:231], v[16:19], v[140:143]
    s_waitcnt lgkmcnt(4)
    v_exp_f32 v194, v194
    v_mfma_f32_16x16x32_bf16 v[144:147], v[232:235], v[12:15], v[144:147]
    ds_read_b128 v[228:231], v34 offset:17408
    v_mfma_f32_16x16x32_bf16 v[152:155], v[232:235], v[16:19], v[152:155]
    buffer_load_dwordx4 v11, s[20:23], s62 offen offset:3072 sc1 lds
    v_exp_f32 v195, v195
    v_smfmac_f32_16x16x64_bf16 v[44:47], v[48:51], v[12:19], v52
    v_mfma_f32_16x16x32_bf16 v[148:151], v[236:239], v[12:15], v[148:151]
    ds_read_b128 v[232:235], v34 offset:18432
    v_cvt_pk_bf16_f32 v57, v194, v195
    v_mfma_f32_16x16x32_bf16 v[156:159], v[236:239], v[16:19], v[156:159]
    v_exp_f32 v196, v196
    v_mfma_f32_16x16x32_bf16 v[160:163], v[240:243], v[12:15], v[160:163]
    ds_read_b128 v[236:239], v34 offset:19456
    v_mfma_f32_16x16x32_bf16 v[168:171], v[240:243], v[16:19], v[168:171]
    s_add_u32 m0, m0, 28672
    s_and_b32 m0, m0, 0x1ffff
    s_waitcnt lgkmcnt(4)
    v_exp_f32 v197, v197
    v_mfma_f32_16x16x32_bf16 v[164:167], v[244:247], v[12:15], v[164:167]
    ds_read_b128 v[240:243], v34 offset:20480
    v_cvt_pk_bf16_f32 v60, v196, v197
    v_mfma_f32_16x16x32_bf16 v[172:175], v[244:247], v[16:19], v[172:175]
    v_exp_f32 v198, v198
    v_mfma_f32_16x16x32_bf16 v[176:179], v[248:251], v[12:15], v[176:179]
    ds_read_b128 v[244:247], v34 offset:21504
    v_mfma_f32_16x16x32_bf16 v[184:187], v[248:251], v[16:19], v[184:187]
    s_add_u32 s62, s62, 32768
    s_cmp_eq_u32 s62, s56
    s_cselect_b32 s62, s61, s62
    v_exp_f32 v199, v199
    v_mfma_f32_16x16x32_bf16 v[180:183], v[252:255], v[12:15], v[180:183]
    ds_read_b128 v[248:251], v34 offset:22528
    v_cvt_pk_bf16_f32 v61, v198, v199
    v_mfma_f32_16x16x32_bf16 v[188:191], v[252:255], v[16:19], v[188:191]
    s_sub_u32 s57, s57, 1
    s_waitcnt lgkmcnt(4)
    v_exp_f32 v200, v200
    v_mov_b32 v33, v34
    v_xad_u32 v34, m0, v42, v43
    s_cbranch_scc0 LA_P
    s_cmp_lg_u32 s99, 0
    s_cbranch_scc1 LA_D
    s_cmp_eq_u32 s59, 0
    s_cselect_b32 s62, s54, s62
    s_cselect_b32 s56, s61, -1
    s_mov_b32 s61, s91
    s_cbranch_scc1 LA_ncl3
    v_readlane_b32 s52, v41, 32
    s_add_u32 s56, s35, 131072
    s_mov_b32 s61, s35
    s_cmp_eq_u32 s52, 65
    s_cselect_b32 s62, s35, s62
    s_waitcnt vmcnt(8)
    s_and_b32 s52, s40, 31
    s_lshl_b32 s52, s52, 13
    s_lshl_b32 s53, s41, 10
    s_add_u32 s52, s52, s53
    s_add_u32 s52, s52, 70255104
    s_lshl_b32 s53, s43, 2
    s_add_u32 s52, s52, s53
    v_mov_b32 v29, 1
    s_mov_b64 s[92:93], exec
    s_mov_b64 exec, 1
    buffer_store_dword v29, off, s[20:23], s52 sc1
    s_mov_b64 exec, s[92:93]
LA_ncl3:
    s_mov_b32 s99, 1
    s_mov_b32 s57, 0
    s_cmp_ge_u32 s90, 2
    s_cbranch_scc1 LA_P
LA_D:
    s_lshl_b32 s60, s90, 5
    s_bitcmp1_b32 s90, 0
    s_cbranch_scc1 LA_X1
LA_X0:
    v_mfma_f32_16x16x32_bf16 v[208:211], v[224:227], v[64:67], 0
    ds_read_b128 v[252:255], v33 offset:23552
    v_mfma_f32_16x16x32_bf16 v[212:215], v[224:227], v[68:71], 0
    s_waitcnt vmcnt(8)
    ds_write_b32 v38, v40
    v_exp_f32 v201, v201
    v_subrev_u32 v35, s60, v36
    v_cvt_f32_i32 v35, v35
    v_mul_f32 v35, 0x71800000, v35
    s_add_u32 s60, s60, 32
    v_min_f32 v192, 0, v35
    v_mfma_f32_16x16x32_bf16 v[208:211], v[228:231], v[72:75], v[208:211]
    ds_read_b128 v[224:227], v33 offset:8192
    v_cvt_pk_bf16_f32 v58, v200, v201
    v_mfma_f32_16x16x32_bf16 v[212:215], v[228:231], v[76:79], v[212:215]
    s_waitcnt lgkmcnt(5)
    v_exp_f32 v202, v202
    v_add_f32 v193, 0xf1800000, v35
    v_min_f32 v193, 0, v193
    v_mfma_f32_16x16x32_bf16 v[208:211], v[232:235], v[80:83], v[208:211]
    ds_read_b128 v[228:231], v33 offset:9216
    v_mfma_f32_16x16x32_bf16 v[212:215], v[232:235], v[84:87], v[212:215]
    v_exp_f32 v203, v203
    v_add_f32 v194, 0xf2000000, v35
    v_min_f32 v194, 0, v194
    v_mfma_f32_16x16x32_bf16 v[208:211], v[236:239], v[88:91], v[208:211]
    ds_read_b128 v[232:235], v33 offset:10240
    v_cvt_pk_bf16_f32 v59, v202, v203
    v_mfma_f32_16x16x32_bf16 v[212:215], v[236:239], v[92:95], v[212:215]
    v_exp_f32 v204, v204
    v_add_f32 v195, 0xf2400000, v35
    v_min_f32 v195, 0, v195
    v_mfma_f32_16x16x32_bf16 v[216:219], v[240:243], v[64:67], 0
    ds_read_b128 v[236:239], v33 offset:11264
    v_mfma_f32_16x16x32_bf16 v[220:223], v[240:243], v[68:71], 0
    ds_read_b32 v41, v39
    s_waitcnt lgkmcnt(6)
    v_exp_f32 v205, v205
    v_add_f32 v196, 0x73800000, v35
    v_min_f32 v196, 0, v196
    v_mfma_f32_16x16x32_bf16 v[216:219], v[244:247], v[72:75], v[216:219]
    ds_read_b128 v[240:243], v33 offset:12288
    v_cvt_pk_bf16_f32 v62, v204, v205
    v_mfma_f32_16x16x32_bf16 v[220:223], v[244:247], v[76:79], v[220:223]
    v_exp_f32 v206, v206
    v_add_f32 v197, 0x73700000, v35
    v_min_f32 v197, 0, v197
    v_mfma_f32_16x16x32_bf16 v[216:219], v[248:251], v[80:83], v[216:219]
    ds_read_b128 v[244:247], v33 offset:13312
    v_mfma_f32_16x16x32_bf16 v[220:223], v[248:251], v[84:87], v[220:223]
    v_exp_f32 v207, v207
    v_add_f32 v198, 0x73600000, v35
    v_min_f32 v198, 0, v198
    v_mfma_f32_16x16x32_bf16 v[216:219], v[252:255], v[88:91], v[216:219]
    ds_read_b128 v[248:251], v33 offset:14336
    v_cvt_pk_bf16_f32 v63, v206, v207
    v_mfma_f32_16x16x32_bf16 v[220:223], v[252:255], v[92:95], v[220:223]
    s_waitcnt lgkmcnt(5)
    v_exp_f32 v208, v208
    v_add_f32 v199, 0x73500000, v35
    v_min_f32 v199, 0, v199
    v_mfma_f32_16x16x32_bf16 v[128:131], v[224:227], v[56:59], v[128:131]
    ds_read_b128 v[252:255], v33 offset:15360
    v_mfma_f32_16x16x32_bf16 v[136:139], v[224:227], v[60:63], v[136:139]
    s_waitcnt lgkmcnt(4)
    v_cmp_gt_u32 vcc, v40, v41
    v_exp_f32 v209, v209
    v_add_f32 v200, 0xf3800000, v35
    v_min_f32 v200, 0, v200
    s_cbranch_vccz LA_X0_s_ok
LA_X0_s_sp:
    ds_read_b32 v41, v39
    s_waitcnt lgkmcnt(0)
    v_cmp_gt_u32 vcc, v40, v41
    s_cbranch_vccnz LA_X0_s_sp
LA_X0_s_ok:
    v_mfma_f32_16x16x32_bf16 v[132:135], v[228:231], v[56:59], v[132:135]
    ds_read_b128 v[224:227], v34 offset:0
    v_cvt_pk_bf16_f32 v12, v208, v209
    v_mfma_f32_16x16x32_bf16 v[140:143], v[228:231], v[60:63], v[140:143]
    v_exp_f32 v210, v210
    v_add_f32 v201, 0xf3880000, v35
    v_min_f32 v201, 0, v201
    v_mfma_f32_16x16x32_bf16 v[144:147], v[232:235], v[56:59], v[144:147]
    ds_read_b128 v[228:231], v34 offset:1024
    v_mfma_f32_16x16x32_bf16 v[152:155], v[232:235], v[60:63], v[152:155]
    buffer_load_dwordx4 v2, s[20:23], s62 offen offset:0 sc1 lds
    s_waitcnt lgkmcnt(4)
    v_add_u32 v40, 1, v40
    v_exp_f32 v211, v211
    v_smfmac_f32_16x16x64_bf16 v[44:47], v[48:51], v[56:63], v52
    v_add_f32 v202, 0xf3900000, v35
    v_min_f32 v202, 0, v202
    v_mfma_f32_16x16x32_bf16 v[148:151], v[236:239], v[56:59], v[148:151]
    ds_read_b128 v[232:235], v34 offset:2048
    v_cvt_pk_bf16_f32 v13, v210, v211
    v_mfma_f32_16x16x32_bf16 v[156:159], v[236:239], v[60:63], v[156:159]
    v_exp_f32 v212, v212
    v_add_f32 v203, 0xf3980000, v35
    v_min_f32 v203, 0, v203
    v_mfma_f32_16x16x32_bf16 v[160:163], v[240:243], v[56:59], v[160:163]
    ds_read_b128 v[236:239], v34 offset:3072
    v_mfma_f32_16x16x32_bf16 v[168:171], v[240:243], v[60:63], v[168:171]
    buffer_load_dwordx4 v2, s[20:23], s62 offen offset:1024 sc1 lds
    v_exp_f32 v213, v213
    v_min_f32 v204, 0, v35
    v_mfma_f32_16x16x32_bf16 v[164:167], v[244:247], v[56:59], v[164:167]
    ds_read_b128 v[240:243], v34 offset:4096
    v_cvt_pk_bf16_f32 v16, v212, v213
    v_mfma_f32_16x16x32_bf16 v[172:175], v[244:247], v[60:63], v[172:175]
    s_waitcnt lgkmcnt(4)
    v_exp_f32 v214, v214
    v_add_f32 v205, 0xf1800000, v35
    v_min_f32 v205, 0, v205
    v_mfma_f32_16x16x32_bf16 v[176:179], v[248:251], v[56:59], v[176:179]
    ds_read_b128 v[244:247], v34 offset:5120
    v_mfma_f32_16x16x32_bf16 v[184:187], v[248:251], v[60:63], v[184:187]
    buffer_load_dwordx4 v2, s[20:23], s62 offen offset:2048 sc1 lds
    v_exp_f32 v215, v215
    v_add_f32 v206, 0xf2000000, v35
    v_min_f32 v206, 0, v206
    v_add_f32 v207, 0xf2400000, v35
    v_min_f32 v207, 0, v207
    v_mfma_f32_16x16x32_bf16 v[180:183], v[252:255], v[56:59], v[180:183]
    ds_read_b128 v[248:251], v34 offset:6144
    v_cvt_pk_bf16_f32 v17, v214, v215
    v_mfma_f32_16x16x32_bf16 v[188:191], v[252:255], v[60:63], v[188:191]
    v_exp_f32 v216, v216
    v_mfma_f32_16x16x32_bf16 v[192:195], v[224:227], v[64:67], v[192:195]
    ds_read_b128 v[252:255], v34 offset:7168
    v_mfma_f32_16x16x32_bf16 v[196:199], v[224:227], v[68:71], v[196:199]
    buffer_load_dwordx4 v2, s[20:23], s62 offen offset:3072 sc1 lds
    s_waitcnt lgkmcnt(4)
    v_exp_f32 v217, v217
    v_mfma_f32_16x16x32_bf16 v[192:195], v[228:231], v[72:75], v[192:195]
    ds_read_b128 v[224:227], v33 offset:24576
    v_cvt_pk_bf16_f32 v14, v216, v217
    v_mfma_f32_16x16x32_bf16 v[196:199], v[228:231], v[76:79], v[196:199]
    v_exp_f32 v218, v218
    v_mfma_f32_16x16x32_bf16 v[192:195], v[232:235], v[80:83], v[192:195]
    ds_read_b128 v[228:231], v33 offset:25600
    v_mfma_f32_16x16x32_bf16 v[196:199], v[232:235], v[84:87], v[196:199]
    s_add_u32 m0, m0, 4096
    v_exp_f32 v219, v219
    v_mfma_f32_16x16x32_bf16 v[192:195], v[236:239], v[88:91], v[192:195]
    ds_read_b128 v[232:235], v33 offset:26624
    v_cvt_pk_bf16_f32 v15, v218, v219
    v_mfma_f32_16x16x32_bf16 v[196:199], v[236:239], v[92:95], v[196:199]
    s_waitcnt lgkmcnt(4)
    v_exp_f32 v220, v220
    v_mfma_f32_16x16x32_bf16 v[200:203], v[240:243], v[64:67], v[200:203]
    ds_read_b128 v[236:239], v33 offset:27648
    v_mfma_f32_16x16x32_bf16 v[204:207], v[240:243], v[68:71], v[204:207]
    buffer_load_dwordx4 v11, s[20:23], s62 offen offset:0 sc1 lds
    v_exp_f32 v221, v221
    v_mfma_f32_16x16x32_bf16 v[200:203], v[244:247], v[72:75], v[200:203]
    ds_read_b128 v[240:243], v33 offset:28672
    v_cvt_pk_bf16_f32 v18, v220, v221
    v_mfma_f32_16x16x32_bf16 v[204:207], v[244:247], v[76:79], v[204:207]
    v_exp_f32 v222, v222
    v_mfma_f32_16x16x32_bf16 v[200:203], v[248:251], v[80:83], v[200:203]
    ds_read_b128 v[244:247], v33 offset:29696
    v_mfma_f32_16x16x32_bf16 v[204:207], v[248:251], v[84:87], v[204:207]
    buffer_load_dwordx4 v11, s[20:23], s62 offen offset:1024 sc1 lds
    s_waitcnt lgkmcnt(4)
    v_exp_f32 v223, v223
    v_mfma_f32_16x16x32_bf16 v[200:203], v[252:255], v[88:91], v[200:203]
    ds_read_b128 v[248:251], v33 offset:30720
    v_cvt_pk_bf16_f32 v19, v222, v223
    v_mfma_f32_16x16x32_bf16 v[204:207], v[252:255], v[92:95], v[204:207]
    v_exp_f32 v192, v192
    v_mfma_f32_16x16x32_bf16 v[128:131], v[224:227], v[12:15], v[128:131]
    ds_read_b128 v[252:255], v33 offset:31744
    v_mfma_f32_16x16x32_bf16 v[136:139], v[224:227], v[16:19], v[136:139]
    buffer_load_dwordx4 v11, s[20:23], s62 offen offset:2048 sc1 lds
    v_exp_f32 v193, v193
    v_mfma_f32_16x16x32_bf16 v[132:135], v[228:231], v[12:15], v[132:135]
    ds_read_b128 v[224:227], v34 offset:16384
    v_cvt_pk_bf16_f32 v56, v192, v193
    v_mfma_f32_16x16x32_bf16 v[140:143], v[228:231], v[16:19], v[140:143]
    s_waitcnt lgkmcnt(4)
    v_exp_f32 v194, v194
    v_mfma_f32_16x16x32_bf16 v[144:147], v[232:235], v[12:15], v[144:147]
    ds_read_b128 v[228:231], v34 offset:17408
    v_mfma_f32_16x16x32_bf16 v[152:155], v[232:235], v[16:19], v[152:155]
    buffer_load_dwordx4 v11, s[20:23], s62 offen offset:3072 sc1 lds
    v_exp_f32 v195, v195
    v_smfmac_f32_16x16x64_bf16 v[44:47], v[48:51], v[12:19], v52
    v_mfma_f32_16x16x32_bf16 v[148:151], v[236:239], v[12:15], v[148:151]
    ds_read_b128 v[232:235], v34 offset:18432
    v_cvt_pk_bf16_f32 v57, v194, v195
    v_mfma_f32_16x16x32_bf16 v[156:159], v[236:239], v[16:19], v[156:159]
    v_exp_f32 v196, v196
    v_mfma_f32_16x16x32_bf16 v[160:163], v[240:243], v[12:15], v[160:163]
    ds_read_b128 v[236:239], v34 offset:19456
    v_mfma_f32_16x16x32_bf16 v[168:171], v[240:243], v[16:19], v[168:171]
    s_add_u32 m0, m0, 28672
    s_and_b32 m0, m0, 0x1ffff
    s_waitcnt lgkmcnt(4)
    v_exp_f32 v197, v197
    v_mfma_f32_16x16x32_bf16 v[164:167], v[244:247], v[12:15], v[164:167]
    ds_read_b128 v[240:243], v34 offset:20480
    v_cvt_pk_bf16_f32 v60, v196, v197
    v_mfma_f32_16x16x32_bf16 v[172:175], v[244:247], v[16:19], v[172:175]
    v_exp_f32 v198, v198
    v_mfma_f32_16x16x32_bf16 v[176:179], v[248:251], v[12:15], v[176:179]
    ds_read_b128 v[244:247], v34 offset:21504
    v_mfma_f32_16x16x32_bf16 v[184:187], v[248:251], v[16:19], v[184:187]
    s_add_u32 s62, s62, 32768
    s_cmp_eq_u32 s62, s56
    s_cselect_b32 s62, s61, s62
    v_exp_f32 v199, v199
    v_mfma_f32_16x16x32_bf16 v[180:183], v[252:255], v[12:15], v[180:183]
    ds_read_b128 v[248:251], v34 offset:22528
    v_cvt_pk_bf16_f32 v61, v198, v199
    v_mfma_f32_16x16x32_bf16 v[188:191], v[252:255], v[16:19], v[188:191]
    s_waitcnt lgkmcnt(4)
    v_exp_f32 v200, v200
    v_mov_b32 v33, v34
    v_xad_u32 v34, m0, v42, v43
LA_H:
    s_waitcnt vmcnt(8) lgkmcnt(0)
    ds_write_b32 v38, v40
    ds_read_b128 v[224:227], v33 offset:8192
    ds_read_b128 v[228:231], v33 offset:9216
    ds_read_b128 v[232:235], v33 offset:10240
    ds_read_b128 v[236:239], v33 offset:11264
    ds_read_b128 v[240:243], v33 offset:12288
    ds_read_b128 v[244:247], v33 offset:13312
    ds_read_b128 v[248:251], v33 offset:14336
    ds_read_b128 v[252:255], v33 offset:15360
    s_cmp_lg_u32 s58, 0
    s_cbranch_scc1 LA_hcl
    s_cmp_lt_u32 s90, 2
    s_cbranch_scc1 LA_hcl
    s_and_b32 s52, s40, 31
    s_lshl_b32 s52, s52, 13
    s_lshl_b32 s53, s41, 10
    s_add_u32 s52, s52, s53
    s_add_u32 s52, s52, 70255104
    s_lshl_b32 s53, s43, 2
    s_add_u32 s52, s52, s53
    v_mov_b32 v29, 1
    s_mov_b64 s[92:93], exec
    s_mov_b64 exec, 1
    buffer_store_dword v29, off, s[20:23], s52 sc1
    s_mov_b64 exec, s[92:93]
LA_hcl:
    v_exp_f32 v201, v201
    v_exp_f32 v202, v202
    v_cvt_pk_bf16_f32 v58, v200, v201
    v_exp_f32 v203, v203
    v_exp_f32 v204, v204
    v_cvt_pk_bf16_f32 v59, v202, v203
    v_exp_f32 v205, v205
    v_exp_f32 v206, v206
    v_cvt_pk_bf16_f32 v62, v204, v205
    v_exp_f32 v207, v207
    s_nop 0
    v_cvt_pk_bf16_f32 v63, v206, v207
    s_nop 0
    s_waitcnt lgkmcnt(7)
    v_smfmac_f32_16x16x64_bf16 v[44:47], v[48:51], v[56:63], v52
    v_mfma_f32_16x16x32_bf16 v[128:131], v[224:227], v[56:59], v[128:131]
    v_mfma_f32_16x16x32_bf16 v[136:139], v[224:227], v[60:63], v[136:139]
    s_waitcnt lgkmcnt(6)
    v_mfma_f32_16x16x32_bf16 v[132:135], v[228:231], v[56:59], v[132:135]
    v_mfma_f32_16x16x32_bf16 v[140:143], v[228:231], v[60:63], v[140:143]
    s_waitcnt lgkmcnt(5)
    v_mfma_f32_16x16x32_bf16 v[144:147], v[232:235], v[56:59], v[144:147]
    v_mfma_f32_16x16x32_bf16 v[152:155], v[232:235], v[60:63], v[152:155]
    s_waitcnt lgkmcnt(4)
    v_mfma_f32_16x16x32_bf16 v[148:151], v[236:239], v[56:59], v[148:151]
    v_mfma_f32_16x16x32_bf16 v[156:159], v[236:239], v[60:63], v[156:159]
    s_waitcnt lgkmcnt(3)
    v_mfma_f32_16x16x32_bf16 v[160:163], v[240:243], v[56:59], v[160:163]
    v_mfma_f32_16x16x32_bf16 v[168:171], v[240:243], v[60:63], v[168:171]
    s_waitcnt lgkmcnt(2)
    v_mfma_f32_16x16x32_bf16 v[164:167], v[244:247], v[56:59], v[164:167]
    v_mfma_f32_16x16x32_bf16 v[172:175], v[244:247], v[60:63], v[172:175]
    s_waitcnt lgkmcnt(1)
    v_mfma_f32_16x16x32_bf16 v[176:179], v[248:251], v[56:59], v[176:179]
    v_mfma_f32_16x16x32_bf16 v[184:187], v[248:251], v[60:63], v[184:187]
    s_waitcnt lgkmcnt(0)
    v_mfma_f32_16x16x32_bf16 v[180:183], v[252:255], v[56:59], v[180:183]
    v_mfma_f32_16x16x32_bf16 v[188:191], v[252:255], v[60:63], v[188:191]
LA_H_sp:
    ds_read_b32 v41, v39
    s_waitcnt lgkmcnt(0)
    v_cmp_gt_u32 vcc, v40, v41
    s_cbranch_vccz LA_H_ok
    s_sleep 1
    s_branch LA_H_sp
LA_H_ok:
    buffer_load_dwordx4 v2, s[20:23], s62 offen offset:0 sc1 lds
    buffer_load_dwordx4 v2, s[20:23], s62 offen offset:1024 sc1 lds
    buffer_load_dwordx4 v2, s[20:23], s62 offen offset:2048 sc1 lds
    buffer_load_dwordx4 v2, s[20:23], s62 offen offset:3072 sc1 lds
    s_add_u32 m0, m0, 4096
    s_nop 0
    buffer_load_dwordx4 v11, s[20:23], s62 offen offset:0 sc1 lds
    buffer_load_dwordx4 v11, s[20:23], s62 offen offset:1024 sc1 lds
    buffer_load_dwordx4 v11, s[20:23], s62 offen offset:2048 sc1 lds
    buffer_load_dwordx4 v11, s[20:23], s62 offen offset:3072 sc1 lds
    s_add_u32 m0, m0, 28672
    s_and_b32 m0, m0, 0x1ffff
    s_add_u32 s62, s62, 32768
    s_cmp_eq_u32 s62, s56
    s_cselect_b32 s62, s61, s62
    v_add_u32 v40, 1, v40
    v_mov_b32 v33, v34
    v_xad_u32 v34, m0, v42, v43
    s_branch LA_fin
LA_X1:
    v_mfma_f32_16x16x32_bf16 v[208:211], v[224:227], v[64:67], 0
    ds_read_b128 v[252:255], v33 offset:23552
    v_mfma_f32_16x16x32_bf16 v[212:215], v[224:227], v[68:71], 0
    s_waitcnt vmcnt(8)
    ds_write_b32 v38, v40
    v_exp_f32 v201, v201
    v_mfma_f32_16x16x32_bf16 v[208:211], v[228:231], v[72:75], v[208:211]
    ds_read_b128 v[224:227], v33 offset:8192
    v_cvt_pk_bf16_f32 v58, v200, v201
    v_mfma_f32_16x16x32_bf16 v[212:215], v[228:231], v[76:79], v[212:215]
    s_waitcnt lgkmcnt(5)
    v_exp_f32 v202, v202
    v_mfma_f32_16x16x32_bf16 v[208:211], v[232:235], v[80:83], v[208:211]
    ds_read_b128 v[228:231], v33 offset:9216
    v_mfma_f32_16x16x32_bf16 v[212:215], v[232:235], v[84:87], v[212:215]
    v_exp_f32 v203, v203
    v_mfma_f32_16x16x32_bf16 v[208:211], v[236:239], v[88:91], v[208:211]
    ds_read_b128 v[232:235], v33 offset:10240
    v_cvt_pk_bf16_f32 v59, v202, v203
    v_mfma_f32_16x16x32_bf16 v[212:215], v[236:239], v[92:95], v[212:215]
    v_exp_f32 v204, v204
    v_mfma_f32_16x16x32_bf16 v[216:219], v[240:243], v[64:67], 0
    ds_read_b128 v[236:239], v33 offset:11264
    v_mfma_f32_16x16x32_bf16 v[220:223], v[240:243], v[68:71], 0
    ds_read_b32 v41, v39
    s_waitcnt lgkmcnt(6)
    v_exp_f32 v205, v205
    v_mfma_f32_16x16x32_bf16 v[216:219], v[244:247], v[72:75], v[216:219]
    ds_read_b128 v[240:243], v33 offset:12288
    v_cvt_pk_bf16_f32 v62, v204, v205
    v_mfma_f32_16x16x32_bf16 v[220:223], v[244:247], v[76:79], v[220:223]
    v_exp_f32 v206, v206
    v_mfma_f32_16x16x32_bf16 v[216:219], v[248:251], v[80:83], v[216:219]
    ds_read_b128 v[244:247], v33 offset:13312
    v_mfma_f32_16x16x32_bf16 v[220:223], v[248:251], v[84:87], v[220:223]
    v_exp_f32 v207, v207
    v_mfma_f32_16x16x32_bf16 v[216:219], v[252:255], v[88:91], v[216:219]
    ds_read_b128 v[248:251], v33 offset:14336
    v_cvt_pk_bf16_f32 v63, v206, v207
    v_mfma_f32_16x16x32_bf16 v[220:223], v[252:255], v[92:95], v[220:223]
    s_waitcnt lgkmcnt(5)
    v_exp_f32 v208, v208
    v_mfma_f32_16x16x32_bf16 v[128:131], v[224:227], v[56:59], v[128:131]
    ds_read_b128 v[252:255], v33 offset:15360
    v_mfma_f32_16x16x32_bf16 v[136:139], v[224:227], v[60:63], v[136:139]
    s_waitcnt lgkmcnt(4)
    v_cmp_gt_u32 vcc, v40, v41
    v_exp_f32 v209, v209
    s_cbranch_vccz LA_X1_s_ok
LA_X1_s_sp:
    ds_read_b32 v41, v39
    s_waitcnt lgkmcnt(0)
    v_cmp_gt_u32 vcc, v40, v41
    s_cbranch_vccnz LA_X1_s_sp
LA_X1_s_ok:
    v_mfma_f32_16x16x32_bf16 v[132:135], v[228:231], v[56:59], v[132:135]
    ds_read_b128 v[224:227], v34 offset:0
    v_cvt_pk_bf16_f32 v12, v208, v209
    v_mfma_f32_16x16x32_bf16 v[140:143], v[228:231], v[60:63], v[140:143]
    v_exp_f32 v210, v210
    v_mfma_f32_16x16x32_bf16 v[144:147], v[232:235], v[56:59], v[144:147]
    ds_read_b128 v[228:231], v34 offset:1024
    v_mfma_f32_16x16x32_bf16 v[152:155], v[232:235], v[60:63], v[152:155]
    buffer_load_dwordx4 v2, s[20:23], s62 offen offset:0 sc1 lds
    s_waitcnt lgkmcnt(4)
    v_add_u32 v40, 1, v40
    v_exp_f32 v211, v211
    v_smfmac_f32_16x16x64_bf16 v[44:47], v[48:51], v[56:63], v52
    v_mfma_f32_16x16x32_bf16 v[148:151], v[236:239], v[56:59], v[148:151]
    ds_read_b128 v[232:235], v34 offset:2048
    v_cvt_pk_bf16_f32 v13, v210, v211
    v_mfma_f32_16x16x32_bf16 v[156:159], v[236:239], v[60:63], v[156:159]
    v_exp_f32 v212, v212
    v_mfma_f32_16x16x32_bf16 v[160:163], v[240:243], v[56:59], v[160:163]
    ds_read_b128 v[236:239], v34 offset:3072
    v_mfma_f32_16x16x32_bf16 v[168:171], v[240:243], v[60:63], v[168:171]
    buffer_load_dwordx4 v2, s[20:23], s62 offen offset:1024 sc1 lds
    v_exp_f32 v213, v213
    v_mfma_f32_16x16x32_bf16 v[164:167], v[244:247], v[56:59], v[164:167]
    ds_read_b128 v[240:243], v34 offset:4096
    v_cvt_pk_bf16_f32 v16, v212, v213
    v_mfma_f32_16x16x32_bf16 v[172:175], v[244:247], v[60:63], v[172:175]
    s_waitcnt lgkmcnt(4)
    v_exp_f32 v214, v214
    v_mfma_f32_16x16x32_bf16 v[176:179], v[248:251], v[56:59], v[176:179]
    ds_read_b128 v[244:247], v34 offset:5120
    v_mfma_f32_16x16x32_bf16 v[184:187], v[248:251], v[60:63], v[184:187]
    buffer_load_dwordx4 v2, s[20:23], s62 offen offset:2048 sc1 lds
    v_exp_f32 v215, v215
    v_mfma_f32_16x16x32_bf16 v[180:183], v[252:255], v[56:59], v[180:183]
    ds_read_b128 v[248:251], v34 offset:6144
    v_cvt_pk_bf16_f32 v17, v214, v215
    v_mfma_f32_16x16x32_bf16 v[188:191], v[252:255], v[60:63], v[188:191]
    v_exp_f32 v216, v216
    v_mfma_f32_16x16x32_bf16 v[192:195], v[224:227], v[64:67], 0
    ds_read_b128 v[252:255], v34 offset:7168
    v_mfma_f32_16x16x32_bf16 v[196:199], v[224:227], v[68:71], 0
    buffer_load_dwordx4 v2, s[20:23], s62 offen offset:3072 sc1 lds
    s_waitcnt lgkmcnt(4)
    v_exp_f32 v217, v217
    v_subrev_u32 v35, s60, v36
    v_cvt_f32_i32 v35, v35
    v_mul_f32 v35, 0x71800000, v35
    s_add_u32 s60, s60, 32
    v_min_f32 v208, 0, v35
    v_mfma_f32_16x16x32_bf16 v[192:195], v[228:231], v[72:75], v[192:195]
    ds_read_b128 v[224:227], v33 offset:24576
    v_cvt_pk_bf16_f32 v14, v216, v217
    v_mfma_f32_16x16x32_bf16 v[196:199], v[228:231], v[76:79], v[196:199]
    v_exp_f32 v218, v218
    v_add_f32 v209, 0xf1800000, v35
    v_min_f32 v209, 0, v209
    v_mfma_f32_16x16x32_bf16 v[192:195], v[232:235], v[80:83], v[192:195]
    ds_read_b128 v[228:231], v33 offset:25600
    v_mfma_f32_16x16x32_bf16 v[196:199], v[232:235], v[84:87], v[196:199]
    s_add_u32 m0, m0, 4096
    v_exp_f32 v219, v219
    v_add_f32 v210, 0xf2000000, v35
    v_min_f32 v210, 0, v210
    v_mfma_f32_16x16x32_bf16 v[192:195], v[236:239], v[88:91], v[192:195]
    ds_read_b128 v[232:235], v33 offset:26624
    v_cvt_pk_bf16_f32 v15, v218, v219
    v_mfma_f32_16x16x32_bf16 v[196:199], v[236:239], v[92:95], v[196:199]
    s_waitcnt lgkmcnt(4)
    v_exp_f32 v220, v220
    v_add_f32 v211, 0xf2400000, v35
    v_min_f32 v211, 0, v211
    v_mfma_f32_16x16x32_bf16 v[200:203], v[240:243], v[64:67], 0
    ds_read_b128 v[236:239], v33 offset:27648
    v_mfma_f32_16x16x32_bf16 v[204:207], v[240:243], v[68:71], 0
    buffer_load_dwordx4 v11, s[20:23], s62 offen offset:0 sc1 lds
    v_exp_f32 v221, v221
    v_add_f32 v212, 0x73800000, v35
    v_min_f32 v212, 0, v212
    v_mfma_f32_16x16x32_bf16 v[200:203], v[244:247], v[72:75], v[200:203]
    ds_read_b128 v[240:243], v33 offset:28672
    v_cvt_pk_bf16_f32 v18, v220, v221
    v_mfma_f32_16x16x32_bf16 v[204:207], v[244:247], v[76:79], v[204:207]
    v_exp_f32 v222, v222
    v_add_f32 v213, 0x73700000, v35
    v_min_f32 v213, 0, v213
    v_mfma_f32_16x16x32_bf16 v[200:203], v[248:251], v[80:83], v[200:203]
    ds_read_b128 v[244:247], v33 offset:29696
    v_mfma_f32_16x16x32_bf16 v[204:207], v[248:251], v[84:87], v[204:207]
    buffer_load_dwordx4 v11, s[20:23], s62 offen offset:1024 sc1 lds
    s_waitcnt lgkmcnt(4)
    v_exp_f32 v223, v223
    v_add_f32 v214, 0x73600000, v35
    v_min_f32 v214, 0, v214
    v_mfma_f32_16x16x32_bf16 v[200:203], v[252:255], v[88:91], v[200:203]
    ds_read_b128 v[248:251], v33 offset:30720
    v_cvt_pk_bf16_f32 v19, v222, v223
    v_mfma_f32_16x16x32_bf16 v[204:207], v[252:255], v[92:95], v[204:207]
    v_exp_f32 v192, v192
    v_add_f32 v215, 0x73500000, v35
    v_min_f32 v215, 0, v215
    v_mfma_f32_16x16x32_bf16 v[128:131], v[224:227], v[12:15], v[128:131]
    ds_read_b128 v[252:255], v33 offset:31744
    v_mfma_f32_16x16x32_bf16 v[136:139], v[224:227], v[16:19], v[136:139]
    buffer_load_dwordx4 v11, s[20:23], s62 offen offset:2048 sc1 lds
    v_exp_f32 v193, v193
    v_add_f32 v216, 0xf3800000, v35
    v_min_f32 v216, 0, v216
    v_mfma_f32_16x16x32_bf16 v[132:135], v[228:231], v[12:15], v[132:135]
    ds_read_b128 v[224:227], v34 offset:16384
    v_cvt_pk_bf16_f32 v56, v192, v193
    v_mfma_f32_16x16x32_bf16 v[140:143], v[228:231], v[16:19], v[140:143]
    s_waitcnt lgkmcnt(4)
    v_exp_f32 v194, v194
    v_add_f32 v217, 0xf3880000, v35
    v_min_f32 v217, 0, v217
    v_mfma_f32_16x16x32_bf16 v[144:147], v[232:235], v[12:15], v[144:147]
    ds_read_b128 v[228:231], v34 offset:17408
    v_mfma_f32_16x16x32_bf16 v[152:155], v[232:235], v[16:19], v[152:155]
    buffer_load_dwordx4 v11, s[20:23], s62 offen offset:3072 sc1 lds
    v_exp_f32 v195, v195
    v_smfmac_f32_16x16x64_bf16 v[44:47], v[48:51], v[12:19], v52
    v_add_f32 v218, 0xf3900000, v35
    v_min_f32 v218, 0, v218
    v_mfma_f32_16x16x32_bf16 v[148:151], v[236:239], v[12:15], v[148:151]
    ds_read_b128 v[232:235], v34 offset:18432
    v_cvt_pk_bf16_f32 v57, v194, v195
    v_mfma_f32_16x16x32_bf16 v[156:159], v[236:239], v[16:19], v[156:159]
    v_exp_f32 v196, v196
    v_add_f32 v219, 0xf3980000, v35
    v_min_f32 v219, 0, v219
    v_mfma_f32_16x16x32_bf16 v[160:163], v[240:243], v[12:15], v[160:163]
    ds_read_b128 v[236:239], v34 offset:19456
    v_mfma_f32_16x16x32_bf16 v[168:171], v[240:243], v[16:19], v[168:171]
    s_add_u32 m0, m0, 28672
    s_and_b32 m0, m0, 0x1ffff
    s_waitcnt lgkmcnt(4)
    v_exp_f32 v197, v197
    v_min_f32 v220, 0, v35
    v_mfma_f32_16x16x32_bf16 v[164:167], v[244:247], v[12:15], v[164:167]
    ds_read_b128 v[240:243], v34 offset:20480
    v_cvt_pk_bf16_f32 v60, v196, v197
    v_mfma_f32_16x16x32_bf16 v[172:175], v[244:247], v[16:19], v[172:175]
    v_exp_f32 v198, v198
    v_add_f32 v221, 0xf1800000, v35
    v_min_f32 v221, 0, v221
    v_mfma_f32_16x16x32_bf16 v[176:179], v[248:251], v[12:15], v[176:179]
    ds_read_b128 v[244:247], v34 offset:21504
    v_mfma_f32_16x16x32_bf16 v[184:187], v[248:251], v[16:19], v[184:187]
    s_add_u32 s62, s62, 32768
    s_cmp_eq_u32 s62, s56
    s_cselect_b32 s62, s61, s62
    v_exp_f32 v199, v199
    v_add_f32 v222, 0xf2000000, v35
    v_min_f32 v222, 0, v222
    v_add_f32 v223, 0xf2400000, v35
    v_min_f32 v223, 0, v223
    v_mfma_f32_16x16x32_bf16 v[180:183], v[252:255], v[12:15], v[180:183]
    ds_read_b128 v[248:251], v34 offset:22528
    v_cvt_pk_bf16_f32 v61, v198, v199
    v_mfma_f32_16x16x32_bf16 v[188:191], v[252:255], v[16:19], v[188:191]
    s_waitcnt lgkmcnt(4)
    v_exp_f32 v200, v200
    v_mov_b32 v33, v34
    v_xad_u32 v34, m0, v42, v43
LA_F:
    v_mfma_f32_16x16x32_bf16 v[208:211], v[224:227], v[64:67], v[208:211]
    ds_read_b128 v[252:255], v33 offset:23552
    v_mfma_f32_16x16x32_bf16 v[212:215], v[224:227], v[68:71], v[212:215]
    s_waitcnt vmcnt(8)
    ds_write_b32 v38, v40
    v_exp_f32 v201, v201
    v_mfma_f32_16x16x32_bf16 v[208:211], v[228:231], v[72:75], v[208:211]
    ds_read_b128 v[224:227], v33 offset:8192
    v_cvt_pk_bf16_f32 v58, v200, v201
    v_mfma_f32_16x16x32_bf16 v[212:215], v[228:231], v[76:79], v[212:215]
    s_cmp_lg_u32 s58, 0
    s_cbranch_scc1 LA_ncl
    s_cmp_lt_u32 s90, 2
    s_cbranch_scc1 LA_ncl
    s_and_b32 s52, s40, 31
    s_lshl_b32 s52, s52, 13
    s_lshl_b32 s53, s41, 10
    s_add_u32 s52, s52, s53
    s_add_u32 s52, s52, 70255104
    s_lshl_b32 s53, s43, 2
    s_add_u32 s52, s52, s53
    v_mov_b32 v29, 1
    s_mov_b64 s[92:93], exec
    s_mov_b64 exec, 1
    buffer_store_dword v29, off, s[20:23], s52 sc1
    s_mov_b64 exec, s[92:93]
LA_ncl:
    v_exp_f32 v202, v202
    v_mfma_f32_16x16x32_bf16 v[208:211], v[232:235], v[80:83], v[208:211]
    ds_read_b128 v[228:231], v33 offset:9216
    v_mfma_f32_16x16x32_bf16 v[212:215], v[232:235], v[84:87], v[212:215]
    v_exp_f32 v203, v203
    s_waitcnt lgkmcnt(7)
    v_mfma_f32_16x16x32_bf16 v[208:211], v[236:239], v[88:91], v[208:211]
    ds_read_b128 v[232:235], v33 offset:10240
    v_cvt_pk_bf16_f32 v59, v202, v203
    v_mfma_f32_16x16x32_bf16 v[212:215], v[236:239], v[92:95], v[212:215]
    v_exp_f32 v204, v204
    s_waitcnt lgkmcnt(7)
    v_mfma_f32_16x16x32_bf16 v[216:219], v[240:243], v[64:67], v[216:219]
    ds_read_b128 v[236:239], v33 offset:11264
    v_mfma_f32_16x16x32_bf16 v[220:223], v[240:243], v[68:71], v[220:223]
    ds_read_b32 v41, v39
    v_exp_f32 v205, v205
    s_waitcnt lgkmcnt(8)
    v_mfma_f32_16x16x32_bf16 v[216:219], v[244:247], v[72:75], v[216:219]
    ds_read_b128 v[240:243], v33 offset:12288
    v_cvt_pk_bf16_f32 v62, v204, v205
    v_mfma_f32_16x16x32_bf16 v[220:223], v[244:247], v[76:79], v[220:223]
    v_exp_f32 v206, v206
    s_waitcnt lgkmcnt(8)
    v_mfma_f32_16x16x32_bf16 v[216:219], v[248:251], v[80:83], v[216:219]
    ds_read_b128 v[244:247], v33 offset:13312
    v_mfma_f32_16x16x32_bf16 v[220:223], v[248:251], v[84:87], v[220:223]
    v_exp_f32 v207, v207
    s_waitcnt lgkmcnt(8)
    v_mfma_f32_16x16x32_bf16 v[216:219], v[252:255], v[88:91], v[216:219]
    ds_read_b128 v[248:251], v33 offset:14336
    v_cvt_pk_bf16_f32 v63, v206, v207
    v_mfma_f32_16x16x32_bf16 v[220:223], v[252:255], v[92:95], v[220:223]
    v_exp_f32 v208, v208
    s_waitcnt lgkmcnt(7)
    v_mfma_f32_16x16x32_bf16 v[128:131], v[224:227], v[56:59], v[128:131]
    ds_read_b128 v[252:255], v33 offset:15360
    v_mfma_f32_16x16x32_bf16 v[136:139], v[224:227], v[60:63], v[136:139]
    s_waitcnt lgkmcnt(4)
    v_cmp_gt_u32 vcc, v40, v41
    v_exp_f32 v209, v209
    s_cbranch_vccz LA_F_s_ok
LA_F_s_sp:
    ds_read_b32 v41, v39
    s_waitcnt lgkmcnt(0)
    v_cmp_gt_u32 vcc, v40, v41
    s_cbranch_vccnz LA_F_s_sp
LA_F_s_ok:
    v_mfma_f32_16x16x32_bf16 v[132:135], v[228:231], v[56:59], v[132:135]
    ds_read_b128 v[224:227], v33 offset:24576
    v_cvt_pk_bf16_f32 v12, v208, v209
    v_mfma_f32_16x16x32_bf16 v[140:143], v[228:231], v[60:63], v[140:143]
    buffer_load_dwordx4 v2, s[20:23], s62 offen offset:0 sc1 lds
    v_exp_f32 v210, v210
    v_mfma_f32_16x16x32_bf16 v[144:147], v[232:235], v[56:59], v[144:147]
    ds_read_b128 v[228:231], v33 offset:25600
    v_mfma_f32_16x16x32_bf16 v[152:155], v[232:235], v[60:63], v[152:155]
    buffer_load_dwordx4 v2, s[20:23], s62 offen offset:1024 sc1 lds
    v_add_u32 v40, 1, v40
    v_exp_f32 v211, v211
    v_smfmac_f32_16x16x64_bf16 v[44:47], v[48:51], v[56:63], v52
    v_mfma_f32_16x16x32_bf16 v[148:151], v[236:239], v[56:59], v[148:151]
    ds_read_b128 v[232:235], v33 offset:26624
    v_cvt_pk_bf16_f32 v13, v210, v211
    v_mfma_f32_16x16x32_bf16 v[156:159], v[236:239], v[60:63], v[156:159]
    buffer_load_dwordx4 v2, s[20:23], s62 offen offset:2048 sc1 lds
    v_exp_f32 v212, v212
    s_waitcnt lgkmcnt(6)
    v_mfma_f32_16x16x32_bf16 v[160:163], v[240:243], v[56:59], v[160:163]
    ds_read_b128 v[236:239], v33 offset:27648
    v_mfma_f32_16x16x32_bf16 v[168:171], v[240:243], v[60:63], v[168:171]
    buffer_load_dwordx4 v2, s[20:23], s62 offen offset:3072 sc1 lds
    v_exp_f32 v213, v213
    s_waitcnt lgkmcnt(6)
    v_mfma_f32_16x16x32_bf16 v[164:167], v[244:247], v[56:59], v[164:167]
    ds_read_b128 v[240:243], v33 offset:28672
    v_cvt_pk_bf16_f32 v16, v212, v213
    v_mfma_f32_16x16x32_bf16 v[172:175], v[244:247], v[60:63], v[172:175]
    s_add_u32 m0, m0, 4096
    v_exp_f32 v214, v214
    s_waitcnt lgkmcnt(6)
    v_mfma_f32_16x16x32_bf16 v[176:179], v[248:251], v[56:59], v[176:179]
    ds_read_b128 v[244:247], v33 offset:29696
    v_mfma_f32_16x16x32_bf16 v[184:187], v[248:251], v[60:63], v[184:187]
    buffer_load_dwordx4 v11, s[20:23], s62 offen offset:0 sc1 lds
    v_exp_f32 v215, v215
    s_waitcnt lgkmcnt(6)
    v_mfma_f32_16x16x32_bf16 v[180:183], v[252:255], v[56:59], v[180:183]
    ds_read_b128 v[248:251], v33 offset:30720
    v_cvt_pk_bf16_f32 v17, v214, v215
    v_mfma_f32_16x16x32_bf16 v[188:191], v[252:255], v[60:63], v[188:191]
    buffer_load_dwordx4 v11, s[20:23], s62 offen offset:1024 sc1 lds
    v_exp_f32 v216, v216
    s_nop 0
    v_exp_f32 v217, v217
    s_nop 0
    v_cvt_pk_bf16_f32 v14, v216, v217
    v_exp_f32 v218, v218
    s_nop 0
    v_exp_f32 v219, v219
    s_nop 0
    v_cvt_pk_bf16_f32 v15, v218, v219
    v_exp_f32 v220, v220
    s_nop 0
    v_exp_f32 v221, v221
    s_nop 0
    v_cvt_pk_bf16_f32 v18, v220, v221
    v_exp_f32 v222, v222
    s_nop 0
    v_exp_f32 v223, v223
    s_nop 0
    v_cvt_pk_bf16_f32 v19, v222, v223
    s_nop 1
    s_waitcnt lgkmcnt(6)
    v_mfma_f32_16x16x32_bf16 v[128:131], v[224:227], v[12:15], v[128:131]
    ds_read_b128 v[252:255], v33 offset:31744
    v_mfma_f32_16x16x32_bf16 v[136:139], v[224:227], v[16:19], v[136:139]
    buffer_load_dwordx4 v11, s[20:23], s62 offen offset:2048 sc1 lds
    s_waitcnt lgkmcnt(6)
    v_mfma_f32_16x16x32_bf16 v[132:135], v[228:231], v[12:15], v[132:135]
    v_mfma_f32_16x16x32_bf16 v[140:143], v[228:231], v[16:19], v[140:143]
    buffer_load_dwordx4 v11, s[20:23], s62 offen offset:3072 sc1 lds
    s_waitcnt lgkmcnt(5)
    v_mfma_f32_16x16x32_bf16 v[144:147], v[232:235], v[12:15], v[144:147]
    v_mfma_f32_16x16x32_bf16 v[152:155], v[232:235], v[16:19], v[152:155]
    v_smfmac_f32_16x16x64_bf16 v[44:47], v[48:51], v[12:19], v52
    s_waitcnt lgkmcnt(4)
    v_mfma_f32_16x16x32_bf16 v[148:151], v[236:239], v[12:15], v[148:151]
    v_mfma_f32_16x16x32_bf16 v[156:159], v[236:239], v[16:19], v[156:159]
    s_waitcnt lgkmcnt(3)
    v_mfma_f32_16x16x32_bf16 v[160:163], v[240:243], v[12:15], v[160:163]
    v_mfma_f32_16x16x32_bf16 v[168:171], v[240:243], v[16:19], v[168:171]
    s_add_u32 m0, m0, 28672
    s_and_b32 m0, m0, 0x1ffff
    s_waitcnt lgkmcnt(2)
    v_mfma_f32_16x16x32_bf16 v[164:167], v[244:247], v[12:15], v[164:167]
    v_mfma_f32_16x16x32_bf16 v[172:175], v[244:247], v[16:19], v[172:175]
    s_waitcnt lgkmcnt(1)
    v_mfma_f32_16x16x32_bf16 v[176:179], v[248:251], v[12:15], v[176:179]
    v_mfma_f32_16x16x32_bf16 v[184:187], v[248:251], v[16:19], v[184:187]
    s_add_u32 s62, s62, 32768
    s_cmp_eq_u32 s62, s56
    s_cselect_b32 s62, s61, s62
    s_waitcnt lgkmcnt(0)
    v_mfma_f32_16x16x32_bf16 v[180:183], v[252:255], v[12:15], v[180:183]
    v_mfma_f32_16x16x32_bf16 v[188:191], v[252:255], v[16:19], v[188:191]
    v_mov_b32 v33, v34
    v_xad_u32 v34, m0, v42, v43
LA_fin:
    s_cmp_ge_u32 s90, 2
    s_cbranch_scc1 LA_n1
    s_waitcnt vmcnt(8)
    ds_write_b32 v38, v40
    s_cmp_lg_u32 s58, 0
    s_cbranch_scc1 LA_ncl1
    s_and_b32 s52, s40, 31
    s_lshl_b32 s52, s52, 13
    s_lshl_b32 s53, s41, 10
    s_add_u32 s52, s52, s53
    s_add_u32 s52, s52, 70255104
    s_lshl_b32 s53, s43, 2
    s_add_u32 s52, s52, s53
    v_mov_b32 v29, 1
    s_mov_b64 s[92:93], exec
    s_mov_b64 exec, 1
    buffer_store_dword v29, off, s[20:23], s52 sc1
    s_mov_b64 exec, s[92:93]
LA_ncl1:
LA_n1:
    s_cmp_eq_u32 s59, 0
    s_cbranch_scc1 LA_nd
    v_mov_b32 v24, 35
    ds_write_b32 v38, v24
    v_readlane_b32 s47, v41, 32
LA_nd:
    v_mov_b32 v27, 0
    v_add_f32 v20, v44, v45
    v_add_f32 v21, v46, v47
    v_maximum3_f32 v27, abs(v128), abs(v129), v27
    v_maximum3_f32 v27, abs(v130), abs(v131), v27
    v_maximum3_f32 v27, abs(v132), abs(v133), v27
    v_maximum3_f32 v27, abs(v134), abs(v135), v27
    v_maximum3_f32 v27, abs(v136), abs(v137), v27
    v_maximum3_f32 v27, abs(v138), abs(v139), v27
    v_maximum3_f32 v27, abs(v140), abs(v141), v27
    v_maximum3_f32 v27, abs(v142), abs(v143), v27
    v_maximum3_f32 v27, abs(v144), abs(v145), v27
    v_maximum3_f32 v27, abs(v146), abs(v147), v27
    v_maximum3_f32 v27, abs(v148), abs(v149), v27
    v_maximum3_f32 v27, abs(v150), abs(v151), v27
    v_maximum3_f32 v27, abs(v152), abs(v153), v27
    v_maximum3_f32 v27, abs(v154), abs(v155), v27
    v_maximum3_f32 v27, abs(v156), abs(v157), v27
    v_maximum3_f32 v27, abs(v158), abs(v159), v27
    v_maximum3_f32 v27, abs(v160), abs(v161), v27
    v_maximum3_f32 v27, abs(v162), abs(v163), v27
    v_maximum3_f32 v27, abs(v164), abs(v165), v27
    v_maximum3_f32 v27, abs(v166), abs(v167), v27
    v_maximum3_f32 v27, abs(v168), abs(v169), v27
    v_maximum3_f32 v27, abs(v170), abs(v171), v27
    v_maximum3_f32 v27, abs(v172), abs(v173), v27
    v_maximum3_f32 v27, abs(v174), abs(v175), v27
    v_maximum3_f32 v27, abs(v176), abs(v177), v27
    v_maximum3_f32 v27, abs(v178), abs(v179), v27
    v_maximum3_f32 v27, abs(v180), abs(v181), v27
    v_maximum3_f32 v27, abs(v182), abs(v183), v27
    v_maximum3_f32 v27, abs(v184), abs(v185), v27
    v_maximum3_f32 v27, abs(v186), abs(v187), v27
    v_maximum3_f32 v27, abs(v188), abs(v189), v27
    v_maximum3_f32 v27, abs(v190), abs(v191), v27
    v_mov_b32 v24, 0x21800000
    v_mov_b32 v25, 0x71800000
    v_mov_b32 v26, 0x7e800000
    v_cmp_nge_f32 vcc, v20, v24
    v_cmp_nle_f32 s[92:93], v20, v25
    s_nop 1
    s_or_b64 s[92:93], s[92:93], vcc
    v_cmp_nlt_f32 vcc, v27, v26
    s_nop 1
    s_or_b64 vcc, s[92:93], vcc
    s_cbranch_vccnz LA_fb
    v_cmp_nge_f32 vcc, v21, v24
    v_cmp_nle_f32 s[92:93], v21, v25
    s_nop 1
    s_or_b64 s[92:93], s[92:93], vcc
    v_cmp_nlt_f32 vcc, v27, v26
    s_nop 1
    s_or_b64 vcc, s[92:93], vcc
    s_cbranch_vccnz LA_fb
LA_norm:
    v_rcp_f32 v22, v20
    v_rcp_f32 v23, v21
    s_lshr_b32 s50, s40, 3
    s_mul_i32 s50, s50, 72
    s_and_b32 s51, s40, 7
    s_lshl_b32 s51, s51, 3
    s_add_u32 s50, s50, s51
    s_lshl_b32 s50, s50, 12
    s_mul_i32 s51, s58, 1179648
    s_add_u32 s50, s50, s51
    s_lshl_b32 s51, s90, 10
    s_add_u32 s50, s50, s51
    s_add_u32 s50, s50, 41943040
    v_mul_f32 v128, v22, v128
    v_mul_f32 v129, v22, v129
    v_mul_f32 v130, v22, v130
    v_mul_f32 v131, v22, v131
    v_mul_f32 v132, v22, v132
    v_mul_f32 v133, v22, v133
    v_mul_f32 v134, v22, v134
    v_mul_f32 v135, v22, v135
    v_mul_f32 v136, v23, v136
    v_mul_f32 v137, v23, v137
    v_mul_f32 v138, v23, v138
    v_mul_f32 v139, v23, v139
    v_mul_f32 v140, v23, v140
    v_mul_f32 v141, v23, v141
    v_mul_f32 v142, v23, v142
    v_mul_f32 v143, v23, v143
    v_cvt_pk_bf16_f32 v128, v128, v129
    v_cvt_pk_bf16_f32 v129, v130, v131
    v_cvt_pk_bf16_f32 v130, v132, v133
    v_cvt_pk_bf16_f32 v131, v134, v135
    v_cvt_pk_bf16_f32 v132, v136, v137
    v_cvt_pk_bf16_f32 v133, v138, v139
    v_cvt_pk_bf16_f32 v134, v140, v141
    v_cvt_pk_bf16_f32 v135, v142, v143
    buffer_store_dwordx4 v[128:131], v9, s[20:23], s50 offen offset:0 sc1
    buffer_store_dwordx4 v[132:135], v9, s[20:23], s50 offen offset:256 sc1
    s_add_u32 s50, s50, 8192
    v_mul_f32 v144, v22, v144
    v_mul_f32 v145, v22, v145
    v_mul_f32 v146, v22, v146
    v_mul_f32 v147, v22, v147
    v_mul_f32 v148, v22, v148
    v_mul_f32 v149, v22, v149
    v_mul_f32 v150, v22, v150
    v_mul_f32 v151, v22, v151
    v_mul_f32 v152, v23, v152
    v_mul_f32 v153, v23, v153
    v_mul_f32 v154, v23, v154
    v_mul_f32 v155, v23, v155
    v_mul_f32 v156, v23, v156
    v_mul_f32 v157, v23, v157
    v_mul_f32 v158, v23, v158
    v_mul_f32 v159, v23, v159
    v_cvt_pk_bf16_f32 v144, v144, v145
    v_cvt_pk_bf16_f32 v145, v146, v147
    v_cvt_pk_bf16_f32 v146, v148, v149
    v_cvt_pk_bf16_f32 v147, v150, v151
    v_cvt_pk_bf16_f32 v148, v152, v153
    v_cvt_pk_bf16_f32 v149, v154, v155
    v_cvt_pk_bf16_f32 v150, v156, v157
    v_cvt_pk_bf16_f32 v151, v158, v159
    buffer_store_dwordx4 v[144:147], v9, s[20:23], s50 offen offset:0 sc1
    buffer_store_dwordx4 v[148:151], v9, s[20:23], s50 offen offset:256 sc1
    s_add_u32 s50, s50, 8192
    v_mul_f32 v160, v22, v160
    v_mul_f32 v161, v22, v161
    v_mul_f32 v162, v22, v162
    v_mul_f32 v163, v22, v163
    v_mul_f32 v164, v22, v164
    v_mul_f32 v165, v22, v165
    v_mul_f32 v166, v22, v166
    v_mul_f32 v167, v22, v167
    v_mul_f32 v168, v23, v168
    v_mul_f32 v169, v23, v169
    v_mul_f32 v170, v23, v170
    v_mul_f32 v171, v23, v171
    v_mul_f32 v172, v23, v172
    v_mul_f32 v173, v23, v173
    v_mul_f32 v174, v23, v174
    v_mul_f32 v175, v23, v175
    v_cvt_pk_bf16_f32 v160, v160, v161
    v_cvt_pk_bf16_f32 v161, v162, v163
    v_cvt_pk_bf16_f32 v162, v164, v165
    v_cvt_pk_bf16_f32 v163, v166, v167
    v_cvt_pk_bf16_f32 v164, v168, v169
    v_cvt_pk_bf16_f32 v165, v170, v171
    v_cvt_pk_bf16_f32 v166, v172, v173
    v_cvt_pk_bf16_f32 v167, v174, v175
    buffer_store_dwordx4 v[160:163], v9, s[20:23], s50 offen offset:0 sc1
    buffer_store_dwordx4 v[164:167], v9, s[20:23], s50 offen offset:256 sc1
    s_add_u32 s50, s50, 8192
    v_mul_f32 v176, v22, v176
    v_mul_f32 v177, v22, v177
    v_mul_f32 v178, v22, v178
    v_mul_f32 v179, v22, v179
    v_mul_f32 v180, v22, v180
    v_mul_f32 v181, v22, v181
    v_mul_f32 v182, v22, v182
    v_mul_f32 v183, v22, v183
    v_mul_f32 v184, v23, v184
    v_mul_f32 v185, v23, v185
    v_mul_f32 v186, v23, v186
    v_mul_f32 v187, v23, v187
    v_mul_f32 v188, v23, v188
    v_mul_f32 v189, v23, v189
    v_mul_f32 v190, v23, v190
    v_mul_f32 v191, v23, v191
    v_cvt_pk_bf16_f32 v176, v176, v177
    v_cvt_pk_bf16_f32 v177, v178, v179
    v_cvt_pk_bf16_f32 v178, v180, v181
    v_cvt_pk_bf16_f32 v179, v182, v183
    v_cvt_pk_bf16_f32 v180, v184, v185
    v_cvt_pk_bf16_f32 v181, v186, v187
    v_cvt_pk_bf16_f32 v182, v188, v189
    v_cvt_pk_bf16_f32 v183, v190, v191
    buffer_store_dwordx4 v[176:179], v9, s[20:23], s50 offen offset:0 sc1
    buffer_store_dwordx4 v[180:183], v9, s[20:23], s50 offen offset:256 sc1
    s_add_u32 s50, s50, 8192
    s_cmp_ge_u32 s90, 2
    s_cbranch_scc1 LA_n2
LA_N_sp:
    ds_read_b32 v41, v39
    s_waitcnt lgkmcnt(0)
    v_cmp_gt_u32 vcc, v40, v41
    s_cbranch_vccz LA_N_ok
    s_sleep 1
    s_branch LA_N_sp
LA_N_ok:
    buffer_load_dwordx4 v2, s[20:23], s62 offen offset:0 sc1 lds
    buffer_load_dwordx4 v2, s[20:23], s62 offen offset:1024 sc1 lds
    buffer_load_dwordx4 v2, s[20:23], s62 offen offset:2048 sc1 lds
    buffer_load_dwordx4 v2, s[20:23], s62 offen offset:3072 sc1 lds
    s_add_u32 m0, m0, 4096
    s_nop 0
    buffer_load_dwordx4 v11, s[20:23], s62 offen offset:0 sc1 lds
    buffer_load_dwordx4 v11, s[20:23], s62 offen offset:1024 sc1 lds
    buffer_load_dwordx4 v11, s[20:23], s62 offen offset:2048 sc1 lds
    buffer_load_dwordx4 v11, s[20:23], s62 offen offset:3072 sc1 lds
    s_add_u32 m0, m0, 28672
    s_and_b32 m0, m0, 0x1ffff
    s_add_u32 s62, s62, 32768
    s_cmp_eq_u32 s62, s56
    s_cselect_b32 s62, s61, s62
    v_add_u32 v40, 1, v40
    v_mov_b32 v33, v34
    v_xad_u32 v34, m0, v42, v43
LA_n2:
    s_cmp_lg_u32 s59, 0
    s_cbranch_scc1 LA_end
    s_mov_b32 s59, 1
    s_mov_b32 s58, s41
    s_lshl_b32 s57, s41, 1
    s_sub_u32 s57, s57, 2
    s_cmp_lg_u32 s41, 0
    s_cbranch_scc1 LA_nw
    s_add_u32 s56, s35, 131072
    s_mov_b32 s61, s35
    s_cmp_eq_u32 s62, s56
    s_cselect_b32 s62, s61, s62
LA_nw:
    s_sub_u32 s90, 3, s43
    s_sub_u32 s50, s90, s43
    s_lshl_b32 s50, s50, 5
    v_add_u32 v36, s50, v36
    v_mov_b32 v64, v96
    v_mov_b32 v65, v97
    v_mov_b32 v66, v98
    v_mov_b32 v67, v99
    v_mov_b32 v68, v100
    v_mov_b32 v69, v101
    v_mov_b32 v70, v102
    v_mov_b32 v71, v103
    v_mov_b32 v72, v104
    v_mov_b32 v73, v105
    v_mov_b32 v74, v106
    v_mov_b32 v75, v107
    v_mov_b32 v76, v108
    v_mov_b32 v77, v109
    v_mov_b32 v78, v110
    v_mov_b32 v79, v111
    v_mov_b32 v80, v112
    v_mov_b32 v81, v113
    v_mov_b32 v82, v114
    v_mov_b32 v83, v115
    v_mov_b32 v84, v116
    v_mov_b32 v85, v117
    v_mov_b32 v86, v118
    v_mov_b32 v87, v119
    v_mov_b32 v88, v120
    v_mov_b32 v89, v121
    v_mov_b32 v90, v122
    v_mov_b32 v91, v123
    v_mov_b32 v92, v124
    v_mov_b32 v93, v125
    v_mov_b32 v94, v126
    v_mov_b32 v95, v127
    s_branch LA_block
LA_end:
    s_lshr_b32 s37, s40, 3
    s_sub_u32 s47, 65, s47
    s_cmp_eq_u32 s47, 1
    s_cselect_b32 s38, s41, s44
    s_mov_b32 s4, s84
    s_and_b32 s5, s85, 0xffff
    s_mov_b32 s6, 0x200000
    s_mov_b32 s7, 0x20000
    s_and_b32 s50, s43, 2
    s_lshr_b32 s51, s37, 1
    s_or_b32 s45, s50, s51
    s_and_b32 s50, s43, 1
    s_lshl_b32 s50, s50, 1
    s_and_b32 s51, s37, 1
    s_or_b32 s46, s50, s51
    v_and_b32 v24, 15, v1
    v_lshlrev_b32 v25, 4, v24
    v_bfe_u32 v26, v1, 4, 1
    v_lshl_add_u32 v25, v26, 9, v25
    v_lshrrev_b32 v26, 5, v1
    v_lshl_add_u32 v25, v26, 12, v25
    s_lshl_b32 s50, s45, 10
    v_add_u32 v12, s50, v25
    v_xor_b32 v15, 1024, v12
    s_lshl_b32 s50, s46, 10
    v_add_u32 v18, s50, v25
    v_xor_b32 v21, 1024, v18
    v_add_u32 v13, 0x10000, v12
    v_add_u32 v14, 0x20000, v12
    v_add_u32 v16, 0x10000, v15
    v_add_u32 v17, 0x20000, v15
    v_add_u32 v19, 0x10000, v18
    v_add_u32 v20, 0x20000, v18
    v_add_u32 v22, 0x10000, v21
    v_add_u32 v23, 0x20000, v21
    v_lshlrev_b32 v24, 2, v24
    s_lshl_b32 s50, s38, 9
    s_lshl_b32 s51, s46, 7
    s_add_u32 s50, s50, s51
    s_add_u32 s50, s50, 69206016
    s_xor_b32 s51, s50, 128
    buffer_load_dword v4, v24, s[20:23], s50 offen offset:0 sc1
    buffer_load_dword v5, v24, s[20:23], s50 offen offset:64 sc1
    buffer_load_dword v6, v24, s[20:23], s51 offen offset:0 sc1
    buffer_load_dword v7, v24, s[20:23], s51 offen offset:64 sc1
    s_cmp_eq_u32 s47, 0
    s_cbranch_scc1 LX_nl
    s_lshl_b32 s50, s90, 10
    s_add_u32 s50, s50, 65536
    v_add_u32 v26, s50, v9
LX_dn:
    ds_read_b32 v41, v39
    s_waitcnt lgkmcnt(0)
    v_cmp_gt_u32 vcc, 35, v41
    s_cbranch_vccz LX_dk
    s_sleep 1
    s_branch LX_dn
LX_dk:
    ds_write_b128 v26, v[128:131] offset:0
    ds_write_b128 v26, v[132:135] offset:256
    ds_write_b128 v26, v[144:147] offset:8192
    ds_write_b128 v26, v[148:151] offset:8448
    ds_write_b128 v26, v[160:163] offset:16384
    ds_write_b128 v26, v[164:167] offset:16640
    ds_write_b128 v26, v[176:179] offset:24576
    ds_write_b128 v26, v[180:183] offset:24832
LX_nl:
    s_waitcnt vmcnt(4) lgkmcnt(0)
    s_and_b32 s52, s40, 31
    s_lshl_b32 s52, s52, 13
    s_lshl_b32 s53, s41, 10
    s_add_u32 s52, s52, s53
    s_add_u32 s52, s52, 70255232
    s_lshl_b32 s53, s43, 2
    s_add_u32 s52, s52, s53
    v_mov_b32 v29, 1
    s_mov_b64 s[92:93], exec
    s_mov_b64 exec, 1
    buffer_store_dword v29, off, s[20:23], s52 sc1
    s_mov_b64 exec, s[92:93]
    s_barrier
    ds_read_b128 v[192:195], v13 offset:32768
    ds_read_b128 v[208:211], v19 offset:0
    ds_read_b128 v[200:203], v13 offset:40960
    ds_read_b128 v[216:219], v19 offset:8192
    ds_read_b128 v[212:215], v19 offset:256
    ds_read_b128 v[220:223], v19 offset:8448
    ds_read_b128 v[196:199], v13 offset:33024
    ds_read_b128 v[204:207], v13 offset:41216
    ds_read_b128 v[224:227], v22 offset:0
    ds_read_b128 v[232:235], v22 offset:8192
    ds_read_b128 v[228:231], v22 offset:256
    ds_read_b128 v[236:239], v22 offset:8448
    s_waitcnt lgkmcnt(10)
    v_mfma_f32_16x16x32_bf16 v[64:67], v[192:195], v[208:211], 0
    ds_read_b128 v[240:243], v16 offset:32768
    s_waitcnt lgkmcnt(9)
    v_mfma_f32_16x16x32_bf16 v[64:67], v[200:203], v[216:219], v[64:67]
    ds_read_b128 v[248:251], v16 offset:40960
    s_waitcnt lgkmcnt(9)
    v_mfma_f32_16x16x32_bf16 v[72:75], v[192:195], v[212:215], 0
    ds_read_b128 v[244:247], v16 offset:33024
    s_waitcnt lgkmcnt(9)
    v_mfma_f32_16x16x32_bf16 v[72:75], v[200:203], v[220:223], v[72:75]
    ds_read_b128 v[252:255], v16 offset:41216
    s_waitcnt lgkmcnt(9)
    v_mfma_f32_16x16x32_bf16 v[76:79], v[196:199], v[212:215], 0
    s_waitcnt lgkmcnt(8)
    v_mfma_f32_16x16x32_bf16 v[76:79], v[204:207], v[220:223], v[76:79]
    v_mfma_f32_16x16x32_bf16 v[68:71], v[196:199], v[208:211], 0
    v_mfma_f32_16x16x32_bf16 v[68:71], v[204:207], v[216:219], v[68:71]
    s_waitcnt lgkmcnt(7)
    v_mfma_f32_16x16x32_bf16 v[80:83], v[192:195], v[224:227], 0
    s_waitcnt lgkmcnt(6)
    v_mfma_f32_16x16x32_bf16 v[80:83], v[200:203], v[232:235], v[80:83]
    s_waitcnt lgkmcnt(5)
    v_mfma_f32_16x16x32_bf16 v[88:91], v[192:195], v[228:231], 0
    s_waitcnt lgkmcnt(4)
    v_mfma_f32_16x16x32_bf16 v[88:91], v[200:203], v[236:239], v[88:91]
    v_mfma_f32_16x16x32_bf16 v[92:95], v[196:199], v[228:231], 0
    v_mfma_f32_16x16x32_bf16 v[92:95], v[204:207], v[236:239], v[92:95]
    s_waitcnt lgkmcnt(0)
    s_barrier
    v_mfma_f32_16x16x32_bf16 v[84:87], v[196:199], v[224:227], 0
    ds_read_b128 v[32:35], v13 offset:49152
    v_mfma_f32_16x16x32_bf16 v[84:87], v[204:207], v[232:235], v[84:87]
    ds_read_b128 v[48:51], v19 offset:16384
    v_mfma_f32_16x16x32_bf16 v[112:115], v[240:243], v[224:227], 0
    ds_read_b128 v[40:43], v13 offset:57344
    v_mfma_f32_16x16x32_bf16 v[112:115], v[248:251], v[232:235], v[112:115]
    ds_read_b128 v[56:59], v19 offset:24576
    v_mfma_f32_16x16x32_bf16 v[120:123], v[240:243], v[228:231], 0
    ds_read_b128 v[52:55], v19 offset:16640
    v_mfma_f32_16x16x32_bf16 v[120:123], v[248:251], v[236:239], v[120:123]
    ds_read_b128 v[60:63], v19 offset:24832
    v_mfma_f32_16x16x32_bf16 v[124:127], v[244:247], v[228:231], 0
    ds_read_b128 v[36:39], v13 offset:49408
    v_mfma_f32_16x16x32_bf16 v[124:127], v[252:255], v[236:239], v[124:127]
    ds_read_b128 v[44:47], v13 offset:57600
    v_mfma_f32_16x16x32_bf16 v[116:119], v[244:247], v[224:227], 0
    ds_read_b128 v[192:195], v22 offset:16384
    v_mfma_f32_16x16x32_bf16 v[116:119], v[252:255], v[232:235], v[116:119]
    ds_read_b128 v[200:203], v22 offset:24576
    v_mfma_f32_16x16x32_bf16 v[96:99], v[240:243], v[208:211], 0
    ds_read_b128 v[196:199], v22 offset:16640
    v_mfma_f32_16x16x32_bf16 v[96:99], v[248:251], v[216:219], v[96:99]
    ds_read_b128 v[204:207], v22 offset:24832
    v_mfma_f32_16x16x32_bf16 v[104:107], v[240:243], v[212:215], 0
    v_mfma_f32_16x16x32_bf16 v[104:107], v[248:251], v[220:223], v[104:107]
    v_mfma_f32_16x16x32_bf16 v[108:111], v[244:247], v[212:215], 0
    v_mfma_f32_16x16x32_bf16 v[108:111], v[252:255], v[220:223], v[108:111]
    v_mfma_f32_16x16x32_bf16 v[100:103], v[244:247], v[208:211], 0
    v_mfma_f32_16x16x32_bf16 v[100:103], v[252:255], v[216:219], v[100:103]
    s_waitcnt lgkmcnt(10)
    v_mfma_f32_16x16x32_bf16 v[64:67], v[32:35], v[48:51], v[64:67]
    ds_read_b128 v[224:227], v16 offset:49152
    s_waitcnt lgkmcnt(9)
    v_mfma_f32_16x16x32_bf16 v[64:67], v[40:43], v[56:59], v[64:67]
    ds_read_b128 v[232:235], v16 offset:57344
    s_waitcnt lgkmcnt(9)
    v_mfma_f32_16x16x32_bf16 v[72:75], v[32:35], v[52:55], v[72:75]
    ds_read_b128 v[228:231], v16 offset:49408
    s_waitcnt lgkmcnt(9)
    v_mfma_f32_16x16x32_bf16 v[72:75], v[40:43], v[60:63], v[72:75]
    ds_read_b128 v[236:239], v16 offset:57600
    s_waitcnt lgkmcnt(9)
    v_mfma_f32_16x16x32_bf16 v[76:79], v[36:39], v[52:55], v[76:79]
    s_waitcnt lgkmcnt(8)
    v_mfma_f32_16x16x32_bf16 v[76:79], v[44:47], v[60:63], v[76:79]
    v_mfma_f32_16x16x32_bf16 v[68:71], v[36:39], v[48:51], v[68:71]
    v_mfma_f32_16x16x32_bf16 v[68:71], v[44:47], v[56:59], v[68:71]
    s_waitcnt lgkmcnt(7)
    v_mfma_f32_16x16x32_bf16 v[80:83], v[32:35], v[192:195], v[80:83]
    s_waitcnt lgkmcnt(6)
    v_mfma_f32_16x16x32_bf16 v[80:83], v[40:43], v[200:203], v[80:83]
    s_waitcnt lgkmcnt(5)
    v_mfma_f32_16x16x32_bf16 v[88:91], v[32:35], v[196:199], v[88:91]
    s_waitcnt lgkmcnt(4)
    v_mfma_f32_16x16x32_bf16 v[88:91], v[40:43], v[204:207], v[88:91]
    v_mfma_f32_16x16x32_bf16 v[92:95], v[36:39], v[196:199], v[92:95]
    v_mfma_f32_16x16x32_bf16 v[92:95], v[44:47], v[204:207], v[92:95]
    s_waitcnt lgkmcnt(0)
    s_barrier
    v_mfma_f32_16x16x32_bf16 v[84:87], v[36:39], v[192:195], v[84:87]
    ds_read_b128 v[240:243], v12 offset:0
    v_mfma_f32_16x16x32_bf16 v[84:87], v[44:47], v[200:203], v[84:87]
    ds_read_b128 v[208:211], v20 offset:0
    v_mfma_f32_16x16x32_bf16 v[112:115], v[224:227], v[192:195], v[112:115]
    ds_read_b128 v[248:251], v12 offset:8192
    v_mfma_f32_16x16x32_bf16 v[112:115], v[232:235], v[200:203], v[112:115]
    ds_read_b128 v[216:219], v20 offset:8192
    v_mfma_f32_16x16x32_bf16 v[120:123], v[224:227], v[196:199], v[120:123]
    ds_read_b128 v[212:215], v20 offset:256
    v_mfma_f32_16x16x32_bf16 v[120:123], v[232:235], v[204:207], v[120:123]
    ds_read_b128 v[220:223], v20 offset:8448
    v_mfma_f32_16x16x32_bf16 v[124:127], v[228:231], v[196:199], v[124:127]
    ds_read_b128 v[244:247], v12 offset:256
    v_mfma_f32_16x16x32_bf16 v[124:127], v[236:239], v[204:207], v[124:127]
    ds_read_b128 v[252:255], v12 offset:8448
    v_mfma_f32_16x16x32_bf16 v[116:119], v[228:231], v[192:195], v[116:119]
    ds_read_b128 v[32:35], v23 offset:0
    v_mfma_f32_16x16x32_bf16 v[116:119], v[236:239], v[200:203], v[116:119]
    ds_read_b128 v[40:43], v23 offset:8192
    v_mfma_f32_16x16x32_bf16 v[96:99], v[224:227], v[48:51], v[96:99]
    ds_read_b128 v[36:39], v23 offset:256
    v_mfma_f32_16x16x32_bf16 v[96:99], v[232:235], v[56:59], v[96:99]
    ds_read_b128 v[44:47], v23 offset:8448
    v_mfma_f32_16x16x32_bf16 v[104:107], v[224:227], v[52:55], v[104:107]
    v_mfma_f32_16x16x32_bf16 v[104:107], v[232:235], v[60:63], v[104:107]
    v_mfma_f32_16x16x32_bf16 v[108:111], v[228:231], v[52:55], v[108:111]
    v_mfma_f32_16x16x32_bf16 v[108:111], v[236:239], v[60:63], v[108:111]
    v_mfma_f32_16x16x32_bf16 v[100:103], v[228:231], v[48:51], v[100:103]
    v_mfma_f32_16x16x32_bf16 v[100:103], v[236:239], v[56:59], v[100:103]
    s_waitcnt lgkmcnt(10)
    v_mfma_f32_16x16x32_bf16 v[64:67], v[240:243], v[208:211], v[64:67]
    ds_read_b128 v[192:195], v15 offset:0
    s_waitcnt lgkmcnt(9)
    v_mfma_f32_16x16x32_bf16 v[64:67], v[248:251], v[216:219], v[64:67]
    ds_read_b128 v[200:203], v15 offset:8192
    s_waitcnt lgkmcnt(9)
    v_mfma_f32_16x16x32_bf16 v[72:75], v[240:243], v[212:215], v[72:75]
    ds_read_b128 v[196:199], v15 offset:256
    s_waitcnt vmcnt(0)
    s_waitcnt lgkmcnt(9)
    v_mfma_f32_16x16x32_bf16 v[72:75], v[248:251], v[220:223], v[72:75]
    ds_read_b128 v[204:207], v15 offset:8448
    v_mul_f32 v4, 0xbfb8aa3b, v4
    s_waitcnt lgkmcnt(9)
    v_mfma_f32_16x16x32_bf16 v[76:79], v[244:247], v[212:215], v[76:79]
    v_exp_f32 v4, v4
    s_waitcnt lgkmcnt(8)
    v_mfma_f32_16x16x32_bf16 v[76:79], v[252:255], v[220:223], v[76:79]
    v_mul_f32 v5, 0xbfb8aa3b, v5
    v_mfma_f32_16x16x32_bf16 v[68:71], v[244:247], v[208:211], v[68:71]
    v_exp_f32 v5, v5
    v_mfma_f32_16x16x32_bf16 v[68:71], v[252:255], v[216:219], v[68:71]
    v_mul_f32 v6, 0xbfb8aa3b, v6
    s_waitcnt lgkmcnt(7)
    v_mfma_f32_16x16x32_bf16 v[80:83], v[240:243], v[32:35], v[80:83]
    v_exp_f32 v6, v6
    s_waitcnt lgkmcnt(6)
    v_mfma_f32_16x16x32_bf16 v[80:83], v[248:251], v[40:43], v[80:83]
    v_mul_f32 v7, 0xbfb8aa3b, v7
    s_waitcnt lgkmcnt(5)
    v_mfma_f32_16x16x32_bf16 v[88:91], v[240:243], v[36:39], v[88:91]
    v_exp_f32 v7, v7
    s_waitcnt lgkmcnt(4)
    v_mfma_f32_16x16x32_bf16 v[88:91], v[248:251], v[44:47], v[88:91]
    v_add_f32 v4, 1.0, v4
    v_mfma_f32_16x16x32_bf16 v[92:95], v[244:247], v[36:39], v[92:95]
    v_rcp_f32 v4, v4
    v_mfma_f32_16x16x32_bf16 v[92:95], v[252:255], v[44:47], v[92:95]
    v_add_f32 v5, 1.0, v5
    s_waitcnt lgkmcnt(0)
    s_barrier
    v_mfma_f32_16x16x32_bf16 v[84:87], v[244:247], v[32:35], v[84:87]
    ds_read_b128 v[224:227], v12 offset:16384
    v_rcp_f32 v5, v5
    v_mfma_f32_16x16x32_bf16 v[84:87], v[252:255], v[40:43], v[84:87]
    ds_read_b128 v[48:51], v20 offset:16384
    v_add_f32 v6, 1.0, v6
    v_mfma_f32_16x16x32_bf16 v[112:115], v[192:195], v[32:35], v[112:115]
    ds_read_b128 v[232:235], v12 offset:24576
    v_rcp_f32 v6, v6
    v_mfma_f32_16x16x32_bf16 v[112:115], v[200:203], v[40:43], v[112:115]
    ds_read_b128 v[56:59], v20 offset:24576
    v_add_f32 v7, 1.0, v7
    v_mfma_f32_16x16x32_bf16 v[120:123], v[192:195], v[36:39], v[120:123]
    ds_read_b128 v[52:55], v20 offset:16640
    v_rcp_f32 v7, v7
    v_mfma_f32_16x16x32_bf16 v[120:123], v[200:203], v[44:47], v[120:123]
    ds_read_b128 v[60:63], v20 offset:24832
    v_sub_f32 v0, 1.0, v4
    v_mfma_f32_16x16x32_bf16 v[124:127], v[196:199], v[36:39], v[124:127]
    ds_read_b128 v[228:231], v12 offset:16640
    v_sub_f32 v8, 1.0, v5
    v_mfma_f32_16x16x32_bf16 v[124:127], v[204:207], v[44:47], v[124:127]
    ds_read_b128 v[236:239], v12 offset:24832
    v_sub_f32 v9, 1.0, v6
    v_mfma_f32_16x16x32_bf16 v[116:119], v[196:199], v[32:35], v[116:119]
    ds_read_b128 v[240:243], v23 offset:16384
    v_sub_f32 v30, 1.0, v7
    v_mfma_f32_16x16x32_bf16 v[116:119], v[204:207], v[40:43], v[116:119]
    ds_read_b128 v[248:251], v23 offset:24576
    v_mfma_f32_16x16x32_bf16 v[96:99], v[192:195], v[208:211], v[96:99]
    ds_read_b128 v[244:247], v23 offset:16640
    v_mfma_f32_16x16x32_bf16 v[96:99], v[200:203], v[216:219], v[96:99]
    ds_read_b128 v[252:255], v23 offset:24832
    v_mfma_f32_16x16x32_bf16 v[104:107], v[192:195], v[212:215], v[104:107]
    v_mfma_f32_16x16x32_bf16 v[104:107], v[200:203], v[220:223], v[104:107]
    v_mfma_f32_16x16x32_bf16 v[108:111], v[196:199], v[212:215], v[108:111]
    v_mfma_f32_16x16x32_bf16 v[108:111], v[204:207], v[220:223], v[108:111]
    v_mfma_f32_16x16x32_bf16 v[100:103], v[196:199], v[208:211], v[100:103]
    v_mfma_f32_16x16x32_bf16 v[100:103], v[204:207], v[216:219], v[100:103]
    s_waitcnt lgkmcnt(10)
    v_mfma_f32_16x16x32_bf16 v[64:67], v[224:227], v[48:51], v[64:67]
    ds_read_b128 v[32:35], v15 offset:16384
    s_waitcnt lgkmcnt(9)
    v_mfma_f32_16x16x32_bf16 v[64:67], v[232:235], v[56:59], v[64:67]
    ds_read_b128 v[40:43], v15 offset:24576
    s_waitcnt lgkmcnt(9)
    v_mfma_f32_16x16x32_bf16 v[72:75], v[224:227], v[52:55], v[72:75]
    ds_read_b128 v[36:39], v15 offset:16640
    s_waitcnt lgkmcnt(9)
    v_mfma_f32_16x16x32_bf16 v[72:75], v[232:235], v[60:63], v[72:75]
    ds_read_b128 v[44:47], v15 offset:24832
    s_waitcnt lgkmcnt(9)
    v_mfma_f32_16x16x32_bf16 v[76:79], v[228:231], v[52:55], v[76:79]
    s_waitcnt lgkmcnt(8)
    v_mfma_f32_16x16x32_bf16 v[76:79], v[236:239], v[60:63], v[76:79]
    v_mfma_f32_16x16x32_bf16 v[68:71], v[228:231], v[48:51], v[68:71]
    v_mfma_f32_16x16x32_bf16 v[68:71], v[236:239], v[56:59], v[68:71]
    s_waitcnt lgkmcnt(7)
    v_mfma_f32_16x16x32_bf16 v[80:83], v[224:227], v[240:243], v[80:83]
    s_waitcnt lgkmcnt(6)
    v_mfma_f32_16x16x32_bf16 v[80:83], v[232:235], v[248:251], v[80:83]
    s_waitcnt lgkmcnt(5)
    v_mfma_f32_16x16x32_bf16 v[88:91], v[224:227], v[244:247], v[88:91]
    s_waitcnt lgkmcnt(4)
    v_mfma_f32_16x16x32_bf16 v[88:91], v[232:235], v[252:255], v[88:91]
    v_mfma_f32_16x16x32_bf16 v[92:95], v[228:231], v[244:247], v[92:95]
    v_mfma_f32_16x16x32_bf16 v[92:95], v[236:239], v[252:255], v[92:95]
    s_waitcnt lgkmcnt(0)
    s_barrier
    v_mfma_f32_16x16x32_bf16 v[84:87], v[228:231], v[240:243], v[84:87]
    ds_read_b128 v[192:195], v12 offset:32768
    v_mfma_f32_16x16x32_bf16 v[84:87], v[236:239], v[248:251], v[84:87]
    ds_read_b128 v[208:211], v19 offset:0
    v_mfma_f32_16x16x32_bf16 v[112:115], v[32:35], v[240:243], v[112:115]
    ds_read_b128 v[200:203], v12 offset:40960
    v_mfma_f32_16x16x32_bf16 v[112:115], v[40:43], v[248:251], v[112:115]
    ds_read_b128 v[216:219], v19 offset:8192
    v_mfma_f32_16x16x32_bf16 v[120:123], v[32:35], v[244:247], v[120:123]
    ds_read_b128 v[212:215], v19 offset:256
    v_mfma_f32_16x16x32_bf16 v[120:123], v[40:43], v[252:255], v[120:123]
    ds_read_b128 v[220:223], v19 offset:8448
    v_mfma_f32_16x16x32_bf16 v[124:127], v[36:39], v[244:247], v[124:127]
    ds_read_b128 v[196:199], v12 offset:33024
    v_mfma_f32_16x16x32_bf16 v[124:127], v[44:47], v[252:255], v[124:127]
    ds_read_b128 v[204:207], v12 offset:41216
    v_mfma_f32_16x16x32_bf16 v[116:119], v[36:39], v[240:243], v[116:119]
    ds_read_b128 v[224:227], v22 offset:0
    v_mfma_f32_16x16x32_bf16 v[116:119], v[44:47], v[248:251], v[116:119]
    ds_read_b128 v[232:235], v22 offset:8192
    v_mfma_f32_16x16x32_bf16 v[96:99], v[32:35], v[48:51], v[96:99]
    ds_read_b128 v[228:231], v22 offset:256
    v_mfma_f32_16x16x32_bf16 v[96:99], v[40:43], v[56:59], v[96:99]
    ds_read_b128 v[236:239], v22 offset:8448
    v_mfma_f32_16x16x32_bf16 v[104:107], v[32:35], v[52:55], v[104:107]
    v_mfma_f32_16x16x32_bf16 v[104:107], v[40:43], v[60:63], v[104:107]
    v_mfma_f32_16x16x32_bf16 v[108:111], v[36:39], v[52:55], v[108:111]
    v_mfma_f32_16x16x32_bf16 v[108:111], v[44:47], v[60:63], v[108:111]
    v_mfma_f32_16x16x32_bf16 v[100:103], v[36:39], v[48:51], v[100:103]
    v_mfma_f32_16x16x32_bf16 v[100:103], v[44:47], v[56:59], v[100:103]
    s_waitcnt lgkmcnt(10)
    v_mfma_f32_16x16x32_bf16 v[64:67], v[192:195], v[208:211], v[64:67]
    ds_read_b128 v[240:243], v15 offset:32768
    s_waitcnt lgkmcnt(9)
    v_mfma_f32_16x16x32_bf16 v[64:67], v[200:203], v[216:219], v[64:67]
    ds_read_b128 v[248:251], v15 offset:40960
    s_waitcnt lgkmcnt(9)
    v_mfma_f32_16x16x32_bf16 v[72:75], v[192:195], v[212:215], v[72:75]
    ds_read_b128 v[244:247], v15 offset:33024
    s_waitcnt lgkmcnt(9)
    v_mfma_f32_16x16x32_bf16 v[72:75], v[200:203], v[220:223], v[72:75]
    ds_read_b128 v[252:255], v15 offset:41216
    s_waitcnt lgkmcnt(9)
    v_mfma_f32_16x16x32_bf16 v[76:79], v[196:199], v[212:215], v[76:79]
    s_waitcnt lgkmcnt(8)
    v_mfma_f32_16x16x32_bf16 v[76:79], v[204:207], v[220:223], v[76:79]
    v_mfma_f32_16x16x32_bf16 v[68:71], v[196:199], v[208:211], v[68:71]
    v_mfma_f32_16x16x32_bf16 v[68:71], v[204:207], v[216:219], v[68:71]
    s_waitcnt lgkmcnt(7)
    v_mfma_f32_16x16x32_bf16 v[80:83], v[192:195], v[224:227], v[80:83]
    s_waitcnt lgkmcnt(6)
    v_mfma_f32_16x16x32_bf16 v[80:83], v[200:203], v[232:235], v[80:83]
    s_waitcnt lgkmcnt(5)
    v_mfma_f32_16x16x32_bf16 v[88:91], v[192:195], v[228:231], v[88:91]
    s_waitcnt lgkmcnt(4)
    v_mfma_f32_16x16x32_bf16 v[88:91], v[200:203], v[236:239], v[88:91]
    v_mfma_f32_16x16x32_bf16 v[92:95], v[196:199], v[228:231], v[92:95]
    v_mfma_f32_16x16x32_bf16 v[92:95], v[204:207], v[236:239], v[92:95]
    s_waitcnt lgkmcnt(0)
    s_barrier
    v_mfma_f32_16x16x32_bf16 v[84:87], v[196:199], v[224:227], v[84:87]
    ds_read_b128 v[32:35], v12 offset:49152
    v_mfma_f32_16x16x32_bf16 v[84:87], v[204:207], v[232:235], v[84:87]
    ds_read_b128 v[48:51], v19 offset:32768
    v_mfma_f32_16x16x32_bf16 v[112:115], v[240:243], v[224:227], v[112:115]
    ds_read_b128 v[40:43], v12 offset:57344
    v_mfma_f32_16x16x32_bf16 v[112:115], v[248:251], v[232:235], v[112:115]
    ds_read_b128 v[56:59], v19 offset:40960
    v_mfma_f32_16x16x32_bf16 v[120:123], v[240:243], v[228:231], v[120:123]
    ds_read_b128 v[52:55], v19 offset:33024
    v_mfma_f32_16x16x32_bf16 v[120:123], v[248:251], v[236:239], v[120:123]
    ds_read_b128 v[60:63], v19 offset:41216
    v_mfma_f32_16x16x32_bf16 v[124:127], v[244:247], v[228:231], v[124:127]
    ds_read_b128 v[36:39], v12 offset:49408
    v_mfma_f32_16x16x32_bf16 v[124:127], v[252:255], v[236:239], v[124:127]
    ds_read_b128 v[44:47], v12 offset:57600
    v_mfma_f32_16x16x32_bf16 v[116:119], v[244:247], v[224:227], v[116:119]
    ds_read_b128 v[192:195], v22 offset:32768
    v_mfma_f32_16x16x32_bf16 v[116:119], v[252:255], v[232:235], v[116:119]
    ds_read_b128 v[200:203], v22 offset:40960
    v_mfma_f32_16x16x32_bf16 v[96:99], v[240:243], v[208:211], v[96:99]
    ds_read_b128 v[196:199], v22 offset:33024
    v_mfma_f32_16x16x32_bf16 v[96:99], v[248:251], v[216:219], v[96:99]
    ds_read_b128 v[204:207], v22 offset:41216
    v_mfma_f32_16x16x32_bf16 v[104:107], v[240:243], v[212:215], v[104:107]
    v_mfma_f32_16x16x32_bf16 v[104:107], v[248:251], v[220:223], v[104:107]
    v_mfma_f32_16x16x32_bf16 v[108:111], v[244:247], v[212:215], v[108:111]
    v_mfma_f32_16x16x32_bf16 v[108:111], v[252:255], v[220:223], v[108:111]
    v_mfma_f32_16x16x32_bf16 v[100:103], v[244:247], v[208:211], v[100:103]
    v_mfma_f32_16x16x32_bf16 v[100:103], v[252:255], v[216:219], v[100:103]
    s_waitcnt lgkmcnt(10)
    v_mfma_f32_16x16x32_bf16 v[64:67], v[32:35], v[48:51], v[64:67]
    ds_read_b128 v[224:227], v15 offset:49152
    s_waitcnt lgkmcnt(9)
    v_mfma_f32_16x16x32_bf16 v[64:67], v[40:43], v[56:59], v[64:67]
    ds_read_b128 v[232:235], v15 offset:57344
    s_waitcnt lgkmcnt(9)
    v_mfma_f32_16x16x32_bf16 v[72:75], v[32:35], v[52:55], v[72:75]
    ds_read_b128 v[228:231], v15 offset:49408
    s_waitcnt lgkmcnt(9)
    v_mfma_f32_16x16x32_bf16 v[72:75], v[40:43], v[60:63], v[72:75]
    ds_read_b128 v[236:239], v15 offset:57600
    s_waitcnt lgkmcnt(9)
    v_mfma_f32_16x16x32_bf16 v[76:79], v[36:39], v[52:55], v[76:79]
    s_waitcnt lgkmcnt(8)
    v_mfma_f32_16x16x32_bf16 v[76:79], v[44:47], v[60:63], v[76:79]
    v_mfma_f32_16x16x32_bf16 v[68:71], v[36:39], v[48:51], v[68:71]
    v_mfma_f32_16x16x32_bf16 v[68:71], v[44:47], v[56:59], v[68:71]
    s_waitcnt lgkmcnt(7)
    v_mfma_f32_16x16x32_bf16 v[80:83], v[32:35], v[192:195], v[80:83]
    s_waitcnt lgkmcnt(6)
    v_mfma_f32_16x16x32_bf16 v[80:83], v[40:43], v[200:203], v[80:83]
    s_waitcnt lgkmcnt(5)
    v_mfma_f32_16x16x32_bf16 v[88:91], v[32:35], v[196:199], v[88:91]
    s_waitcnt lgkmcnt(4)
    v_mfma_f32_16x16x32_bf16 v[88:91], v[40:43], v[204:207], v[88:91]
    v_mfma_f32_16x16x32_bf16 v[92:95], v[36:39], v[196:199], v[92:95]
    v_mfma_f32_16x16x32_bf16 v[92:95], v[44:47], v[204:207], v[92:95]
    s_waitcnt lgkmcnt(0)
    s_barrier
    v_mfma_f32_16x16x32_bf16 v[84:87], v[36:39], v[192:195], v[84:87]
    ds_read_b128 v[240:243], v13 offset:49152
    v_mfma_f32_16x16x32_bf16 v[84:87], v[44:47], v[200:203], v[84:87]
    ds_read_b128 v[208:211], v19 offset:16384
    v_mfma_f32_16x16x32_bf16 v[112:115], v[224:227], v[192:195], v[112:115]
    ds_read_b128 v[248:251], v13 offset:57344
    v_mfma_f32_16x16x32_bf16 v[112:115], v[232:235], v[200:203], v[112:115]
    ds_read_b128 v[216:219], v19 offset:24576
    v_mfma_f32_16x16x32_bf16 v[120:123], v[224:227], v[196:199], v[120:123]
    ds_read_b128 v[212:215], v19 offset:16640
    v_mfma_f32_16x16x32_bf16 v[120:123], v[232:235], v[204:207], v[120:123]
    ds_read_b128 v[220:223], v19 offset:24832
    v_mfma_f32_16x16x32_bf16 v[124:127], v[228:231], v[196:199], v[124:127]
    ds_read_b128 v[244:247], v13 offset:49408
    v_mfma_f32_16x16x32_bf16 v[124:127], v[236:239], v[204:207], v[124:127]
    ds_read_b128 v[252:255], v13 offset:57600
    v_mfma_f32_16x16x32_bf16 v[116:119], v[228:231], v[192:195], v[116:119]
    ds_read_b128 v[32:35], v22 offset:16384
    v_mfma_f32_16x16x32_bf16 v[116:119], v[236:239], v[200:203], v[116:119]
    ds_read_b128 v[40:43], v22 offset:24576
    v_mfma_f32_16x16x32_bf16 v[96:99], v[224:227], v[48:51], v[96:99]
    ds_read_b128 v[36:39], v22 offset:16640
    v_mfma_f32_16x16x32_bf16 v[96:99], v[232:235], v[56:59], v[96:99]
    ds_read_b128 v[44:47], v22 offset:24832
    v_mfma_f32_16x16x32_bf16 v[104:107], v[224:227], v[52:55], v[104:107]
    v_mfma_f32_16x16x32_bf16 v[104:107], v[232:235], v[60:63], v[104:107]
    v_mfma_f32_16x16x32_bf16 v[108:111], v[228:231], v[52:55], v[108:111]
    v_mfma_f32_16x16x32_bf16 v[108:111], v[236:239], v[60:63], v[108:111]
    v_mfma_f32_16x16x32_bf16 v[100:103], v[228:231], v[48:51], v[100:103]
    v_mfma_f32_16x16x32_bf16 v[100:103], v[236:239], v[56:59], v[100:103]
    s_waitcnt lgkmcnt(10)
    v_mfma_f32_16x16x32_bf16 v[64:67], v[240:243], v[208:211], v[64:67]
    ds_read_b128 v[192:195], v16 offset:49152
    s_waitcnt lgkmcnt(9)
    v_mfma_f32_16x16x32_bf16 v[64:67], v[248:251], v[216:219], v[64:67]
    ds_read_b128 v[200:203], v16 offset:57344
    s_waitcnt lgkmcnt(9)
    v_mfma_f32_16x16x32_bf16 v[72:75], v[240:243], v[212:215], v[72:75]
    ds_read_b128 v[196:199], v16 offset:49408
    s_waitcnt lgkmcnt(9)
    v_mfma_f32_16x16x32_bf16 v[72:75], v[248:251], v[220:223], v[72:75]
    ds_read_b128 v[204:207], v16 offset:57600
    s_waitcnt lgkmcnt(9)
    v_mfma_f32_16x16x32_bf16 v[76:79], v[244:247], v[212:215], v[76:79]
    s_waitcnt lgkmcnt(8)
    v_mfma_f32_16x16x32_bf16 v[76:79], v[252:255], v[220:223], v[76:79]
    v_mfma_f32_16x16x32_bf16 v[68:71], v[244:247], v[208:211], v[68:71]
    v_mfma_f32_16x16x32_bf16 v[68:71], v[252:255], v[216:219], v[68:71]
    s_waitcnt lgkmcnt(7)
    v_mfma_f32_16x16x32_bf16 v[80:83], v[240:243], v[32:35], v[80:83]
    s_waitcnt lgkmcnt(6)
    v_mfma_f32_16x16x32_bf16 v[80:83], v[248:251], v[40:43], v[80:83]
    s_waitcnt lgkmcnt(5)
    v_mfma_f32_16x16x32_bf16 v[88:91], v[240:243], v[36:39], v[88:91]
    s_waitcnt lgkmcnt(4)
    v_mfma_f32_16x16x32_bf16 v[88:91], v[248:251], v[44:47], v[88:91]
    v_mfma_f32_16x16x32_bf16 v[92:95], v[244:247], v[36:39], v[92:95]
    v_mfma_f32_16x16x32_bf16 v[92:95], v[252:255], v[44:47], v[92:95]
    s_waitcnt lgkmcnt(0)
    s_barrier
    v_mfma_f32_16x16x32_bf16 v[84:87], v[244:247], v[32:35], v[84:87]
    ds_read_b128 v[224:227], v12 offset:0
    v_mfma_f32_16x16x32_bf16 v[84:87], v[252:255], v[40:43], v[84:87]
    ds_read_b128 v[48:51], v20 offset:0
    v_mfma_f32_16x16x32_bf16 v[112:115], v[192:195], v[32:35], v[112:115]
    ds_read_b128 v[232:235], v12 offset:8192
    v_mfma_f32_16x16x32_bf16 v[112:115], v[200:203], v[40:43], v[112:115]
    ds_read_b128 v[56:59], v20 offset:8192
    v_mfma_f32_16x16x32_bf16 v[120:123], v[192:195], v[36:39], v[120:123]
    ds_read_b128 v[52:55], v20 offset:256
    v_mfma_f32_16x16x32_bf16 v[120:123], v[200:203], v[44:47], v[120:123]
    ds_read_b128 v[60:63], v20 offset:8448
    v_mfma_f32_16x16x32_bf16 v[124:127], v[196:199], v[36:39], v[124:127]
    ds_read_b128 v[228:231], v12 offset:256
    v_mfma_f32_16x16x32_bf16 v[124:127], v[204:207], v[44:47], v[124:127]
    ds_read_b128 v[236:239], v12 offset:8448
    v_mfma_f32_16x16x32_bf16 v[116:119], v[196:199], v[32:35], v[116:119]
    ds_read_b128 v[240:243], v23 offset:0
    v_mfma_f32_16x16x32_bf16 v[116:119], v[204:207], v[40:43], v[116:119]
    ds_read_b128 v[248:251], v23 offset:8192
    v_mfma_f32_16x16x32_bf16 v[96:99], v[192:195], v[208:211], v[96:99]
    ds_read_b128 v[244:247], v23 offset:256
    v_mfma_f32_16x16x32_bf16 v[96:99], v[200:203], v[216:219], v[96:99]
    ds_read_b128 v[252:255], v23 offset:8448
    v_mfma_f32_16x16x32_bf16 v[104:107], v[192:195], v[212:215], v[104:107]
    v_mfma_f32_16x16x32_bf16 v[104:107], v[200:203], v[220:223], v[104:107]
    v_mfma_f32_16x16x32_bf16 v[108:111], v[196:199], v[212:215], v[108:111]
    v_mfma_f32_16x16x32_bf16 v[108:111], v[204:207], v[220:223], v[108:111]
    v_mfma_f32_16x16x32_bf16 v[100:103], v[196:199], v[208:211], v[100:103]
    v_mfma_f32_16x16x32_bf16 v[100:103], v[204:207], v[216:219], v[100:103]
    s_waitcnt lgkmcnt(10)
    v_mfma_f32_16x16x32_bf16 v[64:67], v[224:227], v[48:51], v[64:67]
    ds_read_b128 v[32:35], v15 offset:0
    s_waitcnt lgkmcnt(9)
    v_mfma_f32_16x16x32_bf16 v[64:67], v[232:235], v[56:59], v[64:67]
    ds_read_b128 v[40:43], v15 offset:8192
    s_waitcnt lgkmcnt(9)
    v_mfma_f32_16x16x32_bf16 v[72:75], v[224:227], v[52:55], v[72:75]
    ds_read_b128 v[36:39], v15 offset:256
    s_waitcnt lgkmcnt(9)
    v_mfma_f32_16x16x32_bf16 v[72:75], v[232:235], v[60:63], v[72:75]
    ds_read_b128 v[44:47], v15 offset:8448
    s_waitcnt lgkmcnt(9)
    v_mfma_f32_16x16x32_bf16 v[76:79], v[228:231], v[52:55], v[76:79]
    s_waitcnt lgkmcnt(8)
    v_mfma_f32_16x16x32_bf16 v[76:79], v[236:239], v[60:63], v[76:79]
    v_mfma_f32_16x16x32_bf16 v[68:71], v[228:231], v[48:51], v[68:71]
    v_mfma_f32_16x16x32_bf16 v[68:71], v[236:239], v[56:59], v[68:71]
    s_waitcnt lgkmcnt(7)
    v_mfma_f32_16x16x32_bf16 v[80:83], v[224:227], v[240:243], v[80:83]
    s_waitcnt lgkmcnt(6)
    v_mfma_f32_16x16x32_bf16 v[80:83], v[232:235], v[248:251], v[80:83]
    s_waitcnt lgkmcnt(5)
    v_mfma_f32_16x16x32_bf16 v[88:91], v[224:227], v[244:247], v[88:91]
    s_waitcnt lgkmcnt(4)
    v_mfma_f32_16x16x32_bf16 v[88:91], v[232:235], v[252:255], v[88:91]
    v_mfma_f32_16x16x32_bf16 v[92:95], v[228:231], v[244:247], v[92:95]
    v_mfma_f32_16x16x32_bf16 v[92:95], v[236:239], v[252:255], v[92:95]
    s_waitcnt lgkmcnt(0)
    s_barrier
    v_mfma_f32_16x16x32_bf16 v[84:87], v[228:231], v[240:243], v[84:87]
    ds_read_b128 v[192:195], v12 offset:16384
    v_mfma_f32_16x16x32_bf16 v[84:87], v[236:239], v[248:251], v[84:87]
    ds_read_b128 v[208:211], v20 offset:16384
    v_mfma_f32_16x16x32_bf16 v[112:115], v[32:35], v[240:243], v[112:115]
    ds_read_b128 v[200:203], v12 offset:24576
    v_mfma_f32_16x16x32_bf16 v[112:115], v[40:43], v[248:251], v[112:115]
    ds_read_b128 v[216:219], v20 offset:24576
    v_mfma_f32_16x16x32_bf16 v[120:123], v[32:35], v[244:247], v[120:123]
    ds_read_b128 v[212:215], v20 offset:16640
    v_mfma_f32_16x16x32_bf16 v[120:123], v[40:43], v[252:255], v[120:123]
    ds_read_b128 v[220:223], v20 offset:24832
    v_mfma_f32_16x16x32_bf16 v[124:127], v[36:39], v[244:247], v[124:127]
    ds_read_b128 v[196:199], v12 offset:16640
    v_mfma_f32_16x16x32_bf16 v[124:127], v[44:47], v[252:255], v[124:127]
    ds_read_b128 v[204:207], v12 offset:24832
    v_mfma_f32_16x16x32_bf16 v[116:119], v[36:39], v[240:243], v[116:119]
    ds_read_b128 v[224:227], v23 offset:16384
    v_mfma_f32_16x16x32_bf16 v[116:119], v[44:47], v[248:251], v[116:119]
    ds_read_b128 v[232:235], v23 offset:24576
    v_mfma_f32_16x16x32_bf16 v[96:99], v[32:35], v[48:51], v[96:99]
    ds_read_b128 v[228:231], v23 offset:16640
    v_mfma_f32_16x16x32_bf16 v[96:99], v[40:43], v[56:59], v[96:99]
    ds_read_b128 v[236:239], v23 offset:24832
    v_mfma_f32_16x16x32_bf16 v[104:107], v[32:35], v[52:55], v[104:107]
    v_mfma_f32_16x16x32_bf16 v[104:107], v[40:43], v[60:63], v[104:107]
    v_mfma_f32_16x16x32_bf16 v[108:111], v[36:39], v[52:55], v[108:111]
    v_mfma_f32_16x16x32_bf16 v[108:111], v[44:47], v[60:63], v[108:111]
    v_mfma_f32_16x16x32_bf16 v[100:103], v[36:39], v[48:51], v[100:103]
    v_mfma_f32_16x16x32_bf16 v[100:103], v[44:47], v[56:59], v[100:103]
    s_waitcnt lgkmcnt(10)
    v_mfma_f32_16x16x32_bf16 v[128:131], v[192:195], v[208:211], 0
    ds_read_b128 v[240:243], v15 offset:16384
    s_waitcnt lgkmcnt(9)
    v_mfma_f32_16x16x32_bf16 v[128:131], v[200:203], v[216:219], v[128:131]
    ds_read_b128 v[248:251], v15 offset:24576
    s_waitcnt lgkmcnt(9)
    v_mfma_f32_16x16x32_bf16 v[136:139], v[192:195], v[212:215], 0
    ds_read_b128 v[244:247], v15 offset:16640
    s_waitcnt lgkmcnt(9)
    v_mfma_f32_16x16x32_bf16 v[136:139], v[200:203], v[220:223], v[136:139]
    ds_read_b128 v[252:255], v15 offset:24832
    s_waitcnt lgkmcnt(9)
    v_mfma_f32_16x16x32_bf16 v[140:143], v[196:199], v[212:215], 0
    s_waitcnt lgkmcnt(8)
    v_mfma_f32_16x16x32_bf16 v[140:143], v[204:207], v[220:223], v[140:143]
    v_mfma_f32_16x16x32_bf16 v[132:135], v[196:199], v[208:211], 0
    v_mfma_f32_16x16x32_bf16 v[132:135], v[204:207], v[216:219], v[132:135]
    s_waitcnt lgkmcnt(7)
    v_mfma_f32_16x16x32_bf16 v[144:147], v[192:195], v[224:227], 0
    s_waitcnt lgkmcnt(6)
    v_mfma_f32_16x16x32_bf16 v[144:147], v[200:203], v[232:235], v[144:147]
    s_waitcnt lgkmcnt(5)
    v_mfma_f32_16x16x32_bf16 v[152:155], v[192:195], v[228:231], 0
    s_waitcnt lgkmcnt(4)
    v_mfma_f32_16x16x32_bf16 v[152:155], v[200:203], v[236:239], v[152:155]
    v_mfma_f32_16x16x32_bf16 v[156:159], v[196:199], v[228:231], 0
    v_mfma_f32_16x16x32_bf16 v[156:159], v[204:207], v[236:239], v[156:159]
    s_waitcnt lgkmcnt(0)
    s_barrier
    v_mfma_f32_16x16x32_bf16 v[148:151], v[196:199], v[224:227], 0
    ds_read_b128 v[32:35], v12 offset:32768
    v_mfma_f32_16x16x32_bf16 v[148:151], v[204:207], v[232:235], v[148:151]
    ds_read_b128 v[48:51], v19 offset:0
    v_mfma_f32_16x16x32_bf16 v[176:179], v[240:243], v[224:227], 0
    ds_read_b128 v[40:43], v12 offset:40960
    v_mfma_f32_16x16x32_bf16 v[176:179], v[248:251], v[232:235], v[176:179]
    ds_read_b128 v[56:59], v19 offset:8192
    v_mfma_f32_16x16x32_bf16 v[184:187], v[240:243], v[228:231], 0
    ds_read_b128 v[52:55], v19 offset:256
    v_mfma_f32_16x16x32_bf16 v[184:187], v[248:251], v[236:239], v[184:187]
    ds_read_b128 v[60:63], v19 offset:8448
    v_mfma_f32_16x16x32_bf16 v[188:191], v[244:247], v[228:231], 0
    ds_read_b128 v[36:39], v12 offset:33024
    v_mfma_f32_16x16x32_bf16 v[188:191], v[252:255], v[236:239], v[188:191]
    ds_read_b128 v[44:47], v12 offset:41216
    v_mfma_f32_16x16x32_bf16 v[180:183], v[244:247], v[224:227], 0
    ds_read_b128 v[192:195], v22 offset:0
    v_mfma_f32_16x16x32_bf16 v[180:183], v[252:255], v[232:235], v[180:183]
    ds_read_b128 v[200:203], v22 offset:8192
    v_mfma_f32_16x16x32_bf16 v[160:163], v[240:243], v[208:211], 0
    ds_read_b128 v[196:199], v22 offset:256
    v_mfma_f32_16x16x32_bf16 v[160:163], v[248:251], v[216:219], v[160:163]
    ds_read_b128 v[204:207], v22 offset:8448
    v_mfma_f32_16x16x32_bf16 v[168:171], v[240:243], v[212:215], 0
    v_mfma_f32_16x16x32_bf16 v[168:171], v[248:251], v[220:223], v[168:171]
    v_mfma_f32_16x16x32_bf16 v[172:175], v[244:247], v[212:215], 0
    v_mfma_f32_16x16x32_bf16 v[172:175], v[252:255], v[220:223], v[172:175]
    v_mfma_f32_16x16x32_bf16 v[164:167], v[244:247], v[208:211], 0
    v_mfma_f32_16x16x32_bf16 v[164:167], v[252:255], v[216:219], v[164:167]
    s_waitcnt lgkmcnt(10)
    v_mfma_f32_16x16x32_bf16 v[128:131], v[32:35], v[48:51], v[128:131]
    ds_read_b128 v[224:227], v15 offset:32768
    s_waitcnt lgkmcnt(9)
    v_mfma_f32_16x16x32_bf16 v[128:131], v[40:43], v[56:59], v[128:131]
    ds_read_b128 v[232:235], v15 offset:40960
    s_waitcnt lgkmcnt(9)
    v_mfma_f32_16x16x32_bf16 v[136:139], v[32:35], v[52:55], v[136:139]
    ds_read_b128 v[228:231], v15 offset:33024
    s_waitcnt lgkmcnt(9)
    v_mfma_f32_16x16x32_bf16 v[136:139], v[40:43], v[60:63], v[136:139]
    ds_read_b128 v[236:239], v15 offset:41216
    s_waitcnt lgkmcnt(9)
    v_mfma_f32_16x16x32_bf16 v[140:143], v[36:39], v[52:55], v[140:143]
    s_waitcnt lgkmcnt(8)
    v_mfma_f32_16x16x32_bf16 v[140:143], v[44:47], v[60:63], v[140:143]
    v_mfma_f32_16x16x32_bf16 v[132:135], v[36:39], v[48:51], v[132:135]
    v_mfma_f32_16x16x32_bf16 v[132:135], v[44:47], v[56:59], v[132:135]
    s_waitcnt lgkmcnt(7)
    v_mfma_f32_16x16x32_bf16 v[144:147], v[32:35], v[192:195], v[144:147]
    s_waitcnt lgkmcnt(6)
    v_mfma_f32_16x16x32_bf16 v[144:147], v[40:43], v[200:203], v[144:147]
    s_waitcnt lgkmcnt(5)
    v_mfma_f32_16x16x32_bf16 v[152:155], v[32:35], v[196:199], v[152:155]
    s_waitcnt lgkmcnt(4)
    v_mfma_f32_16x16x32_bf16 v[152:155], v[40:43], v[204:207], v[152:155]
    v_mfma_f32_16x16x32_bf16 v[156:159], v[36:39], v[196:199], v[156:159]
    v_mfma_f32_16x16x32_bf16 v[156:159], v[44:47], v[204:207], v[156:159]
    s_waitcnt lgkmcnt(0)
    s_barrier
    v_mfma_f32_16x16x32_bf16 v[148:151], v[36:39], v[192:195], v[148:151]
    ds_read_b128 v[240:243], v12 offset:49152
    v_mfma_f32_16x16x32_bf16 v[148:151], v[44:47], v[200:203], v[148:151]
    ds_read_b128 v[208:211], v19 offset:32768
    v_mfma_f32_16x16x32_bf16 v[176:179], v[224:227], v[192:195], v[176:179]
    ds_read_b128 v[248:251], v12 offset:57344
    v_mfma_f32_16x16x32_bf16 v[176:179], v[232:235], v[200:203], v[176:179]
    ds_read_b128 v[216:219], v19 offset:40960
    v_mfma_f32_16x16x32_bf16 v[184:187], v[224:227], v[196:199], v[184:187]
    ds_read_b128 v[212:215], v19 offset:33024
    v_mfma_f32_16x16x32_bf16 v[184:187], v[232:235], v[204:207], v[184:187]
    ds_read_b128 v[220:223], v19 offset:41216
    v_mfma_f32_16x16x32_bf16 v[188:191], v[228:231], v[196:199], v[188:191]
    ds_read_b128 v[244:247], v12 offset:49408
    v_mfma_f32_16x16x32_bf16 v[188:191], v[236:239], v[204:207], v[188:191]
    ds_read_b128 v[252:255], v12 offset:57600
    v_mfma_f32_16x16x32_bf16 v[180:183], v[228:231], v[192:195], v[180:183]
    ds_read_b128 v[32:35], v22 offset:32768
    v_mfma_f32_16x16x32_bf16 v[180:183], v[236:239], v[200:203], v[180:183]
    ds_read_b128 v[40:43], v22 offset:40960
    v_mfma_f32_16x16x32_bf16 v[160:163], v[224:227], v[48:51], v[160:163]
    ds_read_b128 v[36:39], v22 offset:33024
    v_mfma_f32_16x16x32_bf16 v[160:163], v[232:235], v[56:59], v[160:163]
    ds_read_b128 v[44:47], v22 offset:41216
    v_mfma_f32_16x16x32_bf16 v[168:171], v[224:227], v[52:55], v[168:171]
    v_mfma_f32_16x16x32_bf16 v[168:171], v[232:235], v[60:63], v[168:171]
    v_mfma_f32_16x16x32_bf16 v[172:175], v[228:231], v[52:55], v[172:175]
    v_mfma_f32_16x16x32_bf16 v[172:175], v[236:239], v[60:63], v[172:175]
    v_mfma_f32_16x16x32_bf16 v[164:167], v[228:231], v[48:51], v[164:167]
    v_mfma_f32_16x16x32_bf16 v[164:167], v[236:239], v[56:59], v[164:167]
    s_waitcnt lgkmcnt(10)
    v_mfma_f32_16x16x32_bf16 v[128:131], v[240:243], v[208:211], v[128:131]
    ds_read_b128 v[192:195], v15 offset:49152
    s_waitcnt lgkmcnt(9)
    v_mfma_f32_16x16x32_bf16 v[128:131], v[248:251], v[216:219], v[128:131]
    ds_read_b128 v[200:203], v15 offset:57344
    s_waitcnt lgkmcnt(9)
    v_mfma_f32_16x16x32_bf16 v[136:139], v[240:243], v[212:215], v[136:139]
    ds_read_b128 v[196:199], v15 offset:49408
    s_waitcnt lgkmcnt(9)
    v_mfma_f32_16x16x32_bf16 v[136:139], v[248:251], v[220:223], v[136:139]
    ds_read_b128 v[204:207], v15 offset:57600
    s_waitcnt lgkmcnt(9)
    v_mfma_f32_16x16x32_bf16 v[140:143], v[244:247], v[212:215], v[140:143]
    s_waitcnt lgkmcnt(8)
    v_mfma_f32_16x16x32_bf16 v[140:143], v[252:255], v[220:223], v[140:143]
    v_mfma_f32_16x16x32_bf16 v[132:135], v[244:247], v[208:211], v[132:135]
    v_mfma_f32_16x16x32_bf16 v[132:135], v[252:255], v[216:219], v[132:135]
    s_waitcnt lgkmcnt(7)
    v_mfma_f32_16x16x32_bf16 v[144:147], v[240:243], v[32:35], v[144:147]
    s_waitcnt lgkmcnt(6)
    v_mfma_f32_16x16x32_bf16 v[144:147], v[248:251], v[40:43], v[144:147]
    s_waitcnt lgkmcnt(5)
    v_mfma_f32_16x16x32_bf16 v[152:155], v[240:243], v[36:39], v[152:155]
    s_waitcnt lgkmcnt(4)
    v_mfma_f32_16x16x32_bf16 v[152:155], v[248:251], v[44:47], v[152:155]
    v_mfma_f32_16x16x32_bf16 v[156:159], v[244:247], v[36:39], v[156:159]
    v_mfma_f32_16x16x32_bf16 v[156:159], v[252:255], v[44:47], v[156:159]
    s_waitcnt lgkmcnt(0)
    s_barrier
    v_mfma_f32_16x16x32_bf16 v[148:151], v[244:247], v[32:35], v[148:151]
    ds_read_b128 v[224:227], v13 offset:49152
    v_mfma_f32_16x16x32_bf16 v[148:151], v[252:255], v[40:43], v[148:151]
    ds_read_b128 v[48:51], v19 offset:16384
    v_mfma_f32_16x16x32_bf16 v[176:179], v[192:195], v[32:35], v[176:179]
    ds_read_b128 v[232:235], v13 offset:57344
    v_mfma_f32_16x16x32_bf16 v[176:179], v[200:203], v[40:43], v[176:179]
    ds_read_b128 v[56:59], v19 offset:24576
    v_mfma_f32_16x16x32_bf16 v[184:187], v[192:195], v[36:39], v[184:187]
    ds_read_b128 v[52:55], v19 offset:16640
    v_mfma_f32_16x16x32_bf16 v[184:187], v[200:203], v[44:47], v[184:187]
    ds_read_b128 v[60:63], v19 offset:24832
    v_mfma_f32_16x16x32_bf16 v[188:191], v[196:199], v[36:39], v[188:191]
    ds_read_b128 v[228:231], v13 offset:49408
    v_mfma_f32_16x16x32_bf16 v[188:191], v[204:207], v[44:47], v[188:191]
    ds_read_b128 v[236:239], v13 offset:57600
    v_mfma_f32_16x16x32_bf16 v[180:183], v[196:199], v[32:35], v[180:183]
    ds_read_b128 v[240:243], v22 offset:16384
    v_mfma_f32_16x16x32_bf16 v[180:183], v[204:207], v[40:43], v[180:183]
    ds_read_b128 v[248:251], v22 offset:24576
    v_mfma_f32_16x16x32_bf16 v[160:163], v[192:195], v[208:211], v[160:163]
    ds_read_b128 v[244:247], v22 offset:16640
    v_mfma_f32_16x16x32_bf16 v[160:163], v[200:203], v[216:219], v[160:163]
    ds_read_b128 v[252:255], v22 offset:24832
    v_mfma_f32_16x16x32_bf16 v[168:171], v[192:195], v[212:215], v[168:171]
    v_mfma_f32_16x16x32_bf16 v[168:171], v[200:203], v[220:223], v[168:171]
    v_mfma_f32_16x16x32_bf16 v[172:175], v[196:199], v[212:215], v[172:175]
    v_mfma_f32_16x16x32_bf16 v[172:175], v[204:207], v[220:223], v[172:175]
    v_mfma_f32_16x16x32_bf16 v[164:167], v[196:199], v[208:211], v[164:167]
    v_mfma_f32_16x16x32_bf16 v[164:167], v[204:207], v[216:219], v[164:167]
    s_waitcnt lgkmcnt(10)
    v_mfma_f32_16x16x32_bf16 v[128:131], v[224:227], v[48:51], v[128:131]
    ds_read_b128 v[32:35], v16 offset:49152
    s_waitcnt lgkmcnt(9)
    v_mfma_f32_16x16x32_bf16 v[128:131], v[232:235], v[56:59], v[128:131]
    ds_read_b128 v[40:43], v16 offset:57344
    s_waitcnt lgkmcnt(9)
    v_mfma_f32_16x16x32_bf16 v[136:139], v[224:227], v[52:55], v[136:139]
    ds_read_b128 v[36:39], v16 offset:49408
    s_waitcnt lgkmcnt(9)
    v_mfma_f32_16x16x32_bf16 v[136:139], v[232:235], v[60:63], v[136:139]
    ds_read_b128 v[44:47], v16 offset:57600
    s_waitcnt lgkmcnt(9)
    v_mfma_f32_16x16x32_bf16 v[140:143], v[228:231], v[52:55], v[140:143]
    s_waitcnt lgkmcnt(8)
    v_mfma_f32_16x16x32_bf16 v[140:143], v[236:239], v[60:63], v[140:143]
    v_mfma_f32_16x16x32_bf16 v[132:135], v[228:231], v[48:51], v[132:135]
    v_mfma_f32_16x16x32_bf16 v[132:135], v[236:239], v[56:59], v[132:135]
    s_waitcnt lgkmcnt(7)
    v_mfma_f32_16x16x32_bf16 v[144:147], v[224:227], v[240:243], v[144:147]
    s_waitcnt lgkmcnt(6)
    v_mfma_f32_16x16x32_bf16 v[144:147], v[232:235], v[248:251], v[144:147]
    s_waitcnt lgkmcnt(5)
    v_mfma_f32_16x16x32_bf16 v[152:155], v[224:227], v[244:247], v[152:155]
    s_waitcnt lgkmcnt(4)
    v_mfma_f32_16x16x32_bf16 v[152:155], v[232:235], v[252:255], v[152:155]
    v_mfma_f32_16x16x32_bf16 v[156:159], v[228:231], v[244:247], v[156:159]
    v_mfma_f32_16x16x32_bf16 v[156:159], v[236:239], v[252:255], v[156:159]
    s_waitcnt lgkmcnt(0)
    s_barrier
    v_mfma_f32_16x16x32_bf16 v[148:151], v[228:231], v[240:243], v[148:151]
    ds_read_b128 v[192:195], v12 offset:0
    v_mfma_f32_16x16x32_bf16 v[148:151], v[236:239], v[248:251], v[148:151]
    ds_read_b128 v[208:211], v20 offset:0
    v_mfma_f32_16x16x32_bf16 v[176:179], v[32:35], v[240:243], v[176:179]
    ds_read_b128 v[200:203], v12 offset:8192
    v_mfma_f32_16x16x32_bf16 v[176:179], v[40:43], v[248:251], v[176:179]
    ds_read_b128 v[216:219], v20 offset:8192
    v_mfma_f32_16x16x32_bf16 v[184:187], v[32:35], v[244:247], v[184:187]
    ds_read_b128 v[212:215], v20 offset:256
    v_mfma_f32_16x16x32_bf16 v[184:187], v[40:43], v[252:255], v[184:187]
    ds_read_b128 v[220:223], v20 offset:8448
    v_mfma_f32_16x16x32_bf16 v[188:191], v[36:39], v[244:247], v[188:191]
    ds_read_b128 v[196:199], v12 offset:256
    v_mfma_f32_16x16x32_bf16 v[188:191], v[44:47], v[252:255], v[188:191]
    ds_read_b128 v[204:207], v12 offset:8448
    v_mfma_f32_16x16x32_bf16 v[180:183], v[36:39], v[240:243], v[180:183]
    ds_read_b128 v[224:227], v23 offset:0
    v_mfma_f32_16x16x32_bf16 v[180:183], v[44:47], v[248:251], v[180:183]
    ds_read_b128 v[232:235], v23 offset:8192
    v_mfma_f32_16x16x32_bf16 v[160:163], v[32:35], v[48:51], v[160:163]
    ds_read_b128 v[228:231], v23 offset:256
    v_mfma_f32_16x16x32_bf16 v[160:163], v[40:43], v[56:59], v[160:163]
    ds_read_b128 v[236:239], v23 offset:8448
    v_mfma_f32_16x16x32_bf16 v[168:171], v[32:35], v[52:55], v[168:171]
    v_mfma_f32_16x16x32_bf16 v[168:171], v[40:43], v[60:63], v[168:171]
    v_mfma_f32_16x16x32_bf16 v[172:175], v[36:39], v[52:55], v[172:175]
    v_mfma_f32_16x16x32_bf16 v[172:175], v[44:47], v[60:63], v[172:175]
    v_mfma_f32_16x16x32_bf16 v[164:167], v[36:39], v[48:51], v[164:167]
    v_mfma_f32_16x16x32_bf16 v[164:167], v[44:47], v[56:59], v[164:167]
    s_waitcnt lgkmcnt(10)
    v_mfma_f32_16x16x32_bf16 v[128:131], v[192:195], v[208:211], v[128:131]
    ds_read_b128 v[240:243], v15 offset:0
    s_waitcnt lgkmcnt(9)
    v_mfma_f32_16x16x32_bf16 v[128:131], v[200:203], v[216:219], v[128:131]
    ds_read_b128 v[248:251], v15 offset:8192
    s_waitcnt lgkmcnt(9)
    v_mfma_f32_16x16x32_bf16 v[136:139], v[192:195], v[212:215], v[136:139]
    ds_read_b128 v[244:247], v15 offset:256
    s_waitcnt lgkmcnt(9)
    v_mfma_f32_16x16x32_bf16 v[136:139], v[200:203], v[220:223], v[136:139]
    ds_read_b128 v[252:255], v15 offset:8448
    s_waitcnt lgkmcnt(9)
    v_mfma_f32_16x16x32_bf16 v[140:143], v[196:199], v[212:215], v[140:143]
    s_waitcnt lgkmcnt(8)
    v_mfma_f32_16x16x32_bf16 v[140:143], v[204:207], v[220:223], v[140:143]
    v_mfma_f32_16x16x32_bf16 v[132:135], v[196:199], v[208:211], v[132:135]
    v_mfma_f32_16x16x32_bf16 v[132:135], v[204:207], v[216:219], v[132:135]
    s_waitcnt lgkmcnt(7)
    v_mfma_f32_16x16x32_bf16 v[144:147], v[192:195], v[224:227], v[144:147]
    s_waitcnt lgkmcnt(6)
    v_mfma_f32_16x16x32_bf16 v[144:147], v[200:203], v[232:235], v[144:147]
    s_waitcnt lgkmcnt(5)
    v_mfma_f32_16x16x32_bf16 v[152:155], v[192:195], v[228:231], v[152:155]
    s_waitcnt lgkmcnt(4)
    v_mfma_f32_16x16x32_bf16 v[152:155], v[200:203], v[236:239], v[152:155]
    v_mfma_f32_16x16x32_bf16 v[156:159], v[196:199], v[228:231], v[156:159]
    v_mfma_f32_16x16x32_bf16 v[156:159], v[204:207], v[236:239], v[156:159]
    s_waitcnt lgkmcnt(0)
    s_barrier
    v_mfma_f32_16x16x32_bf16 v[148:151], v[196:199], v[224:227], v[148:151]
    ds_read_b128 v[32:35], v12 offset:16384
    v_mfma_f32_16x16x32_bf16 v[148:151], v[204:207], v[232:235], v[148:151]
    ds_read_b128 v[48:51], v20 offset:16384
    v_mfma_f32_16x16x32_bf16 v[176:179], v[240:243], v[224:227], v[176:179]
    ds_read_b128 v[40:43], v12 offset:24576
    v_mfma_f32_16x16x32_bf16 v[176:179], v[248:251], v[232:235], v[176:179]
    ds_read_b128 v[56:59], v20 offset:24576
    v_mfma_f32_16x16x32_bf16 v[184:187], v[240:243], v[228:231], v[184:187]
    ds_read_b128 v[52:55], v20 offset:16640
    v_mfma_f32_16x16x32_bf16 v[184:187], v[248:251], v[236:239], v[184:187]
    ds_read_b128 v[60:63], v20 offset:24832
    v_mfma_f32_16x16x32_bf16 v[188:191], v[244:247], v[228:231], v[188:191]
    ds_read_b128 v[36:39], v12 offset:16640
    v_mfma_f32_16x16x32_bf16 v[188:191], v[252:255], v[236:239], v[188:191]
    ds_read_b128 v[44:47], v12 offset:24832
    v_mfma_f32_16x16x32_bf16 v[180:183], v[244:247], v[224:227], v[180:183]
    ds_read_b128 v[192:195], v23 offset:16384
    v_mfma_f32_16x16x32_bf16 v[180:183], v[252:255], v[232:235], v[180:183]
    ds_read_b128 v[200:203], v23 offset:24576
    v_mfma_f32_16x16x32_bf16 v[160:163], v[240:243], v[208:211], v[160:163]
    ds_read_b128 v[196:199], v23 offset:16640
    v_mfma_f32_16x16x32_bf16 v[160:163], v[248:251], v[216:219], v[160:163]
    ds_read_b128 v[204:207], v23 offset:24832
    v_mfma_f32_16x16x32_bf16 v[168:171], v[240:243], v[212:215], v[168:171]
    v_mfma_f32_16x16x32_bf16 v[168:171], v[248:251], v[220:223], v[168:171]
    v_mfma_f32_16x16x32_bf16 v[172:175], v[244:247], v[212:215], v[172:175]
    v_mfma_f32_16x16x32_bf16 v[172:175], v[252:255], v[220:223], v[172:175]
    v_mfma_f32_16x16x32_bf16 v[164:167], v[244:247], v[208:211], v[164:167]
    v_mfma_f32_16x16x32_bf16 v[164:167], v[252:255], v[216:219], v[164:167]
    s_waitcnt lgkmcnt(10)
    v_mfma_f32_16x16x32_bf16 v[128:131], v[32:35], v[48:51], v[128:131]
    ds_read_b128 v[224:227], v15 offset:16384
    s_waitcnt lgkmcnt(9)
    v_mfma_f32_16x16x32_bf16 v[128:131], v[40:43], v[56:59], v[128:131]
    ds_read_b128 v[232:235], v15 offset:24576
    s_waitcnt lgkmcnt(9)
    v_mfma_f32_16x16x32_bf16 v[136:139], v[32:35], v[52:55], v[136:139]
    ds_read_b128 v[228:231], v15 offset:16640
    s_waitcnt lgkmcnt(9)
    v_mfma_f32_16x16x32_bf16 v[136:139], v[40:43], v[60:63], v[136:139]
    ds_read_b128 v[236:239], v15 offset:24832
    s_waitcnt lgkmcnt(9)
    v_mfma_f32_16x16x32_bf16 v[140:143], v[36:39], v[52:55], v[140:143]
    s_waitcnt lgkmcnt(8)
    v_mfma_f32_16x16x32_bf16 v[140:143], v[44:47], v[60:63], v[140:143]
    v_mfma_f32_16x16x32_bf16 v[132:135], v[36:39], v[48:51], v[132:135]
    v_mfma_f32_16x16x32_bf16 v[132:135], v[44:47], v[56:59], v[132:135]
    s_waitcnt lgkmcnt(7)
    v_mfma_f32_16x16x32_bf16 v[144:147], v[32:35], v[192:195], v[144:147]
    s_waitcnt lgkmcnt(6)
    v_mfma_f32_16x16x32_bf16 v[144:147], v[40:43], v[200:203], v[144:147]
    s_waitcnt lgkmcnt(5)
    v_mfma_f32_16x16x32_bf16 v[152:155], v[32:35], v[196:199], v[152:155]
    s_waitcnt lgkmcnt(4)
    v_mfma_f32_16x16x32_bf16 v[152:155], v[40:43], v[204:207], v[152:155]
    v_mfma_f32_16x16x32_bf16 v[156:159], v[36:39], v[196:199], v[156:159]
    v_mfma_f32_16x16x32_bf16 v[156:159], v[44:47], v[204:207], v[156:159]
    s_waitcnt lgkmcnt(0)
    s_barrier
    v_mfma_f32_16x16x32_bf16 v[148:151], v[36:39], v[192:195], v[148:151]
    ds_read_b128 v[240:243], v12 offset:32768
    v_mfma_f32_16x16x32_bf16 v[148:151], v[44:47], v[200:203], v[148:151]
    ds_read_b128 v[208:211], v19 offset:0
    v_mfma_f32_16x16x32_bf16 v[176:179], v[224:227], v[192:195], v[176:179]
    ds_read_b128 v[248:251], v12 offset:40960
    v_mfma_f32_16x16x32_bf16 v[176:179], v[232:235], v[200:203], v[176:179]
    ds_read_b128 v[216:219], v19 offset:8192
    v_mfma_f32_16x16x32_bf16 v[184:187], v[224:227], v[196:199], v[184:187]
    ds_read_b128 v[212:215], v19 offset:256
    v_mfma_f32_16x16x32_bf16 v[184:187], v[232:235], v[204:207], v[184:187]
    ds_read_b128 v[220:223], v19 offset:8448
    v_mfma_f32_16x16x32_bf16 v[188:191], v[228:231], v[196:199], v[188:191]
    ds_read_b128 v[244:247], v12 offset:33024
    v_mfma_f32_16x16x32_bf16 v[188:191], v[236:239], v[204:207], v[188:191]
    ds_read_b128 v[252:255], v12 offset:41216
    v_mfma_f32_16x16x32_bf16 v[180:183], v[228:231], v[192:195], v[180:183]
    ds_read_b128 v[32:35], v22 offset:0
    v_mfma_f32_16x16x32_bf16 v[180:183], v[236:239], v[200:203], v[180:183]
    ds_read_b128 v[40:43], v22 offset:8192
    v_mfma_f32_16x16x32_bf16 v[160:163], v[224:227], v[48:51], v[160:163]
    ds_read_b128 v[36:39], v22 offset:256
    v_mfma_f32_16x16x32_bf16 v[160:163], v[232:235], v[56:59], v[160:163]
    ds_read_b128 v[44:47], v22 offset:8448
    v_mfma_f32_16x16x32_bf16 v[168:171], v[224:227], v[52:55], v[168:171]
    v_mfma_f32_16x16x32_bf16 v[168:171], v[232:235], v[60:63], v[168:171]
    v_mfma_f32_16x16x32_bf16 v[172:175], v[228:231], v[52:55], v[172:175]
    v_mfma_f32_16x16x32_bf16 v[172:175], v[236:239], v[60:63], v[172:175]
    v_mfma_f32_16x16x32_bf16 v[164:167], v[228:231], v[48:51], v[164:167]
    v_mfma_f32_16x16x32_bf16 v[164:167], v[236:239], v[56:59], v[164:167]
    s_waitcnt lgkmcnt(10)
    v_mfma_f32_16x16x32_bf16 v[128:131], v[240:243], v[208:211], v[128:131]
    ds_read_b128 v[192:195], v15 offset:32768
    s_waitcnt lgkmcnt(9)
    v_mfma_f32_16x16x32_bf16 v[128:131], v[248:251], v[216:219], v[128:131]
    ds_read_b128 v[200:203], v15 offset:40960
    s_waitcnt lgkmcnt(9)
    v_mfma_f32_16x16x32_bf16 v[136:139], v[240:243], v[212:215], v[136:139]
    ds_read_b128 v[196:199], v15 offset:33024
    s_waitcnt lgkmcnt(9)
    v_mfma_f32_16x16x32_bf16 v[136:139], v[248:251], v[220:223], v[136:139]
    ds_read_b128 v[204:207], v15 offset:41216
    s_waitcnt lgkmcnt(9)
    v_mfma_f32_16x16x32_bf16 v[140:143], v[244:247], v[212:215], v[140:143]
    s_waitcnt lgkmcnt(8)
    v_mfma_f32_16x16x32_bf16 v[140:143], v[252:255], v[220:223], v[140:143]
    v_mfma_f32_16x16x32_bf16 v[132:135], v[244:247], v[208:211], v[132:135]
    v_mfma_f32_16x16x32_bf16 v[132:135], v[252:255], v[216:219], v[132:135]
    s_waitcnt lgkmcnt(7)
    v_mfma_f32_16x16x32_bf16 v[144:147], v[240:243], v[32:35], v[144:147]
    s_waitcnt lgkmcnt(6)
    v_mfma_f32_16x16x32_bf16 v[144:147], v[248:251], v[40:43], v[144:147]
    s_waitcnt lgkmcnt(5)
    v_mfma_f32_16x16x32_bf16 v[152:155], v[240:243], v[36:39], v[152:155]
    s_waitcnt lgkmcnt(4)
    v_mfma_f32_16x16x32_bf16 v[152:155], v[248:251], v[44:47], v[152:155]
    v_mfma_f32_16x16x32_bf16 v[156:159], v[244:247], v[36:39], v[156:159]
    v_mfma_f32_16x16x32_bf16 v[156:159], v[252:255], v[44:47], v[156:159]
    s_waitcnt lgkmcnt(0)
    s_barrier
    v_mfma_f32_16x16x32_bf16 v[148:151], v[244:247], v[32:35], v[148:151]
    ds_read_b128 v[224:227], v12 offset:49152
    v_mfma_f32_16x16x32_bf16 v[148:151], v[252:255], v[40:43], v[148:151]
    ds_read_b128 v[48:51], v19 offset:32768
    v_mfma_f32_16x16x32_bf16 v[176:179], v[192:195], v[32:35], v[176:179]
    ds_read_b128 v[232:235], v12 offset:57344
    v_mfma_f32_16x16x32_bf16 v[176:179], v[200:203], v[40:43], v[176:179]
    ds_read_b128 v[56:59], v19 offset:40960
    v_mfma_f32_16x16x32_bf16 v[184:187], v[192:195], v[36:39], v[184:187]
    ds_read_b128 v[52:55], v19 offset:33024
    v_mfma_f32_16x16x32_bf16 v[184:187], v[200:203], v[44:47], v[184:187]
    ds_read_b128 v[60:63], v19 offset:41216
    v_mfma_f32_16x16x32_bf16 v[188:191], v[196:199], v[36:39], v[188:191]
    ds_read_b128 v[228:231], v12 offset:49408
    v_mfma_f32_16x16x32_bf16 v[188:191], v[204:207], v[44:47], v[188:191]
    ds_read_b128 v[236:239], v12 offset:57600
    v_mfma_f32_16x16x32_bf16 v[180:183], v[196:199], v[32:35], v[180:183]
    ds_read_b128 v[240:243], v22 offset:32768
    v_mfma_f32_16x16x32_bf16 v[180:183], v[204:207], v[40:43], v[180:183]
    ds_read_b128 v[248:251], v22 offset:40960
    v_mfma_f32_16x16x32_bf16 v[160:163], v[192:195], v[208:211], v[160:163]
    ds_read_b128 v[244:247], v22 offset:33024
    v_mfma_f32_16x16x32_bf16 v[160:163], v[200:203], v[216:219], v[160:163]
    ds_read_b128 v[252:255], v22 offset:41216
    v_mfma_f32_16x16x32_bf16 v[168:171], v[192:195], v[212:215], v[168:171]
    v_mfma_f32_16x16x32_bf16 v[168:171], v[200:203], v[220:223], v[168:171]
    v_mfma_f32_16x16x32_bf16 v[172:175], v[196:199], v[212:215], v[172:175]
    v_mfma_f32_16x16x32_bf16 v[172:175], v[204:207], v[220:223], v[172:175]
    v_mfma_f32_16x16x32_bf16 v[164:167], v[196:199], v[208:211], v[164:167]
    v_mfma_f32_16x16x32_bf16 v[164:167], v[204:207], v[216:219], v[164:167]
    s_waitcnt lgkmcnt(10)
    v_mfma_f32_16x16x32_bf16 v[128:131], v[224:227], v[48:51], v[128:131]
    ds_read_b128 v[32:35], v15 offset:49152
    s_waitcnt lgkmcnt(9)
    v_mfma_f32_16x16x32_bf16 v[128:131], v[232:235], v[56:59], v[128:131]
    ds_read_b128 v[40:43], v15 offset:57344
    s_waitcnt lgkmcnt(9)
    v_mfma_f32_16x16x32_bf16 v[136:139], v[224:227], v[52:55], v[136:139]
    ds_read_b128 v[36:39], v15 offset:49408
    s_waitcnt lgkmcnt(9)
    v_mfma_f32_16x16x32_bf16 v[136:139], v[232:235], v[60:63], v[136:139]
    ds_read_b128 v[44:47], v15 offset:57600
    s_waitcnt lgkmcnt(9)
    v_mfma_f32_16x16x32_bf16 v[140:143], v[228:231], v[52:55], v[140:143]
    s_waitcnt lgkmcnt(8)
    v_mfma_f32_16x16x32_bf16 v[140:143], v[236:239], v[60:63], v[140:143]
    v_mfma_f32_16x16x32_bf16 v[132:135], v[228:231], v[48:51], v[132:135]
    v_mfma_f32_16x16x32_bf16 v[132:135], v[236:239], v[56:59], v[132:135]
    s_waitcnt lgkmcnt(7)
    v_mfma_f32_16x16x32_bf16 v[144:147], v[224:227], v[240:243], v[144:147]
    s_waitcnt lgkmcnt(6)
    v_mfma_f32_16x16x32_bf16 v[144:147], v[232:235], v[248:251], v[144:147]
    s_waitcnt lgkmcnt(5)
    v_mfma_f32_16x16x32_bf16 v[152:155], v[224:227], v[244:247], v[152:155]
    s_waitcnt lgkmcnt(4)
    v_mfma_f32_16x16x32_bf16 v[152:155], v[232:235], v[252:255], v[152:155]
    v_mfma_f32_16x16x32_bf16 v[156:159], v[228:231], v[244:247], v[156:159]
    v_mfma_f32_16x16x32_bf16 v[156:159], v[236:239], v[252:255], v[156:159]
    s_waitcnt lgkmcnt(0)
    s_barrier
    s_barrier
    v_mfma_f32_16x16x32_bf16 v[148:151], v[228:231], v[240:243], v[148:151]
    ds_read_b128 v[192:195], v13 offset:49152
    v_mfma_f32_16x16x32_bf16 v[148:151], v[236:239], v[248:251], v[148:151]
    ds_read_b128 v[200:203], v13 offset:57344
    v_mfma_f32_16x16x32_bf16 v[176:179], v[32:35], v[240:243], v[176:179]
    ds_read_b128 v[196:199], v13 offset:49408
    v_mfma_f32_16x16x32_bf16 v[176:179], v[40:43], v[248:251], v[176:179]
    ds_read_b128 v[204:207], v13 offset:57600
    v_mfma_f32_16x16x32_bf16 v[184:187], v[32:35], v[244:247], v[184:187]
    ds_read_b128 v[208:211], v22 offset:16384
    v_mfma_f32_16x16x32_bf16 v[184:187], v[40:43], v[252:255], v[184:187]
    ds_read_b128 v[216:219], v22 offset:24576
    v_mfma_f32_16x16x32_bf16 v[188:191], v[36:39], v[244:247], v[188:191]
    ds_read_b128 v[212:215], v22 offset:16640
    v_mfma_f32_16x16x32_bf16 v[188:191], v[44:47], v[252:255], v[188:191]
    ds_read_b128 v[220:223], v22 offset:24832
    v_mfma_f32_16x16x32_bf16 v[180:183], v[36:39], v[240:243], v[180:183]
    ds_read_b128 v[224:227], v12 offset:0
    v_add_f32 v80, v80, v144
    v_add_f32 v81, v81, v145
    v_mfma_f32_16x16x32_bf16 v[180:183], v[44:47], v[248:251], v[180:183]
    ds_read_b128 v[232:235], v12 offset:8192
    v_add_f32 v82, v82, v146
    v_add_f32 v83, v83, v147
    v_mfma_f32_16x16x32_bf16 v[160:163], v[32:35], v[48:51], v[160:163]
    ds_read_b128 v[228:231], v12 offset:256
    v_add_f32 v84, v84, v148
    v_add_f32 v85, v85, v149
    v_mfma_f32_16x16x32_bf16 v[160:163], v[40:43], v[56:59], v[160:163]
    ds_read_b128 v[236:239], v12 offset:8448
    v_add_f32 v86, v86, v150
    v_add_f32 v87, v87, v151
    v_mfma_f32_16x16x32_bf16 v[168:171], v[32:35], v[52:55], v[168:171]
    ds_read_b128 v[240:243], v23 offset:0
    v_add_f32 v88, v88, v152
    v_add_f32 v89, v89, v153
    v_mfma_f32_16x16x32_bf16 v[168:171], v[40:43], v[60:63], v[168:171]
    ds_read_b128 v[248:251], v23 offset:8192
    v_add_f32 v90, v90, v154
    v_add_f32 v91, v91, v155
    v_mfma_f32_16x16x32_bf16 v[172:175], v[36:39], v[52:55], v[172:175]
    ds_read_b128 v[244:247], v23 offset:256
    v_add_f32 v92, v92, v156
    v_add_f32 v93, v93, v157
    v_mfma_f32_16x16x32_bf16 v[172:175], v[44:47], v[60:63], v[172:175]
    s_waitcnt lgkmcnt(14)
    ds_read_b128 v[252:255], v23 offset:8448
    v_add_f32 v94, v94, v158
    v_add_f32 v95, v95, v159
    v_mfma_f32_16x16x32_bf16 v[164:167], v[36:39], v[48:51], v[164:167]
    v_mfma_f32_16x16x32_bf16 v[164:167], v[44:47], v[56:59], v[164:167]
    s_waitcnt lgkmcnt(11)
    v_mfma_f32_16x16x32_bf16 v[144:147], v[192:195], v[208:211], 0
    ds_read_b128 v[32:35], v16 offset:49152
    v_add_f32 v112, v112, v176
    v_add_f32 v113, v113, v177
    s_waitcnt lgkmcnt(11)
    v_mfma_f32_16x16x32_bf16 v[144:147], v[200:203], v[216:219], v[144:147]
    ds_read_b128 v[40:43], v16 offset:57344
    v_add_f32 v114, v114, v178
    v_add_f32 v115, v115, v179
    s_waitcnt lgkmcnt(11)
    v_mfma_f32_16x16x32_bf16 v[152:155], v[192:195], v[212:215], 0
    ds_read_b128 v[36:39], v16 offset:49408
    v_add_f32 v116, v116, v180
    v_add_f32 v117, v117, v181
    s_waitcnt lgkmcnt(11)
    v_mfma_f32_16x16x32_bf16 v[152:155], v[200:203], v[220:223], v[152:155]
    ds_read_b128 v[44:47], v16 offset:57600
    v_add_f32 v118, v118, v182
    v_add_f32 v119, v119, v183
    v_mfma_f32_16x16x32_bf16 v[156:159], v[196:199], v[212:215], 0
    ds_read_b128 v[48:51], v15 offset:0
    v_add_f32 v120, v120, v184
    v_add_f32 v121, v121, v185
    v_mfma_f32_16x16x32_bf16 v[156:159], v[204:207], v[220:223], v[156:159]
    ds_read_b128 v[56:59], v15 offset:8192
    v_add_f32 v122, v122, v186
    v_add_f32 v123, v123, v187
    v_mfma_f32_16x16x32_bf16 v[148:151], v[196:199], v[208:211], 0
    ds_read_b128 v[52:55], v15 offset:256
    v_add_f32 v124, v124, v188
    v_add_f32 v125, v125, v189
    v_mfma_f32_16x16x32_bf16 v[148:151], v[204:207], v[216:219], v[148:151]
    s_waitcnt lgkmcnt(14)
    ds_read_b128 v[60:63], v15 offset:8448
    v_add_f32 v126, v126, v190
    v_add_f32 v127, v127, v191
    s_waitcnt lgkmcnt(11)
    v_mfma_f32_16x16x32_bf16 v[144:147], v[224:227], v[240:243], v[144:147]
    s_lshl_b32 s52, s47, 2
    s_and_b32 s50, s40, 3
    v_mul_f32 v80, v6, v80
    v_mul_f32 v81, v6, v81
    s_waitcnt lgkmcnt(10)
    v_mfma_f32_16x16x32_bf16 v[144:147], v[232:235], v[248:251], v[144:147]
    s_add_u32 s52, s52, s50
    s_lshl_b32 s52, s52, 3
    v_mul_f32 v82, v6, v82
    v_mul_f32 v83, v6, v83
    s_waitcnt lgkmcnt(9)
    v_mfma_f32_16x16x32_bf16 v[152:155], v[224:227], v[244:247], v[152:155]
    s_add_u32 s52, s52, s41
    s_lshl_b32 s52, s52, 17
    v_mul_f32 v84, v6, v84
    v_mul_f32 v85, v6, v85
    s_waitcnt lgkmcnt(8)
    v_mfma_f32_16x16x32_bf16 v[152:155], v[232:235], v[252:255], v[152:155]
    s_lshl_b32 s50, s43, 11
    s_add_u32 s52, s52, s50
    v_mul_f32 v86, v6, v86
    v_mul_f32 v87, v6, v87
    v_mfma_f32_16x16x32_bf16 v[156:159], v[228:231], v[244:247], v[156:159]
    s_add_u32 s52, s52, 100663296
    s_lshl_b32 s50, s37, 15
    v_mul_f32 v88, v7, v88
    v_mul_f32 v89, v7, v89
    v_mfma_f32_16x16x32_bf16 v[156:159], v[236:239], v[252:255], v[156:159]
    s_add_u32 s94, s50, s52
    v_mul_f32 v90, v7, v90
    v_mul_f32 v91, v7, v91
    v_mfma_f32_16x16x32_bf16 v[148:151], v[228:231], v[240:243], v[148:151]
    v_mul_f32 v92, v7, v92
    v_mul_f32 v93, v7, v93
    v_mfma_f32_16x16x32_bf16 v[148:151], v[236:239], v[248:251], v[148:151]
    v_mul_f32 v94, v7, v94
    v_mul_f32 v95, v7, v95
    s_waitcnt lgkmcnt(7)
    v_mfma_f32_16x16x32_bf16 v[176:179], v[32:35], v[208:211], 0
    ds_read_b128 v[192:195], v19 offset:16384
    v_add_f32 v96, v96, v160
    v_add_f32 v97, v97, v161
    v_add_f32 v98, v98, v162
    v_add_f32 v99, v99, v163
    s_waitcnt lgkmcnt(7)
    v_mfma_f32_16x16x32_bf16 v[176:179], v[40:43], v[216:219], v[176:179]
    ds_read_b128 v[200:203], v19 offset:24576
    v_add_f32 v100, v100, v164
    v_add_f32 v101, v101, v165
    v_add_f32 v102, v102, v166
    v_add_f32 v103, v103, v167
    s_waitcnt lgkmcnt(5)
    v_mfma_f32_16x16x32_bf16 v[176:179], v[48:51], v[240:243], v[176:179]
    ds_read_b128 v[196:199], v19 offset:16640
    v_add_f32 v104, v104, v168
    v_add_f32 v105, v105, v169
    v_add_f32 v106, v106, v170
    v_add_f32 v107, v107, v171
    s_waitcnt lgkmcnt(5)
    v_mfma_f32_16x16x32_bf16 v[176:179], v[56:59], v[248:251], v[176:179]
    ds_read_b128 v[204:207], v19 offset:24832
    v_add_f32 v108, v108, v172
    v_add_f32 v109, v109, v173
    v_add_f32 v110, v110, v174
    v_add_f32 v111, v111, v175
    v_mfma_f32_16x16x32_bf16 v[184:187], v[32:35], v[212:215], 0
    ds_read_b128 v[224:227], v20 offset:0
    v_fmac_f32 v80, v9, v144
    v_fmac_f32 v81, v9, v145
    v_fmac_f32 v82, v9, v146
    v_fmac_f32 v83, v9, v147
    v_mfma_f32_16x16x32_bf16 v[184:187], v[40:43], v[220:223], v[184:187]
    ds_read_b128 v[232:235], v20 offset:8192
    v_fmac_f32 v84, v9, v148
    v_fmac_f32 v85, v9, v149
    v_fmac_f32 v86, v9, v150
    v_fmac_f32 v87, v9, v151
    v_mfma_f32_16x16x32_bf16 v[184:187], v[48:51], v[244:247], v[184:187]
    ds_read_b128 v[228:231], v20 offset:256
    v_fmac_f32 v88, v30, v152
    v_fmac_f32 v89, v30, v153
    v_fmac_f32 v90, v30, v154
    v_fmac_f32 v91, v30, v155
    v_mfma_f32_16x16x32_bf16 v[184:187], v[56:59], v[252:255], v[184:187]
    ds_read_b128 v[236:239], v20 offset:8448
    v_fmac_f32 v92, v30, v156
    v_fmac_f32 v93, v30, v157
    v_fmac_f32 v94, v30, v158
    v_fmac_f32 v95, v30, v159
    v_mfma_f32_16x16x32_bf16 v[188:191], v[36:39], v[212:215], 0
    v_cvt_pk_bf16_f32 v80, v80, v81
    v_cvt_pk_bf16_f32 v81, v82, v83
    v_cvt_pk_bf16_f32 v82, v84, v85
    v_cvt_pk_bf16_f32 v83, v86, v87
    v_mfma_f32_16x16x32_bf16 v[188:191], v[44:47], v[220:223], v[188:191]
    v_cvt_pk_bf16_f32 v84, v88, v89
    v_cvt_pk_bf16_f32 v85, v90, v91
    v_cvt_pk_bf16_f32 v86, v92, v93
    v_cvt_pk_bf16_f32 v87, v94, v95
    s_waitcnt lgkmcnt(9)
    v_mfma_f32_16x16x32_bf16 v[188:191], v[52:55], v[244:247], v[188:191]
    v_min_u32 v80, -2, v80
    v_min_u32 v81, -2, v81
    v_min_u32 v82, -2, v82
    v_min_u32 v83, -2, v83
    s_waitcnt lgkmcnt(8)
    v_mfma_f32_16x16x32_bf16 v[188:191], v[60:63], v[252:255], v[188:191]
    v_min_u32 v84, -2, v84
    v_min_u32 v85, -2, v85
    v_min_u32 v86, -2, v86
    v_min_u32 v87, -2, v87
    v_mfma_f32_16x16x32_bf16 v[180:183], v[36:39], v[208:211], 0
    s_xor_b32 s50, s37, 1
    s_lshl_b32 s50, s50, 15
    s_add_u32 s50, s50, s52
    s_add_u32 s50, s50, 8192
    v_mfma_f32_16x16x32_bf16 v[180:183], v[44:47], v[216:219], v[180:183]
    buffer_store_dwordx4 v[80:83], v2, s[20:23], s50 offen offset:0 sc1
    buffer_store_dwordx4 v[84:87], v2, s[20:23], s50 offen offset:1024 sc1
    v_mfma_f32_16x16x32_bf16 v[180:183], v[52:55], v[240:243], v[180:183]
    v_mfma_f32_16x16x32_bf16 v[180:183], v[60:63], v[248:251], v[180:183]
    s_waitcnt lgkmcnt(7)
    v_mfma_f32_16x16x32_bf16 v[160:163], v[32:35], v[192:195], 0
    ds_read_b128 v[208:211], v13 offset:49152
    v_mul_f32 v112, v6, v112
    v_mul_f32 v113, v6, v113
    v_mul_f32 v114, v6, v114
    v_mul_f32 v115, v6, v115
    v_mul_f32 v116, v6, v116
    s_waitcnt lgkmcnt(7)
    v_mfma_f32_16x16x32_bf16 v[160:163], v[40:43], v[200:203], v[160:163]
    ds_read_b128 v[216:219], v13 offset:57344
    v_mul_f32 v117, v6, v117
    v_mul_f32 v118, v6, v118
    v_mul_f32 v119, v6, v119
    v_mul_f32 v120, v7, v120
    v_mul_f32 v121, v7, v121
    s_waitcnt lgkmcnt(5)
    v_mfma_f32_16x16x32_bf16 v[160:163], v[48:51], v[224:227], v[160:163]
    ds_read_b128 v[212:215], v13 offset:49408
    v_mul_f32 v122, v7, v122
    v_mul_f32 v123, v7, v123
    v_mul_f32 v124, v7, v124
    v_mul_f32 v125, v7, v125
    v_mul_f32 v126, v7, v126
    s_waitcnt lgkmcnt(5)
    v_mfma_f32_16x16x32_bf16 v[160:163], v[56:59], v[232:235], v[160:163]
    ds_read_b128 v[220:223], v13 offset:57600
    v_mul_f32 v127, v7, v127
    v_fmac_f32 v112, v9, v176
    v_fmac_f32 v113, v9, v177
    v_fmac_f32 v114, v9, v178
    v_fmac_f32 v115, v9, v179
    v_mfma_f32_16x16x32_bf16 v[168:171], v[32:35], v[196:199], 0
    ds_read_b128 v[240:243], v12 offset:0
    v_fmac_f32 v116, v9, v180
    v_fmac_f32 v117, v9, v181
    v_fmac_f32 v118, v9, v182
    v_fmac_f32 v119, v9, v183
    v_fmac_f32 v120, v30, v184
    v_mfma_f32_16x16x32_bf16 v[168:171], v[40:43], v[204:207], v[168:171]
    ds_read_b128 v[248:251], v12 offset:8192
    v_fmac_f32 v121, v30, v185
    v_fmac_f32 v122, v30, v186
    v_fmac_f32 v123, v30, v187
    v_fmac_f32 v124, v30, v188
    v_fmac_f32 v125, v30, v189
    s_waitcnt lgkmcnt(7)
    v_mfma_f32_16x16x32_bf16 v[168:171], v[48:51], v[228:231], v[168:171]
    ds_read_b128 v[244:247], v12 offset:256
    v_fmac_f32 v126, v30, v190
    v_fmac_f32 v127, v30, v191
    v_cvt_pk_bf16_f32 v112, v112, v113
    v_cvt_pk_bf16_f32 v113, v114, v115
    v_cvt_pk_bf16_f32 v114, v116, v117
    s_waitcnt lgkmcnt(7)
    v_mfma_f32_16x16x32_bf16 v[168:171], v[56:59], v[236:239], v[168:171]
    ds_read_b128 v[252:255], v12 offset:8448
    v_cvt_pk_bf16_f32 v115, v118, v119
    v_cvt_pk_bf16_f32 v116, v120, v121
    v_cvt_pk_bf16_f32 v117, v122, v123
    v_cvt_pk_bf16_f32 v118, v124, v125
    v_cvt_pk_bf16_f32 v119, v126, v127
    v_mfma_f32_16x16x32_bf16 v[172:175], v[36:39], v[196:199], 0
    v_min_u32 v112, -2, v112
    v_min_u32 v113, -2, v113
    v_min_u32 v114, -2, v114
    v_min_u32 v115, -2, v115
    v_min_u32 v116, -2, v116
    v_mfma_f32_16x16x32_bf16 v[172:175], v[44:47], v[204:207], v[172:175]
    v_min_u32 v117, -2, v117
    v_min_u32 v118, -2, v118
    v_min_u32 v119, -2, v119
    s_xor_b32 s50, s37, 3
    s_lshl_b32 s50, s50, 15
    v_mfma_f32_16x16x32_bf16 v[172:175], v[52:55], v[228:231], v[172:175]
    s_add_u32 s50, s50, s52
    s_add_u32 s50, s50, 24576
    buffer_store_dwordx4 v[112:115], v2, s[20:23], s50 offen offset:0 sc1
    buffer_store_dwordx4 v[116:119], v2, s[20:23], s50 offen offset:1024 sc1
    v_add_f32 v64, v64, v128
    v_mfma_f32_16x16x32_bf16 v[172:175], v[60:63], v[236:239], v[172:175]
    v_add_f32 v65, v65, v129
    v_add_f32 v66, v66, v130
    v_add_f32 v67, v67, v131
    v_add_f32 v68, v68, v132
    v_add_f32 v69, v69, v133
    v_mfma_f32_16x16x32_bf16 v[164:167], v[36:39], v[192:195], 0
    v_add_f32 v70, v70, v134
    v_add_f32 v71, v71, v135
    v_add_f32 v72, v72, v136
    v_add_f32 v73, v73, v137
    v_add_f32 v74, v74, v138
    v_mfma_f32_16x16x32_bf16 v[164:167], v[44:47], v[200:203], v[164:167]
    v_add_f32 v75, v75, v139
    v_add_f32 v76, v76, v140
    v_add_f32 v77, v77, v141
    v_add_f32 v78, v78, v142
    v_add_f32 v79, v79, v143
    v_mfma_f32_16x16x32_bf16 v[164:167], v[52:55], v[224:227], v[164:167]
    v_mfma_f32_16x16x32_bf16 v[164:167], v[60:63], v[232:235], v[164:167]
    s_waitcnt lgkmcnt(7)
    v_mfma_f32_16x16x32_bf16 v[128:131], v[208:211], v[192:195], 0
    s_add_u32 s51, s94, 8192
    buffer_load_dwordx4 v[40:43], v2, s[20:23], s51 offen offset:0 sc1
    buffer_load_dwordx4 v[44:47], v2, s[20:23], s51 offen offset:1024 sc1
    v_mul_f32 v96, v4, v96
    v_mul_f32 v97, v4, v97
    v_mul_f32 v98, v4, v98
    v_mul_f32 v99, v4, v99
    v_mul_f32 v100, v4, v100
    s_waitcnt lgkmcnt(6)
    v_mfma_f32_16x16x32_bf16 v[128:131], v[216:219], v[200:203], v[128:131]
    s_add_u32 s51, s94, 16384
    buffer_load_dwordx4 v[48:51], v2, s[20:23], s51 offen offset:0 sc1
    buffer_load_dwordx4 v[52:55], v2, s[20:23], s51 offen offset:1024 sc1
    v_mul_f32 v101, v4, v101
    v_mul_f32 v102, v4, v102
    v_mul_f32 v103, v4, v103
    v_mul_f32 v104, v5, v104
    v_mul_f32 v105, v5, v105
    s_waitcnt lgkmcnt(3)
    v_mfma_f32_16x16x32_bf16 v[128:131], v[240:243], v[224:227], v[128:131]
    s_add_u32 s51, s94, 24576
    buffer_load_dwordx4 v[56:59], v2, s[20:23], s51 offen offset:0 sc1
    buffer_load_dwordx4 v[60:63], v2, s[20:23], s51 offen offset:1024 sc1
    v_mul_f32 v106, v5, v106
    v_mul_f32 v107, v5, v107
    v_mul_f32 v108, v5, v108
    v_mul_f32 v109, v5, v109
    v_mul_f32 v110, v5, v110
    s_waitcnt lgkmcnt(2)
    v_mfma_f32_16x16x32_bf16 v[128:131], v[248:251], v[232:235], v[128:131]
    v_mul_f32 v111, v5, v111
    v_fmac_f32 v96, v0, v160
    v_fmac_f32 v97, v0, v161
    v_fmac_f32 v98, v0, v162
    v_fmac_f32 v99, v0, v163
    v_mfma_f32_16x16x32_bf16 v[136:139], v[208:211], v[196:199], 0
    v_fmac_f32 v100, v0, v164
    v_fmac_f32 v101, v0, v165
    v_fmac_f32 v102, v0, v166
    v_fmac_f32 v103, v0, v167
    v_fmac_f32 v104, v8, v168
    v_mfma_f32_16x16x32_bf16 v[136:139], v[216:219], v[204:207], v[136:139]
    v_fmac_f32 v105, v8, v169
    v_fmac_f32 v106, v8, v170
    v_fmac_f32 v107, v8, v171
    v_fmac_f32 v108, v8, v172
    v_fmac_f32 v109, v8, v173
    v_mfma_f32_16x16x32_bf16 v[136:139], v[240:243], v[228:231], v[136:139]
    v_fmac_f32 v110, v8, v174
    v_fmac_f32 v111, v8, v175
    v_cvt_pk_bf16_f32 v96, v96, v97
    v_cvt_pk_bf16_f32 v97, v98, v99
    v_cvt_pk_bf16_f32 v98, v100, v101
    v_mfma_f32_16x16x32_bf16 v[136:139], v[248:251], v[236:239], v[136:139]
    v_cvt_pk_bf16_f32 v99, v102, v103
    v_cvt_pk_bf16_f32 v100, v104, v105
    v_cvt_pk_bf16_f32 v101, v106, v107
    v_cvt_pk_bf16_f32 v102, v108, v109
    v_cvt_pk_bf16_f32 v103, v110, v111
    v_mfma_f32_16x16x32_bf16 v[140:143], v[212:215], v[196:199], 0
    v_min_u32 v96, -2, v96
    v_min_u32 v97, -2, v97
    v_min_u32 v98, -2, v98
    v_min_u32 v99, -2, v99
    v_min_u32 v100, -2, v100
    v_mfma_f32_16x16x32_bf16 v[140:143], v[220:223], v[204:207], v[140:143]
    v_min_u32 v101, -2, v101
    v_min_u32 v102, -2, v102
    v_min_u32 v103, -2, v103
    s_xor_b32 s50, s37, 2
    s_lshl_b32 s50, s50, 15
    s_waitcnt lgkmcnt(1)
    v_mfma_f32_16x16x32_bf16 v[140:143], v[244:247], v[228:231], v[140:143]
    s_add_u32 s50, s50, s52
    s_add_u32 s50, s50, 16384
    buffer_store_dwordx4 v[96:99], v2, s[20:23], s50 offen offset:0 sc1
    buffer_store_dwordx4 v[100:103], v2, s[20:23], s50 offen offset:1024 sc1
    v_mul_f32 v64, v4, v64
    s_waitcnt lgkmcnt(0)
    v_mfma_f32_16x16x32_bf16 v[140:143], v[252:255], v[236:239], v[140:143]
    v_mul_f32 v65, v4, v65
    v_mul_f32 v66, v4, v66
    v_mul_f32 v67, v4, v67
    v_mul_f32 v68, v4, v68
    v_mul_f32 v69, v4, v69
    v_mfma_f32_16x16x32_bf16 v[132:135], v[212:215], v[192:195], 0
    v_mul_f32 v70, v4, v70
    v_mul_f32 v71, v4, v71
    v_mul_f32 v72, v5, v72
    v_mul_f32 v73, v5, v73
    v_mul_f32 v74, v5, v74
    v_mfma_f32_16x16x32_bf16 v[132:135], v[220:223], v[200:203], v[132:135]
    v_mul_f32 v75, v5, v75
    v_mul_f32 v76, v5, v76
    v_mul_f32 v77, v5, v77
    v_mul_f32 v78, v5, v78
    v_mul_f32 v79, v5, v79
    v_mfma_f32_16x16x32_bf16 v[132:135], v[244:247], v[224:227], v[132:135]
    v_mfma_f32_16x16x32_bf16 v[132:135], v[252:255], v[232:235], v[132:135]
    s_lshl_b32 s95, s38, 17
    s_lshl_b32 s50, s46, 15
    s_add_u32 s95, s95, s50
    s_and_b32 s50, s40, 3
    s_lshl_b32 s50, s50, 8
    s_add_u32 s95, s95, s50
    s_lshl_b32 s50, s45, 6
    s_add_u32 s95, s95, s50
    v_and_b32 v24, 15, v1
    v_lshlrev_b32 v24, 10, v24
    v_and_b32 v25, 48, v1
    v_add_u32 v24, v24, v25
    v_add_u32 v28, 16384, v24
    v_fmac_f32 v64, v0, v128
    v_fmac_f32 v65, v0, v129
    v_fmac_f32 v66, v0, v130
    v_fmac_f32 v67, v0, v131
    v_fmac_f32 v68, v0, v132
    v_fmac_f32 v69, v0, v133
    v_fmac_f32 v70, v0, v134
    v_fmac_f32 v71, v0, v135
    v_fmac_f32 v72, v8, v136
    v_fmac_f32 v73, v8, v137
    v_fmac_f32 v74, v8, v138
    v_fmac_f32 v75, v8, v139
    v_fmac_f32 v76, v8, v140
    v_fmac_f32 v77, v8, v141
    v_fmac_f32 v78, v8, v142
    v_fmac_f32 v79, v8, v143
    s_waitcnt vmcnt(2)
LX_c1:
    v_max3_u32 v25, v40, v41, v42
    v_max3_u32 v26, v43, v44, v45
    v_max3_u32 v25, v25, v46, v47
    v_max_u32 v25, v25, v26
    v_cmp_eq_u32 vcc, -1, v25
    s_cbranch_vccz LX_k1
    s_sleep 1
    s_add_u32 s51, s94, 8192
    buffer_load_dwordx4 v[40:43], v2, s[20:23], s51 offen offset:0 sc1
    buffer_load_dwordx4 v[44:47], v2, s[20:23], s51 offen offset:1024 sc1
    s_waitcnt vmcnt(0)
    s_branch LX_c1
LX_k1:
    v_lshlrev_b32 v26, 16, v40
    v_and_b32 v40, 0xffff0000, v40
    v_add_f32 v64, v64, v26
    v_add_f32 v65, v65, v40
    v_lshlrev_b32 v27, 16, v41
    v_and_b32 v41, 0xffff0000, v41
    v_add_f32 v66, v66, v27
    v_add_f32 v67, v67, v41
    v_lshlrev_b32 v26, 16, v42
    v_and_b32 v42, 0xffff0000, v42
    v_add_f32 v68, v68, v26
    v_add_f32 v69, v69, v42
    v_lshlrev_b32 v27, 16, v43
    v_and_b32 v43, 0xffff0000, v43
    v_add_f32 v70, v70, v27
    v_add_f32 v71, v71, v43
    v_lshlrev_b32 v26, 16, v44
    v_and_b32 v44, 0xffff0000, v44
    v_add_f32 v72, v72, v26
    v_add_f32 v73, v73, v44
    v_lshlrev_b32 v27, 16, v45
    v_and_b32 v45, 0xffff0000, v45
    v_add_f32 v74, v74, v27
    v_add_f32 v75, v75, v45
    v_lshlrev_b32 v26, 16, v46
    v_and_b32 v46, 0xffff0000, v46
    v_add_f32 v76, v76, v26
    v_add_f32 v77, v77, v46
    v_lshlrev_b32 v27, 16, v47
    v_and_b32 v47, 0xffff0000, v47
    v_add_f32 v78, v78, v27
    v_add_f32 v79, v79, v47
LX_c2:
    v_max3_u32 v25, v48, v49, v50
    v_max3_u32 v26, v51, v52, v53
    v_max3_u32 v25, v25, v54, v55
    v_max_u32 v25, v25, v26
    v_cmp_eq_u32 vcc, -1, v25
    s_cbranch_vccz LX_k2
    s_sleep 1
    s_add_u32 s51, s94, 16384
    buffer_load_dwordx4 v[48:51], v2, s[20:23], s51 offen offset:0 sc1
    buffer_load_dwordx4 v[52:55], v2, s[20:23], s51 offen offset:1024 sc1
    s_waitcnt vmcnt(0)
    s_branch LX_c2
LX_k2:
    v_lshlrev_b32 v26, 16, v48
    v_and_b32 v48, 0xffff0000, v48
    v_add_f32 v64, v64, v26
    v_add_f32 v65, v65, v48
    v_lshlrev_b32 v27, 16, v49
    v_and_b32 v49, 0xffff0000, v49
    v_add_f32 v66, v66, v27
    v_add_f32 v67, v67, v49
    v_lshlrev_b32 v26, 16, v50
    v_and_b32 v50, 0xffff0000, v50
    v_add_f32 v68, v68, v26
    v_add_f32 v69, v69, v50
    v_lshlrev_b32 v27, 16, v51
    v_and_b32 v51, 0xffff0000, v51
    v_add_f32 v70, v70, v27
    v_add_f32 v71, v71, v51
    v_lshlrev_b32 v26, 16, v52
    v_and_b32 v52, 0xffff0000, v52
    v_add_f32 v72, v72, v26
    v_add_f32 v73, v73, v52
    v_lshlrev_b32 v27, 16, v53
    v_and_b32 v53, 0xffff0000, v53
    v_add_f32 v74, v74, v27
    v_add_f32 v75, v75, v53
    v_lshlrev_b32 v26, 16, v54
    v_and_b32 v54, 0xffff0000, v54
    v_add_f32 v76, v76, v26
    v_add_f32 v77, v77, v54
    v_lshlrev_b32 v27, 16, v55
    v_and_b32 v55, 0xffff0000, v55
    v_add_f32 v78, v78, v27
    v_add_f32 v79, v79, v55
LX_c3:
    v_max3_u32 v25, v56, v57, v58
    v_max3_u32 v26, v59, v60, v61
    v_max3_u32 v25, v25, v62, v63
    v_max_u32 v25, v25, v26
    v_cmp_eq_u32 vcc, -1, v25
    s_cbranch_vccz LX_k3
    s_sleep 1
    s_add_u32 s51, s94, 24576
    buffer_load_dwordx4 v[56:59], v2, s[20:23], s51 offen offset:0 sc1
    buffer_load_dwordx4 v[60:63], v2, s[20:23], s51 offen offset:1024 sc1
    s_waitcnt vmcnt(0)
    s_branch LX_c3
LX_k3:
    v_lshlrev_b32 v26, 16, v56
    v_and_b32 v56, 0xffff0000, v56
    v_add_f32 v64, v64, v26
    v_add_f32 v65, v65, v56
    v_lshlrev_b32 v27, 16, v57
    v_and_b32 v57, 0xffff0000, v57
    v_add_f32 v66, v66, v27
    v_add_f32 v67, v67, v57
    v_lshlrev_b32 v26, 16, v58
    v_and_b32 v58, 0xffff0000, v58
    v_add_f32 v68, v68, v26
    v_add_f32 v69, v69, v58
    v_lshlrev_b32 v27, 16, v59
    v_and_b32 v59, 0xffff0000, v59
    v_add_f32 v70, v70, v27
    v_add_f32 v71, v71, v59
    v_lshlrev_b32 v26, 16, v60
    v_and_b32 v60, 0xffff0000, v60
    v_add_f32 v72, v72, v26
    v_add_f32 v73, v73, v60
    v_lshlrev_b32 v27, 16, v61
    v_and_b32 v61, 0xffff0000, v61
    v_add_f32 v74, v74, v27
    v_add_f32 v75, v75, v61
    v_lshlrev_b32 v26, 16, v62
    v_and_b32 v62, 0xffff0000, v62
    v_add_f32 v76, v76, v26
    v_add_f32 v77, v77, v62
    v_lshlrev_b32 v27, 16, v63
    v_and_b32 v63, 0xffff0000, v63
    v_add_f32 v78, v78, v27
    v_add_f32 v79, v79, v63
    v_cvt_pk_bf16_f32 v64, v64, v65
    v_cvt_pk_bf16_f32 v65, v66, v67
    v_cvt_pk_bf16_f32 v66, v68, v69
    v_cvt_pk_bf16_f32 v67, v70, v71
    v_cvt_pk_bf16_f32 v68, v72, v73
    v_cvt_pk_bf16_f32 v69, v74, v75
    v_cvt_pk_bf16_f32 v70, v76, v77
    v_cvt_pk_bf16_f32 v71, v78, v79
    buffer_store_dwordx4 v[64:67], v24, s[4:7], s95 offen
    buffer_store_dwordx4 v[68:71], v28, s[4:7], s95 offen
    s_endpgm
LA_pro0:
    ds_read_b128 v[224:227], v33 offset:0
    ds_read_b128 v[228:231], v33 offset:1024
    ds_read_b128 v[232:235], v33 offset:2048
    ds_read_b128 v[236:239], v33 offset:3072
    ds_read_b128 v[240:243], v33 offset:4096
    ds_read_b128 v[244:247], v33 offset:5120
    ds_read_b128 v[248:251], v33 offset:6144
    ds_read_b128 v[252:255], v33 offset:7168
    v_mov_b32 v56, 0
    v_mov_b32 v57, 0
    v_mov_b32 v58, 0
    v_mov_b32 v59, 0
    v_mov_b32 v44, 0
    v_mov_b32 v45, 0
    v_mov_b32 v46, 0
    v_mov_b32 v47, 0
    s_mov_b32 s60, 0
    v_mfma_f32_32x32x16_bf16 v[128:143], v[56:59], v[56:59], 0
    v_mfma_f32_32x32x16_bf16 v[144:159], v[56:59], v[56:59], 0
    v_mfma_f32_32x32x16_bf16 v[160:175], v[56:59], v[56:59], 0
    v_mfma_f32_32x32x16_bf16 v[176:191], v[56:59], v[56:59], 0
    v_subrev_u32 v35, s60, v36
    v_cvt_f32_i32 v35, v35
    v_mul_f32 v35, 0x71800000, v35
    s_add_u32 s60, s60, 32
    v_min_f32 v192, 0, v35
    v_add_f32 v193, 0xf1800000, v35
    v_min_f32 v193, 0, v193
    v_add_f32 v194, 0xf2000000, v35
    v_min_f32 v194, 0, v194
    v_add_f32 v195, 0xf2400000, v35
    v_min_f32 v195, 0, v195
    v_add_f32 v196, 0x73800000, v35
    v_min_f32 v196, 0, v196
    v_add_f32 v197, 0x73700000, v35
    v_min_f32 v197, 0, v197
    v_add_f32 v198, 0x73600000, v35
    v_min_f32 v198, 0, v198
    v_add_f32 v199, 0x73500000, v35
    v_min_f32 v199, 0, v199
    v_add_f32 v200, 0xf3800000, v35
    v_min_f32 v200, 0, v200
    v_add_f32 v201, 0xf3880000, v35
    v_min_f32 v201, 0, v201
    v_add_f32 v202, 0xf3900000, v35
    v_min_f32 v202, 0, v202
    v_add_f32 v203, 0xf3980000, v35
    v_min_f32 v203, 0, v203
    v_min_f32 v204, 0, v35
    v_add_f32 v205, 0xf1800000, v35
    v_min_f32 v205, 0, v205
    v_add_f32 v206, 0xf2000000, v35
    v_min_f32 v206, 0, v206
    v_add_f32 v207, 0xf2400000, v35
    v_min_f32 v207, 0, v207
    s_nop 1
    s_waitcnt lgkmcnt(7)
    v_mfma_f32_16x16x32_bf16 v[192:195], v[224:227], v[64:67], v[192:195]
    v_mfma_f32_16x16x32_bf16 v[196:199], v[224:227], v[68:71], v[196:199]
    ds_read_b128 v[224:227], v33 offset:16384
    v_subrev_u32 v35, s60, v36
    v_cvt_f32_i32 v35, v35
    v_mul_f32 v35, 0x71800000, v35
    s_add_u32 s60, s60, 32
    v_min_f32 v208, 0, v35
    s_waitcnt lgkmcnt(7)
    v_mfma_f32_16x16x32_bf16 v[192:195], v[228:231], v[72:75], v[192:195]
    v_mfma_f32_16x16x32_bf16 v[196:199], v[228:231], v[76:79], v[196:199]
    ds_read_b128 v[228:231], v33 offset:17408
    v_add_f32 v209, 0xf1800000, v35
    v_min_f32 v209, 0, v209
    v_add_f32 v210, 0xf2000000, v35
    v_min_f32 v210, 0, v210
    s_waitcnt lgkmcnt(7)
    v_mfma_f32_16x16x32_bf16 v[192:195], v[232:235], v[80:83], v[192:195]
    v_mfma_f32_16x16x32_bf16 v[196:199], v[232:235], v[84:87], v[196:199]
    ds_read_b128 v[232:235], v33 offset:18432
    v_add_f32 v211, 0xf2400000, v35
    v_min_f32 v211, 0, v211
    v_add_f32 v212, 0x73800000, v35
    v_min_f32 v212, 0, v212
    s_waitcnt lgkmcnt(7)
    v_mfma_f32_16x16x32_bf16 v[192:195], v[236:239], v[88:91], v[192:195]
    v_mfma_f32_16x16x32_bf16 v[196:199], v[236:239], v[92:95], v[196:199]
    ds_read_b128 v[236:239], v33 offset:19456
    v_add_f32 v213, 0x73700000, v35
    v_min_f32 v213, 0, v213
    v_add_f32 v214, 0x73600000, v35
    v_min_f32 v214, 0, v214
    s_waitcnt lgkmcnt(7)
    v_mfma_f32_16x16x32_bf16 v[200:203], v[240:243], v[64:67], v[200:203]
    v_mfma_f32_16x16x32_bf16 v[204:207], v[240:243], v[68:71], v[204:207]
    ds_read_b128 v[240:243], v33 offset:20480
    v_add_f32 v215, 0x73500000, v35
    v_min_f32 v215, 0, v215
    v_add_f32 v216, 0xf3800000, v35
    v_min_f32 v216, 0, v216
    v_add_f32 v217, 0xf3880000, v35
    s_waitcnt lgkmcnt(7)
    v_mfma_f32_16x16x32_bf16 v[200:203], v[244:247], v[72:75], v[200:203]
    v_mfma_f32_16x16x32_bf16 v[204:207], v[244:247], v[76:79], v[204:207]
    ds_read_b128 v[244:247], v33 offset:21504
    v_min_f32 v217, 0, v217
    v_add_f32 v218, 0xf3900000, v35
    v_min_f32 v218, 0, v218
    v_add_f32 v219, 0xf3980000, v35
    s_waitcnt lgkmcnt(7)
    v_mfma_f32_16x16x32_bf16 v[200:203], v[248:251], v[80:83], v[200:203]
    v_mfma_f32_16x16x32_bf16 v[204:207], v[248:251], v[84:87], v[204:207]
    ds_read_b128 v[248:251], v33 offset:22528
    v_min_f32 v219, 0, v219
    v_min_f32 v220, 0, v35
    v_add_f32 v221, 0xf1800000, v35
    v_min_f32 v221, 0, v221
    s_waitcnt lgkmcnt(7)
    v_mfma_f32_16x16x32_bf16 v[200:203], v[252:255], v[88:91], v[200:203]
    v_mfma_f32_16x16x32_bf16 v[204:207], v[252:255], v[92:95], v[204:207]
    v_add_f32 v222, 0xf2000000, v35
    v_min_f32 v222, 0, v222
    v_add_f32 v223, 0xf2400000, v35
    v_min_f32 v223, 0, v223
    v_exp_f32 v192, v192
    v_exp_f32 v193, v193
    v_exp_f32 v194, v194
    v_cvt_pk_bf16_f32 v56, v192, v193
    v_exp_f32 v195, v195
    v_exp_f32 v196, v196
    v_cvt_pk_bf16_f32 v57, v194, v195
    v_exp_f32 v197, v197
    v_exp_f32 v198, v198
    v_cvt_pk_bf16_f32 v60, v196, v197
    v_exp_f32 v199, v199
    v_exp_f32 v200, v200
    v_cvt_pk_bf16_f32 v61, v198, v199
    s_waitcnt lgkmcnt(4)
    s_cmp_eq_u32 s90, 0
    s_cbranch_scc1 LA_H
    s_branch LA_F
LA_fb:
    s_lshl_b32 s60, s58, 7
    s_sub_u32 s60, 0, s60
    s_mul_i32 s94, s40, 1050880
    s_add_u32 s95, s58, 1
    s_lshl_b32 s95, s95, 2
    v_mov_b32 v29, 0xff800000
    v_mov_b32 v30, 0xff800000
LA_fb1:
    s_mov_b32 s50, s94
    buffer_load_dwordx4 v[224:227], v2, s[20:23], s50 offen offset:0 sc1
    buffer_load_dwordx4 v[228:231], v2, s[20:23], s50 offen offset:1024 sc1
    buffer_load_dwordx4 v[232:235], v2, s[20:23], s50 offen offset:2048 sc1
    buffer_load_dwordx4 v[236:239], v2, s[20:23], s50 offen offset:3072 sc1
    buffer_load_dwordx4 v[240:243], v11, s[20:23], s50 offen offset:0 sc1
    buffer_load_dwordx4 v[244:247], v11, s[20:23], s50 offen offset:1024 sc1
    buffer_load_dwordx4 v[248:251], v11, s[20:23], s50 offen offset:2048 sc1
    buffer_load_dwordx4 v[252:255], v11, s[20:23], s50 offen offset:3072 sc1
    v_subrev_u32 v35, s60, v36
    v_cvt_f32_i32 v35, v35
    v_mul_f32 v35, 0x71800000, v35
    s_add_u32 s60, s60, 32
    v_min_f32 v192, 0, v35
    v_add_f32 v193, 0xf1800000, v35
    v_min_f32 v193, 0, v193
    v_add_f32 v194, 0xf2000000, v35
    v_min_f32 v194, 0, v194
    v_add_f32 v195, 0xf2400000, v35
    v_min_f32 v195, 0, v195
    v_add_f32 v196, 0x73800000, v35
    v_min_f32 v196, 0, v196
    v_add_f32 v197, 0x73700000, v35
    v_min_f32 v197, 0, v197
    v_add_f32 v198, 0x73600000, v35
    v_min_f32 v198, 0, v198
    v_add_f32 v199, 0x73500000, v35
    v_min_f32 v199, 0, v199
    v_add_f32 v200, 0xf3800000, v35
    v_min_f32 v200, 0, v200
    v_add_f32 v201, 0xf3880000, v35
    v_min_f32 v201, 0, v201
    v_add_f32 v202, 0xf3900000, v35
    v_min_f32 v202, 0, v202
    v_add_f32 v203, 0xf3980000, v35
    v_min_f32 v203, 0, v203
    v_min_f32 v204, 0, v35
    v_add_f32 v205, 0xf1800000, v35
    v_min_f32 v205, 0, v205
    v_add_f32 v206, 0xf2000000, v35
    v_min_f32 v206, 0, v206
    v_add_f32 v207, 0xf2400000, v35
    v_min_f32 v207, 0, v207
    s_waitcnt vmcnt(0)
    s_nop 0
    v_mfma_f32_16x16x32_bf16 v[192:195], v[224:227], v[64:67], v[192:195]
    v_mfma_f32_16x16x32_bf16 v[196:199], v[224:227], v[68:71], v[196:199]
    v_mfma_f32_16x16x32_bf16 v[192:195], v[228:231], v[72:75], v[192:195]
    v_mfma_f32_16x16x32_bf16 v[196:199], v[228:231], v[76:79], v[196:199]
    v_mfma_f32_16x16x32_bf16 v[192:195], v[232:235], v[80:83], v[192:195]
    v_mfma_f32_16x16x32_bf16 v[196:199], v[232:235], v[84:87], v[196:199]
    v_mfma_f32_16x16x32_bf16 v[192:195], v[236:239], v[88:91], v[192:195]
    v_mfma_f32_16x16x32_bf16 v[196:199], v[236:239], v[92:95], v[196:199]
    v_mfma_f32_16x16x32_bf16 v[200:203], v[240:243], v[64:67], v[200:203]
    v_mfma_f32_16x16x32_bf16 v[204:207], v[240:243], v[68:71], v[204:207]
    v_mfma_f32_16x16x32_bf16 v[200:203], v[244:247], v[72:75], v[200:203]
    v_mfma_f32_16x16x32_bf16 v[204:207], v[244:247], v[76:79], v[204:207]
    v_mfma_f32_16x16x32_bf16 v[200:203], v[248:251], v[80:83], v[200:203]
    v_mfma_f32_16x16x32_bf16 v[204:207], v[248:251], v[84:87], v[204:207]
    v_mfma_f32_16x16x32_bf16 v[200:203], v[252:255], v[88:91], v[200:203]
    v_mfma_f32_16x16x32_bf16 v[204:207], v[252:255], v[92:95], v[204:207]
    s_nop 15
    v_max3_f32 v29, v192, v193, v29
    v_max3_f32 v29, v194, v195, v29
    v_max3_f32 v30, v196, v197, v30
    v_max3_f32 v30, v198, v199, v30
    v_max3_f32 v29, v200, v201, v29
    v_max3_f32 v29, v202, v203, v29
    v_max3_f32 v30, v204, v205, v30
    v_max3_f32 v30, v206, v207, v30
    s_add_u32 s94, s94, 16384
    s_sub_u32 s95, s95, 1
    s_cmp_lg_u32 s95, 0
    s_cbranch_scc1 LA_fb1
    v_mov_b32 v24, v29
    s_nop 1
    v_permlane32_swap_b32 v29, v24
    s_nop 1
    v_max_f32 v29, v29, v24
    v_mov_b32 v24, v29
    s_nop 1
    v_permlane16_swap_b32 v29, v24
    s_nop 1
    v_max_f32 v29, v29, v24
    v_mov_b32 v24, v30
    s_nop 1
    v_permlane32_swap_b32 v30, v24
    s_nop 1
    v_max_f32 v30, v30, v24
    v_mov_b32 v24, v30
    s_nop 1
    v_permlane16_swap_b32 v30, v24
    s_nop 1
    v_max_f32 v30, v30, v24
    s_lshl_b32 s60, s58, 7
    s_sub_u32 s60, 0, s60
    s_mul_i32 s94, s40, 1050880
    s_add_u32 s95, s58, 1
    s_lshl_b32 s95, s95, 2
    v_mov_b32 v20, 0
    v_mov_b32 v21, 0
    v_mov_b32 v128, 0
    v_mov_b32 v129, 0
    v_mov_b32 v130, 0
    v_mov_b32 v131, 0
    v_mov_b32 v132, 0
    v_mov_b32 v133, 0
    v_mov_b32 v134, 0
    v_mov_b32 v135, 0
    v_mov_b32 v136, 0
    v_mov_b32 v137, 0
    v_mov_b32 v138, 0
    v_mov_b32 v139, 0
    v_mov_b32 v140, 0
    v_mov_b32 v141, 0
    v_mov_b32 v142, 0
    v_mov_b32 v143, 0
    v_mov_b32 v144, 0
    v_mov_b32 v145, 0
    v_mov_b32 v146, 0
    v_mov_b32 v147, 0
    v_mov_b32 v148, 0
    v_mov_b32 v149, 0
    v_mov_b32 v150, 0
    v_mov_b32 v151, 0
    v_mov_b32 v152, 0
    v_mov_b32 v153, 0
    v_mov_b32 v154, 0
    v_mov_b32 v155, 0
    v_mov_b32 v156, 0
    v_mov_b32 v157, 0
    v_mov_b32 v158, 0
    v_mov_b32 v159, 0
    v_mov_b32 v160, 0
    v_mov_b32 v161, 0
    v_mov_b32 v162, 0
    v_mov_b32 v163, 0
    v_mov_b32 v164, 0
    v_mov_b32 v165, 0
    v_mov_b32 v166, 0
    v_mov_b32 v167, 0
    v_mov_b32 v168, 0
    v_mov_b32 v169, 0
    v_mov_b32 v170, 0
    v_mov_b32 v171, 0
    v_mov_b32 v172, 0
    v_mov_b32 v173, 0
    v_mov_b32 v174, 0
    v_mov_b32 v175, 0
    v_mov_b32 v176, 0
    v_mov_b32 v177, 0
    v_mov_b32 v178, 0
    v_mov_b32 v179, 0
    v_mov_b32 v180, 0
    v_mov_b32 v181, 0
    v_mov_b32 v182, 0
    v_mov_b32 v183, 0
    v_mov_b32 v184, 0
    v_mov_b32 v185, 0
    v_mov_b32 v186, 0
    v_mov_b32 v187, 0
    v_mov_b32 v188, 0
    v_mov_b32 v189, 0
    v_mov_b32 v190, 0
    v_mov_b32 v191, 0
LA_fb2:
    s_mov_b32 s50, s94
    buffer_load_dwordx4 v[224:227], v2, s[20:23], s50 offen offset:0 sc1
    buffer_load_dwordx4 v[228:231], v2, s[20:23], s50 offen offset:1024 sc1
    buffer_load_dwordx4 v[232:235], v2, s[20:23], s50 offen offset:2048 sc1
    buffer_load_dwordx4 v[236:239], v2, s[20:23], s50 offen offset:3072 sc1
    buffer_load_dwordx4 v[240:243], v11, s[20:23], s50 offen offset:0 sc1
    buffer_load_dwordx4 v[244:247], v11, s[20:23], s50 offen offset:1024 sc1
    buffer_load_dwordx4 v[248:251], v11, s[20:23], s50 offen offset:2048 sc1
    buffer_load_dwordx4 v[252:255], v11, s[20:23], s50 offen offset:3072 sc1
    v_subrev_u32 v35, s60, v36
    v_cvt_f32_i32 v35, v35
    v_mul_f32 v35, 0x71800000, v35
    s_add_u32 s60, s60, 32
    v_min_f32 v192, 0, v35
    v_add_f32 v193, 0xf1800000, v35
    v_min_f32 v193, 0, v193
    v_add_f32 v194, 0xf2000000, v35
    v_min_f32 v194, 0, v194
    v_add_f32 v195, 0xf2400000, v35
    v_min_f32 v195, 0, v195
    v_add_f32 v196, 0x73800000, v35
    v_min_f32 v196, 0, v196
    v_add_f32 v197, 0x73700000, v35
    v_min_f32 v197, 0, v197
    v_add_f32 v198, 0x73600000, v35
    v_min_f32 v198, 0, v198
    v_add_f32 v199, 0x73500000, v35
    v_min_f32 v199, 0, v199
    v_add_f32 v200, 0xf3800000, v35
    v_min_f32 v200, 0, v200
    v_add_f32 v201, 0xf3880000, v35
    v_min_f32 v201, 0, v201
    v_add_f32 v202, 0xf3900000, v35
    v_min_f32 v202, 0, v202
    v_add_f32 v203, 0xf3980000, v35
    v_min_f32 v203, 0, v203
    v_min_f32 v204, 0, v35
    v_add_f32 v205, 0xf1800000, v35
    v_min_f32 v205, 0, v205
    v_add_f32 v206, 0xf2000000, v35
    v_min_f32 v206, 0, v206
    v_add_f32 v207, 0xf2400000, v35
    v_min_f32 v207, 0, v207
    s_waitcnt vmcnt(0)
    s_nop 0
    v_mfma_f32_16x16x32_bf16 v[192:195], v[224:227], v[64:67], v[192:195]
    v_mfma_f32_16x16x32_bf16 v[196:199], v[224:227], v[68:71], v[196:199]
    v_mfma_f32_16x16x32_bf16 v[192:195], v[228:231], v[72:75], v[192:195]
    v_mfma_f32_16x16x32_bf16 v[196:199], v[228:231], v[76:79], v[196:199]
    v_mfma_f32_16x16x32_bf16 v[192:195], v[232:235], v[80:83], v[192:195]
    v_mfma_f32_16x16x32_bf16 v[196:199], v[232:235], v[84:87], v[196:199]
    v_mfma_f32_16x16x32_bf16 v[192:195], v[236:239], v[88:91], v[192:195]
    v_mfma_f32_16x16x32_bf16 v[196:199], v[236:239], v[92:95], v[196:199]
    v_mfma_f32_16x16x32_bf16 v[200:203], v[240:243], v[64:67], v[200:203]
    v_mfma_f32_16x16x32_bf16 v[204:207], v[240:243], v[68:71], v[204:207]
    v_mfma_f32_16x16x32_bf16 v[200:203], v[244:247], v[72:75], v[200:203]
    v_mfma_f32_16x16x32_bf16 v[204:207], v[244:247], v[76:79], v[204:207]
    v_mfma_f32_16x16x32_bf16 v[200:203], v[248:251], v[80:83], v[200:203]
    v_mfma_f32_16x16x32_bf16 v[204:207], v[248:251], v[84:87], v[204:207]
    v_mfma_f32_16x16x32_bf16 v[200:203], v[252:255], v[88:91], v[200:203]
    v_mfma_f32_16x16x32_bf16 v[204:207], v[252:255], v[92:95], v[204:207]
    s_add_u32 s50, s94, 8192
    buffer_load_dwordx4 v[224:227], v2, s[20:23], s50 offen offset:0 sc1
    buffer_load_dwordx4 v[228:231], v2, s[20:23], s50 offen offset:1024 sc1
    buffer_load_dwordx4 v[232:235], v2, s[20:23], s50 offen offset:2048 sc1
    buffer_load_dwordx4 v[236:239], v2, s[20:23], s50 offen offset:3072 sc1
    buffer_load_dwordx4 v[240:243], v11, s[20:23], s50 offen offset:0 sc1
    buffer_load_dwordx4 v[244:247], v11, s[20:23], s50 offen offset:1024 sc1
    buffer_load_dwordx4 v[248:251], v11, s[20:23], s50 offen offset:2048 sc1
    buffer_load_dwordx4 v[252:255], v11, s[20:23], s50 offen offset:3072 sc1
    s_nop 7
    v_sub_f32 v192, v192, v29
    v_sub_f32 v193, v193, v29
    v_sub_f32 v194, v194, v29
    v_sub_f32 v195, v195, v29
    v_sub_f32 v196, v196, v30
    v_sub_f32 v197, v197, v30
    v_sub_f32 v198, v198, v30
    v_sub_f32 v199, v199, v30
    v_sub_f32 v200, v200, v29
    v_sub_f32 v201, v201, v29
    v_sub_f32 v202, v202, v29
    v_sub_f32 v203, v203, v29
    v_sub_f32 v204, v204, v30
    v_sub_f32 v205, v205, v30
    v_sub_f32 v206, v206, v30
    v_sub_f32 v207, v207, v30
    v_exp_f32 v192, v192
    v_exp_f32 v193, v193
    v_exp_f32 v194, v194
    v_exp_f32 v195, v195
    v_exp_f32 v196, v196
    v_exp_f32 v197, v197
    v_exp_f32 v198, v198
    v_exp_f32 v199, v199
    v_exp_f32 v200, v200
    v_exp_f32 v201, v201
    v_exp_f32 v202, v202
    v_exp_f32 v203, v203
    v_exp_f32 v204, v204
    v_exp_f32 v205, v205
    v_exp_f32 v206, v206
    v_exp_f32 v207, v207
    s_nop 0
    v_cvt_pk_bf16_f32 v56, v192, v193
    v_cvt_pk_bf16_f32 v57, v194, v195
    v_cvt_pk_bf16_f32 v60, v196, v197
    v_cvt_pk_bf16_f32 v61, v198, v199
    v_cvt_pk_bf16_f32 v58, v200, v201
    v_cvt_pk_bf16_f32 v59, v202, v203
    v_cvt_pk_bf16_f32 v62, v204, v205
    v_cvt_pk_bf16_f32 v63, v206, v207
    v_add_f32 v20, v20, v192
    v_add_f32 v20, v20, v193
    v_add_f32 v20, v20, v194
    v_add_f32 v20, v20, v195
    v_add_f32 v21, v21, v196
    v_add_f32 v21, v21, v197
    v_add_f32 v21, v21, v198
    v_add_f32 v21, v21, v199
    v_add_f32 v20, v20, v200
    v_add_f32 v20, v20, v201
    v_add_f32 v20, v20, v202
    v_add_f32 v20, v20, v203
    v_add_f32 v21, v21, v204
    v_add_f32 v21, v21, v205
    v_add_f32 v21, v21, v206
    v_add_f32 v21, v21, v207
    s_waitcnt vmcnt(0)
    v_mfma_f32_16x16x32_bf16 v[128:131], v[224:227], v[56:59], v[128:131]
    v_mfma_f32_16x16x32_bf16 v[136:139], v[224:227], v[60:63], v[136:139]
    v_mfma_f32_16x16x32_bf16 v[132:135], v[228:231], v[56:59], v[132:135]
    v_mfma_f32_16x16x32_bf16 v[140:143], v[228:231], v[60:63], v[140:143]
    v_mfma_f32_16x16x32_bf16 v[144:147], v[232:235], v[56:59], v[144:147]
    v_mfma_f32_16x16x32_bf16 v[152:155], v[232:235], v[60:63], v[152:155]
    v_mfma_f32_16x16x32_bf16 v[148:151], v[236:239], v[56:59], v[148:151]
    v_mfma_f32_16x16x32_bf16 v[156:159], v[236:239], v[60:63], v[156:159]
    v_mfma_f32_16x16x32_bf16 v[160:163], v[240:243], v[56:59], v[160:163]
    v_mfma_f32_16x16x32_bf16 v[168:171], v[240:243], v[60:63], v[168:171]
    v_mfma_f32_16x16x32_bf16 v[164:167], v[244:247], v[56:59], v[164:167]
    v_mfma_f32_16x16x32_bf16 v[172:175], v[244:247], v[60:63], v[172:175]
    v_mfma_f32_16x16x32_bf16 v[176:179], v[248:251], v[56:59], v[176:179]
    v_mfma_f32_16x16x32_bf16 v[184:187], v[248:251], v[60:63], v[184:187]
    v_mfma_f32_16x16x32_bf16 v[180:183], v[252:255], v[56:59], v[180:183]
    v_mfma_f32_16x16x32_bf16 v[188:191], v[252:255], v[60:63], v[188:191]
    s_add_u32 s94, s94, 16384
    s_sub_u32 s95, s95, 1
    s_cmp_lg_u32 s95, 0
    s_cbranch_scc1 LA_fb2
    s_nop 15
    v_mov_b32 v24, v20
    s_nop 1
    v_permlane32_swap_b32 v20, v24
    s_nop 1
    v_add_f32 v20, v20, v24
    v_mov_b32 v24, v20
    s_nop 1
    v_permlane16_swap_b32 v20, v24
    s_nop 1
    v_add_f32 v20, v20, v24
    v_mov_b32 v24, v21
    s_nop 1
    v_permlane32_swap_b32 v21, v24
    s_nop 1
    v_add_f32 v21, v21, v24
    v_mov_b32 v24, v21
    s_nop 1
    v_permlane16_swap_b32 v21, v24
    s_nop 1
    v_add_f32 v21, v21, v24
    s_branch LA_norm
L12_end:
    s_endpgm
.section .rodata,"a"
.p2align 6
.amdhsa_kernel gated_mix__compressed_kv_cla__mha_block__prompt_kernel
  .amdhsa_next_free_vgpr 256
  .amdhsa_next_free_sgpr 102
  .amdhsa_accum_offset 256
  .amdhsa_group_segment_fixed_size 0
  .amdhsa_kernarg_size 104
  .amdhsa_user_sgpr_count 2
  .amdhsa_user_sgpr_kernarg_segment_ptr 1
  .amdhsa_system_sgpr_workgroup_id_x 1
.end_amdhsa_kernel
```
